```python
import torch

def _softmax(x, axis=-1):
    return torch.softmax(x, dim=axis)
def _gelu(x):
    return torch.nn.functional.gelu(x, approximate="tanh")
def _silu(x):
    return torch.nn.functional.silu(x)
def _sigmoid(x):
    return torch.sigmoid(x)
def _layernorm(x, axis=-1, eps=1e-5):
    m = x.mean(dim=axis, keepdim=True)
    v = x.var(dim=axis, keepdim=True, unbiased=False)
    return (x - m) / torch.sqrt(v + eps)
def _scatter_add(tgt, idx, src, axis=0):
    return tgt.clone().index_add_(axis, idx, src)
def _segment_sum(src, seg, n):
    out = torch.zeros((n,) + src.shape[1:], dtype=src.dtype)
    return out.index_add_(0, seg, src)
def _pad(x, pw):
    flat = tuple(v for pair in reversed(pw) for v in pair)
    return torch.nn.functional.pad(x, flat)

kernel_name = 'gated_mix__mha_block_cached__glu_gated_glu__decode'

def setup_inputs():

    _w = (lambda a: (lambda t: t.to(torch.bfloat16) if t.is_floating_point() else t)(torch.as_tensor(a)))
    def _A_setup():
        B, Sq, D = 2, 1, 448
        H, Sk, Dh = 16, 8192, 256
        return {
            "x": _w((lambda *s: torch.randn(*s, dtype=torch.bfloat16) * 0.05)(B, Sq, D)),
            "k_cache": _w((lambda *s: torch.randn(*s, dtype=torch.bfloat16) * 6.4)(B, H, Sk, Dh)),
            "v_cache": _w((lambda *s: torch.randn(*s, dtype=torch.bfloat16) * 0.4)(B, H, Sk, Dh)),
            "wq": _w((lambda *s: torch.randn(*s, dtype=torch.bfloat16) * 6.4)(D, H * Dh) * (D ** -0.5)),
            "wo": _w((lambda *s: torch.randn(*s, dtype=torch.bfloat16) * 0.4)(H * Dh, D) * ((H * Dh) ** -0.5)),
        }
    _A_in = _A_setup()

    def _B_setup():
        B, S, D, F = 2, 1, 448, 1792
        return {
            "x": _w((lambda *s: torch.randn(*s, dtype=torch.bfloat16) * 0.05)(B, S, D)),
            "w_gate": _w((lambda *s: torch.randn(*s, dtype=torch.bfloat16) * 0.4)(D, F)),
            "w_up": _w((lambda *s: torch.randn(*s, dtype=torch.bfloat16) * 0.05)(D, F)),
            "w_down": _w((lambda *s: torch.randn(*s, dtype=torch.bfloat16) * 0.05)(F, D)),
        }
    _B_in = _B_setup()

    return {
        "A_x": _A_in["x"],
        "A_k_cache": _A_in["k_cache"],
        "A_v_cache": _A_in["v_cache"],
        "A_wq": _A_in["wq"],
        "A_wo": _A_in["wo"],
        "B_x": _B_in["x"],
        "B_w_gate": _B_in["w_gate"],
        "B_w_up": _B_in["w_up"],
        "B_w_down": _B_in["w_down"],
        "gate_w": _w((lambda *s: torch.randn(*s, dtype=torch.bfloat16) * 0.05)(448) * 16.0),
    }

def reference(A_x, A_k_cache, A_v_cache, A_wq, A_wo, B_x, B_w_gate, B_w_up, B_w_down, gate_w):
    def _A_ref(x, k_cache, v_cache, wq, wo):
        B, Sq, D = x.shape
        H, Dh = 16, 256
        q = (lambda x, *d: x.permute(*d))((x @ wq).reshape(B, Sq, H, Dh), 0, 2, 1, 3)
        scores = torch.einsum("bhqd,bhkd->bhqk", q, k_cache) * (Dh ** -0.5)
        p = _softmax(scores, axis=-1)
        o = torch.einsum("bhqk,bhkd->bhqd", p, v_cache)
        return (lambda x, *d: x.permute(*d))(o, 0, 2, 1, 3).reshape(B, Sq, H * Dh) @ wo

    def _B_ref(x, w_gate, w_up, w_down):
        g = torch.einsum("bsd,df->bsf", x, w_gate)
        u = torch.einsum("bsd,df->bsf", x, w_up)
        h = _sigmoid(g) * u
        return torch.einsum("bsf,fd->bsd", h, w_down)

    x = A_x
    g = _sigmoid((x * gate_w).sum(-1, keepdims=True))
    a = _A_ref(x, A_k_cache, A_v_cache, A_wq, A_wo)
    b = _B_ref(x, B_w_gate, B_w_up, B_w_down)
    return g * a + (1 - g) * b
```

```asm
; @launch grid=(256,1,1) block=(256,1,1) lds=32768
.amdgcn_target "amdgcn-amd-amdhsa--gfx950"
.text
.globl gated_mix__mha_block_cached__glu_gated_glu__decode_kernel
.p2align 8
.type gated_mix__mha_block_cached__glu_gated_glu__decode_kernel,@function
gated_mix__mha_block_cached__glu_gated_glu__decode_kernel:
  s_cmp_ge_u32 s2, 256
  s_cbranch_scc1 L_end
  s_load_dwordx16 s[16:31], s[0:1], 0
  s_load_dwordx8 s[32:39], s[0:1], 64
  s_load_dwordx2 s[40:41], s[0:1], 96
  v_lshrrev_b32 v7, 6, v0
  v_and_b32 v2, 15, v0
  v_bfe_u32 v3, v0, 4, 2
  v_readfirstlane_b32 s3, v7
  s_and_b32 s4, s2, 7
  s_lshr_b32 s5, s2, 3
  s_lshr_b32 s12, s5, 4
  s_lshl_b32 s12, s12, 3
  s_add_u32 s6, s4, s12
  s_bfe_u32 s7, s5, 0x10003
  s_and_b32 s8, s5, 7
  s_lshl_b32 s9, s7, 4
  s_add_u32 s9, s9, s6
  s_lshl_b32 s10, s9, 3
  s_add_u32 s10, s10, s8
  s_and_b32 s11, s5, 0x18
  s_add_u32 s11, s11, s4
  s_lshl_b32 s14, s8, 7
  s_movk_i32 s15, 128
  s_cmp_lt_u32 s11, 28
  s_cbranch_scc0 L_units_done
  s_mul_i32 s14, s8, 132
  s_add_u32 s14, s14, 4294967264
  s_movk_i32 s15, 132
  s_cmp_gt_u32 s8, 7
  s_cbranch_scc0 L_units_lo
  s_lshl_b32 s14, s8, 7
  s_add_u32 s14, s14, 0
  s_movk_i32 s15, 128
  s_branch L_units_done
L_units_lo:
  s_cmp_eq_u32 s8, 0
  s_cbranch_scc0 L_units_done
  s_mov_b32 s14, 0
  s_movk_i32 s15, 100
L_units_done:
  s_lshl_b32 s14, s14, 12
  s_lshl_b32 s12, s9, 22
  s_add_u32 s14, s14, s12
  s_lshr_b32 s13, s15, 2
  s_mul_i32 s101, s2, 1
  s_and_b32 s101, s101, 31
  s_sub_u32 s12, s101, s13
  s_cmp_ge_u32 s101, s13
  s_cselect_b32 s101, s12, s101
  s_lshl_b32 s101, s101, 14
  s_lshl_b32 s15, s15, 12
  v_and_b32 v7, 3, v2
  v_lshl_add_u32 v7, v3, 2, v7
  v_lshlrev_b32 v7, 4, v7
  v_lshrrev_b32 v4, 2, v2
  v_lshl_add_u32 v4, v4, 9, v7
  s_lshl_b32 s12, s3, 12
  v_add_u32 v4, s12, v4
  s_waitcnt lgkmcnt(0)
  s_add_u32 s44, s18, s14
  s_addc_u32 s45, s19, 0
  s_and_b32 s45, s45, 0xffff
  s_mov_b32 s46, s15
  s_mov_b32 s47, 0x20000
  s_mov_b32 s96, s101
  buffer_load_dwordx4 a[0:3], v4, s[44:47], s101 offen offset:0 nt
  buffer_load_dwordx4 a[4:7], v4, s[44:47], s101 offen offset:256 nt
  buffer_load_dwordx4 a[8:11], v4, s[44:47], s101 offen offset:2048 nt
  buffer_load_dwordx4 a[12:15], v4, s[44:47], s101 offen offset:2304 nt
  s_add_u32 s101, s101, 16384
  s_cmp_eq_u32 s101, s15
  s_cselect_b32 s101, 0, s101
  buffer_load_dwordx4 a[16:19], v4, s[44:47], s101 offen offset:0 nt
  buffer_load_dwordx4 a[20:23], v4, s[44:47], s101 offen offset:256 nt
  buffer_load_dwordx4 a[24:27], v4, s[44:47], s101 offen offset:2048 nt
  buffer_load_dwordx4 a[28:31], v4, s[44:47], s101 offen offset:2304 nt
  s_add_u32 s48, s20, s14
  s_addc_u32 s49, s21, 0
  s_and_b32 s49, s49, 0xffff
  s_mov_b32 s50, s15
  s_mov_b32 s51, 0x20000
  s_mov_b32 s20, s15
  s_mov_b32 s21, s96
  v_and_b32 v1, 63, v0
  v_lshlrev_b32 v7, 4, v2
  v_lshl_add_u32 v5, v3, 9, v7
  v_add_u32 v5, s12, v5
  s_lshl_b32 s13, s3, 6
  v_add_u32 v6, s13, v3
  v_mul_u32_u24 v6, 896, v6
  v_add_u32 v6, v6, v7
  v_and_b32 v80, 1, v2
  v_mov_b32 v81, 0xffff
  v_lshlrev_b32 v80, 4, v80
  v_lshlrev_b32 v81, v80, v81
  v_lshrrev_b32 v82, 1, v2
  v_cmp_eq_u32 vcc, 0, v82
  s_nop 1
  v_cndmask_b32 v8, 0, v81, vcc
  v_cmp_eq_u32 vcc, 1, v82
  s_nop 1
  v_cndmask_b32 v9, 0, v81, vcc
  v_cmp_eq_u32 vcc, 2, v82
  s_nop 1
  v_cndmask_b32 v10, 0, v81, vcc
  v_cmp_eq_u32 vcc, 3, v82
  s_nop 1
  v_cndmask_b32 v11, 0, v81, vcc
  s_mov_b32 s92, 0x3db8aa3b
  s_lshl_b32 s12, s6, 9
  s_add_u32 s52, s22, s12
  s_addc_u32 s53, s23, 0
  s_and_b32 s53, s53, 0xffff
  s_sub_u32 s54, 3670016, s12
  s_mov_b32 s55, 0x20000
  s_mul_i32 s12, s6, 229376
  s_add_u32 s56, s24, s12
  s_addc_u32 s57, s25, 0
  s_and_b32 s57, s57, 0xffff
  s_mov_b32 s58, 229376
  s_mov_b32 s59, 0x20000
  s_mov_b32 s60, s16
  s_and_b32 s61, s17, 0xffff
  s_mov_b32 s62, 1792
  s_mov_b32 s63, 0x20000
  s_mov_b32 s64, s40
  s_and_b32 s65, s41, 0xffff
  s_mov_b32 s66, 917504
  s_mov_b32 s67, 0x20000
  s_mov_b32 s68, s38
  s_and_b32 s69, s39, 0xffff
  s_mov_b32 s70, 256
  s_mov_b32 s71, 0x20000
  s_cmp_lt_u32 s11, 28
  s_cbranch_scc0 L_light
  s_cmp_eq_u32 s8, 0
  s_cbranch_scc1 L_roleB
  s_cmp_le_u32 s8, 7
  s_cbranch_scc1 L_roleP
  s_branch L_roleN
L_light:
  s_sub_u32 s11, s11, 28
  s_lshl_b32 s11, s11, 3
  s_add_u32 s11, s11, s8
  s_add_u32 s11, s11, 28
  s_cmp_lt_u32 s11, 56
  s_cbranch_scc1 L_roleR
  s_branch L_roleN
L_roleN:
  s_mul_i32 s12, s8, 56
  s_lshr_b32 s13, s3, 1
  s_mul_i32 s13, s13, 28
  s_add_u32 s12, s12, s13
  v_min_u32 v80, 6, v2
  v_lshl_add_u32 v80, v80, 2, v3
  v_add_u32 v80, s12, v80
  v_lshlrev_b32 v80, 1, v80
  s_mul_i32 s13, s7, 896
  buffer_load_ushort v83, v80, s[60:63], s13 offen
  v_lshlrev_b32 v7, 4, v2
  v_lshl_add_u32 v7, v3, 13, v7
  s_lshl_b32 s12, s12, 13
  s_and_b32 s13, s3, 1
  s_lshl_b32 s13, s13, 8
  s_add_u32 s12, s12, s13
  buffer_load_dwordx4 v[96:99], v7, s[52:55], s12 offen nt
  s_add_u32 s12, s12, 32768
  buffer_load_dwordx4 v[100:103], v7, s[52:55], s12 offen nt
  s_add_u32 s12, s12, 32768
  buffer_load_dwordx4 v[104:107], v7, s[52:55], s12 offen nt
  s_add_u32 s12, s12, 32768
  buffer_load_dwordx4 v[108:111], v7, s[52:55], s12 offen nt
  s_add_u32 s12, s12, 32768
  buffer_load_dwordx4 v[112:115], v7, s[52:55], s12 offen nt
  s_add_u32 s12, s12, 32768
  buffer_load_dwordx4 v[116:119], v7, s[52:55], s12 offen nt
  s_add_u32 s12, s12, 32768
  buffer_load_dwordx4 v[120:123], v7, s[52:55], s12 offen nt
  v_mov_b32 v84, -1
  v_mov_b32 v85, -1
  v_mov_b32 v50, -1
  v_mov_b32 v51, -1
  v_mov_b32 v52, -1
  v_mov_b32 v53, -1
  v_lshlrev_b32 v81, 4, v0
  v_mov_b32 v82, 128
  v_cmp_gt_u32 vcc, v82, v0
  v_mov_b32 v82, 0x7ff00000
  s_nop 0
  v_cndmask_b32 v81, v82, v81, vcc
  s_lshl_b32 s12, s10, 11
  s_add_u32 s12, s12, 262144
  buffer_store_dwordx4 v[50:53], v81, s[64:67], s12 offen sc1
  v_cmp_eq_u32 vcc, 0, v0
  v_mov_b32 v82, 0x7ff00000
  v_mov_b32 v86, 0
  v_cndmask_b32 v86, v82, v86, vcc
  s_lshl_b32 s13, s10, 3
  s_add_u32 s13, s13, 786432
  buffer_store_dwordx2 v[84:85], v86, s[64:67], s13 offen sc1
  s_add_u32 s101, s101, 16384
  s_cmp_eq_u32 s101, s20
  s_cselect_b32 s101, 0, s101
  buffer_load_dwordx4 a[32:35], v4, s[44:47], s101 offen offset:0 nt
  buffer_load_dwordx4 a[36:39], v4, s[44:47], s101 offen offset:256 nt
  buffer_load_dwordx4 a[40:43], v4, s[44:47], s101 offen offset:2048 nt
  buffer_load_dwordx4 a[44:47], v4, s[44:47], s101 offen offset:2304 nt
  s_waitcnt vmcnt(13)
  v_lshl_or_b32 v83, v83, 16, v83
  s_nop 1
  v_and_b32_dpp v46, v83, v8 row_newbcast:0 row_mask:0xf bank_mask:0xf
  v_and_b32_dpp v47, v83, v9 row_newbcast:0 row_mask:0xf bank_mask:0xf
  v_and_b32_dpp v48, v83, v10 row_newbcast:0 row_mask:0xf bank_mask:0xf
  v_and_b32_dpp v49, v83, v11 row_newbcast:0 row_mask:0xf bank_mask:0xf
  s_waitcnt vmcnt(12)
  s_nop 0
  v_mfma_f32_16x16x32_bf16 v[38:41], v[96:99], v[46:49], 0
  v_and_b32_dpp v50, v83, v8 row_newbcast:1 row_mask:0xf bank_mask:0xf
  v_and_b32_dpp v51, v83, v9 row_newbcast:1 row_mask:0xf bank_mask:0xf
  v_and_b32_dpp v52, v83, v10 row_newbcast:1 row_mask:0xf bank_mask:0xf
  v_and_b32_dpp v53, v83, v11 row_newbcast:1 row_mask:0xf bank_mask:0xf
  s_waitcnt vmcnt(11)
  s_nop 0
  v_mfma_f32_16x16x32_bf16 v[38:41], v[100:103], v[50:53], v[38:41]
  v_and_b32_dpp v46, v83, v8 row_newbcast:2 row_mask:0xf bank_mask:0xf
  v_and_b32_dpp v47, v83, v9 row_newbcast:2 row_mask:0xf bank_mask:0xf
  v_and_b32_dpp v48, v83, v10 row_newbcast:2 row_mask:0xf bank_mask:0xf
  v_and_b32_dpp v49, v83, v11 row_newbcast:2 row_mask:0xf bank_mask:0xf
  s_waitcnt vmcnt(10)
  s_nop 0
  v_mfma_f32_16x16x32_bf16 v[38:41], v[104:107], v[46:49], v[38:41]
  v_and_b32_dpp v50, v83, v8 row_newbcast:3 row_mask:0xf bank_mask:0xf
  v_and_b32_dpp v51, v83, v9 row_newbcast:3 row_mask:0xf bank_mask:0xf
  v_and_b32_dpp v52, v83, v10 row_newbcast:3 row_mask:0xf bank_mask:0xf
  v_and_b32_dpp v53, v83, v11 row_newbcast:3 row_mask:0xf bank_mask:0xf
  s_waitcnt vmcnt(9)
  s_nop 0
  v_mfma_f32_16x16x32_bf16 v[38:41], v[108:111], v[50:53], v[38:41]
  v_and_b32_dpp v46, v83, v8 row_newbcast:4 row_mask:0xf bank_mask:0xf
  v_and_b32_dpp v47, v83, v9 row_newbcast:4 row_mask:0xf bank_mask:0xf
  v_and_b32_dpp v48, v83, v10 row_newbcast:4 row_mask:0xf bank_mask:0xf
  v_and_b32_dpp v49, v83, v11 row_newbcast:4 row_mask:0xf bank_mask:0xf
  s_waitcnt vmcnt(8)
  s_nop 0
  v_mfma_f32_16x16x32_bf16 v[38:41], v[112:115], v[46:49], v[38:41]
  v_and_b32_dpp v50, v83, v8 row_newbcast:5 row_mask:0xf bank_mask:0xf
  v_and_b32_dpp v51, v83, v9 row_newbcast:5 row_mask:0xf bank_mask:0xf
  v_and_b32_dpp v52, v83, v10 row_newbcast:5 row_mask:0xf bank_mask:0xf
  v_and_b32_dpp v53, v83, v11 row_newbcast:5 row_mask:0xf bank_mask:0xf
  s_waitcnt vmcnt(7)
  s_nop 0
  v_mfma_f32_16x16x32_bf16 v[38:41], v[116:119], v[50:53], v[38:41]
  v_and_b32_dpp v46, v83, v8 row_newbcast:6 row_mask:0xf bank_mask:0xf
  v_and_b32_dpp v47, v83, v9 row_newbcast:6 row_mask:0xf bank_mask:0xf
  v_and_b32_dpp v48, v83, v10 row_newbcast:6 row_mask:0xf bank_mask:0xf
  v_and_b32_dpp v49, v83, v11 row_newbcast:6 row_mask:0xf bank_mask:0xf
  s_waitcnt vmcnt(6)
  s_nop 0
  v_mfma_f32_16x16x32_bf16 v[38:41], v[120:123], v[46:49], v[38:41]
  s_and_b32 s12, s3, 1
  s_lshl_b32 s12, s12, 10
  s_lshr_b32 s13, s3, 1
  s_lshl_b32 s13, s13, 2
  s_add_u32 s12, s12, s13
  v_lshl_add_u32 v80, v3, 5, v2
  v_lshlrev_b32 v80, 3, v80
  v_add_u32 v80, s12, v80
  s_mov_b32 exec_lo, 0x00ff00ff
  s_mov_b32 exec_hi, 0x00ff00ff
  ds_write2_b32 v80, v38, v39 offset0:0 offset1:16
  ds_write2_b32 v80, v40, v41 offset0:32 offset1:48
  s_mov_b64 exec, -1
  s_waitcnt lgkmcnt(0)
  s_barrier
  v_lshlrev_b32 v80, 5, v1
  ds_read_b128 v[46:49], v80 offset:0
  ds_read_b128 v[50:53], v80 offset:16
  v_lshlrev_b32 v81, 4, v0
  v_mov_b32 v82, 0x7ff00000
  v_cmp_gt_u32 vcc, 64, v0
  s_nop 1
  v_cndmask_b32 v81, v82, v81, vcc
  s_lshl_b32 s12, s10, 10
  s_waitcnt lgkmcnt(0)
  v_add_f32 v38, v46, v47
  v_add_f32 v39, v48, v49
  v_add_f32 v40, v50, v51
  v_add_f32 v41, v52, v53
  buffer_store_dwordx4 v[38:41], v81, s[64:67], s12 offen sc1
  s_add_u32 s101, s101, 16384
  s_cmp_eq_u32 s101, s20
  s_cselect_b32 s101, 0, s101
  buffer_load_dwordx4 a[48:51], v4, s[44:47], s101 offen offset:0 nt
  buffer_load_dwordx4 a[52:55], v4, s[44:47], s101 offen offset:256 nt
  buffer_load_dwordx4 a[56:59], v4, s[44:47], s101 offen offset:2048 nt
  buffer_load_dwordx4 a[60:63], v4, s[44:47], s101 offen offset:2304 nt
  s_add_u32 s101, s101, 16384
  s_cmp_eq_u32 s101, s20
  s_cselect_b32 s101, 0, s101
  buffer_load_dwordx4 a[64:67], v4, s[44:47], s101 offen offset:0 nt
  buffer_load_dwordx4 a[68:71], v4, s[44:47], s101 offen offset:256 nt
  buffer_load_dwordx4 a[72:75], v4, s[44:47], s101 offen offset:2048 nt
  buffer_load_dwordx4 a[76:79], v4, s[44:47], s101 offen offset:2304 nt
  s_waitcnt vmcnt(8)
  s_barrier
  v_mov_b32 v84, 1
  s_lshl_b32 s12, s9, 2
  buffer_atomic_add v84, v86, s[68:71], s12 offen
  s_add_u32 s101, s101, 16384
  s_cmp_eq_u32 s101, s20
  s_cselect_b32 s101, 0, s101
  buffer_load_dwordx4 a[80:83], v4, s[44:47], s101 offen offset:0 nt
  buffer_load_dwordx4 a[84:87], v4, s[44:47], s101 offen offset:256 nt
  buffer_load_dwordx4 a[88:91], v4, s[44:47], s101 offen offset:2048 nt
  s_waitcnt vmcnt(11)
  buffer_load_dwordx4 a[92:95], v4, s[44:47], s101 offen offset:2304 nt
  s_waitcnt vmcnt(11)
  s_add_u32 s101, s101, 16384
  s_cmp_eq_u32 s101, s20
  s_cselect_b32 s101, 0, s101
  buffer_load_dwordx4 a[96:99], v4, s[44:47], s101 offen offset:0 nt
  s_waitcnt vmcnt(11)
  buffer_load_dwordx4 a[100:103], v4, s[44:47], s101 offen offset:256 nt
  s_waitcnt vmcnt(11)
  buffer_load_dwordx4 a[104:107], v4, s[44:47], s101 offen offset:2048 nt
  s_waitcnt vmcnt(11)
  buffer_load_dwordx4 a[108:111], v4, s[44:47], s101 offen offset:2304 nt
  s_waitcnt vmcnt(11)
  s_add_u32 s101, s101, 16384
  s_cmp_eq_u32 s101, s20
  s_cselect_b32 s101, 0, s101
  buffer_load_dwordx4 a[112:115], v4, s[44:47], s101 offen offset:0 nt
  s_waitcnt vmcnt(11)
  buffer_load_dwordx4 a[116:119], v4, s[44:47], s101 offen offset:256 nt
  s_waitcnt vmcnt(11)
  buffer_load_dwordx4 a[120:123], v4, s[44:47], s101 offen offset:2048 nt
  s_waitcnt vmcnt(11)
  buffer_load_dwordx4 a[124:127], v4, s[44:47], s101 offen offset:2304 nt
  s_waitcnt vmcnt(11)
  s_add_u32 s101, s101, 16384
  s_cmp_eq_u32 s101, s20
  s_cselect_b32 s101, 0, s101
  buffer_load_dwordx4 a[128:131], v4, s[44:47], s101 offen offset:0 nt
  s_waitcnt vmcnt(11)
  buffer_load_dwordx4 a[132:135], v4, s[44:47], s101 offen offset:256 nt
  s_waitcnt vmcnt(11)
  buffer_load_dwordx4 a[136:139], v4, s[44:47], s101 offen offset:2048 nt
  s_waitcnt vmcnt(11)
  buffer_load_dwordx4 a[140:143], v4, s[44:47], s101 offen offset:2304 nt
  s_waitcnt vmcnt(11)
  s_add_u32 s101, s101, 16384
  s_cmp_eq_u32 s101, s20
  s_cselect_b32 s101, 0, s101
  buffer_load_dwordx4 a[144:147], v4, s[44:47], s101 offen offset:0 nt
  s_waitcnt vmcnt(11)
  buffer_load_dwordx4 a[148:151], v4, s[44:47], s101 offen offset:256 nt
  s_waitcnt vmcnt(11)
  buffer_load_dwordx4 a[152:155], v4, s[44:47], s101 offen offset:2048 nt
  s_waitcnt vmcnt(11)
  buffer_load_dwordx4 a[156:159], v4, s[44:47], s101 offen offset:2304 nt
  s_waitcnt vmcnt(11)
  s_add_u32 s101, s101, 16384
  s_cmp_eq_u32 s101, s20
  s_cselect_b32 s101, 0, s101
  buffer_load_dwordx4 a[160:163], v4, s[44:47], s101 offen offset:0 nt
  s_waitcnt vmcnt(11)
  buffer_load_dwordx4 a[164:167], v4, s[44:47], s101 offen offset:256 nt
  s_waitcnt vmcnt(11)
  buffer_load_dwordx4 a[168:171], v4, s[44:47], s101 offen offset:2048 nt
  s_waitcnt vmcnt(11)
  buffer_load_dwordx4 a[172:175], v4, s[44:47], s101 offen offset:2304 nt
  s_waitcnt vmcnt(11)
  s_add_u32 s101, s101, 16384
  s_cmp_eq_u32 s101, s20
  s_cselect_b32 s101, 0, s101
  buffer_load_dwordx4 a[176:179], v4, s[44:47], s101 offen offset:0 nt
  s_waitcnt vmcnt(11)
  buffer_load_dwordx4 a[180:183], v4, s[44:47], s101 offen offset:256 nt
  s_waitcnt vmcnt(11)
  buffer_load_dwordx4 a[184:187], v4, s[44:47], s101 offen offset:2048 nt
  s_waitcnt vmcnt(11)
  buffer_load_dwordx4 a[188:191], v4, s[44:47], s101 offen offset:2304 nt
  s_waitcnt vmcnt(11)
  s_add_u32 s101, s101, 16384
  s_cmp_eq_u32 s101, s20
  s_cselect_b32 s101, 0, s101
  buffer_load_dwordx4 a[192:195], v4, s[44:47], s101 offen offset:0 nt
  s_waitcnt vmcnt(11)
  buffer_load_dwordx4 a[196:199], v4, s[44:47], s101 offen offset:256 nt
  s_waitcnt vmcnt(11)
  buffer_load_dwordx4 a[200:203], v4, s[44:47], s101 offen offset:2048 nt
  s_waitcnt vmcnt(11)
  buffer_load_dwordx4 a[204:207], v4, s[44:47], s101 offen offset:2304 nt
  v_mov_b32 v80, 0
  s_lshl_b32 s14, s9, 2
  buffer_load_dword v84, v80, s[68:71], s14 offen sc1
  s_add_u32 s101, s101, 16384
  s_cmp_eq_u32 s101, s20
  s_cselect_b32 s101, 0, s101
  buffer_load_dwordx4 a[208:211], v4, s[44:47], s101 offen offset:0 nt
  buffer_load_dwordx4 a[212:215], v4, s[44:47], s101 offen offset:256 nt
  buffer_load_dwordx4 a[216:219], v4, s[44:47], s101 offen offset:2048 nt
  buffer_load_dwordx4 a[220:223], v4, s[44:47], s101 offen offset:2304 nt
  s_add_u32 s101, s101, 16384
  s_cmp_eq_u32 s101, s20
  s_cselect_b32 s101, 0, s101
  buffer_load_dwordx4 a[224:227], v4, s[44:47], s101 offen offset:0 nt
  buffer_load_dwordx4 a[228:231], v4, s[44:47], s101 offen offset:256 nt
  buffer_load_dwordx4 a[232:235], v4, s[44:47], s101 offen offset:2048 nt
  buffer_load_dwordx4 a[236:239], v4, s[44:47], s101 offen offset:2304 nt
  s_add_u32 s101, s101, 16384
  s_cmp_eq_u32 s101, s20
  s_cselect_b32 s101, 0, s101
  buffer_load_dwordx4 a[240:243], v4, s[44:47], s101 offen offset:0 nt
  buffer_load_dwordx4 a[244:247], v4, s[44:47], s101 offen offset:256 nt
  buffer_load_dwordx4 a[248:251], v4, s[44:47], s101 offen offset:2048 nt
  buffer_load_dwordx4 a[252:255], v4, s[44:47], s101 offen offset:2304 nt
  s_waitcnt vmcnt(12)
  v_readfirstlane_b32 s12, v84
  s_nop 2
  s_cmp_ge_u32 s12, 8
  s_cbranch_scc1 L_qokN
  s_mov_b32 s93, 0
L_qspinN:
  buffer_load_dword v84, v80, s[68:71], s14 offen sc1
  s_waitcnt vmcnt(0)
  v_readfirstlane_b32 s12, v84
  s_nop 2
  s_cmp_ge_u32 s12, 8
  s_cbranch_scc1 L_qokN
  s_add_u32 s93, s93, 1
  s_cmp_lt_u32 s93, 0x40000
  s_cbranch_scc0 L_qokN
  s_sleep 4
  s_branch L_qspinN
L_qokN:
  v_lshlrev_b32 v80, 10, v3
  v_lshl_add_u32 v80, v2, 4, v80
  s_lshl_b32 s13, s3, 8
  v_add_u32 v80, s13, v80
  s_lshl_b32 s12, s9, 13
  s_add_u32 s14, s12, 4096
  buffer_load_dwordx4 v[54:57], v80, s[64:67], s12 offen sc1
  buffer_load_dwordx4 v[58:61], v80, s[64:67], s14 offen sc1
  s_add_u32 s101, s101, 16384
  s_cmp_eq_u32 s101, s20
  s_cselect_b32 s101, 0, s101
  buffer_load_dwordx4 v[124:127], v4, s[44:47], s101 offen offset:0 nt
  buffer_load_dwordx4 v[128:131], v4, s[44:47], s101 offen offset:256 nt
  buffer_load_dwordx4 v[132:135], v4, s[44:47], s101 offen offset:2048 nt
  buffer_load_dwordx4 v[136:139], v4, s[44:47], s101 offen offset:2304 nt
  s_add_u32 s101, s101, 16384
  s_cmp_eq_u32 s101, s20
  s_cselect_b32 s101, 0, s101
  buffer_load_dwordx4 v[140:143], v4, s[44:47], s101 offen offset:0 nt
  buffer_load_dwordx4 v[144:147], v4, s[44:47], s101 offen offset:256 nt
  buffer_load_dwordx4 v[148:151], v4, s[44:47], s101 offen offset:2048 nt
  buffer_load_dwordx4 v[152:155], v4, s[44:47], s101 offen offset:2304 nt
  s_add_u32 s101, s101, 16384
  s_cmp_eq_u32 s101, s20
  s_cselect_b32 s101, 0, s101
  buffer_load_dwordx4 v[156:159], v4, s[44:47], s101 offen offset:0 nt
  buffer_load_dwordx4 v[160:163], v4, s[44:47], s101 offen offset:256 nt
  buffer_load_dwordx4 v[164:167], v4, s[44:47], s101 offen offset:2048 nt
  buffer_load_dwordx4 v[168:171], v4, s[44:47], s101 offen offset:2304 nt
  v_lshlrev_b32 v80, 3, v2
  s_lshl_b32 s13, s3, 7
  v_add_u32 v80, s13, v80
  s_waitcnt vmcnt(12)
  v_pk_add_f32 v[54:55], v[54:55], v[58:59]
  v_pk_add_f32 v[56:57], v[56:57], v[60:61]
  v_mov_b32 v58, v54
  v_mov_b32 v59, v55
  v_mov_b32 v60, v56
  v_mov_b32 v61, v57
  v_permlane16_swap_b32 v54, v58
  v_permlane16_swap_b32 v55, v59
  v_permlane16_swap_b32 v56, v60
  v_permlane16_swap_b32 v57, v61
  v_add_f32 v54, v54, v58
  v_add_f32 v55, v55, v59
  v_add_f32 v56, v56, v60
  v_add_f32 v57, v57, v61
  v_mov_b32 v58, v54
  v_mov_b32 v59, v55
  v_mov_b32 v60, v56
  v_mov_b32 v61, v57
  v_permlane32_swap_b32 v54, v58
  v_permlane32_swap_b32 v55, v59
  v_permlane32_swap_b32 v56, v60
  v_permlane32_swap_b32 v57, v61
  v_add_f32 v54, v54, v58
  v_add_f32 v55, v55, v59
  v_add_f32 v56, v56, v60
  v_add_f32 v57, v57, v61
  v_cvt_pk_bf16_f32 v58, v54, v55
  v_cvt_pk_bf16_f32 v59, v56, v57
  ds_write_b64 v80, v[58:59] offset:2048
  v_and_b32 v81, 3, v2
  v_lshl_add_u32 v81, v3, 2, v81
  v_lshlrev_b32 v81, 4, v81
  s_waitcnt lgkmcnt(0)
  s_barrier
  ds_read_b128 v[12:15], v81 offset:2048
  ds_read_b128 v[16:19], v81 offset:2304
  s_waitcnt lgkmcnt(0)
  v_and_b32 v7, 8, v2
  v_lshlrev_b32 v7, 4, v7
  v_sub_u32 v7, v6, v7
  v_mfma_f32_16x16x32_bf16 v[38:41], a[0:3], v[12:15], 0
  v_mfma_f32_16x16x32_bf16 v[38:41], a[4:7], v[16:19], v[38:41]
  v_mfma_f32_16x16x32_bf16 v[42:45], a[8:11], v[12:15], 0
  v_mfma_f32_16x16x32_bf16 v[42:45], a[12:15], v[16:19], v[42:45]
  s_waitcnt vmcnt(11)
  s_add_u32 s101, s101, 16384
  s_cmp_eq_u32 s101, s20
  s_cselect_b32 s101, 0, s101
  buffer_load_dwordx4 v[172:175], v4, s[44:47], s101 offen offset:0 nt
  s_nop 0
  v_add_f32_dpp v88, v39, v38 quad_perm:[1,1,1,1] row_mask:0xf bank_mask:0xf
  v_add_f32_dpp v89, v41, v40 quad_perm:[3,3,3,3] row_mask:0xf bank_mask:0xf
  s_nop 1
  v_add_f32_dpp v20, v89, v88 quad_perm:[2,2,2,2] row_mask:0xf bank_mask:0x1
  v_mfma_f32_16x16x32_bf16 v[38:41], a[16:19], v[12:15], 0
  v_mfma_f32_16x16x32_bf16 v[38:41], a[20:23], v[16:19], v[38:41]
  v_add_f32_dpp v88, v43, v42 quad_perm:[1,1,1,1] row_mask:0xf bank_mask:0xf
  v_add_f32_dpp v89, v45, v44 quad_perm:[3,3,3,3] row_mask:0xf bank_mask:0xf
  s_nop 1
  v_add_f32_dpp v20, v89, v88 quad_perm:[2,2,2,2] row_mask:0xf bank_mask:0x2
  v_mfma_f32_16x16x32_bf16 v[42:45], a[24:27], v[12:15], 0
  v_mfma_f32_16x16x32_bf16 v[42:45], a[28:31], v[16:19], v[42:45]
  s_waitcnt vmcnt(11)
  buffer_load_dwordx4 v[176:179], v4, s[44:47], s101 offen offset:256 nt
  v_add_f32_dpp v88, v39, v38 quad_perm:[1,1,1,1] row_mask:0xf bank_mask:0xf
  v_add_f32_dpp v89, v41, v40 quad_perm:[3,3,3,3] row_mask:0xf bank_mask:0xf
  s_nop 1
  v_add_f32_dpp v20, v89, v88 quad_perm:[2,2,2,2] row_mask:0xf bank_mask:0x4
  v_mfma_f32_16x16x32_bf16 v[38:41], a[32:35], v[12:15], 0
  v_mfma_f32_16x16x32_bf16 v[38:41], a[36:39], v[16:19], v[38:41]
  v_add_f32_dpp v88, v43, v42 quad_perm:[1,1,1,1] row_mask:0xf bank_mask:0xf
  v_add_f32_dpp v89, v45, v44 quad_perm:[3,3,3,3] row_mask:0xf bank_mask:0xf
  s_nop 1
  v_add_f32_dpp v20, v89, v88 quad_perm:[2,2,2,2] row_mask:0xf bank_mask:0x8
  v_mfma_f32_16x16x32_bf16 v[42:45], a[40:43], v[12:15], 0
  v_mfma_f32_16x16x32_bf16 v[42:45], a[44:47], v[16:19], v[42:45]
  s_waitcnt vmcnt(11)
  buffer_load_dwordx4 v[180:183], v4, s[44:47], s101 offen offset:2048 nt
  v_add_f32_dpp v88, v39, v38 quad_perm:[1,1,1,1] row_mask:0xf bank_mask:0xf
  v_add_f32_dpp v89, v41, v40 quad_perm:[3,3,3,3] row_mask:0xf bank_mask:0xf
  s_nop 1
  v_add_f32_dpp v21, v89, v88 quad_perm:[2,2,2,2] row_mask:0xf bank_mask:0x1
  v_mfma_f32_16x16x32_bf16 v[38:41], a[48:51], v[12:15], 0
  v_mfma_f32_16x16x32_bf16 v[38:41], a[52:55], v[16:19], v[38:41]
  v_add_f32_dpp v88, v43, v42 quad_perm:[1,1,1,1] row_mask:0xf bank_mask:0xf
  v_add_f32_dpp v89, v45, v44 quad_perm:[3,3,3,3] row_mask:0xf bank_mask:0xf
  s_nop 1
  v_add_f32_dpp v21, v89, v88 quad_perm:[2,2,2,2] row_mask:0xf bank_mask:0x2
  v_mfma_f32_16x16x32_bf16 v[42:45], a[56:59], v[12:15], 0
  v_mfma_f32_16x16x32_bf16 v[42:45], a[60:63], v[16:19], v[42:45]
  s_waitcnt vmcnt(11)
  buffer_load_dwordx4 v[184:187], v4, s[44:47], s101 offen offset:2304 nt
  v_add_f32_dpp v88, v39, v38 quad_perm:[1,1,1,1] row_mask:0xf bank_mask:0xf
  v_add_f32_dpp v89, v41, v40 quad_perm:[3,3,3,3] row_mask:0xf bank_mask:0xf
  s_nop 1
  v_add_f32_dpp v21, v89, v88 quad_perm:[2,2,2,2] row_mask:0xf bank_mask:0x4
  v_mfma_f32_16x16x32_bf16 v[38:41], a[64:67], v[12:15], 0
  v_mfma_f32_16x16x32_bf16 v[38:41], a[68:71], v[16:19], v[38:41]
  v_add_f32_dpp v88, v43, v42 quad_perm:[1,1,1,1] row_mask:0xf bank_mask:0xf
  v_add_f32_dpp v89, v45, v44 quad_perm:[3,3,3,3] row_mask:0xf bank_mask:0xf
  s_nop 1
  v_add_f32_dpp v21, v89, v88 quad_perm:[2,2,2,2] row_mask:0xf bank_mask:0x8
  v_mfma_f32_16x16x32_bf16 v[42:45], a[72:75], v[12:15], 0
  v_mfma_f32_16x16x32_bf16 v[42:45], a[76:79], v[16:19], v[42:45]
  s_waitcnt vmcnt(11)
  s_add_u32 s101, s101, 16384
  s_cmp_eq_u32 s101, s20
  s_cselect_b32 s101, 0, s101
  buffer_load_dwordx4 v[188:191], v4, s[44:47], s101 offen offset:0 nt
  v_add_f32_dpp v88, v39, v38 quad_perm:[1,1,1,1] row_mask:0xf bank_mask:0xf
  v_add_f32_dpp v89, v41, v40 quad_perm:[3,3,3,3] row_mask:0xf bank_mask:0xf
  s_nop 1
  v_add_f32_dpp v22, v89, v88 quad_perm:[2,2,2,2] row_mask:0xf bank_mask:0x1
  v_mfma_f32_16x16x32_bf16 v[38:41], a[80:83], v[12:15], 0
  v_mfma_f32_16x16x32_bf16 v[38:41], a[84:87], v[16:19], v[38:41]
  v_add_f32_dpp v88, v43, v42 quad_perm:[1,1,1,1] row_mask:0xf bank_mask:0xf
  v_add_f32_dpp v89, v45, v44 quad_perm:[3,3,3,3] row_mask:0xf bank_mask:0xf
  s_nop 1
  v_add_f32_dpp v22, v89, v88 quad_perm:[2,2,2,2] row_mask:0xf bank_mask:0x2
  v_mfma_f32_16x16x32_bf16 v[42:45], a[88:91], v[12:15], 0
  v_mfma_f32_16x16x32_bf16 v[42:45], a[92:95], v[16:19], v[42:45]
  s_waitcnt vmcnt(11)
  buffer_load_dwordx4 v[192:195], v4, s[44:47], s101 offen offset:256 nt
  v_add_f32_dpp v88, v39, v38 quad_perm:[1,1,1,1] row_mask:0xf bank_mask:0xf
  v_add_f32_dpp v89, v41, v40 quad_perm:[3,3,3,3] row_mask:0xf bank_mask:0xf
  s_nop 1
  v_add_f32_dpp v22, v89, v88 quad_perm:[2,2,2,2] row_mask:0xf bank_mask:0x4
  v_mfma_f32_16x16x32_bf16 v[38:41], a[96:99], v[12:15], 0
  v_mfma_f32_16x16x32_bf16 v[38:41], a[100:103], v[16:19], v[38:41]
  v_add_f32_dpp v88, v43, v42 quad_perm:[1,1,1,1] row_mask:0xf bank_mask:0xf
  v_add_f32_dpp v89, v45, v44 quad_perm:[3,3,3,3] row_mask:0xf bank_mask:0xf
  s_nop 1
  v_add_f32_dpp v22, v89, v88 quad_perm:[2,2,2,2] row_mask:0xf bank_mask:0x8
  v_mfma_f32_16x16x32_bf16 v[42:45], a[104:107], v[12:15], 0
  v_mfma_f32_16x16x32_bf16 v[42:45], a[108:111], v[16:19], v[42:45]
  s_waitcnt vmcnt(11)
  buffer_load_dwordx4 v[196:199], v4, s[44:47], s101 offen offset:2048 nt
  v_add_f32_dpp v88, v39, v38 quad_perm:[1,1,1,1] row_mask:0xf bank_mask:0xf
  v_add_f32_dpp v89, v41, v40 quad_perm:[3,3,3,3] row_mask:0xf bank_mask:0xf
  s_nop 1
  v_add_f32_dpp v23, v89, v88 quad_perm:[2,2,2,2] row_mask:0xf bank_mask:0x1
  v_mfma_f32_16x16x32_bf16 v[38:41], a[112:115], v[12:15], 0
  v_mfma_f32_16x16x32_bf16 v[38:41], a[116:119], v[16:19], v[38:41]
  v_add_f32_dpp v88, v43, v42 quad_perm:[1,1,1,1] row_mask:0xf bank_mask:0xf
  v_add_f32_dpp v89, v45, v44 quad_perm:[3,3,3,3] row_mask:0xf bank_mask:0xf
  s_nop 1
  v_add_f32_dpp v23, v89, v88 quad_perm:[2,2,2,2] row_mask:0xf bank_mask:0x2
  v_mfma_f32_16x16x32_bf16 v[42:45], a[120:123], v[12:15], 0
  v_mfma_f32_16x16x32_bf16 v[42:45], a[124:127], v[16:19], v[42:45]
  s_waitcnt vmcnt(11)
  buffer_load_dwordx4 v[200:203], v4, s[44:47], s101 offen offset:2304 nt
  v_add_f32_dpp v88, v39, v38 quad_perm:[1,1,1,1] row_mask:0xf bank_mask:0xf
  v_add_f32_dpp v89, v41, v40 quad_perm:[3,3,3,3] row_mask:0xf bank_mask:0xf
  s_nop 1
  v_add_f32_dpp v23, v89, v88 quad_perm:[2,2,2,2] row_mask:0xf bank_mask:0x4
  v_mfma_f32_16x16x32_bf16 v[38:41], a[128:131], v[12:15], 0
  v_mfma_f32_16x16x32_bf16 v[38:41], a[132:135], v[16:19], v[38:41]
  v_add_f32_dpp v88, v43, v42 quad_perm:[1,1,1,1] row_mask:0xf bank_mask:0xf
  v_add_f32_dpp v89, v45, v44 quad_perm:[3,3,3,3] row_mask:0xf bank_mask:0xf
  s_nop 1
  v_add_f32_dpp v23, v89, v88 quad_perm:[2,2,2,2] row_mask:0xf bank_mask:0x8
  v_mfma_f32_16x16x32_bf16 v[42:45], a[136:139], v[12:15], 0
  v_mfma_f32_16x16x32_bf16 v[42:45], a[140:143], v[16:19], v[42:45]
  s_waitcnt vmcnt(11)
  s_add_u32 s101, s101, 16384
  s_cmp_eq_u32 s101, s20
  s_cselect_b32 s101, 0, s101
  buffer_load_dwordx4 v[204:207], v4, s[44:47], s101 offen offset:0 nt
  v_add_f32_dpp v88, v39, v38 quad_perm:[1,1,1,1] row_mask:0xf bank_mask:0xf
  v_add_f32_dpp v89, v41, v40 quad_perm:[3,3,3,3] row_mask:0xf bank_mask:0xf
  s_nop 1
  v_add_f32_dpp v24, v89, v88 quad_perm:[2,2,2,2] row_mask:0xf bank_mask:0x1
  v_mfma_f32_16x16x32_bf16 v[38:41], a[144:147], v[12:15], 0
  v_mfma_f32_16x16x32_bf16 v[38:41], a[148:151], v[16:19], v[38:41]
  v_add_f32_dpp v88, v43, v42 quad_perm:[1,1,1,1] row_mask:0xf bank_mask:0xf
  v_add_f32_dpp v89, v45, v44 quad_perm:[3,3,3,3] row_mask:0xf bank_mask:0xf
  s_nop 1
  v_add_f32_dpp v24, v89, v88 quad_perm:[2,2,2,2] row_mask:0xf bank_mask:0x2
  v_mfma_f32_16x16x32_bf16 v[42:45], a[152:155], v[12:15], 0
  v_mfma_f32_16x16x32_bf16 v[42:45], a[156:159], v[16:19], v[42:45]
  s_waitcnt vmcnt(11)
  buffer_load_dwordx4 v[208:211], v4, s[44:47], s101 offen offset:256 nt
  v_add_f32_dpp v88, v39, v38 quad_perm:[1,1,1,1] row_mask:0xf bank_mask:0xf
  v_add_f32_dpp v89, v41, v40 quad_perm:[3,3,3,3] row_mask:0xf bank_mask:0xf
  s_nop 1
  v_add_f32_dpp v24, v89, v88 quad_perm:[2,2,2,2] row_mask:0xf bank_mask:0x4
  v_mfma_f32_16x16x32_bf16 v[38:41], a[160:163], v[12:15], 0
  v_mfma_f32_16x16x32_bf16 v[38:41], a[164:167], v[16:19], v[38:41]
  v_add_f32_dpp v88, v43, v42 quad_perm:[1,1,1,1] row_mask:0xf bank_mask:0xf
  v_add_f32_dpp v89, v45, v44 quad_perm:[3,3,3,3] row_mask:0xf bank_mask:0xf
  s_nop 1
  v_add_f32_dpp v24, v89, v88 quad_perm:[2,2,2,2] row_mask:0xf bank_mask:0x8
  v_mfma_f32_16x16x32_bf16 v[42:45], a[168:171], v[12:15], 0
  v_mfma_f32_16x16x32_bf16 v[42:45], a[172:175], v[16:19], v[42:45]
  s_waitcnt vmcnt(11)
  buffer_load_dwordx4 v[212:215], v4, s[44:47], s101 offen offset:2048 nt
  v_add_f32_dpp v88, v39, v38 quad_perm:[1,1,1,1] row_mask:0xf bank_mask:0xf
  v_add_f32_dpp v89, v41, v40 quad_perm:[3,3,3,3] row_mask:0xf bank_mask:0xf
  s_nop 1
  v_add_f32_dpp v25, v89, v88 quad_perm:[2,2,2,2] row_mask:0xf bank_mask:0x1
  v_mfma_f32_16x16x32_bf16 v[38:41], a[176:179], v[12:15], 0
  v_mfma_f32_16x16x32_bf16 v[38:41], a[180:183], v[16:19], v[38:41]
  v_add_f32_dpp v88, v43, v42 quad_perm:[1,1,1,1] row_mask:0xf bank_mask:0xf
  v_add_f32_dpp v89, v45, v44 quad_perm:[3,3,3,3] row_mask:0xf bank_mask:0xf
  s_nop 1
  v_add_f32_dpp v25, v89, v88 quad_perm:[2,2,2,2] row_mask:0xf bank_mask:0x2
  v_mfma_f32_16x16x32_bf16 v[42:45], a[184:187], v[12:15], 0
  v_mfma_f32_16x16x32_bf16 v[42:45], a[188:191], v[16:19], v[42:45]
  s_waitcnt vmcnt(11)
  buffer_load_dwordx4 v[216:219], v4, s[44:47], s101 offen offset:2304 nt
  v_add_f32_dpp v88, v39, v38 quad_perm:[1,1,1,1] row_mask:0xf bank_mask:0xf
  v_add_f32_dpp v89, v41, v40 quad_perm:[3,3,3,3] row_mask:0xf bank_mask:0xf
  s_nop 1
  v_add_f32_dpp v25, v89, v88 quad_perm:[2,2,2,2] row_mask:0xf bank_mask:0x4
  v_mfma_f32_16x16x32_bf16 v[38:41], a[192:195], v[12:15], 0
  v_mfma_f32_16x16x32_bf16 v[38:41], a[196:199], v[16:19], v[38:41]
  v_add_f32_dpp v88, v43, v42 quad_perm:[1,1,1,1] row_mask:0xf bank_mask:0xf
  v_add_f32_dpp v89, v45, v44 quad_perm:[3,3,3,3] row_mask:0xf bank_mask:0xf
  s_nop 1
  v_add_f32_dpp v25, v89, v88 quad_perm:[2,2,2,2] row_mask:0xf bank_mask:0x8
  v_mfma_f32_16x16x32_bf16 v[42:45], a[200:203], v[12:15], 0
  v_mfma_f32_16x16x32_bf16 v[42:45], a[204:207], v[16:19], v[42:45]
  s_waitcnt vmcnt(11)
  s_add_u32 s101, s101, 16384
  s_cmp_eq_u32 s101, s20
  s_cselect_b32 s101, 0, s101
  buffer_load_dwordx4 v[220:223], v4, s[44:47], s101 offen offset:0 nt
  v_add_f32_dpp v88, v39, v38 quad_perm:[1,1,1,1] row_mask:0xf bank_mask:0xf
  v_add_f32_dpp v89, v41, v40 quad_perm:[3,3,3,3] row_mask:0xf bank_mask:0xf
  s_nop 1
  v_add_f32_dpp v26, v89, v88 quad_perm:[2,2,2,2] row_mask:0xf bank_mask:0x1
  v_mfma_f32_16x16x32_bf16 v[38:41], a[208:211], v[12:15], 0
  v_mfma_f32_16x16x32_bf16 v[38:41], a[212:215], v[16:19], v[38:41]
  v_add_f32_dpp v88, v43, v42 quad_perm:[1,1,1,1] row_mask:0xf bank_mask:0xf
  v_add_f32_dpp v89, v45, v44 quad_perm:[3,3,3,3] row_mask:0xf bank_mask:0xf
  s_nop 1
  v_add_f32_dpp v26, v89, v88 quad_perm:[2,2,2,2] row_mask:0xf bank_mask:0x2
  v_mfma_f32_16x16x32_bf16 v[42:45], a[216:219], v[12:15], 0
  v_mfma_f32_16x16x32_bf16 v[42:45], a[220:223], v[16:19], v[42:45]
  s_waitcnt vmcnt(11)
  buffer_load_dwordx4 v[224:227], v4, s[44:47], s101 offen offset:256 nt
  v_add_f32_dpp v88, v39, v38 quad_perm:[1,1,1,1] row_mask:0xf bank_mask:0xf
  v_add_f32_dpp v89, v41, v40 quad_perm:[3,3,3,3] row_mask:0xf bank_mask:0xf
  s_nop 1
  v_add_f32_dpp v26, v89, v88 quad_perm:[2,2,2,2] row_mask:0xf bank_mask:0x4
  v_mfma_f32_16x16x32_bf16 v[38:41], a[224:227], v[12:15], 0
  v_mfma_f32_16x16x32_bf16 v[38:41], a[228:231], v[16:19], v[38:41]
  v_add_f32_dpp v88, v43, v42 quad_perm:[1,1,1,1] row_mask:0xf bank_mask:0xf
  v_add_f32_dpp v89, v45, v44 quad_perm:[3,3,3,3] row_mask:0xf bank_mask:0xf
  s_nop 1
  v_add_f32_dpp v26, v89, v88 quad_perm:[2,2,2,2] row_mask:0xf bank_mask:0x8
  v_mfma_f32_16x16x32_bf16 v[42:45], a[232:235], v[12:15], 0
  v_mfma_f32_16x16x32_bf16 v[42:45], a[236:239], v[16:19], v[42:45]
  s_waitcnt vmcnt(11)
  buffer_load_dwordx4 v[228:231], v4, s[44:47], s101 offen offset:2048 nt
  v_add_f32_dpp v88, v39, v38 quad_perm:[1,1,1,1] row_mask:0xf bank_mask:0xf
  v_add_f32_dpp v89, v41, v40 quad_perm:[3,3,3,3] row_mask:0xf bank_mask:0xf
  s_nop 1
  v_add_f32_dpp v27, v89, v88 quad_perm:[2,2,2,2] row_mask:0xf bank_mask:0x1
  v_mfma_f32_16x16x32_bf16 v[38:41], a[240:243], v[12:15], 0
  v_mfma_f32_16x16x32_bf16 v[38:41], a[244:247], v[16:19], v[38:41]
  v_add_f32_dpp v88, v43, v42 quad_perm:[1,1,1,1] row_mask:0xf bank_mask:0xf
  v_add_f32_dpp v89, v45, v44 quad_perm:[3,3,3,3] row_mask:0xf bank_mask:0xf
  s_nop 1
  v_add_f32_dpp v27, v89, v88 quad_perm:[2,2,2,2] row_mask:0xf bank_mask:0x2
  v_mfma_f32_16x16x32_bf16 v[42:45], a[248:251], v[12:15], 0
  v_mfma_f32_16x16x32_bf16 v[42:45], a[252:255], v[16:19], v[42:45]
  s_waitcnt vmcnt(11)
  buffer_load_dwordx4 v[232:235], v4, s[44:47], s101 offen offset:2304 nt
  v_add_f32_dpp v88, v39, v38 quad_perm:[1,1,1,1] row_mask:0xf bank_mask:0xf
  v_add_f32_dpp v89, v41, v40 quad_perm:[3,3,3,3] row_mask:0xf bank_mask:0xf
  s_nop 1
  v_add_f32_dpp v27, v89, v88 quad_perm:[2,2,2,2] row_mask:0xf bank_mask:0x4
  v_mfma_f32_16x16x32_bf16 v[38:41], v[124:127], v[12:15], 0
  v_mfma_f32_16x16x32_bf16 v[38:41], v[128:131], v[16:19], v[38:41]
  v_add_f32_dpp v88, v43, v42 quad_perm:[1,1,1,1] row_mask:0xf bank_mask:0xf
  v_add_f32_dpp v89, v45, v44 quad_perm:[3,3,3,3] row_mask:0xf bank_mask:0xf
  s_nop 1
  v_add_f32_dpp v27, v89, v88 quad_perm:[2,2,2,2] row_mask:0xf bank_mask:0x8
  v_mfma_f32_16x16x32_bf16 v[42:45], v[132:135], v[12:15], 0
  v_mfma_f32_16x16x32_bf16 v[42:45], v[136:139], v[16:19], v[42:45]
  s_waitcnt vmcnt(11)
  s_add_u32 s101, s101, 16384
  s_cmp_eq_u32 s101, s20
  s_cselect_b32 s101, 0, s101
  buffer_load_dwordx4 v[236:239], v4, s[44:47], s101 offen offset:0 nt
  v_add_f32_dpp v88, v39, v38 quad_perm:[1,1,1,1] row_mask:0xf bank_mask:0xf
  v_add_f32_dpp v89, v41, v40 quad_perm:[3,3,3,3] row_mask:0xf bank_mask:0xf
  s_nop 1
  v_add_f32_dpp v28, v89, v88 quad_perm:[2,2,2,2] row_mask:0xf bank_mask:0x1
  v_mfma_f32_16x16x32_bf16 v[38:41], v[140:143], v[12:15], 0
  v_mfma_f32_16x16x32_bf16 v[38:41], v[144:147], v[16:19], v[38:41]
  v_add_f32_dpp v88, v43, v42 quad_perm:[1,1,1,1] row_mask:0xf bank_mask:0xf
  v_add_f32_dpp v89, v45, v44 quad_perm:[3,3,3,3] row_mask:0xf bank_mask:0xf
  s_nop 1
  v_add_f32_dpp v28, v89, v88 quad_perm:[2,2,2,2] row_mask:0xf bank_mask:0x2
  v_mfma_f32_16x16x32_bf16 v[42:45], v[148:151], v[12:15], 0
  v_mfma_f32_16x16x32_bf16 v[42:45], v[152:155], v[16:19], v[42:45]
  s_waitcnt vmcnt(11)
  buffer_load_dwordx4 v[240:243], v4, s[44:47], s101 offen offset:256 nt
  v_add_f32_dpp v88, v39, v38 quad_perm:[1,1,1,1] row_mask:0xf bank_mask:0xf
  v_add_f32_dpp v89, v41, v40 quad_perm:[3,3,3,3] row_mask:0xf bank_mask:0xf
  s_nop 1
  v_add_f32_dpp v28, v89, v88 quad_perm:[2,2,2,2] row_mask:0xf bank_mask:0x4
  v_mfma_f32_16x16x32_bf16 v[38:41], v[156:159], v[12:15], 0
  v_mfma_f32_16x16x32_bf16 v[38:41], v[160:163], v[16:19], v[38:41]
  v_add_f32_dpp v88, v43, v42 quad_perm:[1,1,1,1] row_mask:0xf bank_mask:0xf
  v_add_f32_dpp v89, v45, v44 quad_perm:[3,3,3,3] row_mask:0xf bank_mask:0xf
  s_nop 1
  v_add_f32_dpp v28, v89, v88 quad_perm:[2,2,2,2] row_mask:0xf bank_mask:0x8
  v_mfma_f32_16x16x32_bf16 v[42:45], v[164:167], v[12:15], 0
  v_mfma_f32_16x16x32_bf16 v[42:45], v[168:171], v[16:19], v[42:45]
  s_waitcnt vmcnt(11)
  buffer_load_dwordx4 v[244:247], v4, s[44:47], s101 offen offset:2048 nt
  v_add_f32_dpp v88, v39, v38 quad_perm:[1,1,1,1] row_mask:0xf bank_mask:0xf
  v_add_f32_dpp v89, v41, v40 quad_perm:[3,3,3,3] row_mask:0xf bank_mask:0xf
  s_nop 1
  v_add_f32_dpp v29, v89, v88 quad_perm:[2,2,2,2] row_mask:0xf bank_mask:0x1
  v_mfma_f32_16x16x32_bf16 v[38:41], v[172:175], v[12:15], 0
  v_mfma_f32_16x16x32_bf16 v[38:41], v[176:179], v[16:19], v[38:41]
  v_add_f32_dpp v88, v43, v42 quad_perm:[1,1,1,1] row_mask:0xf bank_mask:0xf
  v_add_f32_dpp v89, v45, v44 quad_perm:[3,3,3,3] row_mask:0xf bank_mask:0xf
  s_nop 1
  v_add_f32_dpp v29, v89, v88 quad_perm:[2,2,2,2] row_mask:0xf bank_mask:0x2
  v_mfma_f32_16x16x32_bf16 v[42:45], v[180:183], v[12:15], 0
  v_mfma_f32_16x16x32_bf16 v[42:45], v[184:187], v[16:19], v[42:45]
  s_waitcnt vmcnt(11)
  buffer_load_dwordx4 v[248:251], v4, s[44:47], s101 offen offset:2304 nt
  v_add_f32_dpp v88, v39, v38 quad_perm:[1,1,1,1] row_mask:0xf bank_mask:0xf
  v_add_f32_dpp v89, v41, v40 quad_perm:[3,3,3,3] row_mask:0xf bank_mask:0xf
  s_nop 1
  v_add_f32_dpp v29, v89, v88 quad_perm:[2,2,2,2] row_mask:0xf bank_mask:0x4
  v_mfma_f32_16x16x32_bf16 v[38:41], v[188:191], v[12:15], 0
  v_mfma_f32_16x16x32_bf16 v[38:41], v[192:195], v[16:19], v[38:41]
  v_add_f32_dpp v88, v43, v42 quad_perm:[1,1,1,1] row_mask:0xf bank_mask:0xf
  v_add_f32_dpp v89, v45, v44 quad_perm:[3,3,3,3] row_mask:0xf bank_mask:0xf
  s_nop 1
  v_add_f32_dpp v29, v89, v88 quad_perm:[2,2,2,2] row_mask:0xf bank_mask:0x8
  v_mfma_f32_16x16x32_bf16 v[42:45], v[196:199], v[12:15], 0
  v_mfma_f32_16x16x32_bf16 v[42:45], v[200:203], v[16:19], v[42:45]
  s_waitcnt vmcnt(11)
  s_add_u32 s101, s101, 16384
  s_cmp_eq_u32 s101, s20
  s_cselect_b32 s101, 0, s101
  buffer_load_dwordx4 v[252:255], v4, s[44:47], s101 offen offset:0 nt
  v_add_f32_dpp v88, v39, v38 quad_perm:[1,1,1,1] row_mask:0xf bank_mask:0xf
  v_add_f32_dpp v89, v41, v40 quad_perm:[3,3,3,3] row_mask:0xf bank_mask:0xf
  s_nop 1
  v_add_f32_dpp v30, v89, v88 quad_perm:[2,2,2,2] row_mask:0xf bank_mask:0x1
  s_waitcnt vmcnt(11)
  v_mfma_f32_16x16x32_bf16 v[38:41], v[204:207], v[12:15], 0
  v_mfma_f32_16x16x32_bf16 v[38:41], v[208:211], v[16:19], v[38:41]
  buffer_load_dwordx4 v[96:99], v4, s[44:47], s101 offen offset:256 nt
  v_add_f32_dpp v88, v43, v42 quad_perm:[1,1,1,1] row_mask:0xf bank_mask:0xf
  v_add_f32_dpp v89, v45, v44 quad_perm:[3,3,3,3] row_mask:0xf bank_mask:0xf
  s_nop 1
  v_add_f32_dpp v30, v89, v88 quad_perm:[2,2,2,2] row_mask:0xf bank_mask:0x2
  s_waitcnt vmcnt(10)
  v_mfma_f32_16x16x32_bf16 v[42:45], v[212:215], v[12:15], 0
  v_mfma_f32_16x16x32_bf16 v[42:45], v[216:219], v[16:19], v[42:45]
  buffer_load_dwordx4 v[100:103], v4, s[44:47], s101 offen offset:2048 nt
  buffer_load_dwordx4 v[104:107], v4, s[44:47], s101 offen offset:2304 nt
  v_add_f32_dpp v88, v39, v38 quad_perm:[1,1,1,1] row_mask:0xf bank_mask:0xf
  v_add_f32_dpp v89, v41, v40 quad_perm:[3,3,3,3] row_mask:0xf bank_mask:0xf
  s_nop 1
  v_add_f32_dpp v30, v89, v88 quad_perm:[2,2,2,2] row_mask:0xf bank_mask:0x4
  s_waitcnt vmcnt(10)
  v_mfma_f32_16x16x32_bf16 v[38:41], v[220:223], v[12:15], 0
  v_mfma_f32_16x16x32_bf16 v[38:41], v[224:227], v[16:19], v[38:41]
  s_add_u32 s101, s101, 16384
  s_cmp_eq_u32 s101, s20
  s_cselect_b32 s101, 0, s101
  buffer_load_dwordx4 v[108:111], v4, s[44:47], s101 offen offset:0 nt
  buffer_load_dwordx4 v[112:115], v4, s[44:47], s101 offen offset:256 nt
  v_add_f32_dpp v88, v43, v42 quad_perm:[1,1,1,1] row_mask:0xf bank_mask:0xf
  v_add_f32_dpp v89, v45, v44 quad_perm:[3,3,3,3] row_mask:0xf bank_mask:0xf
  s_nop 1
  v_add_f32_dpp v30, v89, v88 quad_perm:[2,2,2,2] row_mask:0xf bank_mask:0x8
  s_waitcnt vmcnt(10)
  v_mfma_f32_16x16x32_bf16 v[42:45], v[228:231], v[12:15], 0
  v_mfma_f32_16x16x32_bf16 v[42:45], v[232:235], v[16:19], v[42:45]
  buffer_load_dwordx4 v[116:119], v4, s[44:47], s101 offen offset:2048 nt
  buffer_load_dwordx4 v[120:123], v4, s[44:47], s101 offen offset:2304 nt
  v_add_f32_dpp v88, v39, v38 quad_perm:[1,1,1,1] row_mask:0xf bank_mask:0xf
  v_add_f32_dpp v89, v41, v40 quad_perm:[3,3,3,3] row_mask:0xf bank_mask:0xf
  s_nop 1
  v_add_f32_dpp v31, v89, v88 quad_perm:[2,2,2,2] row_mask:0xf bank_mask:0x1
  s_waitcnt vmcnt(10)
  v_mfma_f32_16x16x32_bf16 v[38:41], v[236:239], v[12:15], 0
  v_mfma_f32_16x16x32_bf16 v[38:41], v[240:243], v[16:19], v[38:41]
  s_add_u32 s101, s101, 16384
  s_cmp_eq_u32 s101, s20
  s_cselect_b32 s101, 0, s101
  buffer_load_dwordx4 v[124:127], v4, s[44:47], s101 offen offset:0 nt
  buffer_load_dwordx4 v[128:131], v4, s[44:47], s101 offen offset:256 nt
  v_add_f32_dpp v88, v43, v42 quad_perm:[1,1,1,1] row_mask:0xf bank_mask:0xf
  v_add_f32_dpp v89, v45, v44 quad_perm:[3,3,3,3] row_mask:0xf bank_mask:0xf
  s_nop 1
  v_add_f32_dpp v31, v89, v88 quad_perm:[2,2,2,2] row_mask:0xf bank_mask:0x2
  s_waitcnt vmcnt(10)
  v_mfma_f32_16x16x32_bf16 v[42:45], v[244:247], v[12:15], 0
  v_mfma_f32_16x16x32_bf16 v[42:45], v[248:251], v[16:19], v[42:45]
  buffer_load_dwordx4 v[132:135], v4, s[44:47], s101 offen offset:2048 nt
  buffer_load_dwordx4 v[136:139], v4, s[44:47], s101 offen offset:2304 nt
  v_add_f32_dpp v88, v39, v38 quad_perm:[1,1,1,1] row_mask:0xf bank_mask:0xf
  v_add_f32_dpp v89, v41, v40 quad_perm:[3,3,3,3] row_mask:0xf bank_mask:0xf
  s_nop 1
  v_add_f32_dpp v31, v89, v88 quad_perm:[2,2,2,2] row_mask:0xf bank_mask:0x4
  s_waitcnt vmcnt(10)
  v_mfma_f32_16x16x32_bf16 v[38:41], v[252:255], v[12:15], 0
  v_mfma_f32_16x16x32_bf16 v[38:41], v[96:99], v[16:19], v[38:41]
  s_add_u32 s101, s101, 16384
  s_cmp_eq_u32 s101, s20
  s_cselect_b32 s101, 0, s101
  buffer_load_dwordx4 v[140:143], v4, s[44:47], s101 offen offset:0 nt
  buffer_load_dwordx4 v[144:147], v4, s[44:47], s101 offen offset:256 nt
  v_add_f32_dpp v88, v43, v42 quad_perm:[1,1,1,1] row_mask:0xf bank_mask:0xf
  v_add_f32_dpp v89, v45, v44 quad_perm:[3,3,3,3] row_mask:0xf bank_mask:0xf
  s_nop 1
  v_add_f32_dpp v31, v89, v88 quad_perm:[2,2,2,2] row_mask:0xf bank_mask:0x8
  s_waitcnt vmcnt(10)
  v_mfma_f32_16x16x32_bf16 v[42:45], v[100:103], v[12:15], 0
  v_mfma_f32_16x16x32_bf16 v[42:45], v[104:107], v[16:19], v[42:45]
  buffer_load_dwordx4 v[148:151], v4, s[44:47], s101 offen offset:2048 nt
  buffer_load_dwordx4 v[152:155], v4, s[44:47], s101 offen offset:2304 nt
  v_add_f32_dpp v88, v39, v38 quad_perm:[1,1,1,1] row_mask:0xf bank_mask:0xf
  v_add_f32_dpp v89, v41, v40 quad_perm:[3,3,3,3] row_mask:0xf bank_mask:0xf
  s_nop 1
  v_add_f32_dpp v32, v89, v88 quad_perm:[2,2,2,2] row_mask:0xf bank_mask:0x1
  s_waitcnt vmcnt(10)
  v_mfma_f32_16x16x32_bf16 v[38:41], v[108:111], v[12:15], 0
  v_mfma_f32_16x16x32_bf16 v[38:41], v[112:115], v[16:19], v[38:41]
  s_add_u32 s101, s101, 16384
  s_cmp_eq_u32 s101, s20
  s_cselect_b32 s101, 0, s101
  buffer_load_dwordx4 v[156:159], v4, s[44:47], s101 offen offset:0 nt
  buffer_load_dwordx4 v[160:163], v4, s[44:47], s101 offen offset:256 nt
  v_add_f32_dpp v88, v43, v42 quad_perm:[1,1,1,1] row_mask:0xf bank_mask:0xf
  v_add_f32_dpp v89, v45, v44 quad_perm:[3,3,3,3] row_mask:0xf bank_mask:0xf
  s_nop 1
  v_add_f32_dpp v32, v89, v88 quad_perm:[2,2,2,2] row_mask:0xf bank_mask:0x2
  s_waitcnt vmcnt(10)
  v_mfma_f32_16x16x32_bf16 v[42:45], v[116:119], v[12:15], 0
  v_mfma_f32_16x16x32_bf16 v[42:45], v[120:123], v[16:19], v[42:45]
  buffer_load_dwordx4 v[164:167], v4, s[44:47], s101 offen offset:2048 nt
  buffer_load_dwordx4 v[168:171], v4, s[44:47], s101 offen offset:2304 nt
  v_add_f32_dpp v88, v39, v38 quad_perm:[1,1,1,1] row_mask:0xf bank_mask:0xf
  v_add_f32_dpp v89, v41, v40 quad_perm:[3,3,3,3] row_mask:0xf bank_mask:0xf
  s_nop 1
  v_add_f32_dpp v32, v89, v88 quad_perm:[2,2,2,2] row_mask:0xf bank_mask:0x4
  s_waitcnt vmcnt(10)
  v_mfma_f32_16x16x32_bf16 v[38:41], v[124:127], v[12:15], 0
  v_mfma_f32_16x16x32_bf16 v[38:41], v[128:131], v[16:19], v[38:41]
  s_add_u32 s101, s101, 16384
  s_cmp_eq_u32 s101, s20
  s_cselect_b32 s101, 0, s101
  buffer_load_dwordx4 v[172:175], v4, s[44:47], s101 offen offset:0 nt
  buffer_load_dwordx4 v[176:179], v4, s[44:47], s101 offen offset:256 nt
  v_add_f32_dpp v88, v43, v42 quad_perm:[1,1,1,1] row_mask:0xf bank_mask:0xf
  v_add_f32_dpp v89, v45, v44 quad_perm:[3,3,3,3] row_mask:0xf bank_mask:0xf
  s_nop 1
  v_add_f32_dpp v32, v89, v88 quad_perm:[2,2,2,2] row_mask:0xf bank_mask:0x8
  s_waitcnt vmcnt(10)
  v_mfma_f32_16x16x32_bf16 v[42:45], v[132:135], v[12:15], 0
  v_mfma_f32_16x16x32_bf16 v[42:45], v[136:139], v[16:19], v[42:45]
  buffer_load_dwordx4 v[180:183], v4, s[44:47], s101 offen offset:2048 nt
  buffer_load_dwordx4 v[184:187], v4, s[44:47], s101 offen offset:2304 nt
  v_add_f32_dpp v88, v39, v38 quad_perm:[1,1,1,1] row_mask:0xf bank_mask:0xf
  v_add_f32_dpp v89, v41, v40 quad_perm:[3,3,3,3] row_mask:0xf bank_mask:0xf
  s_nop 1
  v_add_f32_dpp v33, v89, v88 quad_perm:[2,2,2,2] row_mask:0xf bank_mask:0x1
  s_waitcnt vmcnt(10)
  v_mfma_f32_16x16x32_bf16 v[38:41], v[140:143], v[12:15], 0
  v_mfma_f32_16x16x32_bf16 v[38:41], v[144:147], v[16:19], v[38:41]
  s_add_u32 s101, s101, 16384
  s_cmp_eq_u32 s101, s20
  s_cselect_b32 s101, 0, s101
  buffer_load_dwordx4 v[188:191], v4, s[44:47], s101 offen offset:0 nt
  buffer_load_dwordx4 v[192:195], v4, s[44:47], s101 offen offset:256 nt
  v_add_f32_dpp v88, v43, v42 quad_perm:[1,1,1,1] row_mask:0xf bank_mask:0xf
  v_add_f32_dpp v89, v45, v44 quad_perm:[3,3,3,3] row_mask:0xf bank_mask:0xf
  s_nop 1
  v_add_f32_dpp v33, v89, v88 quad_perm:[2,2,2,2] row_mask:0xf bank_mask:0x2
  s_waitcnt vmcnt(10)
  v_mfma_f32_16x16x32_bf16 v[42:45], v[148:151], v[12:15], 0
  v_mfma_f32_16x16x32_bf16 v[42:45], v[152:155], v[16:19], v[42:45]
  buffer_load_dwordx4 v[196:199], v4, s[44:47], s101 offen offset:2048 nt
  buffer_load_dwordx4 v[200:203], v4, s[44:47], s101 offen offset:2304 nt
  v_add_f32_dpp v88, v39, v38 quad_perm:[1,1,1,1] row_mask:0xf bank_mask:0xf
  v_add_f32_dpp v89, v41, v40 quad_perm:[3,3,3,3] row_mask:0xf bank_mask:0xf
  s_nop 1
  v_add_f32_dpp v33, v89, v88 quad_perm:[2,2,2,2] row_mask:0xf bank_mask:0x4
  s_waitcnt vmcnt(10)
  v_mfma_f32_16x16x32_bf16 v[38:41], v[156:159], v[12:15], 0
  v_mfma_f32_16x16x32_bf16 v[38:41], v[160:163], v[16:19], v[38:41]
  s_add_u32 s101, s101, 16384
  s_cmp_eq_u32 s101, s20
  s_cselect_b32 s101, 0, s101
  buffer_load_dwordx4 v[204:207], v4, s[44:47], s101 offen offset:0 nt
  buffer_load_dwordx4 v[208:211], v4, s[44:47], s101 offen offset:256 nt
  v_add_f32_dpp v88, v43, v42 quad_perm:[1,1,1,1] row_mask:0xf bank_mask:0xf
  v_add_f32_dpp v89, v45, v44 quad_perm:[3,3,3,3] row_mask:0xf bank_mask:0xf
  s_nop 1
  v_add_f32_dpp v33, v89, v88 quad_perm:[2,2,2,2] row_mask:0xf bank_mask:0x8
  s_waitcnt vmcnt(10)
  v_mfma_f32_16x16x32_bf16 v[42:45], v[164:167], v[12:15], 0
  v_mfma_f32_16x16x32_bf16 v[42:45], v[168:171], v[16:19], v[42:45]
  buffer_load_dwordx4 v[212:215], v4, s[44:47], s101 offen offset:2048 nt
  buffer_load_dwordx4 v[216:219], v4, s[44:47], s101 offen offset:2304 nt
  v_add_f32_dpp v88, v39, v38 quad_perm:[1,1,1,1] row_mask:0xf bank_mask:0xf
  v_add_f32_dpp v89, v41, v40 quad_perm:[3,3,3,3] row_mask:0xf bank_mask:0xf
  s_nop 1
  v_add_f32_dpp v34, v89, v88 quad_perm:[2,2,2,2] row_mask:0xf bank_mask:0x1
  s_waitcnt vmcnt(10)
  v_mfma_f32_16x16x32_bf16 v[38:41], v[172:175], v[12:15], 0
  v_mfma_f32_16x16x32_bf16 v[38:41], v[176:179], v[16:19], v[38:41]
  buffer_load_dwordx4 v[220:223], v5, s[48:51], s21 offen offset:0 nt
  buffer_load_dwordx4 v[224:227], v5, s[48:51], s21 offen offset:256 nt
  v_add_f32_dpp v88, v43, v42 quad_perm:[1,1,1,1] row_mask:0xf bank_mask:0xf
  v_add_f32_dpp v89, v45, v44 quad_perm:[3,3,3,3] row_mask:0xf bank_mask:0xf
  s_nop 1
  v_add_f32_dpp v34, v89, v88 quad_perm:[2,2,2,2] row_mask:0xf bank_mask:0x2
  s_waitcnt vmcnt(10)
  v_mfma_f32_16x16x32_bf16 v[42:45], v[180:183], v[12:15], 0
  v_mfma_f32_16x16x32_bf16 v[42:45], v[184:187], v[16:19], v[42:45]
  buffer_load_dwordx4 v[228:231], v5, s[48:51], s21 offen offset:2048 nt
  buffer_load_dwordx4 v[232:235], v5, s[48:51], s21 offen offset:2304 nt
  v_add_f32_dpp v88, v39, v38 quad_perm:[1,1,1,1] row_mask:0xf bank_mask:0xf
  v_add_f32_dpp v89, v41, v40 quad_perm:[3,3,3,3] row_mask:0xf bank_mask:0xf
  s_nop 1
  v_add_f32_dpp v34, v89, v88 quad_perm:[2,2,2,2] row_mask:0xf bank_mask:0x4
  s_waitcnt vmcnt(10)
  v_mfma_f32_16x16x32_bf16 v[38:41], v[188:191], v[12:15], 0
  v_mfma_f32_16x16x32_bf16 v[38:41], v[192:195], v[16:19], v[38:41]
  s_add_u32 s21, s21, 16384
  s_cmp_eq_u32 s21, s20
  s_cselect_b32 s21, 0, s21
  buffer_load_dwordx4 v[236:239], v5, s[48:51], s21 offen offset:0 nt
  buffer_load_dwordx4 v[240:243], v5, s[48:51], s21 offen offset:256 nt
  s_mov_b32 s96, 0
  buffer_load_dwordx4 a[0:3], v6, s[56:59], s96 offen offset:0
  s_mov_b32 s96, 0
  buffer_load_dwordx4 a[4:7], v6, s[56:59], s96 offen offset:256
  v_add_f32_dpp v88, v43, v42 quad_perm:[1,1,1,1] row_mask:0xf bank_mask:0xf
  v_add_f32_dpp v89, v45, v44 quad_perm:[3,3,3,3] row_mask:0xf bank_mask:0xf
  s_nop 1
  v_add_f32_dpp v34, v89, v88 quad_perm:[2,2,2,2] row_mask:0xf bank_mask:0x8
  s_waitcnt vmcnt(12)
  v_mfma_f32_16x16x32_bf16 v[42:45], v[196:199], v[12:15], 0
  v_mfma_f32_16x16x32_bf16 v[42:45], v[200:203], v[16:19], v[42:45]
  s_waitcnt vmcnt(11)
  buffer_load_dwordx4 v[244:247], v5, s[48:51], s21 offen offset:2048 nt
  s_waitcnt vmcnt(11)
  buffer_load_dwordx4 v[248:251], v5, s[48:51], s21 offen offset:2304 nt
  s_mov_b32 s96, 0
  buffer_load_dwordx4 a[8:11], v6, s[56:59], s96 offen offset:512
  v_add_f32_dpp v88, v39, v38 quad_perm:[1,1,1,1] row_mask:0xf bank_mask:0xf
  v_add_f32_dpp v89, v41, v40 quad_perm:[3,3,3,3] row_mask:0xf bank_mask:0xf
  s_nop 1
  v_add_f32_dpp v35, v89, v88 quad_perm:[2,2,2,2] row_mask:0xf bank_mask:0x1
  v_mfma_f32_16x16x32_bf16 v[38:41], v[204:207], v[12:15], 0
  v_mfma_f32_16x16x32_bf16 v[38:41], v[208:211], v[16:19], v[38:41]
  s_waitcnt vmcnt(11)
  s_add_u32 s21, s21, 16384
  s_cmp_eq_u32 s21, s20
  s_cselect_b32 s21, 0, s21
  buffer_load_dwordx4 v[252:255], v5, s[48:51], s21 offen offset:0 nt
  s_waitcnt vmcnt(11)
  buffer_load_dwordx4 v[96:99], v5, s[48:51], s21 offen offset:256 nt
  s_mov_b32 s96, 0
  buffer_load_dwordx4 a[12:15], v7, s[56:59], s96 offen offset:768
  v_add_f32_dpp v88, v43, v42 quad_perm:[1,1,1,1] row_mask:0xf bank_mask:0xf
  v_add_f32_dpp v89, v45, v44 quad_perm:[3,3,3,3] row_mask:0xf bank_mask:0xf
  s_nop 1
  v_add_f32_dpp v35, v89, v88 quad_perm:[2,2,2,2] row_mask:0xf bank_mask:0x2
  v_mfma_f32_16x16x32_bf16 v[42:45], v[212:215], v[12:15], 0
  v_mfma_f32_16x16x32_bf16 v[42:45], v[216:219], v[16:19], v[42:45]
  s_waitcnt vmcnt(11)
  buffer_load_dwordx4 v[100:103], v5, s[48:51], s21 offen offset:2048 nt
  s_waitcnt vmcnt(11)
  buffer_load_dwordx4 v[104:107], v5, s[48:51], s21 offen offset:2304 nt
  s_mov_b32 s96, 3584
  buffer_load_dwordx4 a[16:19], v6, s[56:59], s96 offen offset:0
  v_add_f32_dpp v88, v39, v38 quad_perm:[1,1,1,1] row_mask:0xf bank_mask:0xf
  v_add_f32_dpp v89, v41, v40 quad_perm:[3,3,3,3] row_mask:0xf bank_mask:0xf
  s_nop 1
  v_add_f32_dpp v35, v89, v88 quad_perm:[2,2,2,2] row_mask:0xf bank_mask:0x4
  v_add_f32_dpp v88, v43, v42 quad_perm:[1,1,1,1] row_mask:0xf bank_mask:0xf
  v_add_f32_dpp v89, v45, v44 quad_perm:[3,3,3,3] row_mask:0xf bank_mask:0xf
  s_nop 1
  v_add_f32_dpp v35, v89, v88 quad_perm:[2,2,2,2] row_mask:0xf bank_mask:0x8
  v_max3_f32 v80, v20, v21, v22
  v_max3_f32 v80, v80, v23, v24
  v_max3_f32 v80, v80, v25, v26
  v_max3_f32 v80, v80, v27, v28
  v_max3_f32 v80, v80, v29, v30
  v_max3_f32 v80, v80, v31, v32
  v_max3_f32 v80, v80, v33, v34
  v_max_f32 v80, v80, v35
  s_nop 1
  v_mov_b32_dpp v81, v80 quad_perm:[0,0,0,0] row_mask:0xf bank_mask:0xf
  s_nop 1
  v_max_f32_dpp v80, v81, v81 row_ror:4 row_mask:0xf bank_mask:0xf
  s_nop 1
  v_max_f32_dpp v81, v80, v80 row_ror:8 row_mask:0xf bank_mask:0xf
  s_lshl_b32 s12, s3, 4
  v_lshlrev_b32 v82, 2, v3
  v_add_u32 v82, s12, v82
  ds_write_b32 v82, v81 offset:2560
  s_waitcnt lgkmcnt(0)
  s_barrier
  v_mov_b32 v83, 0
  ds_read_b128 v[54:57], v83 offset:2560
  ds_read_b128 v[58:61], v83 offset:2576
  ds_read_b128 v[62:65], v83 offset:2592
  ds_read_b128 v[66:69], v83 offset:2608
  s_waitcnt lgkmcnt(0)
  v_max3_f32 v80, v54, v55, v56
  v_max3_f32 v80, v80, v57, v58
  v_max3_f32 v80, v80, v59, v60
  v_max3_f32 v80, v80, v61, v62
  v_max3_f32 v80, v80, v63, v64
  v_max3_f32 v80, v80, v65, v66
  v_max3_f32 v80, v80, v67, v68
  v_max_f32 v80, v80, v69
  v_mul_f32 v80, s92, v80
  v_fma_f32 v20, v20, s92, -v80
  v_fma_f32 v21, v21, s92, -v80
  v_fma_f32 v22, v22, s92, -v80
  v_fma_f32 v23, v23, s92, -v80
  v_fma_f32 v24, v24, s92, -v80
  v_fma_f32 v25, v25, s92, -v80
  v_fma_f32 v26, v26, s92, -v80
  v_fma_f32 v27, v27, s92, -v80
  v_fma_f32 v28, v28, s92, -v80
  v_fma_f32 v29, v29, s92, -v80
  v_fma_f32 v30, v30, s92, -v80
  v_fma_f32 v31, v31, s92, -v80
  v_fma_f32 v32, v32, s92, -v80
  v_fma_f32 v33, v33, s92, -v80
  v_fma_f32 v34, v34, s92, -v80
  v_fma_f32 v35, v35, s92, -v80
  v_exp_f32 v20, v20
  v_exp_f32 v21, v21
  v_exp_f32 v22, v22
  v_exp_f32 v23, v23
  v_exp_f32 v24, v24
  v_exp_f32 v25, v25
  v_exp_f32 v26, v26
  v_exp_f32 v27, v27
  v_exp_f32 v28, v28
  v_exp_f32 v29, v29
  v_exp_f32 v30, v30
  v_exp_f32 v31, v31
  v_exp_f32 v32, v32
  v_exp_f32 v33, v33
  v_exp_f32 v34, v34
  v_exp_f32 v35, v35
  v_add_f32 v81, v20, v21
  v_add_f32 v81, v81, v22
  v_add_f32 v81, v81, v23
  v_add_f32 v81, v81, v24
  v_add_f32 v81, v81, v25
  v_add_f32 v81, v81, v26
  v_add_f32 v81, v81, v27
  v_add_f32 v81, v81, v28
  v_add_f32 v81, v81, v29
  v_add_f32 v81, v81, v30
  v_add_f32 v81, v81, v31
  v_add_f32 v81, v81, v32
  v_add_f32 v81, v81, v33
  v_add_f32 v81, v81, v34
  v_add_f32 v81, v81, v35
  v_cvt_pk_bf16_f32 v20, v20, v20
  v_cvt_pk_bf16_f32 v21, v21, v21
  v_cvt_pk_bf16_f32 v22, v22, v22
  v_cvt_pk_bf16_f32 v23, v23, v23
  v_cvt_pk_bf16_f32 v24, v24, v24
  v_cvt_pk_bf16_f32 v25, v25, v25
  v_cvt_pk_bf16_f32 v26, v26, v26
  v_cvt_pk_bf16_f32 v27, v27, v27
  v_cvt_pk_bf16_f32 v28, v28, v28
  v_cvt_pk_bf16_f32 v29, v29, v29
  v_cvt_pk_bf16_f32 v30, v30, v30
  v_cvt_pk_bf16_f32 v31, v31, v31
  v_cvt_pk_bf16_f32 v32, v32, v32
  v_cvt_pk_bf16_f32 v33, v33, v33
  v_cvt_pk_bf16_f32 v34, v34, v34
  v_cvt_pk_bf16_f32 v35, v35, v35
  v_mov_b32_dpp v83, v81 quad_perm:[0,0,0,0] row_mask:0xf bank_mask:0xf
  s_nop 1
  v_add_f32_dpp v81, v83, v83 row_ror:4 row_mask:0xf bank_mask:0xf
  s_nop 1
  v_add_f32_dpp v83, v81, v81 row_ror:8 row_mask:0xf bank_mask:0xf
  ds_write_b32 v82, v83 offset:2688
  s_waitcnt lgkmcnt(0)
  s_barrier
  v_mov_b32 v83, 0
  ds_read_b128 v[54:57], v83 offset:2688
  ds_read_b128 v[58:61], v83 offset:2704
  ds_read_b128 v[62:65], v83 offset:2720
  ds_read_b128 v[66:69], v83 offset:2736
  s_waitcnt lgkmcnt(0)
  v_add_f32 v54, v54, v55
  v_add_f32 v56, v56, v57
  v_add_f32 v58, v58, v59
  v_add_f32 v60, v60, v61
  v_add_f32 v62, v62, v63
  v_add_f32 v64, v64, v65
  v_add_f32 v66, v66, v67
  v_add_f32 v68, v68, v69
  v_add_f32 v54, v54, v56
  v_add_f32 v58, v58, v60
  v_add_f32 v62, v62, v64
  v_add_f32 v66, v66, v68
  v_add_f32 v54, v54, v58
  v_add_f32 v62, v62, v66
  v_add_f32 v54, v54, v62
  v_min_u32 v46, -2, v80
  v_min_u32 v47, -2, v54
  v_cmp_eq_u32 vcc, 0, v0
  v_mov_b32 v84, 0x7ff00000
  v_mov_b32 v85, 0
  v_cndmask_b32 v84, v84, v85, vcc
  s_lshl_b32 s13, s10, 3
  s_add_u32 s13, s13, 786432
  buffer_store_dwordx2 v[46:47], v84, s[64:67], s13 offen sc1
  v_and_b32_dpp v46, v20, v8 row_newbcast:0 row_mask:0xf bank_mask:0xf
  v_and_b32_dpp v47, v20, v9 row_newbcast:0 row_mask:0xf bank_mask:0xf
  v_and_b32_dpp v48, v20, v10 row_newbcast:0 row_mask:0xf bank_mask:0xf
  v_and_b32_dpp v49, v20, v11 row_newbcast:0 row_mask:0xf bank_mask:0xf
  v_and_b32_dpp v50, v20, v8 row_newbcast:4 row_mask:0xf bank_mask:0xf
  v_and_b32_dpp v51, v20, v9 row_newbcast:4 row_mask:0xf bank_mask:0xf
  v_and_b32_dpp v52, v20, v10 row_newbcast:4 row_mask:0xf bank_mask:0xf
  v_and_b32_dpp v53, v20, v11 row_newbcast:4 row_mask:0xf bank_mask:0xf
  v_mfma_f32_16x16x32_bf16 v[38:41], v[220:223], v[46:49], 0
  v_mfma_f32_16x16x32_bf16 v[42:45], v[224:227], v[46:49], 0
  s_add_u32 s21, s21, 16384
  s_cmp_eq_u32 s21, s20
  s_cselect_b32 s21, 0, s21
  buffer_load_dwordx4 v[108:111], v5, s[48:51], s21 offen offset:0 nt
  buffer_load_dwordx4 v[112:115], v5, s[48:51], s21 offen offset:256 nt
  s_mov_b32 s96, 3584
  buffer_load_dwordx4 a[20:23], v6, s[56:59], s96 offen offset:256
  s_mov_b32 s96, 3584
  buffer_load_dwordx4 a[24:27], v6, s[56:59], s96 offen offset:512
  v_and_b32_dpp v46, v20, v8 row_newbcast:8 row_mask:0xf bank_mask:0xf
  v_and_b32_dpp v47, v20, v9 row_newbcast:8 row_mask:0xf bank_mask:0xf
  v_and_b32_dpp v48, v20, v10 row_newbcast:8 row_mask:0xf bank_mask:0xf
  v_and_b32_dpp v49, v20, v11 row_newbcast:8 row_mask:0xf bank_mask:0xf
  v_mfma_f32_16x16x32_bf16 v[38:41], v[228:231], v[50:53], v[38:41]
  v_mfma_f32_16x16x32_bf16 v[42:45], v[232:235], v[50:53], v[42:45]
  buffer_load_dwordx4 v[116:119], v5, s[48:51], s21 offen offset:2048 nt
  buffer_load_dwordx4 v[120:123], v5, s[48:51], s21 offen offset:2304 nt
  s_mov_b32 s96, 3584
  buffer_load_dwordx4 a[28:31], v7, s[56:59], s96 offen offset:768
  v_and_b32_dpp v50, v20, v8 row_newbcast:12 row_mask:0xf bank_mask:0xf
  v_and_b32_dpp v51, v20, v9 row_newbcast:12 row_mask:0xf bank_mask:0xf
  v_and_b32_dpp v52, v20, v10 row_newbcast:12 row_mask:0xf bank_mask:0xf
  v_and_b32_dpp v53, v20, v11 row_newbcast:12 row_mask:0xf bank_mask:0xf
  s_waitcnt vmcnt(19)
  v_mfma_f32_16x16x32_bf16 v[38:41], v[236:239], v[46:49], v[38:41]
  v_mfma_f32_16x16x32_bf16 v[42:45], v[240:243], v[46:49], v[42:45]
  s_add_u32 s21, s21, 16384
  s_cmp_eq_u32 s21, s20
  s_cselect_b32 s21, 0, s21
  buffer_load_dwordx4 v[124:127], v5, s[48:51], s21 offen offset:0 nt
  buffer_load_dwordx4 v[128:131], v5, s[48:51], s21 offen offset:256 nt
  s_mov_b32 s96, 7168
  buffer_load_dwordx4 a[32:35], v6, s[56:59], s96 offen offset:0
  v_and_b32_dpp v46, v21, v8 row_newbcast:0 row_mask:0xf bank_mask:0xf
  v_and_b32_dpp v47, v21, v9 row_newbcast:0 row_mask:0xf bank_mask:0xf
  v_and_b32_dpp v48, v21, v10 row_newbcast:0 row_mask:0xf bank_mask:0xf
  v_and_b32_dpp v49, v21, v11 row_newbcast:0 row_mask:0xf bank_mask:0xf
  s_waitcnt vmcnt(18)
  v_mfma_f32_16x16x32_bf16 v[38:41], v[244:247], v[50:53], v[38:41]
  v_mfma_f32_16x16x32_bf16 v[42:45], v[248:251], v[50:53], v[42:45]
  buffer_load_dwordx4 v[132:135], v5, s[48:51], s21 offen offset:2048 nt
  buffer_load_dwordx4 v[136:139], v5, s[48:51], s21 offen offset:2304 nt
  s_mov_b32 s96, 7168
  buffer_load_dwordx4 a[36:39], v6, s[56:59], s96 offen offset:256
  v_and_b32_dpp v50, v21, v8 row_newbcast:4 row_mask:0xf bank_mask:0xf
  v_and_b32_dpp v51, v21, v9 row_newbcast:4 row_mask:0xf bank_mask:0xf
  v_and_b32_dpp v52, v21, v10 row_newbcast:4 row_mask:0xf bank_mask:0xf
  v_and_b32_dpp v53, v21, v11 row_newbcast:4 row_mask:0xf bank_mask:0xf
  s_waitcnt vmcnt(18)
  v_mfma_f32_16x16x32_bf16 v[38:41], v[252:255], v[46:49], v[38:41]
  v_mfma_f32_16x16x32_bf16 v[42:45], v[96:99], v[46:49], v[42:45]
  s_add_u32 s21, s21, 16384
  s_cmp_eq_u32 s21, s20
  s_cselect_b32 s21, 0, s21
  buffer_load_dwordx4 v[140:143], v5, s[48:51], s21 offen offset:0 nt
  buffer_load_dwordx4 v[144:147], v5, s[48:51], s21 offen offset:256 nt
  s_mov_b32 s96, 7168
  buffer_load_dwordx4 a[40:43], v6, s[56:59], s96 offen offset:512
  v_and_b32_dpp v46, v21, v8 row_newbcast:8 row_mask:0xf bank_mask:0xf
  v_and_b32_dpp v47, v21, v9 row_newbcast:8 row_mask:0xf bank_mask:0xf
  v_and_b32_dpp v48, v21, v10 row_newbcast:8 row_mask:0xf bank_mask:0xf
  v_and_b32_dpp v49, v21, v11 row_newbcast:8 row_mask:0xf bank_mask:0xf
  s_waitcnt vmcnt(18)
  v_mfma_f32_16x16x32_bf16 v[38:41], v[100:103], v[50:53], v[38:41]
  v_mfma_f32_16x16x32_bf16 v[42:45], v[104:107], v[50:53], v[42:45]
  buffer_load_dwordx4 v[148:151], v5, s[48:51], s21 offen offset:2048 nt
  buffer_load_dwordx4 v[152:155], v5, s[48:51], s21 offen offset:2304 nt
  s_mov_b32 s96, 7168
  buffer_load_dwordx4 a[44:47], v7, s[56:59], s96 offen offset:768
  s_mov_b32 s96, 10752
  buffer_load_dwordx4 a[48:51], v6, s[56:59], s96 offen offset:0
  v_and_b32_dpp v50, v21, v8 row_newbcast:12 row_mask:0xf bank_mask:0xf
  v_and_b32_dpp v51, v21, v9 row_newbcast:12 row_mask:0xf bank_mask:0xf
  v_and_b32_dpp v52, v21, v10 row_newbcast:12 row_mask:0xf bank_mask:0xf
  v_and_b32_dpp v53, v21, v11 row_newbcast:12 row_mask:0xf bank_mask:0xf
  s_waitcnt vmcnt(18)
  v_mfma_f32_16x16x32_bf16 v[38:41], v[108:111], v[46:49], v[38:41]
  v_mfma_f32_16x16x32_bf16 v[42:45], v[112:115], v[46:49], v[42:45]
  s_add_u32 s21, s21, 16384
  s_cmp_eq_u32 s21, s20
  s_cselect_b32 s21, 0, s21
  buffer_load_dwordx4 v[156:159], v5, s[48:51], s21 offen offset:0 nt
  buffer_load_dwordx4 v[160:163], v5, s[48:51], s21 offen offset:256 nt
  s_mov_b32 s96, 10752
  buffer_load_dwordx4 a[52:55], v6, s[56:59], s96 offen offset:256
  v_and_b32_dpp v46, v22, v8 row_newbcast:0 row_mask:0xf bank_mask:0xf
  v_and_b32_dpp v47, v22, v9 row_newbcast:0 row_mask:0xf bank_mask:0xf
  v_and_b32_dpp v48, v22, v10 row_newbcast:0 row_mask:0xf bank_mask:0xf
  v_and_b32_dpp v49, v22, v11 row_newbcast:0 row_mask:0xf bank_mask:0xf
  s_waitcnt vmcnt(17)
  v_mfma_f32_16x16x32_bf16 v[38:41], v[116:119], v[50:53], v[38:41]
  v_mfma_f32_16x16x32_bf16 v[42:45], v[120:123], v[50:53], v[42:45]
  buffer_load_dwordx4 v[164:167], v5, s[48:51], s21 offen offset:2048 nt
  buffer_load_dwordx4 v[168:171], v5, s[48:51], s21 offen offset:2304 nt
  s_mov_b32 s96, 10752
  buffer_load_dwordx4 a[56:59], v6, s[56:59], s96 offen offset:512
  v_and_b32_dpp v50, v22, v8 row_newbcast:4 row_mask:0xf bank_mask:0xf
  v_and_b32_dpp v51, v22, v9 row_newbcast:4 row_mask:0xf bank_mask:0xf
  v_and_b32_dpp v52, v22, v10 row_newbcast:4 row_mask:0xf bank_mask:0xf
  v_and_b32_dpp v53, v22, v11 row_newbcast:4 row_mask:0xf bank_mask:0xf
  s_waitcnt vmcnt(17)
  v_mfma_f32_16x16x32_bf16 v[38:41], v[124:127], v[46:49], v[38:41]
  v_mfma_f32_16x16x32_bf16 v[42:45], v[128:131], v[46:49], v[42:45]
  s_add_u32 s21, s21, 16384
  s_cmp_eq_u32 s21, s20
  s_cselect_b32 s21, 0, s21
  buffer_load_dwordx4 v[172:175], v5, s[48:51], s21 offen offset:0 nt
  buffer_load_dwordx4 v[176:179], v5, s[48:51], s21 offen offset:256 nt
  s_mov_b32 s96, 10752
  buffer_load_dwordx4 a[60:63], v7, s[56:59], s96 offen offset:768
  v_and_b32_dpp v46, v22, v8 row_newbcast:8 row_mask:0xf bank_mask:0xf
  v_and_b32_dpp v47, v22, v9 row_newbcast:8 row_mask:0xf bank_mask:0xf
  v_and_b32_dpp v48, v22, v10 row_newbcast:8 row_mask:0xf bank_mask:0xf
  v_and_b32_dpp v49, v22, v11 row_newbcast:8 row_mask:0xf bank_mask:0xf
  s_waitcnt vmcnt(17)
  v_mfma_f32_16x16x32_bf16 v[38:41], v[132:135], v[50:53], v[38:41]
  v_mfma_f32_16x16x32_bf16 v[42:45], v[136:139], v[50:53], v[42:45]
  buffer_load_dwordx4 v[180:183], v5, s[48:51], s21 offen offset:2048 nt
  buffer_load_dwordx4 v[184:187], v5, s[48:51], s21 offen offset:2304 nt
  s_mov_b32 s96, 14336
  buffer_load_dwordx4 a[64:67], v6, s[56:59], s96 offen offset:0
  v_and_b32_dpp v50, v22, v8 row_newbcast:12 row_mask:0xf bank_mask:0xf
  v_and_b32_dpp v51, v22, v9 row_newbcast:12 row_mask:0xf bank_mask:0xf
  v_and_b32_dpp v52, v22, v10 row_newbcast:12 row_mask:0xf bank_mask:0xf
  v_and_b32_dpp v53, v22, v11 row_newbcast:12 row_mask:0xf bank_mask:0xf
  s_waitcnt vmcnt(17)
  v_mfma_f32_16x16x32_bf16 v[38:41], v[140:143], v[46:49], v[38:41]
  v_mfma_f32_16x16x32_bf16 v[42:45], v[144:147], v[46:49], v[42:45]
  s_add_u32 s21, s21, 16384
  s_cmp_eq_u32 s21, s20
  s_cselect_b32 s21, 0, s21
  buffer_load_dwordx4 v[188:191], v5, s[48:51], s21 offen offset:0 nt
  buffer_load_dwordx4 v[192:195], v5, s[48:51], s21 offen offset:256 nt
  s_mov_b32 s96, 14336
  buffer_load_dwordx4 a[68:71], v6, s[56:59], s96 offen offset:256
  s_mov_b32 s96, 14336
  buffer_load_dwordx4 a[72:75], v6, s[56:59], s96 offen offset:512
  v_and_b32_dpp v46, v23, v8 row_newbcast:0 row_mask:0xf bank_mask:0xf
  v_and_b32_dpp v47, v23, v9 row_newbcast:0 row_mask:0xf bank_mask:0xf
  v_and_b32_dpp v48, v23, v10 row_newbcast:0 row_mask:0xf bank_mask:0xf
  v_and_b32_dpp v49, v23, v11 row_newbcast:0 row_mask:0xf bank_mask:0xf
  s_waitcnt vmcnt(18)
  v_mfma_f32_16x16x32_bf16 v[38:41], v[148:151], v[50:53], v[38:41]
  v_mfma_f32_16x16x32_bf16 v[42:45], v[152:155], v[50:53], v[42:45]
  buffer_load_dwordx4 v[196:199], v5, s[48:51], s21 offen offset:2048 nt
  buffer_load_dwordx4 v[200:203], v5, s[48:51], s21 offen offset:2304 nt
  s_mov_b32 s96, 14336
  buffer_load_dwordx4 a[76:79], v7, s[56:59], s96 offen offset:768
  v_and_b32_dpp v50, v23, v8 row_newbcast:4 row_mask:0xf bank_mask:0xf
  v_and_b32_dpp v51, v23, v9 row_newbcast:4 row_mask:0xf bank_mask:0xf
  v_and_b32_dpp v52, v23, v10 row_newbcast:4 row_mask:0xf bank_mask:0xf
  v_and_b32_dpp v53, v23, v11 row_newbcast:4 row_mask:0xf bank_mask:0xf
  s_waitcnt vmcnt(17)
  v_mfma_f32_16x16x32_bf16 v[38:41], v[156:159], v[46:49], v[38:41]
  v_mfma_f32_16x16x32_bf16 v[42:45], v[160:163], v[46:49], v[42:45]
  s_add_u32 s21, s21, 16384
  s_cmp_eq_u32 s21, s20
  s_cselect_b32 s21, 0, s21
  buffer_load_dwordx4 v[204:207], v5, s[48:51], s21 offen offset:0 nt
  buffer_load_dwordx4 v[208:211], v5, s[48:51], s21 offen offset:256 nt
  s_mov_b32 s96, 17920
  buffer_load_dwordx4 a[80:83], v6, s[56:59], s96 offen offset:0
  v_and_b32_dpp v46, v23, v8 row_newbcast:8 row_mask:0xf bank_mask:0xf
  v_and_b32_dpp v47, v23, v9 row_newbcast:8 row_mask:0xf bank_mask:0xf
  v_and_b32_dpp v48, v23, v10 row_newbcast:8 row_mask:0xf bank_mask:0xf
  v_and_b32_dpp v49, v23, v11 row_newbcast:8 row_mask:0xf bank_mask:0xf
  s_waitcnt vmcnt(17)
  v_mfma_f32_16x16x32_bf16 v[38:41], v[164:167], v[50:53], v[38:41]
  v_mfma_f32_16x16x32_bf16 v[42:45], v[168:171], v[50:53], v[42:45]
  buffer_load_dwordx4 v[212:215], v5, s[48:51], s21 offen offset:2048 nt
  buffer_load_dwordx4 v[216:219], v5, s[48:51], s21 offen offset:2304 nt
  s_mov_b32 s96, 17920
  buffer_load_dwordx4 a[84:87], v6, s[56:59], s96 offen offset:256
  v_and_b32_dpp v50, v23, v8 row_newbcast:12 row_mask:0xf bank_mask:0xf
  v_and_b32_dpp v51, v23, v9 row_newbcast:12 row_mask:0xf bank_mask:0xf
  v_and_b32_dpp v52, v23, v10 row_newbcast:12 row_mask:0xf bank_mask:0xf
  v_and_b32_dpp v53, v23, v11 row_newbcast:12 row_mask:0xf bank_mask:0xf
  s_waitcnt vmcnt(17)
  v_mfma_f32_16x16x32_bf16 v[38:41], v[172:175], v[46:49], v[38:41]
  v_mfma_f32_16x16x32_bf16 v[42:45], v[176:179], v[46:49], v[42:45]
  s_add_u32 s21, s21, 16384
  s_cmp_eq_u32 s21, s20
  s_cselect_b32 s21, 0, s21
  buffer_load_dwordx4 v[220:223], v5, s[48:51], s21 offen offset:0 nt
  buffer_load_dwordx4 v[224:227], v5, s[48:51], s21 offen offset:256 nt
  s_mov_b32 s96, 17920
  buffer_load_dwordx4 a[88:91], v6, s[56:59], s96 offen offset:512
  v_and_b32_dpp v46, v24, v8 row_newbcast:0 row_mask:0xf bank_mask:0xf
  v_and_b32_dpp v47, v24, v9 row_newbcast:0 row_mask:0xf bank_mask:0xf
  v_and_b32_dpp v48, v24, v10 row_newbcast:0 row_mask:0xf bank_mask:0xf
  v_and_b32_dpp v49, v24, v11 row_newbcast:0 row_mask:0xf bank_mask:0xf
  s_waitcnt vmcnt(17)
  v_mfma_f32_16x16x32_bf16 v[38:41], v[180:183], v[50:53], v[38:41]
  v_mfma_f32_16x16x32_bf16 v[42:45], v[184:187], v[50:53], v[42:45]
  buffer_load_dwordx4 v[228:231], v5, s[48:51], s21 offen offset:2048 nt
  buffer_load_dwordx4 v[232:235], v5, s[48:51], s21 offen offset:2304 nt
  s_mov_b32 s96, 17920
  buffer_load_dwordx4 a[92:95], v7, s[56:59], s96 offen offset:768
  s_mov_b32 s96, 21504
  buffer_load_dwordx4 a[96:99], v6, s[56:59], s96 offen offset:0
  v_and_b32_dpp v50, v24, v8 row_newbcast:4 row_mask:0xf bank_mask:0xf
  v_and_b32_dpp v51, v24, v9 row_newbcast:4 row_mask:0xf bank_mask:0xf
  v_and_b32_dpp v52, v24, v10 row_newbcast:4 row_mask:0xf bank_mask:0xf
  v_and_b32_dpp v53, v24, v11 row_newbcast:4 row_mask:0xf bank_mask:0xf
  s_waitcnt vmcnt(18)
  v_mfma_f32_16x16x32_bf16 v[38:41], v[188:191], v[46:49], v[38:41]
  v_mfma_f32_16x16x32_bf16 v[42:45], v[192:195], v[46:49], v[42:45]
  s_add_u32 s21, s21, 16384
  s_cmp_eq_u32 s21, s20
  s_cselect_b32 s21, 0, s21
  buffer_load_dwordx4 v[236:239], v5, s[48:51], s21 offen offset:0 nt
  buffer_load_dwordx4 v[240:243], v5, s[48:51], s21 offen offset:256 nt
  s_mov_b32 s96, 21504
  buffer_load_dwordx4 a[100:103], v6, s[56:59], s96 offen offset:256
  v_and_b32_dpp v46, v24, v8 row_newbcast:8 row_mask:0xf bank_mask:0xf
  v_and_b32_dpp v47, v24, v9 row_newbcast:8 row_mask:0xf bank_mask:0xf
  v_and_b32_dpp v48, v24, v10 row_newbcast:8 row_mask:0xf bank_mask:0xf
  v_and_b32_dpp v49, v24, v11 row_newbcast:8 row_mask:0xf bank_mask:0xf
  s_waitcnt vmcnt(17)
  v_mfma_f32_16x16x32_bf16 v[38:41], v[196:199], v[50:53], v[38:41]
  v_mfma_f32_16x16x32_bf16 v[42:45], v[200:203], v[50:53], v[42:45]
  buffer_load_dwordx4 v[244:247], v5, s[48:51], s21 offen offset:2048 nt
  buffer_load_dwordx4 v[248:251], v5, s[48:51], s21 offen offset:2304 nt
  s_mov_b32 s96, 21504
  buffer_load_dwordx4 a[104:107], v6, s[56:59], s96 offen offset:512
  v_and_b32_dpp v50, v24, v8 row_newbcast:12 row_mask:0xf bank_mask:0xf
  v_and_b32_dpp v51, v24, v9 row_newbcast:12 row_mask:0xf bank_mask:0xf
  v_and_b32_dpp v52, v24, v10 row_newbcast:12 row_mask:0xf bank_mask:0xf
  v_and_b32_dpp v53, v24, v11 row_newbcast:12 row_mask:0xf bank_mask:0xf
  s_waitcnt vmcnt(17)
  v_mfma_f32_16x16x32_bf16 v[38:41], v[204:207], v[46:49], v[38:41]
  v_mfma_f32_16x16x32_bf16 v[42:45], v[208:211], v[46:49], v[42:45]
  s_add_u32 s21, s21, 16384
  s_cmp_eq_u32 s21, s20
  s_cselect_b32 s21, 0, s21
  buffer_load_dwordx4 v[252:255], v5, s[48:51], s21 offen offset:0 nt
  buffer_load_dwordx4 v[96:99], v5, s[48:51], s21 offen offset:256 nt
  s_mov_b32 s96, 21504
  buffer_load_dwordx4 a[108:111], v7, s[56:59], s96 offen offset:768
  v_and_b32_dpp v46, v25, v8 row_newbcast:0 row_mask:0xf bank_mask:0xf
  v_and_b32_dpp v47, v25, v9 row_newbcast:0 row_mask:0xf bank_mask:0xf
  v_and_b32_dpp v48, v25, v10 row_newbcast:0 row_mask:0xf bank_mask:0xf
  v_and_b32_dpp v49, v25, v11 row_newbcast:0 row_mask:0xf bank_mask:0xf
  s_waitcnt vmcnt(17)
  v_mfma_f32_16x16x32_bf16 v[38:41], v[212:215], v[50:53], v[38:41]
  v_mfma_f32_16x16x32_bf16 v[42:45], v[216:219], v[50:53], v[42:45]
  buffer_load_dwordx4 v[100:103], v5, s[48:51], s21 offen offset:2048 nt
  buffer_load_dwordx4 v[104:107], v5, s[48:51], s21 offen offset:2304 nt
  s_mov_b32 s96, 25088
  buffer_load_dwordx4 a[112:115], v6, s[56:59], s96 offen offset:0
  v_and_b32_dpp v50, v25, v8 row_newbcast:4 row_mask:0xf bank_mask:0xf
  v_and_b32_dpp v51, v25, v9 row_newbcast:4 row_mask:0xf bank_mask:0xf
  v_and_b32_dpp v52, v25, v10 row_newbcast:4 row_mask:0xf bank_mask:0xf
  v_and_b32_dpp v53, v25, v11 row_newbcast:4 row_mask:0xf bank_mask:0xf
  s_waitcnt vmcnt(17)
  v_mfma_f32_16x16x32_bf16 v[38:41], v[220:223], v[46:49], v[38:41]
  v_mfma_f32_16x16x32_bf16 v[42:45], v[224:227], v[46:49], v[42:45]
  s_add_u32 s21, s21, 16384
  s_cmp_eq_u32 s21, s20
  s_cselect_b32 s21, 0, s21
  buffer_load_dwordx4 v[108:111], v5, s[48:51], s21 offen offset:0 nt
  buffer_load_dwordx4 v[112:115], v5, s[48:51], s21 offen offset:256 nt
  s_mov_b32 s96, 25088
  buffer_load_dwordx4 a[116:119], v6, s[56:59], s96 offen offset:256
  s_mov_b32 s96, 25088
  buffer_load_dwordx4 a[120:123], v6, s[56:59], s96 offen offset:512
  v_and_b32_dpp v46, v25, v8 row_newbcast:8 row_mask:0xf bank_mask:0xf
  v_and_b32_dpp v47, v25, v9 row_newbcast:8 row_mask:0xf bank_mask:0xf
  v_and_b32_dpp v48, v25, v10 row_newbcast:8 row_mask:0xf bank_mask:0xf
  v_and_b32_dpp v49, v25, v11 row_newbcast:8 row_mask:0xf bank_mask:0xf
  s_waitcnt vmcnt(18)
  v_mfma_f32_16x16x32_bf16 v[38:41], v[228:231], v[50:53], v[38:41]
  v_mfma_f32_16x16x32_bf16 v[42:45], v[232:235], v[50:53], v[42:45]
  buffer_load_dwordx4 v[116:119], v5, s[48:51], s21 offen offset:2048 nt
  buffer_load_dwordx4 v[120:123], v5, s[48:51], s21 offen offset:2304 nt
  s_mov_b32 s96, 25088
  buffer_load_dwordx4 a[124:127], v7, s[56:59], s96 offen offset:768
  v_and_b32_dpp v50, v25, v8 row_newbcast:12 row_mask:0xf bank_mask:0xf
  v_and_b32_dpp v51, v25, v9 row_newbcast:12 row_mask:0xf bank_mask:0xf
  v_and_b32_dpp v52, v25, v10 row_newbcast:12 row_mask:0xf bank_mask:0xf
  v_and_b32_dpp v53, v25, v11 row_newbcast:12 row_mask:0xf bank_mask:0xf
  s_waitcnt vmcnt(17)
  v_mfma_f32_16x16x32_bf16 v[38:41], v[236:239], v[46:49], v[38:41]
  v_mfma_f32_16x16x32_bf16 v[42:45], v[240:243], v[46:49], v[42:45]
  s_add_u32 s21, s21, 16384
  s_cmp_eq_u32 s21, s20
  s_cselect_b32 s21, 0, s21
  buffer_load_dwordx4 v[124:127], v5, s[48:51], s21 offen offset:0 nt
  buffer_load_dwordx4 v[128:131], v5, s[48:51], s21 offen offset:256 nt
  s_mov_b32 s96, 28672
  buffer_load_dwordx4 a[128:131], v6, s[56:59], s96 offen offset:0
  v_and_b32_dpp v46, v26, v8 row_newbcast:0 row_mask:0xf bank_mask:0xf
  v_and_b32_dpp v47, v26, v9 row_newbcast:0 row_mask:0xf bank_mask:0xf
  v_and_b32_dpp v48, v26, v10 row_newbcast:0 row_mask:0xf bank_mask:0xf
  v_and_b32_dpp v49, v26, v11 row_newbcast:0 row_mask:0xf bank_mask:0xf
  s_waitcnt vmcnt(17)
  v_mfma_f32_16x16x32_bf16 v[38:41], v[244:247], v[50:53], v[38:41]
  v_mfma_f32_16x16x32_bf16 v[42:45], v[248:251], v[50:53], v[42:45]
  buffer_load_dwordx4 v[132:135], v5, s[48:51], s21 offen offset:2048 nt
  buffer_load_dwordx4 v[136:139], v5, s[48:51], s21 offen offset:2304 nt
  s_mov_b32 s96, 28672
  buffer_load_dwordx4 a[132:135], v6, s[56:59], s96 offen offset:256
  v_and_b32_dpp v50, v26, v8 row_newbcast:4 row_mask:0xf bank_mask:0xf
  v_and_b32_dpp v51, v26, v9 row_newbcast:4 row_mask:0xf bank_mask:0xf
  v_and_b32_dpp v52, v26, v10 row_newbcast:4 row_mask:0xf bank_mask:0xf
  v_and_b32_dpp v53, v26, v11 row_newbcast:4 row_mask:0xf bank_mask:0xf
  s_waitcnt vmcnt(17)
  v_mfma_f32_16x16x32_bf16 v[38:41], v[252:255], v[46:49], v[38:41]
  v_mfma_f32_16x16x32_bf16 v[42:45], v[96:99], v[46:49], v[42:45]
  s_add_u32 s21, s21, 16384
  s_cmp_eq_u32 s21, s20
  s_cselect_b32 s21, 0, s21
  buffer_load_dwordx4 v[140:143], v5, s[48:51], s21 offen offset:0 nt
  buffer_load_dwordx4 v[144:147], v5, s[48:51], s21 offen offset:256 nt
  s_mov_b32 s96, 28672
  buffer_load_dwordx4 a[136:139], v6, s[56:59], s96 offen offset:512
  s_mov_b32 s96, 28672
  buffer_load_dwordx4 a[140:143], v7, s[56:59], s96 offen offset:768
  v_and_b32_dpp v46, v26, v8 row_newbcast:8 row_mask:0xf bank_mask:0xf
  v_and_b32_dpp v47, v26, v9 row_newbcast:8 row_mask:0xf bank_mask:0xf
  v_and_b32_dpp v48, v26, v10 row_newbcast:8 row_mask:0xf bank_mask:0xf
  v_and_b32_dpp v49, v26, v11 row_newbcast:8 row_mask:0xf bank_mask:0xf
  s_waitcnt vmcnt(18)
  v_mfma_f32_16x16x32_bf16 v[38:41], v[100:103], v[50:53], v[38:41]
  v_mfma_f32_16x16x32_bf16 v[42:45], v[104:107], v[50:53], v[42:45]
  buffer_load_dwordx4 v[148:151], v5, s[48:51], s21 offen offset:2048 nt
  buffer_load_dwordx4 v[152:155], v5, s[48:51], s21 offen offset:2304 nt
  s_mov_b32 s96, 32256
  buffer_load_dwordx4 a[144:147], v6, s[56:59], s96 offen offset:0
  v_and_b32_dpp v50, v26, v8 row_newbcast:12 row_mask:0xf bank_mask:0xf
  v_and_b32_dpp v51, v26, v9 row_newbcast:12 row_mask:0xf bank_mask:0xf
  v_and_b32_dpp v52, v26, v10 row_newbcast:12 row_mask:0xf bank_mask:0xf
  v_and_b32_dpp v53, v26, v11 row_newbcast:12 row_mask:0xf bank_mask:0xf
  s_waitcnt vmcnt(18)
  v_mfma_f32_16x16x32_bf16 v[38:41], v[108:111], v[46:49], v[38:41]
  v_mfma_f32_16x16x32_bf16 v[42:45], v[112:115], v[46:49], v[42:45]
  s_add_u32 s21, s21, 16384
  s_cmp_eq_u32 s21, s20
  s_cselect_b32 s21, 0, s21
  buffer_load_dwordx4 v[156:159], v5, s[48:51], s21 offen offset:0 nt
  buffer_load_dwordx4 v[160:163], v5, s[48:51], s21 offen offset:256 nt
  s_mov_b32 s96, 32256
  buffer_load_dwordx4 a[148:151], v6, s[56:59], s96 offen offset:256
  v_and_b32_dpp v46, v27, v8 row_newbcast:0 row_mask:0xf bank_mask:0xf
  v_and_b32_dpp v47, v27, v9 row_newbcast:0 row_mask:0xf bank_mask:0xf
  v_and_b32_dpp v48, v27, v10 row_newbcast:0 row_mask:0xf bank_mask:0xf
  v_and_b32_dpp v49, v27, v11 row_newbcast:0 row_mask:0xf bank_mask:0xf
  s_waitcnt vmcnt(17)
  v_mfma_f32_16x16x32_bf16 v[38:41], v[116:119], v[50:53], v[38:41]
  v_mfma_f32_16x16x32_bf16 v[42:45], v[120:123], v[50:53], v[42:45]
  buffer_load_dwordx4 v[164:167], v5, s[48:51], s21 offen offset:2048 nt
  buffer_load_dwordx4 v[168:171], v5, s[48:51], s21 offen offset:2304 nt
  s_mov_b32 s96, 32256
  buffer_load_dwordx4 a[152:155], v6, s[56:59], s96 offen offset:512
  v_and_b32_dpp v50, v27, v8 row_newbcast:4 row_mask:0xf bank_mask:0xf
  v_and_b32_dpp v51, v27, v9 row_newbcast:4 row_mask:0xf bank_mask:0xf
  v_and_b32_dpp v52, v27, v10 row_newbcast:4 row_mask:0xf bank_mask:0xf
  v_and_b32_dpp v53, v27, v11 row_newbcast:4 row_mask:0xf bank_mask:0xf
  s_waitcnt vmcnt(17)
  v_mfma_f32_16x16x32_bf16 v[38:41], v[124:127], v[46:49], v[38:41]
  v_mfma_f32_16x16x32_bf16 v[42:45], v[128:131], v[46:49], v[42:45]
  s_add_u32 s21, s21, 16384
  s_cmp_eq_u32 s21, s20
  s_cselect_b32 s21, 0, s21
  buffer_load_dwordx4 v[172:175], v5, s[48:51], s21 offen offset:0 nt
  buffer_load_dwordx4 v[176:179], v5, s[48:51], s21 offen offset:256 nt
  s_mov_b32 s96, 32256
  buffer_load_dwordx4 a[156:159], v7, s[56:59], s96 offen offset:768
  v_and_b32_dpp v46, v27, v8 row_newbcast:8 row_mask:0xf bank_mask:0xf
  v_and_b32_dpp v47, v27, v9 row_newbcast:8 row_mask:0xf bank_mask:0xf
  v_and_b32_dpp v48, v27, v10 row_newbcast:8 row_mask:0xf bank_mask:0xf
  v_and_b32_dpp v49, v27, v11 row_newbcast:8 row_mask:0xf bank_mask:0xf
  s_waitcnt vmcnt(17)
  v_mfma_f32_16x16x32_bf16 v[38:41], v[132:135], v[50:53], v[38:41]
  v_mfma_f32_16x16x32_bf16 v[42:45], v[136:139], v[50:53], v[42:45]
  buffer_load_dwordx4 v[180:183], v5, s[48:51], s21 offen offset:2048 nt
  buffer_load_dwordx4 v[184:187], v5, s[48:51], s21 offen offset:2304 nt
  s_mov_b32 s96, 35840
  buffer_load_dwordx4 a[160:163], v6, s[56:59], s96 offen offset:0
  s_mov_b32 s96, 35840
  buffer_load_dwordx4 a[164:167], v6, s[56:59], s96 offen offset:256
  v_and_b32_dpp v50, v27, v8 row_newbcast:12 row_mask:0xf bank_mask:0xf
  v_and_b32_dpp v51, v27, v9 row_newbcast:12 row_mask:0xf bank_mask:0xf
  v_and_b32_dpp v52, v27, v10 row_newbcast:12 row_mask:0xf bank_mask:0xf
  v_and_b32_dpp v53, v27, v11 row_newbcast:12 row_mask:0xf bank_mask:0xf
  s_waitcnt vmcnt(18)
  v_mfma_f32_16x16x32_bf16 v[38:41], v[140:143], v[46:49], v[38:41]
  v_mfma_f32_16x16x32_bf16 v[42:45], v[144:147], v[46:49], v[42:45]
  s_add_u32 s21, s21, 16384
  s_cmp_eq_u32 s21, s20
  s_cselect_b32 s21, 0, s21
  buffer_load_dwordx4 v[188:191], v5, s[48:51], s21 offen offset:0 nt
  buffer_load_dwordx4 v[192:195], v5, s[48:51], s21 offen offset:256 nt
  s_mov_b32 s96, 35840
  buffer_load_dwordx4 a[168:171], v6, s[56:59], s96 offen offset:512
  v_and_b32_dpp v46, v28, v8 row_newbcast:0 row_mask:0xf bank_mask:0xf
  v_and_b32_dpp v47, v28, v9 row_newbcast:0 row_mask:0xf bank_mask:0xf
  v_and_b32_dpp v48, v28, v10 row_newbcast:0 row_mask:0xf bank_mask:0xf
  v_and_b32_dpp v49, v28, v11 row_newbcast:0 row_mask:0xf bank_mask:0xf
  s_waitcnt vmcnt(17)
  v_mfma_f32_16x16x32_bf16 v[38:41], v[148:151], v[50:53], v[38:41]
  v_mfma_f32_16x16x32_bf16 v[42:45], v[152:155], v[50:53], v[42:45]
  buffer_load_dwordx4 v[196:199], v5, s[48:51], s21 offen offset:2048 nt
  buffer_load_dwordx4 v[200:203], v5, s[48:51], s21 offen offset:2304 nt
  s_mov_b32 s96, 35840
  buffer_load_dwordx4 a[172:175], v7, s[56:59], s96 offen offset:768
  v_and_b32_dpp v50, v28, v8 row_newbcast:4 row_mask:0xf bank_mask:0xf
  v_and_b32_dpp v51, v28, v9 row_newbcast:4 row_mask:0xf bank_mask:0xf
  v_and_b32_dpp v52, v28, v10 row_newbcast:4 row_mask:0xf bank_mask:0xf
  v_and_b32_dpp v53, v28, v11 row_newbcast:4 row_mask:0xf bank_mask:0xf
  s_waitcnt vmcnt(17)
  v_mfma_f32_16x16x32_bf16 v[38:41], v[156:159], v[46:49], v[38:41]
  v_mfma_f32_16x16x32_bf16 v[42:45], v[160:163], v[46:49], v[42:45]
  s_add_u32 s21, s21, 16384
  s_cmp_eq_u32 s21, s20
  s_cselect_b32 s21, 0, s21
  buffer_load_dwordx4 v[204:207], v5, s[48:51], s21 offen offset:0 nt
  buffer_load_dwordx4 v[208:211], v5, s[48:51], s21 offen offset:256 nt
  s_mov_b32 s96, 39424
  buffer_load_dwordx4 a[176:179], v6, s[56:59], s96 offen offset:0
  v_and_b32_dpp v46, v28, v8 row_newbcast:8 row_mask:0xf bank_mask:0xf
  v_and_b32_dpp v47, v28, v9 row_newbcast:8 row_mask:0xf bank_mask:0xf
  v_and_b32_dpp v48, v28, v10 row_newbcast:8 row_mask:0xf bank_mask:0xf
  v_and_b32_dpp v49, v28, v11 row_newbcast:8 row_mask:0xf bank_mask:0xf
  s_waitcnt vmcnt(17)
  v_mfma_f32_16x16x32_bf16 v[38:41], v[164:167], v[50:53], v[38:41]
  v_mfma_f32_16x16x32_bf16 v[42:45], v[168:171], v[50:53], v[42:45]
  buffer_load_dwordx4 v[212:215], v5, s[48:51], s21 offen offset:2048 nt
  buffer_load_dwordx4 v[216:219], v5, s[48:51], s21 offen offset:2304 nt
  s_mov_b32 s96, 39424
  buffer_load_dwordx4 a[180:183], v6, s[56:59], s96 offen offset:256
  v_and_b32_dpp v50, v28, v8 row_newbcast:12 row_mask:0xf bank_mask:0xf
  v_and_b32_dpp v51, v28, v9 row_newbcast:12 row_mask:0xf bank_mask:0xf
  v_and_b32_dpp v52, v28, v10 row_newbcast:12 row_mask:0xf bank_mask:0xf
  v_and_b32_dpp v53, v28, v11 row_newbcast:12 row_mask:0xf bank_mask:0xf
  s_waitcnt vmcnt(17)
  v_mfma_f32_16x16x32_bf16 v[38:41], v[172:175], v[46:49], v[38:41]
  v_mfma_f32_16x16x32_bf16 v[42:45], v[176:179], v[46:49], v[42:45]
  s_add_u32 s21, s21, 16384
  s_cmp_eq_u32 s21, s20
  s_cselect_b32 s21, 0, s21
  buffer_load_dwordx4 v[220:223], v5, s[48:51], s21 offen offset:0 nt
  buffer_load_dwordx4 v[224:227], v5, s[48:51], s21 offen offset:256 nt
  s_mov_b32 s96, 39424
  buffer_load_dwordx4 a[184:187], v6, s[56:59], s96 offen offset:512
  s_mov_b32 s96, 39424
  buffer_load_dwordx4 a[188:191], v7, s[56:59], s96 offen offset:768
  v_and_b32_dpp v46, v29, v8 row_newbcast:0 row_mask:0xf bank_mask:0xf
  v_and_b32_dpp v47, v29, v9 row_newbcast:0 row_mask:0xf bank_mask:0xf
  v_and_b32_dpp v48, v29, v10 row_newbcast:0 row_mask:0xf bank_mask:0xf
  v_and_b32_dpp v49, v29, v11 row_newbcast:0 row_mask:0xf bank_mask:0xf
  s_waitcnt vmcnt(18)
  v_mfma_f32_16x16x32_bf16 v[38:41], v[180:183], v[50:53], v[38:41]
  v_mfma_f32_16x16x32_bf16 v[42:45], v[184:187], v[50:53], v[42:45]
  buffer_load_dwordx4 v[228:231], v5, s[48:51], s21 offen offset:2048 nt
  buffer_load_dwordx4 v[232:235], v5, s[48:51], s21 offen offset:2304 nt
  s_mov_b32 s96, 43008
  buffer_load_dwordx4 a[192:195], v6, s[56:59], s96 offen offset:0
  v_and_b32_dpp v50, v29, v8 row_newbcast:4 row_mask:0xf bank_mask:0xf
  v_and_b32_dpp v51, v29, v9 row_newbcast:4 row_mask:0xf bank_mask:0xf
  v_and_b32_dpp v52, v29, v10 row_newbcast:4 row_mask:0xf bank_mask:0xf
  v_and_b32_dpp v53, v29, v11 row_newbcast:4 row_mask:0xf bank_mask:0xf
  s_waitcnt vmcnt(17)
  v_mfma_f32_16x16x32_bf16 v[38:41], v[188:191], v[46:49], v[38:41]
  v_mfma_f32_16x16x32_bf16 v[42:45], v[192:195], v[46:49], v[42:45]
  s_add_u32 s21, s21, 16384
  s_cmp_eq_u32 s21, s20
  s_cselect_b32 s21, 0, s21
  buffer_load_dwordx4 v[236:239], v5, s[48:51], s21 offen offset:0 nt
  buffer_load_dwordx4 v[240:243], v5, s[48:51], s21 offen offset:256 nt
  s_mov_b32 s96, 43008
  buffer_load_dwordx4 a[196:199], v6, s[56:59], s96 offen offset:256
  v_and_b32_dpp v46, v29, v8 row_newbcast:8 row_mask:0xf bank_mask:0xf
  v_and_b32_dpp v47, v29, v9 row_newbcast:8 row_mask:0xf bank_mask:0xf
  v_and_b32_dpp v48, v29, v10 row_newbcast:8 row_mask:0xf bank_mask:0xf
  v_and_b32_dpp v49, v29, v11 row_newbcast:8 row_mask:0xf bank_mask:0xf
  s_waitcnt vmcnt(17)
  v_mfma_f32_16x16x32_bf16 v[38:41], v[196:199], v[50:53], v[38:41]
  v_mfma_f32_16x16x32_bf16 v[42:45], v[200:203], v[50:53], v[42:45]
  buffer_load_dwordx4 v[244:247], v5, s[48:51], s21 offen offset:2048 nt
  buffer_load_dwordx4 v[248:251], v5, s[48:51], s21 offen offset:2304 nt
  s_mov_b32 s96, 43008
  buffer_load_dwordx4 a[200:203], v6, s[56:59], s96 offen offset:512
  v_and_b32_dpp v50, v29, v8 row_newbcast:12 row_mask:0xf bank_mask:0xf
  v_and_b32_dpp v51, v29, v9 row_newbcast:12 row_mask:0xf bank_mask:0xf
  v_and_b32_dpp v52, v29, v10 row_newbcast:12 row_mask:0xf bank_mask:0xf
  v_and_b32_dpp v53, v29, v11 row_newbcast:12 row_mask:0xf bank_mask:0xf
  s_waitcnt vmcnt(17)
  v_mfma_f32_16x16x32_bf16 v[38:41], v[204:207], v[46:49], v[38:41]
  v_mfma_f32_16x16x32_bf16 v[42:45], v[208:211], v[46:49], v[42:45]
  s_add_u32 s21, s21, 16384
  s_cmp_eq_u32 s21, s20
  s_cselect_b32 s21, 0, s21
  buffer_load_dwordx4 v[252:255], v5, s[48:51], s21 offen offset:0 nt
  buffer_load_dwordx4 v[96:99], v5, s[48:51], s21 offen offset:256 nt
  s_mov_b32 s96, 43008
  buffer_load_dwordx4 a[204:207], v7, s[56:59], s96 offen offset:768
  v_and_b32_dpp v46, v30, v8 row_newbcast:0 row_mask:0xf bank_mask:0xf
  v_and_b32_dpp v47, v30, v9 row_newbcast:0 row_mask:0xf bank_mask:0xf
  v_and_b32_dpp v48, v30, v10 row_newbcast:0 row_mask:0xf bank_mask:0xf
  v_and_b32_dpp v49, v30, v11 row_newbcast:0 row_mask:0xf bank_mask:0xf
  s_waitcnt vmcnt(17)
  v_mfma_f32_16x16x32_bf16 v[38:41], v[212:215], v[50:53], v[38:41]
  v_mfma_f32_16x16x32_bf16 v[42:45], v[216:219], v[50:53], v[42:45]
  buffer_load_dwordx4 v[100:103], v5, s[48:51], s21 offen offset:2048 nt
  buffer_load_dwordx4 v[104:107], v5, s[48:51], s21 offen offset:2304 nt
  s_mov_b32 s96, 46592
  buffer_load_dwordx4 a[208:211], v6, s[56:59], s96 offen offset:0
  s_mov_b32 s96, 46592
  buffer_load_dwordx4 a[212:215], v6, s[56:59], s96 offen offset:256
  v_and_b32_dpp v50, v30, v8 row_newbcast:4 row_mask:0xf bank_mask:0xf
  v_and_b32_dpp v51, v30, v9 row_newbcast:4 row_mask:0xf bank_mask:0xf
  v_and_b32_dpp v52, v30, v10 row_newbcast:4 row_mask:0xf bank_mask:0xf
  v_and_b32_dpp v53, v30, v11 row_newbcast:4 row_mask:0xf bank_mask:0xf
  s_waitcnt vmcnt(18)
  v_mfma_f32_16x16x32_bf16 v[38:41], v[220:223], v[46:49], v[38:41]
  v_mfma_f32_16x16x32_bf16 v[42:45], v[224:227], v[46:49], v[42:45]
  s_add_u32 s21, s21, 16384
  s_cmp_eq_u32 s21, s20
  s_cselect_b32 s21, 0, s21
  buffer_load_dwordx4 v[108:111], v5, s[48:51], s21 offen offset:0 nt
  buffer_load_dwordx4 v[112:115], v5, s[48:51], s21 offen offset:256 nt
  s_mov_b32 s96, 46592
  buffer_load_dwordx4 a[216:219], v6, s[56:59], s96 offen offset:512
  v_and_b32_dpp v46, v30, v8 row_newbcast:8 row_mask:0xf bank_mask:0xf
  v_and_b32_dpp v47, v30, v9 row_newbcast:8 row_mask:0xf bank_mask:0xf
  v_and_b32_dpp v48, v30, v10 row_newbcast:8 row_mask:0xf bank_mask:0xf
  v_and_b32_dpp v49, v30, v11 row_newbcast:8 row_mask:0xf bank_mask:0xf
  s_waitcnt vmcnt(17)
  v_mfma_f32_16x16x32_bf16 v[38:41], v[228:231], v[50:53], v[38:41]
  v_mfma_f32_16x16x32_bf16 v[42:45], v[232:235], v[50:53], v[42:45]
  buffer_load_dwordx4 v[116:119], v5, s[48:51], s21 offen offset:2048 nt
  buffer_load_dwordx4 v[120:123], v5, s[48:51], s21 offen offset:2304 nt
  s_mov_b32 s96, 46592
  buffer_load_dwordx4 a[220:223], v7, s[56:59], s96 offen offset:768
  v_and_b32_dpp v50, v30, v8 row_newbcast:12 row_mask:0xf bank_mask:0xf
  v_and_b32_dpp v51, v30, v9 row_newbcast:12 row_mask:0xf bank_mask:0xf
  v_and_b32_dpp v52, v30, v10 row_newbcast:12 row_mask:0xf bank_mask:0xf
  v_and_b32_dpp v53, v30, v11 row_newbcast:12 row_mask:0xf bank_mask:0xf
  s_waitcnt vmcnt(17)
  v_mfma_f32_16x16x32_bf16 v[38:41], v[236:239], v[46:49], v[38:41]
  v_mfma_f32_16x16x32_bf16 v[42:45], v[240:243], v[46:49], v[42:45]
  s_add_u32 s21, s21, 16384
  s_cmp_eq_u32 s21, s20
  s_cselect_b32 s21, 0, s21
  buffer_load_dwordx4 v[124:127], v5, s[48:51], s21 offen offset:0 nt
  buffer_load_dwordx4 v[128:131], v5, s[48:51], s21 offen offset:256 nt
  s_mov_b32 s96, 50176
  buffer_load_dwordx4 a[224:227], v6, s[56:59], s96 offen offset:0
  v_and_b32_dpp v46, v31, v8 row_newbcast:0 row_mask:0xf bank_mask:0xf
  v_and_b32_dpp v47, v31, v9 row_newbcast:0 row_mask:0xf bank_mask:0xf
  v_and_b32_dpp v48, v31, v10 row_newbcast:0 row_mask:0xf bank_mask:0xf
  v_and_b32_dpp v49, v31, v11 row_newbcast:0 row_mask:0xf bank_mask:0xf
  s_waitcnt vmcnt(17)
  v_mfma_f32_16x16x32_bf16 v[38:41], v[244:247], v[50:53], v[38:41]
  v_mfma_f32_16x16x32_bf16 v[42:45], v[248:251], v[50:53], v[42:45]
  buffer_load_dwordx4 v[132:135], v5, s[48:51], s21 offen offset:2048 nt
  buffer_load_dwordx4 v[136:139], v5, s[48:51], s21 offen offset:2304 nt
  s_mov_b32 s96, 50176
  buffer_load_dwordx4 a[228:231], v6, s[56:59], s96 offen offset:256
  v_and_b32_dpp v50, v31, v8 row_newbcast:4 row_mask:0xf bank_mask:0xf
  v_and_b32_dpp v51, v31, v9 row_newbcast:4 row_mask:0xf bank_mask:0xf
  v_and_b32_dpp v52, v31, v10 row_newbcast:4 row_mask:0xf bank_mask:0xf
  v_and_b32_dpp v53, v31, v11 row_newbcast:4 row_mask:0xf bank_mask:0xf
  s_waitcnt vmcnt(17)
  v_mfma_f32_16x16x32_bf16 v[38:41], v[252:255], v[46:49], v[38:41]
  v_mfma_f32_16x16x32_bf16 v[42:45], v[96:99], v[46:49], v[42:45]
  s_add_u32 s21, s21, 16384
  s_cmp_eq_u32 s21, s20
  s_cselect_b32 s21, 0, s21
  buffer_load_dwordx4 v[140:143], v5, s[48:51], s21 offen offset:0 nt
  buffer_load_dwordx4 v[144:147], v5, s[48:51], s21 offen offset:256 nt
  s_mov_b32 s96, 50176
  buffer_load_dwordx4 a[232:235], v6, s[56:59], s96 offen offset:512
  s_mov_b32 s96, 50176
  buffer_load_dwordx4 a[236:239], v7, s[56:59], s96 offen offset:768
  v_and_b32_dpp v46, v31, v8 row_newbcast:8 row_mask:0xf bank_mask:0xf
  v_and_b32_dpp v47, v31, v9 row_newbcast:8 row_mask:0xf bank_mask:0xf
  v_and_b32_dpp v48, v31, v10 row_newbcast:8 row_mask:0xf bank_mask:0xf
  v_and_b32_dpp v49, v31, v11 row_newbcast:8 row_mask:0xf bank_mask:0xf
  s_waitcnt vmcnt(18)
  v_mfma_f32_16x16x32_bf16 v[38:41], v[100:103], v[50:53], v[38:41]
  v_mfma_f32_16x16x32_bf16 v[42:45], v[104:107], v[50:53], v[42:45]
  buffer_load_dwordx4 v[148:151], v5, s[48:51], s21 offen offset:2048 nt
  buffer_load_dwordx4 v[152:155], v5, s[48:51], s21 offen offset:2304 nt
  s_mov_b32 s96, 53760
  buffer_load_dwordx4 a[240:243], v6, s[56:59], s96 offen offset:0
  v_and_b32_dpp v50, v31, v8 row_newbcast:12 row_mask:0xf bank_mask:0xf
  v_and_b32_dpp v51, v31, v9 row_newbcast:12 row_mask:0xf bank_mask:0xf
  v_and_b32_dpp v52, v31, v10 row_newbcast:12 row_mask:0xf bank_mask:0xf
  v_and_b32_dpp v53, v31, v11 row_newbcast:12 row_mask:0xf bank_mask:0xf
  s_waitcnt vmcnt(17)
  v_mfma_f32_16x16x32_bf16 v[38:41], v[108:111], v[46:49], v[38:41]
  v_mfma_f32_16x16x32_bf16 v[42:45], v[112:115], v[46:49], v[42:45]
  s_add_u32 s21, s21, 16384
  s_cmp_eq_u32 s21, s20
  s_cselect_b32 s21, 0, s21
  buffer_load_dwordx4 v[156:159], v5, s[48:51], s21 offen offset:0 nt
  buffer_load_dwordx4 v[160:163], v5, s[48:51], s21 offen offset:256 nt
  s_mov_b32 s96, 53760
  buffer_load_dwordx4 a[244:247], v6, s[56:59], s96 offen offset:256
  v_and_b32_dpp v46, v32, v8 row_newbcast:0 row_mask:0xf bank_mask:0xf
  v_and_b32_dpp v47, v32, v9 row_newbcast:0 row_mask:0xf bank_mask:0xf
  v_and_b32_dpp v48, v32, v10 row_newbcast:0 row_mask:0xf bank_mask:0xf
  v_and_b32_dpp v49, v32, v11 row_newbcast:0 row_mask:0xf bank_mask:0xf
  s_waitcnt vmcnt(17)
  v_mfma_f32_16x16x32_bf16 v[38:41], v[116:119], v[50:53], v[38:41]
  v_mfma_f32_16x16x32_bf16 v[42:45], v[120:123], v[50:53], v[42:45]
  buffer_load_dwordx4 v[164:167], v5, s[48:51], s21 offen offset:2048 nt
  buffer_load_dwordx4 v[168:171], v5, s[48:51], s21 offen offset:2304 nt
  s_mov_b32 s96, 53760
  buffer_load_dwordx4 a[248:251], v6, s[56:59], s96 offen offset:512
  v_and_b32_dpp v50, v32, v8 row_newbcast:4 row_mask:0xf bank_mask:0xf
  v_and_b32_dpp v51, v32, v9 row_newbcast:4 row_mask:0xf bank_mask:0xf
  v_and_b32_dpp v52, v32, v10 row_newbcast:4 row_mask:0xf bank_mask:0xf
  v_and_b32_dpp v53, v32, v11 row_newbcast:4 row_mask:0xf bank_mask:0xf
  s_waitcnt vmcnt(17)
  v_mfma_f32_16x16x32_bf16 v[38:41], v[124:127], v[46:49], v[38:41]
  v_mfma_f32_16x16x32_bf16 v[42:45], v[128:131], v[46:49], v[42:45]
  s_add_u32 s21, s21, 16384
  s_cmp_eq_u32 s21, s20
  s_cselect_b32 s21, 0, s21
  buffer_load_dwordx4 v[172:175], v5, s[48:51], s21 offen offset:0 nt
  buffer_load_dwordx4 v[176:179], v5, s[48:51], s21 offen offset:256 nt
  s_mov_b32 s96, 53760
  buffer_load_dwordx4 a[252:255], v7, s[56:59], s96 offen offset:768
  v_and_b32_dpp v46, v32, v8 row_newbcast:8 row_mask:0xf bank_mask:0xf
  v_and_b32_dpp v47, v32, v9 row_newbcast:8 row_mask:0xf bank_mask:0xf
  v_and_b32_dpp v48, v32, v10 row_newbcast:8 row_mask:0xf bank_mask:0xf
  v_and_b32_dpp v49, v32, v11 row_newbcast:8 row_mask:0xf bank_mask:0xf
  s_waitcnt vmcnt(17)
  v_mfma_f32_16x16x32_bf16 v[38:41], v[132:135], v[50:53], v[38:41]
  v_mfma_f32_16x16x32_bf16 v[42:45], v[136:139], v[50:53], v[42:45]
  buffer_load_dwordx4 v[180:183], v5, s[48:51], s21 offen offset:2048 nt
  buffer_load_dwordx4 v[184:187], v5, s[48:51], s21 offen offset:2304 nt
  v_and_b32_dpp v50, v32, v8 row_newbcast:12 row_mask:0xf bank_mask:0xf
  v_and_b32_dpp v51, v32, v9 row_newbcast:12 row_mask:0xf bank_mask:0xf
  v_and_b32_dpp v52, v32, v10 row_newbcast:12 row_mask:0xf bank_mask:0xf
  v_and_b32_dpp v53, v32, v11 row_newbcast:12 row_mask:0xf bank_mask:0xf
  s_waitcnt vmcnt(16)
  v_mfma_f32_16x16x32_bf16 v[38:41], v[140:143], v[46:49], v[38:41]
  v_mfma_f32_16x16x32_bf16 v[42:45], v[144:147], v[46:49], v[42:45]
  s_add_u32 s21, s21, 16384
  s_cmp_eq_u32 s21, s20
  s_cselect_b32 s21, 0, s21
  buffer_load_dwordx4 v[188:191], v5, s[48:51], s21 offen offset:0 nt
  buffer_load_dwordx4 v[192:195], v5, s[48:51], s21 offen offset:256 nt
  v_and_b32_dpp v46, v33, v8 row_newbcast:0 row_mask:0xf bank_mask:0xf
  v_and_b32_dpp v47, v33, v9 row_newbcast:0 row_mask:0xf bank_mask:0xf
  v_and_b32_dpp v48, v33, v10 row_newbcast:0 row_mask:0xf bank_mask:0xf
  v_and_b32_dpp v49, v33, v11 row_newbcast:0 row_mask:0xf bank_mask:0xf
  s_waitcnt vmcnt(14)
  v_mfma_f32_16x16x32_bf16 v[38:41], v[148:151], v[50:53], v[38:41]
  v_mfma_f32_16x16x32_bf16 v[42:45], v[152:155], v[50:53], v[42:45]
  buffer_load_dwordx4 v[196:199], v5, s[48:51], s21 offen offset:2048 nt
  buffer_load_dwordx4 v[200:203], v5, s[48:51], s21 offen offset:2304 nt
  v_and_b32_dpp v50, v33, v8 row_newbcast:4 row_mask:0xf bank_mask:0xf
  v_and_b32_dpp v51, v33, v9 row_newbcast:4 row_mask:0xf bank_mask:0xf
  v_and_b32_dpp v52, v33, v10 row_newbcast:4 row_mask:0xf bank_mask:0xf
  v_and_b32_dpp v53, v33, v11 row_newbcast:4 row_mask:0xf bank_mask:0xf
  s_waitcnt vmcnt(13)
  v_mfma_f32_16x16x32_bf16 v[38:41], v[156:159], v[46:49], v[38:41]
  v_mfma_f32_16x16x32_bf16 v[42:45], v[160:163], v[46:49], v[42:45]
  s_add_u32 s21, s21, 16384
  s_cmp_eq_u32 s21, s20
  s_cselect_b32 s21, 0, s21
  buffer_load_dwordx4 v[204:207], v5, s[48:51], s21 offen offset:0 nt
  buffer_load_dwordx4 v[208:211], v5, s[48:51], s21 offen offset:256 nt
  v_and_b32_dpp v46, v33, v8 row_newbcast:8 row_mask:0xf bank_mask:0xf
  v_and_b32_dpp v47, v33, v9 row_newbcast:8 row_mask:0xf bank_mask:0xf
  v_and_b32_dpp v48, v33, v10 row_newbcast:8 row_mask:0xf bank_mask:0xf
  v_and_b32_dpp v49, v33, v11 row_newbcast:8 row_mask:0xf bank_mask:0xf
  s_waitcnt vmcnt(12)
  v_mfma_f32_16x16x32_bf16 v[38:41], v[164:167], v[50:53], v[38:41]
  v_mfma_f32_16x16x32_bf16 v[42:45], v[168:171], v[50:53], v[42:45]
  buffer_load_dwordx4 v[212:215], v5, s[48:51], s21 offen offset:2048 nt
  buffer_load_dwordx4 v[216:219], v5, s[48:51], s21 offen offset:2304 nt
  v_and_b32_dpp v50, v33, v8 row_newbcast:12 row_mask:0xf bank_mask:0xf
  v_and_b32_dpp v51, v33, v9 row_newbcast:12 row_mask:0xf bank_mask:0xf
  v_and_b32_dpp v52, v33, v10 row_newbcast:12 row_mask:0xf bank_mask:0xf
  v_and_b32_dpp v53, v33, v11 row_newbcast:12 row_mask:0xf bank_mask:0xf
  s_waitcnt vmcnt(11)
  v_mfma_f32_16x16x32_bf16 v[38:41], v[172:175], v[46:49], v[38:41]
  v_mfma_f32_16x16x32_bf16 v[42:45], v[176:179], v[46:49], v[42:45]
  s_add_u32 s21, s21, 16384
  s_cmp_eq_u32 s21, s20
  s_cselect_b32 s21, 0, s21
  buffer_load_dwordx4 v[220:223], v5, s[48:51], s21 offen offset:0 nt
  buffer_load_dwordx4 v[224:227], v5, s[48:51], s21 offen offset:256 nt
  v_and_b32_dpp v46, v34, v8 row_newbcast:0 row_mask:0xf bank_mask:0xf
  v_and_b32_dpp v47, v34, v9 row_newbcast:0 row_mask:0xf bank_mask:0xf
  v_and_b32_dpp v48, v34, v10 row_newbcast:0 row_mask:0xf bank_mask:0xf
  v_and_b32_dpp v49, v34, v11 row_newbcast:0 row_mask:0xf bank_mask:0xf
  s_waitcnt vmcnt(10)
  v_mfma_f32_16x16x32_bf16 v[38:41], v[180:183], v[50:53], v[38:41]
  v_mfma_f32_16x16x32_bf16 v[42:45], v[184:187], v[50:53], v[42:45]
  buffer_load_dwordx4 v[228:231], v5, s[48:51], s21 offen offset:2048 nt
  buffer_load_dwordx4 v[232:235], v5, s[48:51], s21 offen offset:2304 nt
  v_and_b32_dpp v50, v34, v8 row_newbcast:4 row_mask:0xf bank_mask:0xf
  v_and_b32_dpp v51, v34, v9 row_newbcast:4 row_mask:0xf bank_mask:0xf
  v_and_b32_dpp v52, v34, v10 row_newbcast:4 row_mask:0xf bank_mask:0xf
  v_and_b32_dpp v53, v34, v11 row_newbcast:4 row_mask:0xf bank_mask:0xf
  s_waitcnt vmcnt(10)
  v_mfma_f32_16x16x32_bf16 v[38:41], v[188:191], v[46:49], v[38:41]
  v_mfma_f32_16x16x32_bf16 v[42:45], v[192:195], v[46:49], v[42:45]
  s_add_u32 s21, s21, 16384
  s_cmp_eq_u32 s21, s20
  s_cselect_b32 s21, 0, s21
  buffer_load_dwordx4 v[236:239], v5, s[48:51], s21 offen offset:0 nt
  buffer_load_dwordx4 v[240:243], v5, s[48:51], s21 offen offset:256 nt
  v_lshrrev_b32 v80, 1, v2
  v_lshl_add_u32 v80, v3, 4, v80
  v_lshlrev_b32 v80, 5, v80
  v_and_b32 v81, 1, v2
  v_lshl_add_u32 v80, v81, 2, v80
  s_lshl_b32 s12, s3, 3
  s_add_u32 s12, s12, 4096
  v_add_u32 v80, s12, v80
  v_add_u32 v81, 2048, v80
  v_lshrrev_b32 v82, 2, v2
  v_lshlrev_b32 v82, 1, v82
  v_and_b32 v83, 1, v3
  v_add_u32 v82, v82, v83
  v_lshlrev_b32 v82, 5, v82
  s_lshl_b32 s13, s3, 10
  s_add_u32 s13, s13, 4096
  v_add_u32 v82, s13, v82
  v_lshlrev_b32 v83, 4, v1
  s_lshl_b32 s14, s3, 11
  v_add_u32 v83, s14, v83
  v_and_b32 v85, 127, v0
  v_lshlrev_b32 v85, 4, v85
  v_and_b32 v84, 0x68, v0
  v_mov_b32 v86, 0x68
  v_cmp_ne_u32 vcc, v84, v86
  v_mov_b32 v87, 0x7ff00000
  s_nop 0
  v_cndmask_b32 v86, v87, v85, vcc
  v_mov_b32 v84, 128
  v_cmp_gt_u32 vcc, v84, v0
  s_nop 1
  v_cndmask_b32 v86, v87, v86, vcc
  s_lshl_b32 s15, s10, 11
  s_add_u32 s15, s15, 262144
  v_bfe_u32 v90, v2, 2, 1
  v_lshrrev_b32 v87, 1, v3
  v_lshrrev_b32 v88, 3, v2
  v_cmp_eq_u32 s[94:95], v87, v88
  v_cmp_eq_u32 vcc, 0, v90
  s_nop 2
  s_and_b64 vcc, vcc, s[94:95]
  v_mov_b32 v89, 0xffff
  v_cndmask_b32 v62, 0, v89, vcc
  v_cmp_eq_u32 vcc, 1, v90
  s_nop 2
  s_and_b64 vcc, vcc, s[94:95]
  v_mov_b32 v89, 0xffff
  v_cndmask_b32 v63, 0, v89, vcc
  v_cmp_eq_u32 vcc, 0, v90
  s_nop 2
  s_and_b64 vcc, vcc, s[94:95]
  v_mov_b32 v89, 0xffff0000
  v_cndmask_b32 v64, 0, v89, vcc
  v_cmp_eq_u32 vcc, 1, v90
  s_nop 2
  s_and_b64 vcc, vcc, s[94:95]
  v_mov_b32 v89, 0xffff0000
  v_cndmask_b32 v65, 0, v89, vcc
  v_and_b32 v90, 3, v2
  v_add_u32 v87, 1, v90
  v_and_b32 v87, 3, v87
  v_lshl_or_b32 v88, v87, 2, v90
  v_lshl_or_b32 v89, v90, 2, v87
  v_lshl_or_b32 v88, v88, 4, v88
  v_lshl_or_b32 v89, v89, 4, v89
  v_lshl_or_b32 v66, v89, 8, v88
  v_mov_b32 v54, 0
  v_mov_b32 v55, 0
  v_mov_b32 v56, 0
  v_mov_b32 v57, 0
  v_mov_b32 v58, 0
  v_mov_b32 v59, 0
  v_mov_b32 v60, 0
  v_mov_b32 v61, 0
  v_and_b32_dpp v46, v34, v8 row_newbcast:8 row_mask:0xf bank_mask:0xf
  v_and_b32_dpp v47, v34, v9 row_newbcast:8 row_mask:0xf bank_mask:0xf
  v_and_b32_dpp v48, v34, v10 row_newbcast:8 row_mask:0xf bank_mask:0xf
  v_and_b32_dpp v49, v34, v11 row_newbcast:8 row_mask:0xf bank_mask:0xf
  s_waitcnt vmcnt(10)
  v_mfma_f32_16x16x32_bf16 v[38:41], v[196:199], v[50:53], v[38:41]
  v_mfma_f32_16x16x32_bf16 v[42:45], v[200:203], v[50:53], v[42:45]
  buffer_load_dwordx4 v[244:247], v5, s[48:51], s21 offen offset:2048 nt
  buffer_load_dwordx4 v[248:251], v5, s[48:51], s21 offen offset:2304 nt
  v_and_b32_dpp v50, v34, v8 row_newbcast:12 row_mask:0xf bank_mask:0xf
  v_and_b32_dpp v51, v34, v9 row_newbcast:12 row_mask:0xf bank_mask:0xf
  v_and_b32_dpp v52, v34, v10 row_newbcast:12 row_mask:0xf bank_mask:0xf
  v_and_b32_dpp v53, v34, v11 row_newbcast:12 row_mask:0xf bank_mask:0xf
  s_waitcnt vmcnt(10)
  v_mfma_f32_16x16x32_bf16 v[38:41], v[204:207], v[46:49], v[38:41]
  v_mfma_f32_16x16x32_bf16 v[42:45], v[208:211], v[46:49], v[42:45]
  v_and_b32_dpp v46, v35, v8 row_newbcast:0 row_mask:0xf bank_mask:0xf
  v_and_b32_dpp v47, v35, v9 row_newbcast:0 row_mask:0xf bank_mask:0xf
  v_and_b32_dpp v48, v35, v10 row_newbcast:0 row_mask:0xf bank_mask:0xf
  v_and_b32_dpp v49, v35, v11 row_newbcast:0 row_mask:0xf bank_mask:0xf
  s_waitcnt vmcnt(8)
  v_mfma_f32_16x16x32_bf16 v[38:41], v[212:215], v[50:53], v[38:41]
  v_mfma_f32_16x16x32_bf16 v[42:45], v[216:219], v[50:53], v[42:45]
  v_and_b32_dpp v50, v35, v8 row_newbcast:4 row_mask:0xf bank_mask:0xf
  v_and_b32_dpp v51, v35, v9 row_newbcast:4 row_mask:0xf bank_mask:0xf
  v_and_b32_dpp v52, v35, v10 row_newbcast:4 row_mask:0xf bank_mask:0xf
  v_and_b32_dpp v53, v35, v11 row_newbcast:4 row_mask:0xf bank_mask:0xf
  s_waitcnt vmcnt(6)
  v_mfma_f32_16x16x32_bf16 v[38:41], v[220:223], v[46:49], v[38:41]
  v_mfma_f32_16x16x32_bf16 v[42:45], v[224:227], v[46:49], v[42:45]
  v_and_b32_dpp v46, v35, v8 row_newbcast:8 row_mask:0xf bank_mask:0xf
  v_and_b32_dpp v47, v35, v9 row_newbcast:8 row_mask:0xf bank_mask:0xf
  v_and_b32_dpp v48, v35, v10 row_newbcast:8 row_mask:0xf bank_mask:0xf
  v_and_b32_dpp v49, v35, v11 row_newbcast:8 row_mask:0xf bank_mask:0xf
  s_waitcnt vmcnt(4)
  v_mfma_f32_16x16x32_bf16 v[38:41], v[228:231], v[50:53], v[38:41]
  v_mfma_f32_16x16x32_bf16 v[42:45], v[232:235], v[50:53], v[42:45]
  v_and_b32_dpp v50, v35, v8 row_newbcast:12 row_mask:0xf bank_mask:0xf
  v_and_b32_dpp v51, v35, v9 row_newbcast:12 row_mask:0xf bank_mask:0xf
  v_and_b32_dpp v52, v35, v10 row_newbcast:12 row_mask:0xf bank_mask:0xf
  v_and_b32_dpp v53, v35, v11 row_newbcast:12 row_mask:0xf bank_mask:0xf
  s_waitcnt vmcnt(2)
  v_mfma_f32_16x16x32_bf16 v[38:41], v[236:239], v[46:49], v[38:41]
  v_mfma_f32_16x16x32_bf16 v[42:45], v[240:243], v[46:49], v[42:45]
  s_waitcnt vmcnt(0)
  v_mfma_f32_16x16x32_bf16 v[38:41], v[244:247], v[50:53], v[38:41]
  v_mfma_f32_16x16x32_bf16 v[42:45], v[248:251], v[50:53], v[42:45]
  s_mov_b32 exec_lo, 0x00ff00ff
  s_mov_b32 exec_hi, 0x00ff00ff
  s_nop 4
  ds_write2_b32 v80, v38, v39 offset0:0 offset1:32
  ds_write2_b32 v80, v40, v41 offset0:64 offset1:96
  ds_write2_b32 v81, v42, v43 offset0:0 offset1:32
  ds_write2_b32 v81, v44, v45 offset0:64 offset1:96
  s_mov_b64 exec, -1
  s_waitcnt lgkmcnt(0)
  s_barrier
  ds_read_b128 v[20:23], v82 offset:0
  ds_read_b128 v[24:27], v82 offset:16
  ds_read_b128 v[28:31], v82 offset:256
  ds_read_b128 v[32:35], v82 offset:272
  ds_read_b128 v[38:41], v82 offset:512
  ds_read_b128 v[42:45], v82 offset:528
  ds_read_b128 v[46:49], v82 offset:768
  ds_read_b128 v[50:53], v82 offset:784
  s_waitcnt vmcnt(0)
  s_waitcnt lgkmcnt(6)
  v_pk_add_f32 v[20:21], v[20:21], v[22:23]
  v_pk_add_f32 v[24:25], v[24:25], v[26:27]
  v_pk_add_f32 v[20:21], v[20:21], v[24:25]
  v_cvt_pk_bf16_f32 v36, v20, v21
  s_waitcnt lgkmcnt(4)
  v_pk_add_f32 v[28:29], v[28:29], v[30:31]
  v_pk_add_f32 v[32:33], v[32:33], v[34:35]
  v_pk_add_f32 v[28:29], v[28:29], v[32:33]
  v_cvt_pk_bf16_f32 v37, v28, v29
  s_waitcnt lgkmcnt(2)
  v_pk_add_f32 v[38:39], v[38:39], v[40:41]
  v_pk_add_f32 v[42:43], v[42:43], v[44:45]
  v_pk_add_f32 v[38:39], v[38:39], v[42:43]
  v_cvt_pk_bf16_f32 v88, v38, v39
  s_waitcnt lgkmcnt(0)
  v_pk_add_f32 v[46:47], v[46:47], v[48:49]
  v_pk_add_f32 v[50:51], v[50:51], v[52:53]
  v_pk_add_f32 v[46:47], v[46:47], v[50:51]
  v_cvt_pk_bf16_f32 v89, v46, v47
  s_nop 0
  v_and_b32_dpp v46, v36, v62 row_newbcast:0 row_mask:0xf bank_mask:0xf
  v_and_b32_dpp v47, v36, v63 row_newbcast:0 row_mask:0xf bank_mask:0xf
  v_and_b32_dpp v48, v36, v64 row_newbcast:0 row_mask:0xf bank_mask:0xf
  v_and_b32_dpp v49, v36, v65 row_newbcast:0 row_mask:0xf bank_mask:0xf
  v_and_b32_dpp v50, v36, v62 row_newbcast:4 row_mask:0xf bank_mask:0xf
  v_and_b32_dpp v51, v36, v63 row_newbcast:4 row_mask:0xf bank_mask:0xf
  v_smfmac_f32_16x16x64_bf16 v[54:57], v[46:49], a[0:7], v66
  v_and_b32_dpp v52, v36, v64 row_newbcast:4 row_mask:0xf bank_mask:0xf
  v_and_b32_dpp v53, v36, v65 row_newbcast:4 row_mask:0xf bank_mask:0xf
  v_smfmac_f32_16x16x64_bf16 v[58:61], v[46:49], a[8:15], v66
  v_and_b32_dpp v46, v36, v62 row_newbcast:8 row_mask:0xf bank_mask:0xf
  v_and_b32_dpp v47, v36, v63 row_newbcast:8 row_mask:0xf bank_mask:0xf
  v_smfmac_f32_16x16x64_bf16 v[54:57], v[50:53], a[16:23], v66
  v_and_b32_dpp v48, v36, v64 row_newbcast:8 row_mask:0xf bank_mask:0xf
  v_and_b32_dpp v49, v36, v65 row_newbcast:8 row_mask:0xf bank_mask:0xf
  v_smfmac_f32_16x16x64_bf16 v[58:61], v[50:53], a[24:31], v66
  v_and_b32_dpp v50, v36, v62 row_newbcast:12 row_mask:0xf bank_mask:0xf
  v_and_b32_dpp v51, v36, v63 row_newbcast:12 row_mask:0xf bank_mask:0xf
  v_smfmac_f32_16x16x64_bf16 v[54:57], v[46:49], a[32:39], v66
  v_and_b32_dpp v52, v36, v64 row_newbcast:12 row_mask:0xf bank_mask:0xf
  v_and_b32_dpp v53, v36, v65 row_newbcast:12 row_mask:0xf bank_mask:0xf
  v_smfmac_f32_16x16x64_bf16 v[58:61], v[46:49], a[40:47], v66
  v_and_b32_dpp v46, v37, v62 row_newbcast:0 row_mask:0xf bank_mask:0xf
  v_and_b32_dpp v47, v37, v63 row_newbcast:0 row_mask:0xf bank_mask:0xf
  v_smfmac_f32_16x16x64_bf16 v[54:57], v[50:53], a[48:55], v66
  v_and_b32_dpp v48, v37, v64 row_newbcast:0 row_mask:0xf bank_mask:0xf
  v_and_b32_dpp v49, v37, v65 row_newbcast:0 row_mask:0xf bank_mask:0xf
  v_smfmac_f32_16x16x64_bf16 v[58:61], v[50:53], a[56:63], v66
  v_and_b32_dpp v50, v37, v62 row_newbcast:4 row_mask:0xf bank_mask:0xf
  v_and_b32_dpp v51, v37, v63 row_newbcast:4 row_mask:0xf bank_mask:0xf
  v_smfmac_f32_16x16x64_bf16 v[54:57], v[46:49], a[64:71], v66
  v_and_b32_dpp v52, v37, v64 row_newbcast:4 row_mask:0xf bank_mask:0xf
  v_and_b32_dpp v53, v37, v65 row_newbcast:4 row_mask:0xf bank_mask:0xf
  v_smfmac_f32_16x16x64_bf16 v[58:61], v[46:49], a[72:79], v66
  v_and_b32_dpp v46, v37, v62 row_newbcast:8 row_mask:0xf bank_mask:0xf
  v_and_b32_dpp v47, v37, v63 row_newbcast:8 row_mask:0xf bank_mask:0xf
  v_smfmac_f32_16x16x64_bf16 v[54:57], v[50:53], a[80:87], v66
  v_and_b32_dpp v48, v37, v64 row_newbcast:8 row_mask:0xf bank_mask:0xf
  v_and_b32_dpp v49, v37, v65 row_newbcast:8 row_mask:0xf bank_mask:0xf
  v_smfmac_f32_16x16x64_bf16 v[58:61], v[50:53], a[88:95], v66
  v_and_b32_dpp v50, v37, v62 row_newbcast:12 row_mask:0xf bank_mask:0xf
  v_and_b32_dpp v51, v37, v63 row_newbcast:12 row_mask:0xf bank_mask:0xf
  v_smfmac_f32_16x16x64_bf16 v[54:57], v[46:49], a[96:103], v66
  v_and_b32_dpp v52, v37, v64 row_newbcast:12 row_mask:0xf bank_mask:0xf
  v_and_b32_dpp v53, v37, v65 row_newbcast:12 row_mask:0xf bank_mask:0xf
  v_smfmac_f32_16x16x64_bf16 v[58:61], v[46:49], a[104:111], v66
  v_and_b32_dpp v46, v88, v62 row_newbcast:0 row_mask:0xf bank_mask:0xf
  v_and_b32_dpp v47, v88, v63 row_newbcast:0 row_mask:0xf bank_mask:0xf
  v_smfmac_f32_16x16x64_bf16 v[54:57], v[50:53], a[112:119], v66
  v_and_b32_dpp v48, v88, v64 row_newbcast:0 row_mask:0xf bank_mask:0xf
  v_and_b32_dpp v49, v88, v65 row_newbcast:0 row_mask:0xf bank_mask:0xf
  v_smfmac_f32_16x16x64_bf16 v[58:61], v[50:53], a[120:127], v66
  v_and_b32_dpp v50, v88, v62 row_newbcast:4 row_mask:0xf bank_mask:0xf
  v_and_b32_dpp v51, v88, v63 row_newbcast:4 row_mask:0xf bank_mask:0xf
  v_smfmac_f32_16x16x64_bf16 v[54:57], v[46:49], a[128:135], v66
  v_and_b32_dpp v52, v88, v64 row_newbcast:4 row_mask:0xf bank_mask:0xf
  v_and_b32_dpp v53, v88, v65 row_newbcast:4 row_mask:0xf bank_mask:0xf
  v_smfmac_f32_16x16x64_bf16 v[58:61], v[46:49], a[136:143], v66
  v_and_b32_dpp v46, v88, v62 row_newbcast:8 row_mask:0xf bank_mask:0xf
  v_and_b32_dpp v47, v88, v63 row_newbcast:8 row_mask:0xf bank_mask:0xf
  v_smfmac_f32_16x16x64_bf16 v[54:57], v[50:53], a[144:151], v66
  v_and_b32_dpp v48, v88, v64 row_newbcast:8 row_mask:0xf bank_mask:0xf
  v_and_b32_dpp v49, v88, v65 row_newbcast:8 row_mask:0xf bank_mask:0xf
  v_smfmac_f32_16x16x64_bf16 v[58:61], v[50:53], a[152:159], v66
  v_and_b32_dpp v50, v88, v62 row_newbcast:12 row_mask:0xf bank_mask:0xf
  v_and_b32_dpp v51, v88, v63 row_newbcast:12 row_mask:0xf bank_mask:0xf
  v_smfmac_f32_16x16x64_bf16 v[54:57], v[46:49], a[160:167], v66
  v_and_b32_dpp v52, v88, v64 row_newbcast:12 row_mask:0xf bank_mask:0xf
  v_and_b32_dpp v53, v88, v65 row_newbcast:12 row_mask:0xf bank_mask:0xf
  v_smfmac_f32_16x16x64_bf16 v[58:61], v[46:49], a[168:175], v66
  v_and_b32_dpp v46, v89, v62 row_newbcast:0 row_mask:0xf bank_mask:0xf
  v_and_b32_dpp v47, v89, v63 row_newbcast:0 row_mask:0xf bank_mask:0xf
  v_smfmac_f32_16x16x64_bf16 v[54:57], v[50:53], a[176:183], v66
  v_and_b32_dpp v48, v89, v64 row_newbcast:0 row_mask:0xf bank_mask:0xf
  v_and_b32_dpp v49, v89, v65 row_newbcast:0 row_mask:0xf bank_mask:0xf
  v_smfmac_f32_16x16x64_bf16 v[58:61], v[50:53], a[184:191], v66
  v_and_b32_dpp v50, v89, v62 row_newbcast:4 row_mask:0xf bank_mask:0xf
  v_and_b32_dpp v51, v89, v63 row_newbcast:4 row_mask:0xf bank_mask:0xf
  v_smfmac_f32_16x16x64_bf16 v[54:57], v[46:49], a[192:199], v66
  v_and_b32_dpp v52, v89, v64 row_newbcast:4 row_mask:0xf bank_mask:0xf
  v_and_b32_dpp v53, v89, v65 row_newbcast:4 row_mask:0xf bank_mask:0xf
  v_smfmac_f32_16x16x64_bf16 v[58:61], v[46:49], a[200:207], v66
  v_and_b32_dpp v46, v89, v62 row_newbcast:8 row_mask:0xf bank_mask:0xf
  v_and_b32_dpp v47, v89, v63 row_newbcast:8 row_mask:0xf bank_mask:0xf
  v_smfmac_f32_16x16x64_bf16 v[54:57], v[50:53], a[208:215], v66
  v_and_b32_dpp v48, v89, v64 row_newbcast:8 row_mask:0xf bank_mask:0xf
  v_and_b32_dpp v49, v89, v65 row_newbcast:8 row_mask:0xf bank_mask:0xf
  v_smfmac_f32_16x16x64_bf16 v[58:61], v[50:53], a[216:223], v66
  v_and_b32_dpp v50, v89, v62 row_newbcast:12 row_mask:0xf bank_mask:0xf
  v_and_b32_dpp v51, v89, v63 row_newbcast:12 row_mask:0xf bank_mask:0xf
  v_smfmac_f32_16x16x64_bf16 v[54:57], v[46:49], a[224:231], v66
  v_and_b32_dpp v52, v89, v64 row_newbcast:12 row_mask:0xf bank_mask:0xf
  v_and_b32_dpp v53, v89, v65 row_newbcast:12 row_mask:0xf bank_mask:0xf
  v_smfmac_f32_16x16x64_bf16 v[58:61], v[46:49], a[232:239], v66
  s_nop 0
  v_smfmac_f32_16x16x64_bf16 v[54:57], v[50:53], a[240:247], v66
  v_smfmac_f32_16x16x64_bf16 v[58:61], v[50:53], a[248:255], v66
  s_nop 6
  ds_write_b128 v83, v[54:57] offset:16384
  ds_write_b128 v83, v[58:61] offset:17408
  s_waitcnt lgkmcnt(0)
  s_barrier
  ds_read_b128 v[20:23], v85 offset:16384
  ds_read_b128 v[24:27], v85 offset:18432
  ds_read_b128 v[28:31], v85 offset:20480
  ds_read_b128 v[32:35], v85 offset:22528
  s_waitcnt lgkmcnt(2)
  v_pk_add_f32 v[20:21], v[20:21], v[24:25]
  v_pk_add_f32 v[22:23], v[22:23], v[26:27]
  s_waitcnt lgkmcnt(0)
  v_pk_add_f32 v[28:29], v[28:29], v[32:33]
  v_pk_add_f32 v[30:31], v[30:31], v[34:35]
  v_pk_add_f32 v[20:21], v[20:21], v[28:29]
  v_pk_add_f32 v[22:23], v[22:23], v[30:31]
  v_min_u32 v20, -2, v20
  v_min_u32 v21, -2, v21
  v_min_u32 v22, -2, v22
  v_min_u32 v23, -2, v23
  buffer_store_dwordx4 v[20:23], v86, s[64:67], s15 offen sc1
  s_endpgm
L_roleP:
  s_mul_i32 s12, s8, 56
  s_lshr_b32 s13, s3, 1
  s_mul_i32 s13, s13, 28
  s_add_u32 s12, s12, s13
  v_min_u32 v80, 6, v2
  v_lshl_add_u32 v80, v80, 2, v3
  v_add_u32 v80, s12, v80
  v_lshlrev_b32 v80, 1, v80
  s_mul_i32 s13, s7, 896
  buffer_load_ushort v83, v80, s[60:63], s13 offen
  v_lshlrev_b32 v7, 4, v2
  v_lshl_add_u32 v7, v3, 13, v7
  s_lshl_b32 s12, s12, 13
  s_and_b32 s13, s3, 1
  s_lshl_b32 s13, s13, 8
  s_add_u32 s12, s12, s13
  buffer_load_dwordx4 v[96:99], v7, s[52:55], s12 offen nt
  s_add_u32 s12, s12, 32768
  buffer_load_dwordx4 v[100:103], v7, s[52:55], s12 offen nt
  s_add_u32 s12, s12, 32768
  buffer_load_dwordx4 v[104:107], v7, s[52:55], s12 offen nt
  s_add_u32 s12, s12, 32768
  buffer_load_dwordx4 v[108:111], v7, s[52:55], s12 offen nt
  s_add_u32 s12, s12, 32768
  buffer_load_dwordx4 v[112:115], v7, s[52:55], s12 offen nt
  s_add_u32 s12, s12, 32768
  buffer_load_dwordx4 v[116:119], v7, s[52:55], s12 offen nt
  s_add_u32 s12, s12, 32768
  buffer_load_dwordx4 v[120:123], v7, s[52:55], s12 offen nt
  v_mov_b32 v84, -1
  v_mov_b32 v85, -1
  v_mov_b32 v50, -1
  v_mov_b32 v51, -1
  v_mov_b32 v52, -1
  v_mov_b32 v53, -1
  v_lshlrev_b32 v81, 4, v0
  v_mov_b32 v82, 128
  v_cmp_gt_u32 vcc, v82, v0
  v_mov_b32 v82, 0x7ff00000
  s_nop 0
  v_cndmask_b32 v81, v82, v81, vcc
  s_lshl_b32 s12, s10, 11
  s_add_u32 s12, s12, 262144
  buffer_store_dwordx4 v[50:53], v81, s[64:67], s12 offen sc1
  v_cmp_eq_u32 vcc, 0, v0
  v_mov_b32 v82, 0x7ff00000
  v_mov_b32 v86, 0
  v_cndmask_b32 v86, v82, v86, vcc
  s_lshl_b32 s13, s10, 3
  s_add_u32 s13, s13, 786432
  buffer_store_dwordx2 v[84:85], v86, s[64:67], s13 offen sc1
  s_add_u32 s101, s101, 16384
  s_cmp_eq_u32 s101, s20
  s_cselect_b32 s101, 0, s101
  buffer_load_dwordx4 a[32:35], v4, s[44:47], s101 offen offset:0 nt
  buffer_load_dwordx4 a[36:39], v4, s[44:47], s101 offen offset:256 nt
  buffer_load_dwordx4 a[40:43], v4, s[44:47], s101 offen offset:2048 nt
  buffer_load_dwordx4 a[44:47], v4, s[44:47], s101 offen offset:2304 nt
  s_waitcnt vmcnt(13)
  v_lshl_or_b32 v83, v83, 16, v83
  s_nop 1
  v_and_b32_dpp v46, v83, v8 row_newbcast:0 row_mask:0xf bank_mask:0xf
  v_and_b32_dpp v47, v83, v9 row_newbcast:0 row_mask:0xf bank_mask:0xf
  v_and_b32_dpp v48, v83, v10 row_newbcast:0 row_mask:0xf bank_mask:0xf
  v_and_b32_dpp v49, v83, v11 row_newbcast:0 row_mask:0xf bank_mask:0xf
  s_waitcnt vmcnt(12)
  s_nop 0
  v_mfma_f32_16x16x32_bf16 v[38:41], v[96:99], v[46:49], 0
  v_and_b32_dpp v50, v83, v8 row_newbcast:1 row_mask:0xf bank_mask:0xf
  v_and_b32_dpp v51, v83, v9 row_newbcast:1 row_mask:0xf bank_mask:0xf
  v_and_b32_dpp v52, v83, v10 row_newbcast:1 row_mask:0xf bank_mask:0xf
  v_and_b32_dpp v53, v83, v11 row_newbcast:1 row_mask:0xf bank_mask:0xf
  s_waitcnt vmcnt(11)
  s_nop 0
  v_mfma_f32_16x16x32_bf16 v[38:41], v[100:103], v[50:53], v[38:41]
  v_and_b32_dpp v46, v83, v8 row_newbcast:2 row_mask:0xf bank_mask:0xf
  v_and_b32_dpp v47, v83, v9 row_newbcast:2 row_mask:0xf bank_mask:0xf
  v_and_b32_dpp v48, v83, v10 row_newbcast:2 row_mask:0xf bank_mask:0xf
  v_and_b32_dpp v49, v83, v11 row_newbcast:2 row_mask:0xf bank_mask:0xf
  s_waitcnt vmcnt(10)
  s_nop 0
  v_mfma_f32_16x16x32_bf16 v[38:41], v[104:107], v[46:49], v[38:41]
  v_and_b32_dpp v50, v83, v8 row_newbcast:3 row_mask:0xf bank_mask:0xf
  v_and_b32_dpp v51, v83, v9 row_newbcast:3 row_mask:0xf bank_mask:0xf
  v_and_b32_dpp v52, v83, v10 row_newbcast:3 row_mask:0xf bank_mask:0xf
  v_and_b32_dpp v53, v83, v11 row_newbcast:3 row_mask:0xf bank_mask:0xf
  s_waitcnt vmcnt(9)
  s_nop 0
  v_mfma_f32_16x16x32_bf16 v[38:41], v[108:111], v[50:53], v[38:41]
  v_and_b32_dpp v46, v83, v8 row_newbcast:4 row_mask:0xf bank_mask:0xf
  v_and_b32_dpp v47, v83, v9 row_newbcast:4 row_mask:0xf bank_mask:0xf
  v_and_b32_dpp v48, v83, v10 row_newbcast:4 row_mask:0xf bank_mask:0xf
  v_and_b32_dpp v49, v83, v11 row_newbcast:4 row_mask:0xf bank_mask:0xf
  s_waitcnt vmcnt(8)
  s_nop 0
  v_mfma_f32_16x16x32_bf16 v[38:41], v[112:115], v[46:49], v[38:41]
  v_and_b32_dpp v50, v83, v8 row_newbcast:5 row_mask:0xf bank_mask:0xf
  v_and_b32_dpp v51, v83, v9 row_newbcast:5 row_mask:0xf bank_mask:0xf
  v_and_b32_dpp v52, v83, v10 row_newbcast:5 row_mask:0xf bank_mask:0xf
  v_and_b32_dpp v53, v83, v11 row_newbcast:5 row_mask:0xf bank_mask:0xf
  s_waitcnt vmcnt(7)
  s_nop 0
  v_mfma_f32_16x16x32_bf16 v[38:41], v[116:119], v[50:53], v[38:41]
  v_and_b32_dpp v46, v83, v8 row_newbcast:6 row_mask:0xf bank_mask:0xf
  v_and_b32_dpp v47, v83, v9 row_newbcast:6 row_mask:0xf bank_mask:0xf
  v_and_b32_dpp v48, v83, v10 row_newbcast:6 row_mask:0xf bank_mask:0xf
  v_and_b32_dpp v49, v83, v11 row_newbcast:6 row_mask:0xf bank_mask:0xf
  s_waitcnt vmcnt(6)
  s_nop 0
  v_mfma_f32_16x16x32_bf16 v[38:41], v[120:123], v[46:49], v[38:41]
  s_and_b32 s12, s3, 1
  s_lshl_b32 s12, s12, 10
  s_lshr_b32 s13, s3, 1
  s_lshl_b32 s13, s13, 2
  s_add_u32 s12, s12, s13
  v_lshl_add_u32 v80, v3, 5, v2
  v_lshlrev_b32 v80, 3, v80
  v_add_u32 v80, s12, v80
  s_mov_b32 exec_lo, 0x00ff00ff
  s_mov_b32 exec_hi, 0x00ff00ff
  ds_write2_b32 v80, v38, v39 offset0:0 offset1:16
  ds_write2_b32 v80, v40, v41 offset0:32 offset1:48
  s_mov_b64 exec, -1
  s_waitcnt lgkmcnt(0)
  s_barrier
  v_lshlrev_b32 v80, 5, v1
  ds_read_b128 v[46:49], v80 offset:0
  ds_read_b128 v[50:53], v80 offset:16
  v_lshlrev_b32 v81, 4, v0
  v_mov_b32 v82, 0x7ff00000
  v_cmp_gt_u32 vcc, 64, v0
  s_nop 1
  v_cndmask_b32 v81, v82, v81, vcc
  s_lshl_b32 s12, s10, 10
  s_waitcnt lgkmcnt(0)
  v_add_f32 v38, v46, v47
  v_add_f32 v39, v48, v49
  v_add_f32 v40, v50, v51
  v_add_f32 v41, v52, v53
  buffer_store_dwordx4 v[38:41], v81, s[64:67], s12 offen sc1
  s_add_u32 s101, s101, 16384
  s_cmp_eq_u32 s101, s20
  s_cselect_b32 s101, 0, s101
  buffer_load_dwordx4 a[48:51], v4, s[44:47], s101 offen offset:0 nt
  buffer_load_dwordx4 a[52:55], v4, s[44:47], s101 offen offset:256 nt
  buffer_load_dwordx4 a[56:59], v4, s[44:47], s101 offen offset:2048 nt
  buffer_load_dwordx4 a[60:63], v4, s[44:47], s101 offen offset:2304 nt
  s_add_u32 s101, s101, 16384
  s_cmp_eq_u32 s101, s20
  s_cselect_b32 s101, 0, s101
  buffer_load_dwordx4 a[64:67], v4, s[44:47], s101 offen offset:0 nt
  buffer_load_dwordx4 a[68:71], v4, s[44:47], s101 offen offset:256 nt
  buffer_load_dwordx4 a[72:75], v4, s[44:47], s101 offen offset:2048 nt
  buffer_load_dwordx4 a[76:79], v4, s[44:47], s101 offen offset:2304 nt
  s_waitcnt vmcnt(8)
  s_barrier
  v_mov_b32 v84, 1
  s_lshl_b32 s12, s9, 2
  buffer_atomic_add v84, v86, s[68:71], s12 offen
  s_add_u32 s101, s101, 16384
  s_cmp_eq_u32 s101, s20
  s_cselect_b32 s101, 0, s101
  buffer_load_dwordx4 a[80:83], v4, s[44:47], s101 offen offset:0 nt
  buffer_load_dwordx4 a[84:87], v4, s[44:47], s101 offen offset:256 nt
  buffer_load_dwordx4 a[88:91], v4, s[44:47], s101 offen offset:2048 nt
  s_waitcnt vmcnt(11)
  buffer_load_dwordx4 a[92:95], v4, s[44:47], s101 offen offset:2304 nt
  s_waitcnt vmcnt(11)
  s_add_u32 s101, s101, 16384
  s_cmp_eq_u32 s101, s20
  s_cselect_b32 s101, 0, s101
  buffer_load_dwordx4 a[96:99], v4, s[44:47], s101 offen offset:0 nt
  s_waitcnt vmcnt(11)
  buffer_load_dwordx4 a[100:103], v4, s[44:47], s101 offen offset:256 nt
  s_waitcnt vmcnt(11)
  buffer_load_dwordx4 a[104:107], v4, s[44:47], s101 offen offset:2048 nt
  s_waitcnt vmcnt(11)
  buffer_load_dwordx4 a[108:111], v4, s[44:47], s101 offen offset:2304 nt
  s_waitcnt vmcnt(11)
  s_add_u32 s101, s101, 16384
  s_cmp_eq_u32 s101, s20
  s_cselect_b32 s101, 0, s101
  buffer_load_dwordx4 a[112:115], v4, s[44:47], s101 offen offset:0 nt
  s_waitcnt vmcnt(11)
  buffer_load_dwordx4 a[116:119], v4, s[44:47], s101 offen offset:256 nt
  s_waitcnt vmcnt(11)
  buffer_load_dwordx4 a[120:123], v4, s[44:47], s101 offen offset:2048 nt
  s_waitcnt vmcnt(11)
  buffer_load_dwordx4 a[124:127], v4, s[44:47], s101 offen offset:2304 nt
  s_waitcnt vmcnt(11)
  s_add_u32 s101, s101, 16384
  s_cmp_eq_u32 s101, s20
  s_cselect_b32 s101, 0, s101
  buffer_load_dwordx4 a[128:131], v4, s[44:47], s101 offen offset:0 nt
  s_waitcnt vmcnt(11)
  buffer_load_dwordx4 a[132:135], v4, s[44:47], s101 offen offset:256 nt
  s_waitcnt vmcnt(11)
  buffer_load_dwordx4 a[136:139], v4, s[44:47], s101 offen offset:2048 nt
  s_waitcnt vmcnt(11)
  buffer_load_dwordx4 a[140:143], v4, s[44:47], s101 offen offset:2304 nt
  s_waitcnt vmcnt(11)
  s_add_u32 s101, s101, 16384
  s_cmp_eq_u32 s101, s20
  s_cselect_b32 s101, 0, s101
  buffer_load_dwordx4 a[144:147], v4, s[44:47], s101 offen offset:0 nt
  s_waitcnt vmcnt(11)
  buffer_load_dwordx4 a[148:151], v4, s[44:47], s101 offen offset:256 nt
  s_waitcnt vmcnt(11)
  buffer_load_dwordx4 a[152:155], v4, s[44:47], s101 offen offset:2048 nt
  s_waitcnt vmcnt(11)
  buffer_load_dwordx4 a[156:159], v4, s[44:47], s101 offen offset:2304 nt
  s_waitcnt vmcnt(11)
  s_add_u32 s101, s101, 16384
  s_cmp_eq_u32 s101, s20
  s_cselect_b32 s101, 0, s101
  buffer_load_dwordx4 a[160:163], v4, s[44:47], s101 offen offset:0 nt
  s_waitcnt vmcnt(11)
  buffer_load_dwordx4 a[164:167], v4, s[44:47], s101 offen offset:256 nt
  s_waitcnt vmcnt(11)
  buffer_load_dwordx4 a[168:171], v4, s[44:47], s101 offen offset:2048 nt
  s_waitcnt vmcnt(11)
  buffer_load_dwordx4 a[172:175], v4, s[44:47], s101 offen offset:2304 nt
  s_waitcnt vmcnt(11)
  s_add_u32 s101, s101, 16384
  s_cmp_eq_u32 s101, s20
  s_cselect_b32 s101, 0, s101
  buffer_load_dwordx4 a[176:179], v4, s[44:47], s101 offen offset:0 nt
  s_waitcnt vmcnt(11)
  buffer_load_dwordx4 a[180:183], v4, s[44:47], s101 offen offset:256 nt
  s_waitcnt vmcnt(11)
  buffer_load_dwordx4 a[184:187], v4, s[44:47], s101 offen offset:2048 nt
  s_waitcnt vmcnt(11)
  buffer_load_dwordx4 a[188:191], v4, s[44:47], s101 offen offset:2304 nt
  s_waitcnt vmcnt(11)
  s_add_u32 s101, s101, 16384
  s_cmp_eq_u32 s101, s20
  s_cselect_b32 s101, 0, s101
  buffer_load_dwordx4 a[192:195], v4, s[44:47], s101 offen offset:0 nt
  s_waitcnt vmcnt(11)
  buffer_load_dwordx4 a[196:199], v4, s[44:47], s101 offen offset:256 nt
  s_waitcnt vmcnt(11)
  buffer_load_dwordx4 a[200:203], v4, s[44:47], s101 offen offset:2048 nt
  s_waitcnt vmcnt(11)
  buffer_load_dwordx4 a[204:207], v4, s[44:47], s101 offen offset:2304 nt
  v_mov_b32 v80, 0
  s_lshl_b32 s14, s9, 2
  buffer_load_dword v84, v80, s[68:71], s14 offen sc1
  s_add_u32 s101, s101, 16384
  s_cmp_eq_u32 s101, s20
  s_cselect_b32 s101, 0, s101
  buffer_load_dwordx4 a[208:211], v4, s[44:47], s101 offen offset:0 nt
  buffer_load_dwordx4 a[212:215], v4, s[44:47], s101 offen offset:256 nt
  buffer_load_dwordx4 a[216:219], v4, s[44:47], s101 offen offset:2048 nt
  buffer_load_dwordx4 a[220:223], v4, s[44:47], s101 offen offset:2304 nt
  s_add_u32 s101, s101, 16384
  s_cmp_eq_u32 s101, s20
  s_cselect_b32 s101, 0, s101
  buffer_load_dwordx4 a[224:227], v4, s[44:47], s101 offen offset:0 nt
  buffer_load_dwordx4 a[228:231], v4, s[44:47], s101 offen offset:256 nt
  buffer_load_dwordx4 a[232:235], v4, s[44:47], s101 offen offset:2048 nt
  buffer_load_dwordx4 a[236:239], v4, s[44:47], s101 offen offset:2304 nt
  s_add_u32 s101, s101, 16384
  s_cmp_eq_u32 s101, s20
  s_cselect_b32 s101, 0, s101
  buffer_load_dwordx4 a[240:243], v4, s[44:47], s101 offen offset:0 nt
  buffer_load_dwordx4 a[244:247], v4, s[44:47], s101 offen offset:256 nt
  buffer_load_dwordx4 a[248:251], v4, s[44:47], s101 offen offset:2048 nt
  buffer_load_dwordx4 a[252:255], v4, s[44:47], s101 offen offset:2304 nt
  s_waitcnt vmcnt(12)
  v_readfirstlane_b32 s12, v84
  s_nop 2
  s_cmp_ge_u32 s12, 8
  s_cbranch_scc1 L_qokP
  s_mov_b32 s93, 0
L_qspinP:
  buffer_load_dword v84, v80, s[68:71], s14 offen sc1
  s_waitcnt vmcnt(0)
  v_readfirstlane_b32 s12, v84
  s_nop 2
  s_cmp_ge_u32 s12, 8
  s_cbranch_scc1 L_qokP
  s_add_u32 s93, s93, 1
  s_cmp_lt_u32 s93, 0x40000
  s_cbranch_scc0 L_qokP
  s_sleep 4
  s_branch L_qspinP
L_qokP:
  v_lshlrev_b32 v80, 10, v3
  v_lshl_add_u32 v80, v2, 4, v80
  s_lshl_b32 s13, s3, 8
  v_add_u32 v80, s13, v80
  s_lshl_b32 s12, s9, 13
  s_add_u32 s14, s12, 4096
  buffer_load_dwordx4 v[54:57], v80, s[64:67], s12 offen sc1
  buffer_load_dwordx4 v[58:61], v80, s[64:67], s14 offen sc1
  s_add_u32 s101, s101, 16384
  s_cmp_eq_u32 s101, s20
  s_cselect_b32 s101, 0, s101
  buffer_load_dwordx4 v[124:127], v4, s[44:47], s101 offen offset:0 nt
  buffer_load_dwordx4 v[128:131], v4, s[44:47], s101 offen offset:256 nt
  buffer_load_dwordx4 v[132:135], v4, s[44:47], s101 offen offset:2048 nt
  buffer_load_dwordx4 v[136:139], v4, s[44:47], s101 offen offset:2304 nt
  s_add_u32 s101, s101, 16384
  s_cmp_eq_u32 s101, s20
  s_cselect_b32 s101, 0, s101
  buffer_load_dwordx4 v[140:143], v4, s[44:47], s101 offen offset:0 nt
  buffer_load_dwordx4 v[144:147], v4, s[44:47], s101 offen offset:256 nt
  buffer_load_dwordx4 v[148:151], v4, s[44:47], s101 offen offset:2048 nt
  buffer_load_dwordx4 v[152:155], v4, s[44:47], s101 offen offset:2304 nt
  s_add_u32 s101, s101, 16384
  s_cmp_eq_u32 s101, s20
  s_cselect_b32 s101, 0, s101
  buffer_load_dwordx4 v[156:159], v4, s[44:47], s101 offen offset:0 nt
  buffer_load_dwordx4 v[160:163], v4, s[44:47], s101 offen offset:256 nt
  buffer_load_dwordx4 v[164:167], v4, s[44:47], s101 offen offset:2048 nt
  buffer_load_dwordx4 v[168:171], v4, s[44:47], s101 offen offset:2304 nt
  v_lshlrev_b32 v80, 3, v2
  s_lshl_b32 s13, s3, 7
  v_add_u32 v80, s13, v80
  s_waitcnt vmcnt(12)
  v_pk_add_f32 v[54:55], v[54:55], v[58:59]
  v_pk_add_f32 v[56:57], v[56:57], v[60:61]
  v_mov_b32 v58, v54
  v_mov_b32 v59, v55
  v_mov_b32 v60, v56
  v_mov_b32 v61, v57
  v_permlane16_swap_b32 v54, v58
  v_permlane16_swap_b32 v55, v59
  v_permlane16_swap_b32 v56, v60
  v_permlane16_swap_b32 v57, v61
  v_add_f32 v54, v54, v58
  v_add_f32 v55, v55, v59
  v_add_f32 v56, v56, v60
  v_add_f32 v57, v57, v61
  v_mov_b32 v58, v54
  v_mov_b32 v59, v55
  v_mov_b32 v60, v56
  v_mov_b32 v61, v57
  v_permlane32_swap_b32 v54, v58
  v_permlane32_swap_b32 v55, v59
  v_permlane32_swap_b32 v56, v60
  v_permlane32_swap_b32 v57, v61
  v_add_f32 v54, v54, v58
  v_add_f32 v55, v55, v59
  v_add_f32 v56, v56, v60
  v_add_f32 v57, v57, v61
  v_cvt_pk_bf16_f32 v58, v54, v55
  v_cvt_pk_bf16_f32 v59, v56, v57
  ds_write_b64 v80, v[58:59] offset:2048
  v_and_b32 v81, 3, v2
  v_lshl_add_u32 v81, v3, 2, v81
  v_lshlrev_b32 v81, 4, v81
  s_waitcnt lgkmcnt(0)
  s_barrier
  ds_read_b128 v[12:15], v81 offset:2048
  ds_read_b128 v[16:19], v81 offset:2304
  s_waitcnt lgkmcnt(0)
  v_and_b32 v7, 8, v2
  v_lshlrev_b32 v7, 4, v7
  v_sub_u32 v7, v6, v7
  v_mov_b32 v36, 0xff800000
  v_mfma_f32_16x16x32_bf16 v[38:41], a[0:3], v[12:15], 0
  v_mfma_f32_16x16x32_bf16 v[38:41], a[4:7], v[16:19], v[38:41]
  v_mfma_f32_16x16x32_bf16 v[42:45], a[8:11], v[12:15], 0
  v_mfma_f32_16x16x32_bf16 v[42:45], a[12:15], v[16:19], v[42:45]
  s_waitcnt vmcnt(11)
  s_add_u32 s101, s101, 16384
  s_cmp_eq_u32 s101, s20
  s_cselect_b32 s101, 0, s101
  buffer_load_dwordx4 v[172:175], v4, s[44:47], s101 offen offset:0 nt
  s_nop 0
  v_add_f32_dpp v88, v39, v38 quad_perm:[1,1,1,1] row_mask:0xf bank_mask:0xf
  v_add_f32_dpp v89, v41, v40 quad_perm:[3,3,3,3] row_mask:0xf bank_mask:0xf
  s_nop 1
  v_add_f32_dpp v20, v89, v88 quad_perm:[2,2,2,2] row_mask:0xf bank_mask:0x1
  v_mfma_f32_16x16x32_bf16 v[38:41], a[16:19], v[12:15], 0
  v_mfma_f32_16x16x32_bf16 v[38:41], a[20:23], v[16:19], v[38:41]
  v_add_f32_dpp v88, v43, v42 quad_perm:[1,1,1,1] row_mask:0xf bank_mask:0xf
  v_add_f32_dpp v89, v45, v44 quad_perm:[3,3,3,3] row_mask:0xf bank_mask:0xf
  s_nop 1
  v_add_f32_dpp v20, v89, v88 quad_perm:[2,2,2,2] row_mask:0xf bank_mask:0x2
  v_mfma_f32_16x16x32_bf16 v[42:45], a[24:27], v[12:15], 0
  v_mfma_f32_16x16x32_bf16 v[42:45], a[28:31], v[16:19], v[42:45]
  s_waitcnt vmcnt(11)
  buffer_load_dwordx4 v[176:179], v4, s[44:47], s101 offen offset:256 nt
  v_add_f32_dpp v88, v39, v38 quad_perm:[1,1,1,1] row_mask:0xf bank_mask:0xf
  v_add_f32_dpp v89, v41, v40 quad_perm:[3,3,3,3] row_mask:0xf bank_mask:0xf
  s_nop 1
  v_add_f32_dpp v20, v89, v88 quad_perm:[2,2,2,2] row_mask:0xf bank_mask:0x4
  v_mfma_f32_16x16x32_bf16 v[38:41], a[32:35], v[12:15], 0
  v_mfma_f32_16x16x32_bf16 v[38:41], a[36:39], v[16:19], v[38:41]
  v_add_f32_dpp v88, v43, v42 quad_perm:[1,1,1,1] row_mask:0xf bank_mask:0xf
  v_add_f32_dpp v89, v45, v44 quad_perm:[3,3,3,3] row_mask:0xf bank_mask:0xf
  s_nop 1
  v_add_f32_dpp v20, v89, v88 quad_perm:[2,2,2,2] row_mask:0xf bank_mask:0x8
  v_mfma_f32_16x16x32_bf16 v[42:45], a[40:43], v[12:15], 0
  v_mfma_f32_16x16x32_bf16 v[42:45], a[44:47], v[16:19], v[42:45]
  s_waitcnt vmcnt(11)
  buffer_load_dwordx4 v[180:183], v4, s[44:47], s101 offen offset:2048 nt
  v_add_f32_dpp v88, v39, v38 quad_perm:[1,1,1,1] row_mask:0xf bank_mask:0xf
  v_add_f32_dpp v89, v41, v40 quad_perm:[3,3,3,3] row_mask:0xf bank_mask:0xf
  s_nop 1
  v_add_f32_dpp v21, v89, v88 quad_perm:[2,2,2,2] row_mask:0xf bank_mask:0x1
  v_mfma_f32_16x16x32_bf16 v[38:41], a[48:51], v[12:15], 0
  v_mfma_f32_16x16x32_bf16 v[38:41], a[52:55], v[16:19], v[38:41]
  v_add_f32_dpp v88, v43, v42 quad_perm:[1,1,1,1] row_mask:0xf bank_mask:0xf
  v_add_f32_dpp v89, v45, v44 quad_perm:[3,3,3,3] row_mask:0xf bank_mask:0xf
  s_nop 1
  v_add_f32_dpp v21, v89, v88 quad_perm:[2,2,2,2] row_mask:0xf bank_mask:0x2
  v_mfma_f32_16x16x32_bf16 v[42:45], a[56:59], v[12:15], 0
  v_mfma_f32_16x16x32_bf16 v[42:45], a[60:63], v[16:19], v[42:45]
  s_waitcnt vmcnt(11)
  buffer_load_dwordx4 v[184:187], v4, s[44:47], s101 offen offset:2304 nt
  v_add_f32_dpp v88, v39, v38 quad_perm:[1,1,1,1] row_mask:0xf bank_mask:0xf
  v_add_f32_dpp v89, v41, v40 quad_perm:[3,3,3,3] row_mask:0xf bank_mask:0xf
  s_nop 1
  v_add_f32_dpp v21, v89, v88 quad_perm:[2,2,2,2] row_mask:0xf bank_mask:0x4
  v_mfma_f32_16x16x32_bf16 v[38:41], a[64:67], v[12:15], 0
  v_mfma_f32_16x16x32_bf16 v[38:41], a[68:71], v[16:19], v[38:41]
  v_add_f32_dpp v88, v43, v42 quad_perm:[1,1,1,1] row_mask:0xf bank_mask:0xf
  v_add_f32_dpp v89, v45, v44 quad_perm:[3,3,3,3] row_mask:0xf bank_mask:0xf
  s_nop 1
  v_add_f32_dpp v21, v89, v88 quad_perm:[2,2,2,2] row_mask:0xf bank_mask:0x8
  v_mfma_f32_16x16x32_bf16 v[42:45], a[72:75], v[12:15], 0
  v_mfma_f32_16x16x32_bf16 v[42:45], a[76:79], v[16:19], v[42:45]
  s_waitcnt vmcnt(11)
  s_add_u32 s101, s101, 16384
  s_cmp_eq_u32 s101, s20
  s_cselect_b32 s101, 0, s101
  buffer_load_dwordx4 v[188:191], v4, s[44:47], s101 offen offset:0 nt
  v_add_f32_dpp v88, v39, v38 quad_perm:[1,1,1,1] row_mask:0xf bank_mask:0xf
  v_add_f32_dpp v89, v41, v40 quad_perm:[3,3,3,3] row_mask:0xf bank_mask:0xf
  s_nop 1
  v_add_f32_dpp v22, v89, v88 quad_perm:[2,2,2,2] row_mask:0xf bank_mask:0x1
  v_mfma_f32_16x16x32_bf16 v[38:41], a[80:83], v[12:15], 0
  v_mfma_f32_16x16x32_bf16 v[38:41], a[84:87], v[16:19], v[38:41]
  v_add_f32_dpp v88, v43, v42 quad_perm:[1,1,1,1] row_mask:0xf bank_mask:0xf
  v_add_f32_dpp v89, v45, v44 quad_perm:[3,3,3,3] row_mask:0xf bank_mask:0xf
  s_nop 1
  v_add_f32_dpp v22, v89, v88 quad_perm:[2,2,2,2] row_mask:0xf bank_mask:0x2
  v_mfma_f32_16x16x32_bf16 v[42:45], a[88:91], v[12:15], 0
  v_mfma_f32_16x16x32_bf16 v[42:45], a[92:95], v[16:19], v[42:45]
  s_waitcnt vmcnt(11)
  buffer_load_dwordx4 v[192:195], v4, s[44:47], s101 offen offset:256 nt
  v_add_f32_dpp v88, v39, v38 quad_perm:[1,1,1,1] row_mask:0xf bank_mask:0xf
  v_add_f32_dpp v89, v41, v40 quad_perm:[3,3,3,3] row_mask:0xf bank_mask:0xf
  s_nop 1
  v_add_f32_dpp v22, v89, v88 quad_perm:[2,2,2,2] row_mask:0xf bank_mask:0x4
  v_mfma_f32_16x16x32_bf16 v[38:41], a[96:99], v[12:15], 0
  v_mfma_f32_16x16x32_bf16 v[38:41], a[100:103], v[16:19], v[38:41]
  v_add_f32_dpp v88, v43, v42 quad_perm:[1,1,1,1] row_mask:0xf bank_mask:0xf
  v_add_f32_dpp v89, v45, v44 quad_perm:[3,3,3,3] row_mask:0xf bank_mask:0xf
  s_nop 1
  v_add_f32_dpp v22, v89, v88 quad_perm:[2,2,2,2] row_mask:0xf bank_mask:0x8
  v_mfma_f32_16x16x32_bf16 v[42:45], a[104:107], v[12:15], 0
  v_mfma_f32_16x16x32_bf16 v[42:45], a[108:111], v[16:19], v[42:45]
  s_waitcnt vmcnt(11)
  buffer_load_dwordx4 v[196:199], v4, s[44:47], s101 offen offset:2048 nt
  v_add_f32_dpp v88, v39, v38 quad_perm:[1,1,1,1] row_mask:0xf bank_mask:0xf
  v_add_f32_dpp v89, v41, v40 quad_perm:[3,3,3,3] row_mask:0xf bank_mask:0xf
  s_nop 1
  v_add_f32_dpp v23, v89, v88 quad_perm:[2,2,2,2] row_mask:0xf bank_mask:0x1
  v_mfma_f32_16x16x32_bf16 v[38:41], a[112:115], v[12:15], 0
  v_mfma_f32_16x16x32_bf16 v[38:41], a[116:119], v[16:19], v[38:41]
  v_add_f32_dpp v88, v43, v42 quad_perm:[1,1,1,1] row_mask:0xf bank_mask:0xf
  v_add_f32_dpp v89, v45, v44 quad_perm:[3,3,3,3] row_mask:0xf bank_mask:0xf
  s_nop 1
  v_add_f32_dpp v23, v89, v88 quad_perm:[2,2,2,2] row_mask:0xf bank_mask:0x2
  v_mfma_f32_16x16x32_bf16 v[42:45], a[120:123], v[12:15], 0
  v_mfma_f32_16x16x32_bf16 v[42:45], a[124:127], v[16:19], v[42:45]
  s_waitcnt vmcnt(11)
  buffer_load_dwordx4 v[200:203], v4, s[44:47], s101 offen offset:2304 nt
  v_add_f32_dpp v88, v39, v38 quad_perm:[1,1,1,1] row_mask:0xf bank_mask:0xf
  v_add_f32_dpp v89, v41, v40 quad_perm:[3,3,3,3] row_mask:0xf bank_mask:0xf
  s_nop 1
  v_add_f32_dpp v23, v89, v88 quad_perm:[2,2,2,2] row_mask:0xf bank_mask:0x4
  v_mfma_f32_16x16x32_bf16 v[38:41], a[128:131], v[12:15], 0
  v_mfma_f32_16x16x32_bf16 v[38:41], a[132:135], v[16:19], v[38:41]
  v_add_f32_dpp v88, v43, v42 quad_perm:[1,1,1,1] row_mask:0xf bank_mask:0xf
  v_add_f32_dpp v89, v45, v44 quad_perm:[3,3,3,3] row_mask:0xf bank_mask:0xf
  s_nop 1
  v_add_f32_dpp v23, v89, v88 quad_perm:[2,2,2,2] row_mask:0xf bank_mask:0x8
  v_mfma_f32_16x16x32_bf16 v[42:45], a[136:139], v[12:15], 0
  v_mfma_f32_16x16x32_bf16 v[42:45], a[140:143], v[16:19], v[42:45]
  s_waitcnt vmcnt(11)
  s_add_u32 s101, s101, 16384
  s_cmp_eq_u32 s101, s20
  s_cselect_b32 s101, 0, s101
  buffer_load_dwordx4 v[204:207], v4, s[44:47], s101 offen offset:0 nt
  v_add_f32_dpp v88, v39, v38 quad_perm:[1,1,1,1] row_mask:0xf bank_mask:0xf
  v_add_f32_dpp v89, v41, v40 quad_perm:[3,3,3,3] row_mask:0xf bank_mask:0xf
  s_nop 1
  v_add_f32_dpp v24, v89, v88 quad_perm:[2,2,2,2] row_mask:0xf bank_mask:0x1
  v_mfma_f32_16x16x32_bf16 v[38:41], a[144:147], v[12:15], 0
  v_mfma_f32_16x16x32_bf16 v[38:41], a[148:151], v[16:19], v[38:41]
  v_add_f32_dpp v88, v43, v42 quad_perm:[1,1,1,1] row_mask:0xf bank_mask:0xf
  v_add_f32_dpp v89, v45, v44 quad_perm:[3,3,3,3] row_mask:0xf bank_mask:0xf
  s_nop 1
  v_add_f32_dpp v24, v89, v88 quad_perm:[2,2,2,2] row_mask:0xf bank_mask:0x2
  v_mfma_f32_16x16x32_bf16 v[42:45], a[152:155], v[12:15], 0
  v_mfma_f32_16x16x32_bf16 v[42:45], a[156:159], v[16:19], v[42:45]
  s_waitcnt vmcnt(11)
  buffer_load_dwordx4 v[208:211], v4, s[44:47], s101 offen offset:256 nt
  v_add_f32_dpp v88, v39, v38 quad_perm:[1,1,1,1] row_mask:0xf bank_mask:0xf
  v_add_f32_dpp v89, v41, v40 quad_perm:[3,3,3,3] row_mask:0xf bank_mask:0xf
  s_nop 1
  v_add_f32_dpp v24, v89, v88 quad_perm:[2,2,2,2] row_mask:0xf bank_mask:0x4
  v_mfma_f32_16x16x32_bf16 v[38:41], a[160:163], v[12:15], 0
  v_mfma_f32_16x16x32_bf16 v[38:41], a[164:167], v[16:19], v[38:41]
  v_add_f32_dpp v88, v43, v42 quad_perm:[1,1,1,1] row_mask:0xf bank_mask:0xf
  v_add_f32_dpp v89, v45, v44 quad_perm:[3,3,3,3] row_mask:0xf bank_mask:0xf
  s_nop 1
  v_add_f32_dpp v24, v89, v88 quad_perm:[2,2,2,2] row_mask:0xf bank_mask:0x8
  v_mfma_f32_16x16x32_bf16 v[42:45], a[168:171], v[12:15], 0
  v_mfma_f32_16x16x32_bf16 v[42:45], a[172:175], v[16:19], v[42:45]
  s_waitcnt vmcnt(11)
  buffer_load_dwordx4 v[212:215], v4, s[44:47], s101 offen offset:2048 nt
  v_add_f32_dpp v88, v39, v38 quad_perm:[1,1,1,1] row_mask:0xf bank_mask:0xf
  v_add_f32_dpp v89, v41, v40 quad_perm:[3,3,3,3] row_mask:0xf bank_mask:0xf
  s_nop 1
  v_add_f32_dpp v25, v89, v88 quad_perm:[2,2,2,2] row_mask:0xf bank_mask:0x1
  v_mfma_f32_16x16x32_bf16 v[38:41], a[176:179], v[12:15], 0
  v_mfma_f32_16x16x32_bf16 v[38:41], a[180:183], v[16:19], v[38:41]
  v_add_f32_dpp v88, v43, v42 quad_perm:[1,1,1,1] row_mask:0xf bank_mask:0xf
  v_add_f32_dpp v89, v45, v44 quad_perm:[3,3,3,3] row_mask:0xf bank_mask:0xf
  s_nop 1
  v_add_f32_dpp v25, v89, v88 quad_perm:[2,2,2,2] row_mask:0xf bank_mask:0x2
  v_mfma_f32_16x16x32_bf16 v[42:45], a[184:187], v[12:15], 0
  v_mfma_f32_16x16x32_bf16 v[42:45], a[188:191], v[16:19], v[42:45]
  s_waitcnt vmcnt(11)
  buffer_load_dwordx4 v[216:219], v4, s[44:47], s101 offen offset:2304 nt
  v_add_f32_dpp v88, v39, v38 quad_perm:[1,1,1,1] row_mask:0xf bank_mask:0xf
  v_add_f32_dpp v89, v41, v40 quad_perm:[3,3,3,3] row_mask:0xf bank_mask:0xf
  s_nop 1
  v_add_f32_dpp v25, v89, v88 quad_perm:[2,2,2,2] row_mask:0xf bank_mask:0x4
  v_mfma_f32_16x16x32_bf16 v[38:41], a[192:195], v[12:15], 0
  v_mfma_f32_16x16x32_bf16 v[38:41], a[196:199], v[16:19], v[38:41]
  v_add_f32_dpp v88, v43, v42 quad_perm:[1,1,1,1] row_mask:0xf bank_mask:0xf
  v_add_f32_dpp v89, v45, v44 quad_perm:[3,3,3,3] row_mask:0xf bank_mask:0xf
  s_nop 1
  v_add_f32_dpp v25, v89, v88 quad_perm:[2,2,2,2] row_mask:0xf bank_mask:0x8
  v_mfma_f32_16x16x32_bf16 v[42:45], a[200:203], v[12:15], 0
  v_mfma_f32_16x16x32_bf16 v[42:45], a[204:207], v[16:19], v[42:45]
  s_waitcnt vmcnt(11)
  s_add_u32 s101, s101, 16384
  s_cmp_eq_u32 s101, s20
  s_cselect_b32 s101, 0, s101
  buffer_load_dwordx4 v[220:223], v4, s[44:47], s101 offen offset:0 nt
  v_add_f32_dpp v88, v39, v38 quad_perm:[1,1,1,1] row_mask:0xf bank_mask:0xf
  v_add_f32_dpp v89, v41, v40 quad_perm:[3,3,3,3] row_mask:0xf bank_mask:0xf
  s_nop 1
  v_add_f32_dpp v26, v89, v88 quad_perm:[2,2,2,2] row_mask:0xf bank_mask:0x1
  v_mfma_f32_16x16x32_bf16 v[38:41], a[208:211], v[12:15], 0
  v_mfma_f32_16x16x32_bf16 v[38:41], a[212:215], v[16:19], v[38:41]
  v_add_f32_dpp v88, v43, v42 quad_perm:[1,1,1,1] row_mask:0xf bank_mask:0xf
  v_add_f32_dpp v89, v45, v44 quad_perm:[3,3,3,3] row_mask:0xf bank_mask:0xf
  s_nop 1
  v_add_f32_dpp v26, v89, v88 quad_perm:[2,2,2,2] row_mask:0xf bank_mask:0x2
  v_mfma_f32_16x16x32_bf16 v[42:45], a[216:219], v[12:15], 0
  v_mfma_f32_16x16x32_bf16 v[42:45], a[220:223], v[16:19], v[42:45]
  s_waitcnt vmcnt(11)
  buffer_load_dwordx4 v[224:227], v4, s[44:47], s101 offen offset:256 nt
  v_add_f32_dpp v88, v39, v38 quad_perm:[1,1,1,1] row_mask:0xf bank_mask:0xf
  v_add_f32_dpp v89, v41, v40 quad_perm:[3,3,3,3] row_mask:0xf bank_mask:0xf
  s_nop 1
  v_add_f32_dpp v26, v89, v88 quad_perm:[2,2,2,2] row_mask:0xf bank_mask:0x4
  v_mfma_f32_16x16x32_bf16 v[38:41], a[224:227], v[12:15], 0
  v_mfma_f32_16x16x32_bf16 v[38:41], a[228:231], v[16:19], v[38:41]
  v_add_f32_dpp v88, v43, v42 quad_perm:[1,1,1,1] row_mask:0xf bank_mask:0xf
  v_add_f32_dpp v89, v45, v44 quad_perm:[3,3,3,3] row_mask:0xf bank_mask:0xf
  s_nop 1
  v_add_f32_dpp v26, v89, v88 quad_perm:[2,2,2,2] row_mask:0xf bank_mask:0x8
  v_mfma_f32_16x16x32_bf16 v[42:45], a[232:235], v[12:15], 0
  v_mfma_f32_16x16x32_bf16 v[42:45], a[236:239], v[16:19], v[42:45]
  s_waitcnt vmcnt(11)
  buffer_load_dwordx4 v[228:231], v4, s[44:47], s101 offen offset:2048 nt
  v_add_f32_dpp v88, v39, v38 quad_perm:[1,1,1,1] row_mask:0xf bank_mask:0xf
  v_add_f32_dpp v89, v41, v40 quad_perm:[3,3,3,3] row_mask:0xf bank_mask:0xf
  s_nop 1
  v_add_f32_dpp v27, v89, v88 quad_perm:[2,2,2,2] row_mask:0xf bank_mask:0x1
  v_mfma_f32_16x16x32_bf16 v[38:41], a[240:243], v[12:15], 0
  v_mfma_f32_16x16x32_bf16 v[38:41], a[244:247], v[16:19], v[38:41]
  v_add_f32_dpp v88, v43, v42 quad_perm:[1,1,1,1] row_mask:0xf bank_mask:0xf
  v_add_f32_dpp v89, v45, v44 quad_perm:[3,3,3,3] row_mask:0xf bank_mask:0xf
  s_nop 1
  v_add_f32_dpp v27, v89, v88 quad_perm:[2,2,2,2] row_mask:0xf bank_mask:0x2
  v_mfma_f32_16x16x32_bf16 v[42:45], a[248:251], v[12:15], 0
  v_mfma_f32_16x16x32_bf16 v[42:45], a[252:255], v[16:19], v[42:45]
  s_waitcnt vmcnt(11)
  buffer_load_dwordx4 v[232:235], v4, s[44:47], s101 offen offset:2304 nt
  v_add_f32_dpp v88, v39, v38 quad_perm:[1,1,1,1] row_mask:0xf bank_mask:0xf
  v_add_f32_dpp v89, v41, v40 quad_perm:[3,3,3,3] row_mask:0xf bank_mask:0xf
  s_nop 1
  v_add_f32_dpp v27, v89, v88 quad_perm:[2,2,2,2] row_mask:0xf bank_mask:0x4
  v_mfma_f32_16x16x32_bf16 v[38:41], v[124:127], v[12:15], 0
  v_mfma_f32_16x16x32_bf16 v[38:41], v[128:131], v[16:19], v[38:41]
  v_add_f32_dpp v88, v43, v42 quad_perm:[1,1,1,1] row_mask:0xf bank_mask:0xf
  v_add_f32_dpp v89, v45, v44 quad_perm:[3,3,3,3] row_mask:0xf bank_mask:0xf
  s_nop 1
  v_add_f32_dpp v27, v89, v88 quad_perm:[2,2,2,2] row_mask:0xf bank_mask:0x8
  v_mfma_f32_16x16x32_bf16 v[42:45], v[132:135], v[12:15], 0
  v_mfma_f32_16x16x32_bf16 v[42:45], v[136:139], v[16:19], v[42:45]
  s_waitcnt vmcnt(11)
  s_add_u32 s101, s101, 16384
  s_cmp_eq_u32 s101, s20
  s_cselect_b32 s101, 0, s101
  buffer_load_dwordx4 v[236:239], v4, s[44:47], s101 offen offset:0 nt
  v_add_f32_dpp v88, v39, v38 quad_perm:[1,1,1,1] row_mask:0xf bank_mask:0xf
  v_add_f32_dpp v89, v41, v40 quad_perm:[3,3,3,3] row_mask:0xf bank_mask:0xf
  s_nop 1
  v_add_f32_dpp v28, v89, v88 quad_perm:[2,2,2,2] row_mask:0xf bank_mask:0x1
  v_mfma_f32_16x16x32_bf16 v[38:41], v[140:143], v[12:15], 0
  v_mfma_f32_16x16x32_bf16 v[38:41], v[144:147], v[16:19], v[38:41]
  v_add_f32_dpp v88, v43, v42 quad_perm:[1,1,1,1] row_mask:0xf bank_mask:0xf
  v_add_f32_dpp v89, v45, v44 quad_perm:[3,3,3,3] row_mask:0xf bank_mask:0xf
  s_nop 1
  v_add_f32_dpp v28, v89, v88 quad_perm:[2,2,2,2] row_mask:0xf bank_mask:0x2
  v_mfma_f32_16x16x32_bf16 v[42:45], v[148:151], v[12:15], 0
  v_mfma_f32_16x16x32_bf16 v[42:45], v[152:155], v[16:19], v[42:45]
  s_waitcnt vmcnt(11)
  buffer_load_dwordx4 v[240:243], v4, s[44:47], s101 offen offset:256 nt
  v_add_f32_dpp v88, v39, v38 quad_perm:[1,1,1,1] row_mask:0xf bank_mask:0xf
  v_add_f32_dpp v89, v41, v40 quad_perm:[3,3,3,3] row_mask:0xf bank_mask:0xf
  s_nop 1
  v_add_f32_dpp v28, v89, v88 quad_perm:[2,2,2,2] row_mask:0xf bank_mask:0x4
  v_mfma_f32_16x16x32_bf16 v[38:41], v[156:159], v[12:15], 0
  v_mfma_f32_16x16x32_bf16 v[38:41], v[160:163], v[16:19], v[38:41]
  v_add_f32_dpp v88, v43, v42 quad_perm:[1,1,1,1] row_mask:0xf bank_mask:0xf
  v_add_f32_dpp v89, v45, v44 quad_perm:[3,3,3,3] row_mask:0xf bank_mask:0xf
  s_nop 1
  v_add_f32_dpp v28, v89, v88 quad_perm:[2,2,2,2] row_mask:0xf bank_mask:0x8
  v_mfma_f32_16x16x32_bf16 v[42:45], v[164:167], v[12:15], 0
  v_mfma_f32_16x16x32_bf16 v[42:45], v[168:171], v[16:19], v[42:45]
  s_waitcnt vmcnt(11)
  buffer_load_dwordx4 v[244:247], v4, s[44:47], s101 offen offset:2048 nt
  v_add_f32_dpp v88, v39, v38 quad_perm:[1,1,1,1] row_mask:0xf bank_mask:0xf
  v_add_f32_dpp v89, v41, v40 quad_perm:[3,3,3,3] row_mask:0xf bank_mask:0xf
  s_nop 1
  v_add_f32_dpp v29, v89, v88 quad_perm:[2,2,2,2] row_mask:0xf bank_mask:0x1
  v_mfma_f32_16x16x32_bf16 v[38:41], v[172:175], v[12:15], 0
  v_mfma_f32_16x16x32_bf16 v[38:41], v[176:179], v[16:19], v[38:41]
  v_add_f32_dpp v88, v43, v42 quad_perm:[1,1,1,1] row_mask:0xf bank_mask:0xf
  v_add_f32_dpp v89, v45, v44 quad_perm:[3,3,3,3] row_mask:0xf bank_mask:0xf
  s_nop 1
  v_add_f32_dpp v29, v89, v88 quad_perm:[2,2,2,2] row_mask:0xf bank_mask:0x2
  v_mfma_f32_16x16x32_bf16 v[42:45], v[180:183], v[12:15], 0
  v_mfma_f32_16x16x32_bf16 v[42:45], v[184:187], v[16:19], v[42:45]
  s_waitcnt vmcnt(11)
  buffer_load_dwordx4 v[248:251], v4, s[44:47], s101 offen offset:2304 nt
  v_add_f32_dpp v88, v39, v38 quad_perm:[1,1,1,1] row_mask:0xf bank_mask:0xf
  v_add_f32_dpp v89, v41, v40 quad_perm:[3,3,3,3] row_mask:0xf bank_mask:0xf
  s_nop 1
  v_add_f32_dpp v29, v89, v88 quad_perm:[2,2,2,2] row_mask:0xf bank_mask:0x4
  v_mfma_f32_16x16x32_bf16 v[38:41], v[188:191], v[12:15], 0
  v_mfma_f32_16x16x32_bf16 v[38:41], v[192:195], v[16:19], v[38:41]
  v_add_f32_dpp v88, v43, v42 quad_perm:[1,1,1,1] row_mask:0xf bank_mask:0xf
  v_add_f32_dpp v89, v45, v44 quad_perm:[3,3,3,3] row_mask:0xf bank_mask:0xf
  s_nop 1
  v_add_f32_dpp v29, v89, v88 quad_perm:[2,2,2,2] row_mask:0xf bank_mask:0x8
  v_mfma_f32_16x16x32_bf16 v[42:45], v[196:199], v[12:15], 0
  v_mfma_f32_16x16x32_bf16 v[42:45], v[200:203], v[16:19], v[42:45]
  s_waitcnt vmcnt(11)
  s_add_u32 s101, s101, 16384
  s_cmp_eq_u32 s101, s20
  s_cselect_b32 s101, 0, s101
  buffer_load_dwordx4 v[252:255], v4, s[44:47], s101 offen offset:0 nt
  v_add_f32_dpp v88, v39, v38 quad_perm:[1,1,1,1] row_mask:0xf bank_mask:0xf
  v_add_f32_dpp v89, v41, v40 quad_perm:[3,3,3,3] row_mask:0xf bank_mask:0xf
  s_nop 1
  v_add_f32_dpp v30, v89, v88 quad_perm:[2,2,2,2] row_mask:0xf bank_mask:0x1
  s_waitcnt vmcnt(11)
  v_mfma_f32_16x16x32_bf16 v[38:41], v[204:207], v[12:15], 0
  v_mfma_f32_16x16x32_bf16 v[38:41], v[208:211], v[16:19], v[38:41]
  buffer_load_dwordx4 v[96:99], v4, s[44:47], s101 offen offset:256 nt
  v_add_f32_dpp v88, v43, v42 quad_perm:[1,1,1,1] row_mask:0xf bank_mask:0xf
  v_add_f32_dpp v89, v45, v44 quad_perm:[3,3,3,3] row_mask:0xf bank_mask:0xf
  s_nop 1
  v_add_f32_dpp v30, v89, v88 quad_perm:[2,2,2,2] row_mask:0xf bank_mask:0x2
  s_waitcnt vmcnt(10)
  v_mfma_f32_16x16x32_bf16 v[42:45], v[212:215], v[12:15], 0
  v_mfma_f32_16x16x32_bf16 v[42:45], v[216:219], v[16:19], v[42:45]
  buffer_load_dwordx4 v[100:103], v4, s[44:47], s101 offen offset:2048 nt
  buffer_load_dwordx4 v[104:107], v4, s[44:47], s101 offen offset:2304 nt
  v_add_f32_dpp v88, v39, v38 quad_perm:[1,1,1,1] row_mask:0xf bank_mask:0xf
  v_add_f32_dpp v89, v41, v40 quad_perm:[3,3,3,3] row_mask:0xf bank_mask:0xf
  s_nop 1
  v_add_f32_dpp v30, v89, v88 quad_perm:[2,2,2,2] row_mask:0xf bank_mask:0x4
  s_waitcnt vmcnt(10)
  v_mfma_f32_16x16x32_bf16 v[38:41], v[220:223], v[12:15], 0
  v_mfma_f32_16x16x32_bf16 v[38:41], v[224:227], v[16:19], v[38:41]
  s_add_u32 s101, s101, 16384
  s_cmp_eq_u32 s101, s20
  s_cselect_b32 s101, 0, s101
  buffer_load_dwordx4 v[108:111], v4, s[44:47], s101 offen offset:0 nt
  buffer_load_dwordx4 v[112:115], v4, s[44:47], s101 offen offset:256 nt
  v_add_f32_dpp v88, v43, v42 quad_perm:[1,1,1,1] row_mask:0xf bank_mask:0xf
  v_add_f32_dpp v89, v45, v44 quad_perm:[3,3,3,3] row_mask:0xf bank_mask:0xf
  s_nop 1
  v_add_f32_dpp v30, v89, v88 quad_perm:[2,2,2,2] row_mask:0xf bank_mask:0x8
  s_waitcnt vmcnt(10)
  v_mfma_f32_16x16x32_bf16 v[42:45], v[228:231], v[12:15], 0
  v_mfma_f32_16x16x32_bf16 v[42:45], v[232:235], v[16:19], v[42:45]
  buffer_load_dwordx4 v[116:119], v4, s[44:47], s101 offen offset:2048 nt
  buffer_load_dwordx4 v[120:123], v4, s[44:47], s101 offen offset:2304 nt
  v_add_f32_dpp v88, v39, v38 quad_perm:[1,1,1,1] row_mask:0xf bank_mask:0xf
  v_add_f32_dpp v89, v41, v40 quad_perm:[3,3,3,3] row_mask:0xf bank_mask:0xf
  s_nop 1
  v_add_f32_dpp v31, v89, v88 quad_perm:[2,2,2,2] row_mask:0xf bank_mask:0x1
  s_waitcnt vmcnt(10)
  v_mfma_f32_16x16x32_bf16 v[38:41], v[236:239], v[12:15], 0
  v_mfma_f32_16x16x32_bf16 v[38:41], v[240:243], v[16:19], v[38:41]
  s_add_u32 s101, s101, 16384
  s_cmp_eq_u32 s101, s20
  s_cselect_b32 s101, 0, s101
  buffer_load_dwordx4 v[124:127], v4, s[44:47], s101 offen offset:0 nt
  buffer_load_dwordx4 v[128:131], v4, s[44:47], s101 offen offset:256 nt
  v_add_f32_dpp v88, v43, v42 quad_perm:[1,1,1,1] row_mask:0xf bank_mask:0xf
  v_add_f32_dpp v89, v45, v44 quad_perm:[3,3,3,3] row_mask:0xf bank_mask:0xf
  s_nop 1
  v_add_f32_dpp v31, v89, v88 quad_perm:[2,2,2,2] row_mask:0xf bank_mask:0x2
  s_waitcnt vmcnt(10)
  v_mfma_f32_16x16x32_bf16 v[42:45], v[244:247], v[12:15], 0
  v_mfma_f32_16x16x32_bf16 v[42:45], v[248:251], v[16:19], v[42:45]
  buffer_load_dwordx4 v[132:135], v4, s[44:47], s101 offen offset:2048 nt
  buffer_load_dwordx4 v[136:139], v4, s[44:47], s101 offen offset:2304 nt
  v_add_f32_dpp v88, v39, v38 quad_perm:[1,1,1,1] row_mask:0xf bank_mask:0xf
  v_add_f32_dpp v89, v41, v40 quad_perm:[3,3,3,3] row_mask:0xf bank_mask:0xf
  s_nop 1
  v_add_f32_dpp v31, v89, v88 quad_perm:[2,2,2,2] row_mask:0xf bank_mask:0x4
  s_waitcnt vmcnt(10)
  v_mfma_f32_16x16x32_bf16 v[38:41], v[252:255], v[12:15], 0
  v_mfma_f32_16x16x32_bf16 v[38:41], v[96:99], v[16:19], v[38:41]
  s_add_u32 s101, s101, 16384
  s_cmp_eq_u32 s101, s20
  s_cselect_b32 s101, 0, s101
  buffer_load_dwordx4 v[140:143], v4, s[44:47], s101 offen offset:0 nt
  buffer_load_dwordx4 v[144:147], v4, s[44:47], s101 offen offset:256 nt
  v_add_f32_dpp v88, v43, v42 quad_perm:[1,1,1,1] row_mask:0xf bank_mask:0xf
  v_add_f32_dpp v89, v45, v44 quad_perm:[3,3,3,3] row_mask:0xf bank_mask:0xf
  s_nop 1
  v_add_f32_dpp v31, v89, v88 quad_perm:[2,2,2,2] row_mask:0xf bank_mask:0x8
  s_waitcnt vmcnt(10)
  v_mfma_f32_16x16x32_bf16 v[42:45], v[100:103], v[12:15], 0
  v_mfma_f32_16x16x32_bf16 v[42:45], v[104:107], v[16:19], v[42:45]
  buffer_load_dwordx4 v[148:151], v4, s[44:47], s101 offen offset:2048 nt
  buffer_load_dwordx4 v[152:155], v4, s[44:47], s101 offen offset:2304 nt
  v_add_f32_dpp v88, v39, v38 quad_perm:[1,1,1,1] row_mask:0xf bank_mask:0xf
  v_add_f32_dpp v89, v41, v40 quad_perm:[3,3,3,3] row_mask:0xf bank_mask:0xf
  s_nop 1
  v_add_f32_dpp v32, v89, v88 quad_perm:[2,2,2,2] row_mask:0xf bank_mask:0x1
  s_waitcnt vmcnt(10)
  v_mfma_f32_16x16x32_bf16 v[38:41], v[108:111], v[12:15], 0
  v_mfma_f32_16x16x32_bf16 v[38:41], v[112:115], v[16:19], v[38:41]
  s_add_u32 s101, s101, 16384
  s_cmp_eq_u32 s101, s20
  s_cselect_b32 s101, 0, s101
  buffer_load_dwordx4 v[156:159], v4, s[44:47], s101 offen offset:0 nt
  buffer_load_dwordx4 v[160:163], v4, s[44:47], s101 offen offset:256 nt
  v_add_f32_dpp v88, v43, v42 quad_perm:[1,1,1,1] row_mask:0xf bank_mask:0xf
  v_add_f32_dpp v89, v45, v44 quad_perm:[3,3,3,3] row_mask:0xf bank_mask:0xf
  s_nop 1
  v_add_f32_dpp v32, v89, v88 quad_perm:[2,2,2,2] row_mask:0xf bank_mask:0x2
  s_waitcnt vmcnt(10)
  v_mfma_f32_16x16x32_bf16 v[42:45], v[116:119], v[12:15], 0
  v_mfma_f32_16x16x32_bf16 v[42:45], v[120:123], v[16:19], v[42:45]
  buffer_load_dwordx4 v[164:167], v4, s[44:47], s101 offen offset:2048 nt
  buffer_load_dwordx4 v[168:171], v4, s[44:47], s101 offen offset:2304 nt
  v_add_f32_dpp v88, v39, v38 quad_perm:[1,1,1,1] row_mask:0xf bank_mask:0xf
  v_add_f32_dpp v89, v41, v40 quad_perm:[3,3,3,3] row_mask:0xf bank_mask:0xf
  s_nop 1
  v_add_f32_dpp v32, v89, v88 quad_perm:[2,2,2,2] row_mask:0xf bank_mask:0x4
  s_waitcnt vmcnt(10)
  v_mfma_f32_16x16x32_bf16 v[38:41], v[124:127], v[12:15], 0
  v_mfma_f32_16x16x32_bf16 v[38:41], v[128:131], v[16:19], v[38:41]
  s_add_u32 s101, s101, 16384
  s_cmp_eq_u32 s101, s20
  s_cselect_b32 s101, 0, s101
  buffer_load_dwordx4 v[172:175], v4, s[44:47], s101 offen offset:0 nt
  buffer_load_dwordx4 v[176:179], v4, s[44:47], s101 offen offset:256 nt
  v_add_f32_dpp v88, v43, v42 quad_perm:[1,1,1,1] row_mask:0xf bank_mask:0xf
  v_add_f32_dpp v89, v45, v44 quad_perm:[3,3,3,3] row_mask:0xf bank_mask:0xf
  s_nop 1
  v_add_f32_dpp v32, v89, v88 quad_perm:[2,2,2,2] row_mask:0xf bank_mask:0x8
  s_waitcnt vmcnt(10)
  v_mfma_f32_16x16x32_bf16 v[42:45], v[132:135], v[12:15], 0
  v_mfma_f32_16x16x32_bf16 v[42:45], v[136:139], v[16:19], v[42:45]
  buffer_load_dwordx4 v[180:183], v4, s[44:47], s101 offen offset:2048 nt
  buffer_load_dwordx4 v[184:187], v4, s[44:47], s101 offen offset:2304 nt
  v_add_f32_dpp v88, v39, v38 quad_perm:[1,1,1,1] row_mask:0xf bank_mask:0xf
  v_add_f32_dpp v89, v41, v40 quad_perm:[3,3,3,3] row_mask:0xf bank_mask:0xf
  s_nop 1
  v_add_f32_dpp v33, v89, v88 quad_perm:[2,2,2,2] row_mask:0xf bank_mask:0x1
  s_waitcnt vmcnt(10)
  v_mfma_f32_16x16x32_bf16 v[38:41], v[140:143], v[12:15], 0
  v_mfma_f32_16x16x32_bf16 v[38:41], v[144:147], v[16:19], v[38:41]
  s_add_u32 s101, s101, 16384
  s_cmp_eq_u32 s101, s20
  s_cselect_b32 s101, 0, s101
  buffer_load_dwordx4 v[188:191], v4, s[44:47], s101 offen offset:0 nt
  buffer_load_dwordx4 v[192:195], v4, s[44:47], s101 offen offset:256 nt
  v_add_f32_dpp v88, v43, v42 quad_perm:[1,1,1,1] row_mask:0xf bank_mask:0xf
  v_add_f32_dpp v89, v45, v44 quad_perm:[3,3,3,3] row_mask:0xf bank_mask:0xf
  s_nop 1
  v_add_f32_dpp v33, v89, v88 quad_perm:[2,2,2,2] row_mask:0xf bank_mask:0x2
  s_waitcnt vmcnt(10)
  v_mfma_f32_16x16x32_bf16 v[42:45], v[148:151], v[12:15], 0
  v_mfma_f32_16x16x32_bf16 v[42:45], v[152:155], v[16:19], v[42:45]
  buffer_load_dwordx4 v[196:199], v4, s[44:47], s101 offen offset:2048 nt
  buffer_load_dwordx4 v[200:203], v4, s[44:47], s101 offen offset:2304 nt
  v_add_f32_dpp v88, v39, v38 quad_perm:[1,1,1,1] row_mask:0xf bank_mask:0xf
  v_add_f32_dpp v89, v41, v40 quad_perm:[3,3,3,3] row_mask:0xf bank_mask:0xf
  s_nop 1
  v_add_f32_dpp v33, v89, v88 quad_perm:[2,2,2,2] row_mask:0xf bank_mask:0x4
  s_waitcnt vmcnt(10)
  v_mfma_f32_16x16x32_bf16 v[38:41], v[156:159], v[12:15], 0
  v_mfma_f32_16x16x32_bf16 v[38:41], v[160:163], v[16:19], v[38:41]
  s_add_u32 s101, s101, 16384
  s_cmp_eq_u32 s101, s20
  s_cselect_b32 s101, 0, s101
  buffer_load_dwordx4 v[204:207], v4, s[44:47], s101 offen offset:0 nt
  buffer_load_dwordx4 v[208:211], v4, s[44:47], s101 offen offset:256 nt
  v_add_f32_dpp v88, v43, v42 quad_perm:[1,1,1,1] row_mask:0xf bank_mask:0xf
  v_add_f32_dpp v89, v45, v44 quad_perm:[3,3,3,3] row_mask:0xf bank_mask:0xf
  s_nop 1
  v_add_f32_dpp v33, v89, v88 quad_perm:[2,2,2,2] row_mask:0xf bank_mask:0x8
  s_waitcnt vmcnt(10)
  v_mfma_f32_16x16x32_bf16 v[42:45], v[164:167], v[12:15], 0
  v_mfma_f32_16x16x32_bf16 v[42:45], v[168:171], v[16:19], v[42:45]
  buffer_load_dwordx4 v[212:215], v4, s[44:47], s101 offen offset:2048 nt
  buffer_load_dwordx4 v[216:219], v4, s[44:47], s101 offen offset:2304 nt
  v_add_f32_dpp v88, v39, v38 quad_perm:[1,1,1,1] row_mask:0xf bank_mask:0xf
  v_add_f32_dpp v89, v41, v40 quad_perm:[3,3,3,3] row_mask:0xf bank_mask:0xf
  s_nop 1
  v_add_f32_dpp v34, v89, v88 quad_perm:[2,2,2,2] row_mask:0xf bank_mask:0x1
  s_waitcnt vmcnt(10)
  v_mfma_f32_16x16x32_bf16 v[38:41], v[172:175], v[12:15], 0
  v_mfma_f32_16x16x32_bf16 v[38:41], v[176:179], v[16:19], v[38:41]
  s_add_u32 s101, s101, 16384
  s_cmp_eq_u32 s101, s20
  s_cselect_b32 s101, 0, s101
  buffer_load_dwordx4 v[220:223], v4, s[44:47], s101 offen offset:0 nt
  buffer_load_dwordx4 v[224:227], v4, s[44:47], s101 offen offset:256 nt
  v_add_f32_dpp v88, v43, v42 quad_perm:[1,1,1,1] row_mask:0xf bank_mask:0xf
  v_add_f32_dpp v89, v45, v44 quad_perm:[3,3,3,3] row_mask:0xf bank_mask:0xf
  s_nop 1
  v_add_f32_dpp v34, v89, v88 quad_perm:[2,2,2,2] row_mask:0xf bank_mask:0x2
  s_waitcnt vmcnt(10)
  v_mfma_f32_16x16x32_bf16 v[42:45], v[180:183], v[12:15], 0
  v_mfma_f32_16x16x32_bf16 v[42:45], v[184:187], v[16:19], v[42:45]
  buffer_load_dwordx4 v[228:231], v4, s[44:47], s101 offen offset:2048 nt
  buffer_load_dwordx4 v[232:235], v4, s[44:47], s101 offen offset:2304 nt
  v_add_f32_dpp v88, v39, v38 quad_perm:[1,1,1,1] row_mask:0xf bank_mask:0xf
  v_add_f32_dpp v89, v41, v40 quad_perm:[3,3,3,3] row_mask:0xf bank_mask:0xf
  s_nop 1
  v_add_f32_dpp v34, v89, v88 quad_perm:[2,2,2,2] row_mask:0xf bank_mask:0x4
  s_waitcnt vmcnt(10)
  v_mfma_f32_16x16x32_bf16 v[38:41], v[188:191], v[12:15], 0
  v_mfma_f32_16x16x32_bf16 v[38:41], v[192:195], v[16:19], v[38:41]
  buffer_load_dwordx4 v[236:239], v5, s[48:51], s21 offen offset:0 nt
  buffer_load_dwordx4 v[240:243], v5, s[48:51], s21 offen offset:256 nt
  v_add_f32_dpp v88, v43, v42 quad_perm:[1,1,1,1] row_mask:0xf bank_mask:0xf
  v_add_f32_dpp v89, v45, v44 quad_perm:[3,3,3,3] row_mask:0xf bank_mask:0xf
  s_nop 1
  v_add_f32_dpp v34, v89, v88 quad_perm:[2,2,2,2] row_mask:0xf bank_mask:0x8
  s_waitcnt vmcnt(10)
  v_mfma_f32_16x16x32_bf16 v[42:45], v[196:199], v[12:15], 0
  v_mfma_f32_16x16x32_bf16 v[42:45], v[200:203], v[16:19], v[42:45]
  buffer_load_dwordx4 v[244:247], v5, s[48:51], s21 offen offset:2048 nt
  buffer_load_dwordx4 v[248:251], v5, s[48:51], s21 offen offset:2304 nt
  v_add_f32_dpp v88, v39, v38 quad_perm:[1,1,1,1] row_mask:0xf bank_mask:0xf
  v_add_f32_dpp v89, v41, v40 quad_perm:[3,3,3,3] row_mask:0xf bank_mask:0xf
  s_nop 1
  v_add_f32_dpp v35, v89, v88 quad_perm:[2,2,2,2] row_mask:0xf bank_mask:0x1
  s_waitcnt vmcnt(10)
  v_mfma_f32_16x16x32_bf16 v[38:41], v[204:207], v[12:15], 0
  v_mfma_f32_16x16x32_bf16 v[38:41], v[208:211], v[16:19], v[38:41]
  s_add_u32 s21, s21, 16384
  s_cmp_eq_u32 s21, s20
  s_cselect_b32 s21, 0, s21
  buffer_load_dwordx4 v[252:255], v5, s[48:51], s21 offen offset:0 nt
  buffer_load_dwordx4 v[96:99], v5, s[48:51], s21 offen offset:256 nt
  s_mov_b32 s96, 0
  buffer_load_dwordx4 a[0:3], v6, s[56:59], s96 offen offset:0
  s_mov_b32 s96, 0
  buffer_load_dwordx4 a[4:7], v6, s[56:59], s96 offen offset:256
  v_add_f32_dpp v88, v43, v42 quad_perm:[1,1,1,1] row_mask:0xf bank_mask:0xf
  v_add_f32_dpp v89, v45, v44 quad_perm:[3,3,3,3] row_mask:0xf bank_mask:0xf
  s_nop 1
  v_add_f32_dpp v35, v89, v88 quad_perm:[2,2,2,2] row_mask:0xf bank_mask:0x2
  s_waitcnt vmcnt(12)
  v_mfma_f32_16x16x32_bf16 v[42:45], v[212:215], v[12:15], 0
  v_mfma_f32_16x16x32_bf16 v[42:45], v[216:219], v[16:19], v[42:45]
  s_waitcnt vmcnt(11)
  buffer_load_dwordx4 v[100:103], v5, s[48:51], s21 offen offset:2048 nt
  s_waitcnt vmcnt(11)
  buffer_load_dwordx4 v[104:107], v5, s[48:51], s21 offen offset:2304 nt
  s_mov_b32 s96, 0
  buffer_load_dwordx4 a[8:11], v6, s[56:59], s96 offen offset:512
  v_add_f32_dpp v88, v39, v38 quad_perm:[1,1,1,1] row_mask:0xf bank_mask:0xf
  v_add_f32_dpp v89, v41, v40 quad_perm:[3,3,3,3] row_mask:0xf bank_mask:0xf
  s_nop 1
  v_add_f32_dpp v35, v89, v88 quad_perm:[2,2,2,2] row_mask:0xf bank_mask:0x4
  v_mfma_f32_16x16x32_bf16 v[38:41], v[220:223], v[12:15], 0
  v_mfma_f32_16x16x32_bf16 v[38:41], v[224:227], v[16:19], v[38:41]
  s_waitcnt vmcnt(11)
  s_add_u32 s21, s21, 16384
  s_cmp_eq_u32 s21, s20
  s_cselect_b32 s21, 0, s21
  buffer_load_dwordx4 v[108:111], v5, s[48:51], s21 offen offset:0 nt
  s_waitcnt vmcnt(11)
  buffer_load_dwordx4 v[112:115], v5, s[48:51], s21 offen offset:256 nt
  s_mov_b32 s96, 0
  buffer_load_dwordx4 a[12:15], v7, s[56:59], s96 offen offset:768
  v_add_f32_dpp v88, v43, v42 quad_perm:[1,1,1,1] row_mask:0xf bank_mask:0xf
  v_add_f32_dpp v89, v45, v44 quad_perm:[3,3,3,3] row_mask:0xf bank_mask:0xf
  s_nop 1
  v_add_f32_dpp v35, v89, v88 quad_perm:[2,2,2,2] row_mask:0xf bank_mask:0x8
  v_mfma_f32_16x16x32_bf16 v[42:45], v[228:231], v[12:15], 0
  v_mfma_f32_16x16x32_bf16 v[42:45], v[232:235], v[16:19], v[42:45]
  s_waitcnt vmcnt(11)
  buffer_load_dwordx4 v[116:119], v5, s[48:51], s21 offen offset:2048 nt
  s_waitcnt vmcnt(11)
  buffer_load_dwordx4 v[120:123], v5, s[48:51], s21 offen offset:2304 nt
  s_mov_b32 s96, 3584
  buffer_load_dwordx4 a[16:19], v6, s[56:59], s96 offen offset:0
  v_add_f32_dpp v88, v39, v38 quad_perm:[1,1,1,1] row_mask:0xf bank_mask:0xf
  v_add_f32_dpp v89, v41, v40 quad_perm:[3,3,3,3] row_mask:0xf bank_mask:0xf
  s_nop 1
  v_add_f32_dpp v36, v89, v88 quad_perm:[2,2,2,2] row_mask:0xf bank_mask:0x1
  v_add_f32_dpp v88, v43, v42 quad_perm:[1,1,1,1] row_mask:0xf bank_mask:0xf
  v_add_f32_dpp v89, v45, v44 quad_perm:[3,3,3,3] row_mask:0xf bank_mask:0xf
  s_nop 1
  v_add_f32_dpp v36, v89, v88 quad_perm:[2,2,2,2] row_mask:0xf bank_mask:0x2
  v_max3_f32 v80, v20, v21, v22
  v_max3_f32 v80, v80, v23, v24
  v_max3_f32 v80, v80, v25, v26
  v_max3_f32 v80, v80, v27, v28
  v_max3_f32 v80, v80, v29, v30
  v_max3_f32 v80, v80, v31, v32
  v_max3_f32 v80, v80, v33, v34
  v_max3_f32 v80, v80, v35, v36
  s_nop 1
  v_mov_b32_dpp v81, v80 quad_perm:[0,0,0,0] row_mask:0xf bank_mask:0xf
  s_nop 1
  v_max_f32_dpp v80, v81, v81 row_ror:4 row_mask:0xf bank_mask:0xf
  s_nop 1
  v_max_f32_dpp v81, v80, v80 row_ror:8 row_mask:0xf bank_mask:0xf
  s_lshl_b32 s12, s3, 4
  v_lshlrev_b32 v82, 2, v3
  v_add_u32 v82, s12, v82
  ds_write_b32 v82, v81 offset:2560
  s_waitcnt lgkmcnt(0)
  s_barrier
  v_mov_b32 v83, 0
  ds_read_b128 v[54:57], v83 offset:2560
  ds_read_b128 v[58:61], v83 offset:2576
  ds_read_b128 v[62:65], v83 offset:2592
  ds_read_b128 v[66:69], v83 offset:2608
  s_waitcnt lgkmcnt(0)
  v_max3_f32 v80, v54, v55, v56
  v_max3_f32 v80, v80, v57, v58
  v_max3_f32 v80, v80, v59, v60
  v_max3_f32 v80, v80, v61, v62
  v_max3_f32 v80, v80, v63, v64
  v_max3_f32 v80, v80, v65, v66
  v_max3_f32 v80, v80, v67, v68
  v_max_f32 v80, v80, v69
  v_mul_f32 v80, s92, v80
  v_fma_f32 v20, v20, s92, -v80
  v_fma_f32 v21, v21, s92, -v80
  v_fma_f32 v22, v22, s92, -v80
  v_fma_f32 v23, v23, s92, -v80
  v_fma_f32 v24, v24, s92, -v80
  v_fma_f32 v25, v25, s92, -v80
  v_fma_f32 v26, v26, s92, -v80
  v_fma_f32 v27, v27, s92, -v80
  v_fma_f32 v28, v28, s92, -v80
  v_fma_f32 v29, v29, s92, -v80
  v_fma_f32 v30, v30, s92, -v80
  v_fma_f32 v31, v31, s92, -v80
  v_fma_f32 v32, v32, s92, -v80
  v_fma_f32 v33, v33, s92, -v80
  v_fma_f32 v34, v34, s92, -v80
  v_fma_f32 v35, v35, s92, -v80
  v_fma_f32 v36, v36, s92, -v80
  v_exp_f32 v20, v20
  v_exp_f32 v21, v21
  v_exp_f32 v22, v22
  v_exp_f32 v23, v23
  v_exp_f32 v24, v24
  v_exp_f32 v25, v25
  v_exp_f32 v26, v26
  v_exp_f32 v27, v27
  v_exp_f32 v28, v28
  v_exp_f32 v29, v29
  v_exp_f32 v30, v30
  v_exp_f32 v31, v31
  v_exp_f32 v32, v32
  v_exp_f32 v33, v33
  v_exp_f32 v34, v34
  v_exp_f32 v35, v35
  v_exp_f32 v36, v36
  v_add_f32 v81, v20, v21
  v_add_f32 v81, v81, v22
  v_add_f32 v81, v81, v23
  v_add_f32 v81, v81, v24
  v_add_f32 v81, v81, v25
  v_add_f32 v81, v81, v26
  v_add_f32 v81, v81, v27
  v_add_f32 v81, v81, v28
  v_add_f32 v81, v81, v29
  v_add_f32 v81, v81, v30
  v_add_f32 v81, v81, v31
  v_add_f32 v81, v81, v32
  v_add_f32 v81, v81, v33
  v_add_f32 v81, v81, v34
  v_add_f32 v81, v81, v35
  v_add_f32 v81, v81, v36
  v_cvt_pk_bf16_f32 v20, v20, v20
  v_cvt_pk_bf16_f32 v21, v21, v21
  v_cvt_pk_bf16_f32 v22, v22, v22
  v_cvt_pk_bf16_f32 v23, v23, v23
  v_cvt_pk_bf16_f32 v24, v24, v24
  v_cvt_pk_bf16_f32 v25, v25, v25
  v_cvt_pk_bf16_f32 v26, v26, v26
  v_cvt_pk_bf16_f32 v27, v27, v27
  v_cvt_pk_bf16_f32 v28, v28, v28
  v_cvt_pk_bf16_f32 v29, v29, v29
  v_cvt_pk_bf16_f32 v30, v30, v30
  v_cvt_pk_bf16_f32 v31, v31, v31
  v_cvt_pk_bf16_f32 v32, v32, v32
  v_cvt_pk_bf16_f32 v33, v33, v33
  v_cvt_pk_bf16_f32 v34, v34, v34
  v_cvt_pk_bf16_f32 v35, v35, v35
  v_cvt_pk_bf16_f32 v36, v36, v36
  v_mov_b32_dpp v83, v81 quad_perm:[0,0,0,0] row_mask:0xf bank_mask:0xf
  s_nop 1
  v_add_f32_dpp v81, v83, v83 row_ror:4 row_mask:0xf bank_mask:0xf
  s_nop 1
  v_add_f32_dpp v83, v81, v81 row_ror:8 row_mask:0xf bank_mask:0xf
  ds_write_b32 v82, v83 offset:2688
  s_waitcnt lgkmcnt(0)
  s_barrier
  v_mov_b32 v83, 0
  ds_read_b128 v[54:57], v83 offset:2688
  ds_read_b128 v[58:61], v83 offset:2704
  ds_read_b128 v[62:65], v83 offset:2720
  ds_read_b128 v[66:69], v83 offset:2736
  s_waitcnt lgkmcnt(0)
  v_add_f32 v54, v54, v55
  v_add_f32 v56, v56, v57
  v_add_f32 v58, v58, v59
  v_add_f32 v60, v60, v61
  v_add_f32 v62, v62, v63
  v_add_f32 v64, v64, v65
  v_add_f32 v66, v66, v67
  v_add_f32 v68, v68, v69
  v_add_f32 v54, v54, v56
  v_add_f32 v58, v58, v60
  v_add_f32 v62, v62, v64
  v_add_f32 v66, v66, v68
  v_add_f32 v54, v54, v58
  v_add_f32 v62, v62, v66
  v_add_f32 v54, v54, v62
  v_min_u32 v46, -2, v80
  v_min_u32 v47, -2, v54
  v_cmp_eq_u32 vcc, 0, v0
  v_mov_b32 v84, 0x7ff00000
  v_mov_b32 v85, 0
  v_cndmask_b32 v84, v84, v85, vcc
  s_lshl_b32 s13, s10, 3
  s_add_u32 s13, s13, 786432
  buffer_store_dwordx2 v[46:47], v84, s[64:67], s13 offen sc1
  v_and_b32_dpp v46, v20, v8 row_newbcast:0 row_mask:0xf bank_mask:0xf
  v_and_b32_dpp v47, v20, v9 row_newbcast:0 row_mask:0xf bank_mask:0xf
  v_and_b32_dpp v48, v20, v10 row_newbcast:0 row_mask:0xf bank_mask:0xf
  v_and_b32_dpp v49, v20, v11 row_newbcast:0 row_mask:0xf bank_mask:0xf
  v_and_b32_dpp v50, v20, v8 row_newbcast:4 row_mask:0xf bank_mask:0xf
  v_and_b32_dpp v51, v20, v9 row_newbcast:4 row_mask:0xf bank_mask:0xf
  v_and_b32_dpp v52, v20, v10 row_newbcast:4 row_mask:0xf bank_mask:0xf
  v_and_b32_dpp v53, v20, v11 row_newbcast:4 row_mask:0xf bank_mask:0xf
  v_mfma_f32_16x16x32_bf16 v[38:41], v[236:239], v[46:49], 0
  v_mfma_f32_16x16x32_bf16 v[42:45], v[240:243], v[46:49], 0
  s_add_u32 s21, s21, 16384
  s_cmp_eq_u32 s21, s20
  s_cselect_b32 s21, 0, s21
  buffer_load_dwordx4 v[124:127], v5, s[48:51], s21 offen offset:0 nt
  buffer_load_dwordx4 v[128:131], v5, s[48:51], s21 offen offset:256 nt
  s_mov_b32 s96, 3584
  buffer_load_dwordx4 a[20:23], v6, s[56:59], s96 offen offset:256
  v_and_b32_dpp v46, v20, v8 row_newbcast:8 row_mask:0xf bank_mask:0xf
  v_and_b32_dpp v47, v20, v9 row_newbcast:8 row_mask:0xf bank_mask:0xf
  v_and_b32_dpp v48, v20, v10 row_newbcast:8 row_mask:0xf bank_mask:0xf
  v_and_b32_dpp v49, v20, v11 row_newbcast:8 row_mask:0xf bank_mask:0xf
  v_mfma_f32_16x16x32_bf16 v[38:41], v[244:247], v[50:53], v[38:41]
  v_mfma_f32_16x16x32_bf16 v[42:45], v[248:251], v[50:53], v[42:45]
  buffer_load_dwordx4 v[132:135], v5, s[48:51], s21 offen offset:2048 nt
  buffer_load_dwordx4 v[136:139], v5, s[48:51], s21 offen offset:2304 nt
  s_mov_b32 s96, 3584
  buffer_load_dwordx4 a[24:27], v6, s[56:59], s96 offen offset:512
  v_and_b32_dpp v50, v20, v8 row_newbcast:12 row_mask:0xf bank_mask:0xf
  v_and_b32_dpp v51, v20, v9 row_newbcast:12 row_mask:0xf bank_mask:0xf
  v_and_b32_dpp v52, v20, v10 row_newbcast:12 row_mask:0xf bank_mask:0xf
  v_and_b32_dpp v53, v20, v11 row_newbcast:12 row_mask:0xf bank_mask:0xf
  s_waitcnt vmcnt(18)
  v_mfma_f32_16x16x32_bf16 v[38:41], v[252:255], v[46:49], v[38:41]
  v_mfma_f32_16x16x32_bf16 v[42:45], v[96:99], v[46:49], v[42:45]
  s_add_u32 s21, s21, 16384
  s_cmp_eq_u32 s21, s20
  s_cselect_b32 s21, 0, s21
  buffer_load_dwordx4 v[140:143], v5, s[48:51], s21 offen offset:0 nt
  buffer_load_dwordx4 v[144:147], v5, s[48:51], s21 offen offset:256 nt
  s_mov_b32 s96, 3584
  buffer_load_dwordx4 a[28:31], v7, s[56:59], s96 offen offset:768
  s_mov_b32 s96, 7168
  buffer_load_dwordx4 a[32:35], v6, s[56:59], s96 offen offset:0
  v_and_b32_dpp v46, v21, v8 row_newbcast:0 row_mask:0xf bank_mask:0xf
  v_and_b32_dpp v47, v21, v9 row_newbcast:0 row_mask:0xf bank_mask:0xf
  v_and_b32_dpp v48, v21, v10 row_newbcast:0 row_mask:0xf bank_mask:0xf
  v_and_b32_dpp v49, v21, v11 row_newbcast:0 row_mask:0xf bank_mask:0xf
  s_waitcnt vmcnt(18)
  v_mfma_f32_16x16x32_bf16 v[38:41], v[100:103], v[50:53], v[38:41]
  v_mfma_f32_16x16x32_bf16 v[42:45], v[104:107], v[50:53], v[42:45]
  buffer_load_dwordx4 v[148:151], v5, s[48:51], s21 offen offset:2048 nt
  buffer_load_dwordx4 v[152:155], v5, s[48:51], s21 offen offset:2304 nt
  s_mov_b32 s96, 7168
  buffer_load_dwordx4 a[36:39], v6, s[56:59], s96 offen offset:256
  v_and_b32_dpp v50, v21, v8 row_newbcast:4 row_mask:0xf bank_mask:0xf
  v_and_b32_dpp v51, v21, v9 row_newbcast:4 row_mask:0xf bank_mask:0xf
  v_and_b32_dpp v52, v21, v10 row_newbcast:4 row_mask:0xf bank_mask:0xf
  v_and_b32_dpp v53, v21, v11 row_newbcast:4 row_mask:0xf bank_mask:0xf
  s_waitcnt vmcnt(18)
  v_mfma_f32_16x16x32_bf16 v[38:41], v[108:111], v[46:49], v[38:41]
  v_mfma_f32_16x16x32_bf16 v[42:45], v[112:115], v[46:49], v[42:45]
  s_add_u32 s21, s21, 16384
  s_cmp_eq_u32 s21, s20
  s_cselect_b32 s21, 0, s21
  buffer_load_dwordx4 v[156:159], v5, s[48:51], s21 offen offset:0 nt
  buffer_load_dwordx4 v[160:163], v5, s[48:51], s21 offen offset:256 nt
  s_mov_b32 s96, 7168
  buffer_load_dwordx4 a[40:43], v6, s[56:59], s96 offen offset:512
  v_and_b32_dpp v46, v21, v8 row_newbcast:8 row_mask:0xf bank_mask:0xf
  v_and_b32_dpp v47, v21, v9 row_newbcast:8 row_mask:0xf bank_mask:0xf
  v_and_b32_dpp v48, v21, v10 row_newbcast:8 row_mask:0xf bank_mask:0xf
  v_and_b32_dpp v49, v21, v11 row_newbcast:8 row_mask:0xf bank_mask:0xf
  s_waitcnt vmcnt(18)
  v_mfma_f32_16x16x32_bf16 v[38:41], v[116:119], v[50:53], v[38:41]
  v_mfma_f32_16x16x32_bf16 v[42:45], v[120:123], v[50:53], v[42:45]
  buffer_load_dwordx4 v[164:167], v5, s[48:51], s21 offen offset:2048 nt
  buffer_load_dwordx4 v[168:171], v5, s[48:51], s21 offen offset:2304 nt
  s_mov_b32 s96, 7168
  buffer_load_dwordx4 a[44:47], v7, s[56:59], s96 offen offset:768
  v_and_b32_dpp v50, v21, v8 row_newbcast:12 row_mask:0xf bank_mask:0xf
  v_and_b32_dpp v51, v21, v9 row_newbcast:12 row_mask:0xf bank_mask:0xf
  v_and_b32_dpp v52, v21, v10 row_newbcast:12 row_mask:0xf bank_mask:0xf
  v_and_b32_dpp v53, v21, v11 row_newbcast:12 row_mask:0xf bank_mask:0xf
  s_waitcnt vmcnt(17)
  v_mfma_f32_16x16x32_bf16 v[38:41], v[124:127], v[46:49], v[38:41]
  v_mfma_f32_16x16x32_bf16 v[42:45], v[128:131], v[46:49], v[42:45]
  s_add_u32 s21, s21, 16384
  s_cmp_eq_u32 s21, s20
  s_cselect_b32 s21, 0, s21
  buffer_load_dwordx4 v[172:175], v5, s[48:51], s21 offen offset:0 nt
  buffer_load_dwordx4 v[176:179], v5, s[48:51], s21 offen offset:256 nt
  s_mov_b32 s96, 10752
  buffer_load_dwordx4 a[48:51], v6, s[56:59], s96 offen offset:0
  v_and_b32_dpp v46, v22, v8 row_newbcast:0 row_mask:0xf bank_mask:0xf
  v_and_b32_dpp v47, v22, v9 row_newbcast:0 row_mask:0xf bank_mask:0xf
  v_and_b32_dpp v48, v22, v10 row_newbcast:0 row_mask:0xf bank_mask:0xf
  v_and_b32_dpp v49, v22, v11 row_newbcast:0 row_mask:0xf bank_mask:0xf
  s_waitcnt vmcnt(17)
  v_mfma_f32_16x16x32_bf16 v[38:41], v[132:135], v[50:53], v[38:41]
  v_mfma_f32_16x16x32_bf16 v[42:45], v[136:139], v[50:53], v[42:45]
  buffer_load_dwordx4 v[180:183], v5, s[48:51], s21 offen offset:2048 nt
  buffer_load_dwordx4 v[184:187], v5, s[48:51], s21 offen offset:2304 nt
  s_mov_b32 s96, 10752
  buffer_load_dwordx4 a[52:55], v6, s[56:59], s96 offen offset:256
  v_and_b32_dpp v50, v22, v8 row_newbcast:4 row_mask:0xf bank_mask:0xf
  v_and_b32_dpp v51, v22, v9 row_newbcast:4 row_mask:0xf bank_mask:0xf
  v_and_b32_dpp v52, v22, v10 row_newbcast:4 row_mask:0xf bank_mask:0xf
  v_and_b32_dpp v53, v22, v11 row_newbcast:4 row_mask:0xf bank_mask:0xf
  s_waitcnt vmcnt(17)
  v_mfma_f32_16x16x32_bf16 v[38:41], v[140:143], v[46:49], v[38:41]
  v_mfma_f32_16x16x32_bf16 v[42:45], v[144:147], v[46:49], v[42:45]
  s_add_u32 s21, s21, 16384
  s_cmp_eq_u32 s21, s20
  s_cselect_b32 s21, 0, s21
  buffer_load_dwordx4 v[188:191], v5, s[48:51], s21 offen offset:0 nt
  buffer_load_dwordx4 v[192:195], v5, s[48:51], s21 offen offset:256 nt
  s_mov_b32 s96, 10752
  buffer_load_dwordx4 a[56:59], v6, s[56:59], s96 offen offset:512
  s_mov_b32 s96, 10752
  buffer_load_dwordx4 a[60:63], v7, s[56:59], s96 offen offset:768
  v_and_b32_dpp v46, v22, v8 row_newbcast:8 row_mask:0xf bank_mask:0xf
  v_and_b32_dpp v47, v22, v9 row_newbcast:8 row_mask:0xf bank_mask:0xf
  v_and_b32_dpp v48, v22, v10 row_newbcast:8 row_mask:0xf bank_mask:0xf
  v_and_b32_dpp v49, v22, v11 row_newbcast:8 row_mask:0xf bank_mask:0xf
  s_waitcnt vmcnt(17)
  v_mfma_f32_16x16x32_bf16 v[38:41], v[148:151], v[50:53], v[38:41]
  v_mfma_f32_16x16x32_bf16 v[42:45], v[152:155], v[50:53], v[42:45]
  buffer_load_dwordx4 v[196:199], v5, s[48:51], s21 offen offset:2048 nt
  buffer_load_dwordx4 v[200:203], v5, s[48:51], s21 offen offset:2304 nt
  s_mov_b32 s96, 14336
  buffer_load_dwordx4 a[64:67], v6, s[56:59], s96 offen offset:0
  v_and_b32_dpp v50, v22, v8 row_newbcast:12 row_mask:0xf bank_mask:0xf
  v_and_b32_dpp v51, v22, v9 row_newbcast:12 row_mask:0xf bank_mask:0xf
  v_and_b32_dpp v52, v22, v10 row_newbcast:12 row_mask:0xf bank_mask:0xf
  v_and_b32_dpp v53, v22, v11 row_newbcast:12 row_mask:0xf bank_mask:0xf
  s_waitcnt vmcnt(17)
  v_mfma_f32_16x16x32_bf16 v[38:41], v[156:159], v[46:49], v[38:41]
  v_mfma_f32_16x16x32_bf16 v[42:45], v[160:163], v[46:49], v[42:45]
  s_add_u32 s21, s21, 16384
  s_cmp_eq_u32 s21, s20
  s_cselect_b32 s21, 0, s21
  buffer_load_dwordx4 v[204:207], v5, s[48:51], s21 offen offset:0 nt
  buffer_load_dwordx4 v[208:211], v5, s[48:51], s21 offen offset:256 nt
  s_mov_b32 s96, 14336
  buffer_load_dwordx4 a[68:71], v6, s[56:59], s96 offen offset:256
  v_and_b32_dpp v46, v23, v8 row_newbcast:0 row_mask:0xf bank_mask:0xf
  v_and_b32_dpp v47, v23, v9 row_newbcast:0 row_mask:0xf bank_mask:0xf
  v_and_b32_dpp v48, v23, v10 row_newbcast:0 row_mask:0xf bank_mask:0xf
  v_and_b32_dpp v49, v23, v11 row_newbcast:0 row_mask:0xf bank_mask:0xf
  s_waitcnt vmcnt(17)
  v_mfma_f32_16x16x32_bf16 v[38:41], v[164:167], v[50:53], v[38:41]
  v_mfma_f32_16x16x32_bf16 v[42:45], v[168:171], v[50:53], v[42:45]
  buffer_load_dwordx4 v[212:215], v5, s[48:51], s21 offen offset:2048 nt
  buffer_load_dwordx4 v[216:219], v5, s[48:51], s21 offen offset:2304 nt
  s_mov_b32 s96, 14336
  buffer_load_dwordx4 a[72:75], v6, s[56:59], s96 offen offset:512
  v_and_b32_dpp v50, v23, v8 row_newbcast:4 row_mask:0xf bank_mask:0xf
  v_and_b32_dpp v51, v23, v9 row_newbcast:4 row_mask:0xf bank_mask:0xf
  v_and_b32_dpp v52, v23, v10 row_newbcast:4 row_mask:0xf bank_mask:0xf
  v_and_b32_dpp v53, v23, v11 row_newbcast:4 row_mask:0xf bank_mask:0xf
  s_waitcnt vmcnt(17)
  v_mfma_f32_16x16x32_bf16 v[38:41], v[172:175], v[46:49], v[38:41]
  v_mfma_f32_16x16x32_bf16 v[42:45], v[176:179], v[46:49], v[42:45]
  s_add_u32 s21, s21, 16384
  s_cmp_eq_u32 s21, s20
  s_cselect_b32 s21, 0, s21
  buffer_load_dwordx4 v[220:223], v5, s[48:51], s21 offen offset:0 nt
  buffer_load_dwordx4 v[224:227], v5, s[48:51], s21 offen offset:256 nt
  s_mov_b32 s96, 14336
  buffer_load_dwordx4 a[76:79], v7, s[56:59], s96 offen offset:768
  v_and_b32_dpp v46, v23, v8 row_newbcast:8 row_mask:0xf bank_mask:0xf
  v_and_b32_dpp v47, v23, v9 row_newbcast:8 row_mask:0xf bank_mask:0xf
  v_and_b32_dpp v48, v23, v10 row_newbcast:8 row_mask:0xf bank_mask:0xf
  v_and_b32_dpp v49, v23, v11 row_newbcast:8 row_mask:0xf bank_mask:0xf
  s_waitcnt vmcnt(17)
  v_mfma_f32_16x16x32_bf16 v[38:41], v[180:183], v[50:53], v[38:41]
  v_mfma_f32_16x16x32_bf16 v[42:45], v[184:187], v[50:53], v[42:45]
  buffer_load_dwordx4 v[228:231], v5, s[48:51], s21 offen offset:2048 nt
  buffer_load_dwordx4 v[232:235], v5, s[48:51], s21 offen offset:2304 nt
  s_mov_b32 s96, 17920
  buffer_load_dwordx4 a[80:83], v6, s[56:59], s96 offen offset:0
  v_and_b32_dpp v50, v23, v8 row_newbcast:12 row_mask:0xf bank_mask:0xf
  v_and_b32_dpp v51, v23, v9 row_newbcast:12 row_mask:0xf bank_mask:0xf
  v_and_b32_dpp v52, v23, v10 row_newbcast:12 row_mask:0xf bank_mask:0xf
  v_and_b32_dpp v53, v23, v11 row_newbcast:12 row_mask:0xf bank_mask:0xf
  s_waitcnt vmcnt(17)
  v_mfma_f32_16x16x32_bf16 v[38:41], v[188:191], v[46:49], v[38:41]
  v_mfma_f32_16x16x32_bf16 v[42:45], v[192:195], v[46:49], v[42:45]
  s_add_u32 s21, s21, 16384
  s_cmp_eq_u32 s21, s20
  s_cselect_b32 s21, 0, s21
  buffer_load_dwordx4 v[236:239], v5, s[48:51], s21 offen offset:0 nt
  buffer_load_dwordx4 v[240:243], v5, s[48:51], s21 offen offset:256 nt
  s_mov_b32 s96, 17920
  buffer_load_dwordx4 a[84:87], v6, s[56:59], s96 offen offset:256
  s_mov_b32 s96, 17920
  buffer_load_dwordx4 a[88:91], v6, s[56:59], s96 offen offset:512
  v_and_b32_dpp v46, v24, v8 row_newbcast:0 row_mask:0xf bank_mask:0xf
  v_and_b32_dpp v47, v24, v9 row_newbcast:0 row_mask:0xf bank_mask:0xf
  v_and_b32_dpp v48, v24, v10 row_newbcast:0 row_mask:0xf bank_mask:0xf
  v_and_b32_dpp v49, v24, v11 row_newbcast:0 row_mask:0xf bank_mask:0xf
  s_waitcnt vmcnt(17)
  v_mfma_f32_16x16x32_bf16 v[38:41], v[196:199], v[50:53], v[38:41]
  v_mfma_f32_16x16x32_bf16 v[42:45], v[200:203], v[50:53], v[42:45]
  buffer_load_dwordx4 v[244:247], v5, s[48:51], s21 offen offset:2048 nt
  buffer_load_dwordx4 v[248:251], v5, s[48:51], s21 offen offset:2304 nt
  s_mov_b32 s96, 17920
  buffer_load_dwordx4 a[92:95], v7, s[56:59], s96 offen offset:768
  v_and_b32_dpp v50, v24, v8 row_newbcast:4 row_mask:0xf bank_mask:0xf
  v_and_b32_dpp v51, v24, v9 row_newbcast:4 row_mask:0xf bank_mask:0xf
  v_and_b32_dpp v52, v24, v10 row_newbcast:4 row_mask:0xf bank_mask:0xf
  v_and_b32_dpp v53, v24, v11 row_newbcast:4 row_mask:0xf bank_mask:0xf
  s_waitcnt vmcnt(17)
  v_mfma_f32_16x16x32_bf16 v[38:41], v[204:207], v[46:49], v[38:41]
  v_mfma_f32_16x16x32_bf16 v[42:45], v[208:211], v[46:49], v[42:45]
  s_add_u32 s21, s21, 16384
  s_cmp_eq_u32 s21, s20
  s_cselect_b32 s21, 0, s21
  buffer_load_dwordx4 v[252:255], v5, s[48:51], s21 offen offset:0 nt
  buffer_load_dwordx4 v[96:99], v5, s[48:51], s21 offen offset:256 nt
  s_mov_b32 s96, 21504
  buffer_load_dwordx4 a[96:99], v6, s[56:59], s96 offen offset:0
  v_and_b32_dpp v46, v24, v8 row_newbcast:8 row_mask:0xf bank_mask:0xf
  v_and_b32_dpp v47, v24, v9 row_newbcast:8 row_mask:0xf bank_mask:0xf
  v_and_b32_dpp v48, v24, v10 row_newbcast:8 row_mask:0xf bank_mask:0xf
  v_and_b32_dpp v49, v24, v11 row_newbcast:8 row_mask:0xf bank_mask:0xf
  s_waitcnt vmcnt(17)
  v_mfma_f32_16x16x32_bf16 v[38:41], v[212:215], v[50:53], v[38:41]
  v_mfma_f32_16x16x32_bf16 v[42:45], v[216:219], v[50:53], v[42:45]
  buffer_load_dwordx4 v[100:103], v5, s[48:51], s21 offen offset:2048 nt
  buffer_load_dwordx4 v[104:107], v5, s[48:51], s21 offen offset:2304 nt
  s_mov_b32 s96, 21504
  buffer_load_dwordx4 a[100:103], v6, s[56:59], s96 offen offset:256
  v_and_b32_dpp v50, v24, v8 row_newbcast:12 row_mask:0xf bank_mask:0xf
  v_and_b32_dpp v51, v24, v9 row_newbcast:12 row_mask:0xf bank_mask:0xf
  v_and_b32_dpp v52, v24, v10 row_newbcast:12 row_mask:0xf bank_mask:0xf
  v_and_b32_dpp v53, v24, v11 row_newbcast:12 row_mask:0xf bank_mask:0xf
  s_waitcnt vmcnt(17)
  v_mfma_f32_16x16x32_bf16 v[38:41], v[220:223], v[46:49], v[38:41]
  v_mfma_f32_16x16x32_bf16 v[42:45], v[224:227], v[46:49], v[42:45]
  s_add_u32 s21, s21, 16384
  s_cmp_eq_u32 s21, s20
  s_cselect_b32 s21, 0, s21
  buffer_load_dwordx4 v[108:111], v5, s[48:51], s21 offen offset:0 nt
  buffer_load_dwordx4 v[112:115], v5, s[48:51], s21 offen offset:256 nt
  s_mov_b32 s96, 21504
  buffer_load_dwordx4 a[104:107], v6, s[56:59], s96 offen offset:512
  v_and_b32_dpp v46, v25, v8 row_newbcast:0 row_mask:0xf bank_mask:0xf
  v_and_b32_dpp v47, v25, v9 row_newbcast:0 row_mask:0xf bank_mask:0xf
  v_and_b32_dpp v48, v25, v10 row_newbcast:0 row_mask:0xf bank_mask:0xf
  v_and_b32_dpp v49, v25, v11 row_newbcast:0 row_mask:0xf bank_mask:0xf
  s_waitcnt vmcnt(17)
  v_mfma_f32_16x16x32_bf16 v[38:41], v[228:231], v[50:53], v[38:41]
  v_mfma_f32_16x16x32_bf16 v[42:45], v[232:235], v[50:53], v[42:45]
  buffer_load_dwordx4 v[116:119], v5, s[48:51], s21 offen offset:2048 nt
  buffer_load_dwordx4 v[120:123], v5, s[48:51], s21 offen offset:2304 nt
  s_mov_b32 s96, 21504
  buffer_load_dwordx4 a[108:111], v7, s[56:59], s96 offen offset:768
  v_and_b32_dpp v50, v25, v8 row_newbcast:4 row_mask:0xf bank_mask:0xf
  v_and_b32_dpp v51, v25, v9 row_newbcast:4 row_mask:0xf bank_mask:0xf
  v_and_b32_dpp v52, v25, v10 row_newbcast:4 row_mask:0xf bank_mask:0xf
  v_and_b32_dpp v53, v25, v11 row_newbcast:4 row_mask:0xf bank_mask:0xf
  s_waitcnt vmcnt(17)
  v_mfma_f32_16x16x32_bf16 v[38:41], v[236:239], v[46:49], v[38:41]
  v_mfma_f32_16x16x32_bf16 v[42:45], v[240:243], v[46:49], v[42:45]
  s_add_u32 s21, s21, 16384
  s_cmp_eq_u32 s21, s20
  s_cselect_b32 s21, 0, s21
  buffer_load_dwordx4 v[124:127], v5, s[48:51], s21 offen offset:0 nt
  buffer_load_dwordx4 v[128:131], v5, s[48:51], s21 offen offset:256 nt
  s_mov_b32 s96, 25088
  buffer_load_dwordx4 a[112:115], v6, s[56:59], s96 offen offset:0
  s_mov_b32 s96, 25088
  buffer_load_dwordx4 a[116:119], v6, s[56:59], s96 offen offset:256
  v_and_b32_dpp v46, v25, v8 row_newbcast:8 row_mask:0xf bank_mask:0xf
  v_and_b32_dpp v47, v25, v9 row_newbcast:8 row_mask:0xf bank_mask:0xf
  v_and_b32_dpp v48, v25, v10 row_newbcast:8 row_mask:0xf bank_mask:0xf
  v_and_b32_dpp v49, v25, v11 row_newbcast:8 row_mask:0xf bank_mask:0xf
  s_waitcnt vmcnt(17)
  v_mfma_f32_16x16x32_bf16 v[38:41], v[244:247], v[50:53], v[38:41]
  v_mfma_f32_16x16x32_bf16 v[42:45], v[248:251], v[50:53], v[42:45]
  buffer_load_dwordx4 v[132:135], v5, s[48:51], s21 offen offset:2048 nt
  buffer_load_dwordx4 v[136:139], v5, s[48:51], s21 offen offset:2304 nt
  s_mov_b32 s96, 25088
  buffer_load_dwordx4 a[120:123], v6, s[56:59], s96 offen offset:512
  v_and_b32_dpp v50, v25, v8 row_newbcast:12 row_mask:0xf bank_mask:0xf
  v_and_b32_dpp v51, v25, v9 row_newbcast:12 row_mask:0xf bank_mask:0xf
  v_and_b32_dpp v52, v25, v10 row_newbcast:12 row_mask:0xf bank_mask:0xf
  v_and_b32_dpp v53, v25, v11 row_newbcast:12 row_mask:0xf bank_mask:0xf
  s_waitcnt vmcnt(17)
  v_mfma_f32_16x16x32_bf16 v[38:41], v[252:255], v[46:49], v[38:41]
  v_mfma_f32_16x16x32_bf16 v[42:45], v[96:99], v[46:49], v[42:45]
  s_add_u32 s21, s21, 16384
  s_cmp_eq_u32 s21, s20
  s_cselect_b32 s21, 0, s21
  buffer_load_dwordx4 v[140:143], v5, s[48:51], s21 offen offset:0 nt
  buffer_load_dwordx4 v[144:147], v5, s[48:51], s21 offen offset:256 nt
  s_mov_b32 s96, 25088
  buffer_load_dwordx4 a[124:127], v7, s[56:59], s96 offen offset:768
  v_and_b32_dpp v46, v26, v8 row_newbcast:0 row_mask:0xf bank_mask:0xf
  v_and_b32_dpp v47, v26, v9 row_newbcast:0 row_mask:0xf bank_mask:0xf
  v_and_b32_dpp v48, v26, v10 row_newbcast:0 row_mask:0xf bank_mask:0xf
  v_and_b32_dpp v49, v26, v11 row_newbcast:0 row_mask:0xf bank_mask:0xf
  s_waitcnt vmcnt(17)
  v_mfma_f32_16x16x32_bf16 v[38:41], v[100:103], v[50:53], v[38:41]
  v_mfma_f32_16x16x32_bf16 v[42:45], v[104:107], v[50:53], v[42:45]
  buffer_load_dwordx4 v[148:151], v5, s[48:51], s21 offen offset:2048 nt
  buffer_load_dwordx4 v[152:155], v5, s[48:51], s21 offen offset:2304 nt
  s_mov_b32 s96, 28672
  buffer_load_dwordx4 a[128:131], v6, s[56:59], s96 offen offset:0
  v_and_b32_dpp v50, v26, v8 row_newbcast:4 row_mask:0xf bank_mask:0xf
  v_and_b32_dpp v51, v26, v9 row_newbcast:4 row_mask:0xf bank_mask:0xf
  v_and_b32_dpp v52, v26, v10 row_newbcast:4 row_mask:0xf bank_mask:0xf
  v_and_b32_dpp v53, v26, v11 row_newbcast:4 row_mask:0xf bank_mask:0xf
  s_waitcnt vmcnt(17)
  v_mfma_f32_16x16x32_bf16 v[38:41], v[108:111], v[46:49], v[38:41]
  v_mfma_f32_16x16x32_bf16 v[42:45], v[112:115], v[46:49], v[42:45]
  s_add_u32 s21, s21, 16384
  s_cmp_eq_u32 s21, s20
  s_cselect_b32 s21, 0, s21
  buffer_load_dwordx4 v[156:159], v5, s[48:51], s21 offen offset:0 nt
  buffer_load_dwordx4 v[160:163], v5, s[48:51], s21 offen offset:256 nt
  s_mov_b32 s96, 28672
  buffer_load_dwordx4 a[132:135], v6, s[56:59], s96 offen offset:256
  v_and_b32_dpp v46, v26, v8 row_newbcast:8 row_mask:0xf bank_mask:0xf
  v_and_b32_dpp v47, v26, v9 row_newbcast:8 row_mask:0xf bank_mask:0xf
  v_and_b32_dpp v48, v26, v10 row_newbcast:8 row_mask:0xf bank_mask:0xf
  v_and_b32_dpp v49, v26, v11 row_newbcast:8 row_mask:0xf bank_mask:0xf
  s_waitcnt vmcnt(17)
  v_mfma_f32_16x16x32_bf16 v[38:41], v[116:119], v[50:53], v[38:41]
  v_mfma_f32_16x16x32_bf16 v[42:45], v[120:123], v[50:53], v[42:45]
  buffer_load_dwordx4 v[164:167], v5, s[48:51], s21 offen offset:2048 nt
  buffer_load_dwordx4 v[168:171], v5, s[48:51], s21 offen offset:2304 nt
  s_mov_b32 s96, 28672
  buffer_load_dwordx4 a[136:139], v6, s[56:59], s96 offen offset:512
  v_and_b32_dpp v50, v26, v8 row_newbcast:12 row_mask:0xf bank_mask:0xf
  v_and_b32_dpp v51, v26, v9 row_newbcast:12 row_mask:0xf bank_mask:0xf
  v_and_b32_dpp v52, v26, v10 row_newbcast:12 row_mask:0xf bank_mask:0xf
  v_and_b32_dpp v53, v26, v11 row_newbcast:12 row_mask:0xf bank_mask:0xf
  s_waitcnt vmcnt(17)
  v_mfma_f32_16x16x32_bf16 v[38:41], v[124:127], v[46:49], v[38:41]
  v_mfma_f32_16x16x32_bf16 v[42:45], v[128:131], v[46:49], v[42:45]
  s_add_u32 s21, s21, 16384
  s_cmp_eq_u32 s21, s20
  s_cselect_b32 s21, 0, s21
  buffer_load_dwordx4 v[172:175], v5, s[48:51], s21 offen offset:0 nt
  buffer_load_dwordx4 v[176:179], v5, s[48:51], s21 offen offset:256 nt
  s_mov_b32 s96, 28672
  buffer_load_dwordx4 a[140:143], v7, s[56:59], s96 offen offset:768
  s_mov_b32 s96, 32256
  buffer_load_dwordx4 a[144:147], v6, s[56:59], s96 offen offset:0
  v_and_b32_dpp v46, v27, v8 row_newbcast:0 row_mask:0xf bank_mask:0xf
  v_and_b32_dpp v47, v27, v9 row_newbcast:0 row_mask:0xf bank_mask:0xf
  v_and_b32_dpp v48, v27, v10 row_newbcast:0 row_mask:0xf bank_mask:0xf
  v_and_b32_dpp v49, v27, v11 row_newbcast:0 row_mask:0xf bank_mask:0xf
  s_waitcnt vmcnt(17)
  v_mfma_f32_16x16x32_bf16 v[38:41], v[132:135], v[50:53], v[38:41]
  v_mfma_f32_16x16x32_bf16 v[42:45], v[136:139], v[50:53], v[42:45]
  buffer_load_dwordx4 v[180:183], v5, s[48:51], s21 offen offset:2048 nt
  buffer_load_dwordx4 v[184:187], v5, s[48:51], s21 offen offset:2304 nt
  s_mov_b32 s96, 32256
  buffer_load_dwordx4 a[148:151], v6, s[56:59], s96 offen offset:256
  v_and_b32_dpp v50, v27, v8 row_newbcast:4 row_mask:0xf bank_mask:0xf
  v_and_b32_dpp v51, v27, v9 row_newbcast:4 row_mask:0xf bank_mask:0xf
  v_and_b32_dpp v52, v27, v10 row_newbcast:4 row_mask:0xf bank_mask:0xf
  v_and_b32_dpp v53, v27, v11 row_newbcast:4 row_mask:0xf bank_mask:0xf
  s_waitcnt vmcnt(17)
  v_mfma_f32_16x16x32_bf16 v[38:41], v[140:143], v[46:49], v[38:41]
  v_mfma_f32_16x16x32_bf16 v[42:45], v[144:147], v[46:49], v[42:45]
  s_add_u32 s21, s21, 16384
  s_cmp_eq_u32 s21, s20
  s_cselect_b32 s21, 0, s21
  buffer_load_dwordx4 v[188:191], v5, s[48:51], s21 offen offset:0 nt
  buffer_load_dwordx4 v[192:195], v5, s[48:51], s21 offen offset:256 nt
  s_mov_b32 s96, 32256
  buffer_load_dwordx4 a[152:155], v6, s[56:59], s96 offen offset:512
  v_and_b32_dpp v46, v27, v8 row_newbcast:8 row_mask:0xf bank_mask:0xf
  v_and_b32_dpp v47, v27, v9 row_newbcast:8 row_mask:0xf bank_mask:0xf
  v_and_b32_dpp v48, v27, v10 row_newbcast:8 row_mask:0xf bank_mask:0xf
  v_and_b32_dpp v49, v27, v11 row_newbcast:8 row_mask:0xf bank_mask:0xf
  s_waitcnt vmcnt(17)
  v_mfma_f32_16x16x32_bf16 v[38:41], v[148:151], v[50:53], v[38:41]
  v_mfma_f32_16x16x32_bf16 v[42:45], v[152:155], v[50:53], v[42:45]
  buffer_load_dwordx4 v[196:199], v5, s[48:51], s21 offen offset:2048 nt
  buffer_load_dwordx4 v[200:203], v5, s[48:51], s21 offen offset:2304 nt
  s_mov_b32 s96, 32256
  buffer_load_dwordx4 a[156:159], v7, s[56:59], s96 offen offset:768
  v_and_b32_dpp v50, v27, v8 row_newbcast:12 row_mask:0xf bank_mask:0xf
  v_and_b32_dpp v51, v27, v9 row_newbcast:12 row_mask:0xf bank_mask:0xf
  v_and_b32_dpp v52, v27, v10 row_newbcast:12 row_mask:0xf bank_mask:0xf
  v_and_b32_dpp v53, v27, v11 row_newbcast:12 row_mask:0xf bank_mask:0xf
  s_waitcnt vmcnt(17)
  v_mfma_f32_16x16x32_bf16 v[38:41], v[156:159], v[46:49], v[38:41]
  v_mfma_f32_16x16x32_bf16 v[42:45], v[160:163], v[46:49], v[42:45]
  s_add_u32 s21, s21, 16384
  s_cmp_eq_u32 s21, s20
  s_cselect_b32 s21, 0, s21
  buffer_load_dwordx4 v[204:207], v5, s[48:51], s21 offen offset:0 nt
  buffer_load_dwordx4 v[208:211], v5, s[48:51], s21 offen offset:256 nt
  s_mov_b32 s96, 35840
  buffer_load_dwordx4 a[160:163], v6, s[56:59], s96 offen offset:0
  v_and_b32_dpp v46, v28, v8 row_newbcast:0 row_mask:0xf bank_mask:0xf
  v_and_b32_dpp v47, v28, v9 row_newbcast:0 row_mask:0xf bank_mask:0xf
  v_and_b32_dpp v48, v28, v10 row_newbcast:0 row_mask:0xf bank_mask:0xf
  v_and_b32_dpp v49, v28, v11 row_newbcast:0 row_mask:0xf bank_mask:0xf
  s_waitcnt vmcnt(17)
  v_mfma_f32_16x16x32_bf16 v[38:41], v[164:167], v[50:53], v[38:41]
  v_mfma_f32_16x16x32_bf16 v[42:45], v[168:171], v[50:53], v[42:45]
  buffer_load_dwordx4 v[212:215], v5, s[48:51], s21 offen offset:2048 nt
  buffer_load_dwordx4 v[216:219], v5, s[48:51], s21 offen offset:2304 nt
  s_mov_b32 s96, 35840
  buffer_load_dwordx4 a[164:167], v6, s[56:59], s96 offen offset:256
  v_and_b32_dpp v50, v28, v8 row_newbcast:4 row_mask:0xf bank_mask:0xf
  v_and_b32_dpp v51, v28, v9 row_newbcast:4 row_mask:0xf bank_mask:0xf
  v_and_b32_dpp v52, v28, v10 row_newbcast:4 row_mask:0xf bank_mask:0xf
  v_and_b32_dpp v53, v28, v11 row_newbcast:4 row_mask:0xf bank_mask:0xf
  s_waitcnt vmcnt(17)
  v_mfma_f32_16x16x32_bf16 v[38:41], v[172:175], v[46:49], v[38:41]
  v_mfma_f32_16x16x32_bf16 v[42:45], v[176:179], v[46:49], v[42:45]
  s_add_u32 s21, s21, 16384
  s_cmp_eq_u32 s21, s20
  s_cselect_b32 s21, 0, s21
  buffer_load_dwordx4 v[220:223], v5, s[48:51], s21 offen offset:0 nt
  buffer_load_dwordx4 v[224:227], v5, s[48:51], s21 offen offset:256 nt
  s_mov_b32 s96, 35840
  buffer_load_dwordx4 a[168:171], v6, s[56:59], s96 offen offset:512
  s_mov_b32 s96, 35840
  buffer_load_dwordx4 a[172:175], v7, s[56:59], s96 offen offset:768
  v_and_b32_dpp v46, v28, v8 row_newbcast:8 row_mask:0xf bank_mask:0xf
  v_and_b32_dpp v47, v28, v9 row_newbcast:8 row_mask:0xf bank_mask:0xf
  v_and_b32_dpp v48, v28, v10 row_newbcast:8 row_mask:0xf bank_mask:0xf
  v_and_b32_dpp v49, v28, v11 row_newbcast:8 row_mask:0xf bank_mask:0xf
  s_waitcnt vmcnt(17)
  v_mfma_f32_16x16x32_bf16 v[38:41], v[180:183], v[50:53], v[38:41]
  v_mfma_f32_16x16x32_bf16 v[42:45], v[184:187], v[50:53], v[42:45]
  buffer_load_dwordx4 v[228:231], v5, s[48:51], s21 offen offset:2048 nt
  buffer_load_dwordx4 v[232:235], v5, s[48:51], s21 offen offset:2304 nt
  s_mov_b32 s96, 39424
  buffer_load_dwordx4 a[176:179], v6, s[56:59], s96 offen offset:0
  v_and_b32_dpp v50, v28, v8 row_newbcast:12 row_mask:0xf bank_mask:0xf
  v_and_b32_dpp v51, v28, v9 row_newbcast:12 row_mask:0xf bank_mask:0xf
  v_and_b32_dpp v52, v28, v10 row_newbcast:12 row_mask:0xf bank_mask:0xf
  v_and_b32_dpp v53, v28, v11 row_newbcast:12 row_mask:0xf bank_mask:0xf
  s_waitcnt vmcnt(17)
  v_mfma_f32_16x16x32_bf16 v[38:41], v[188:191], v[46:49], v[38:41]
  v_mfma_f32_16x16x32_bf16 v[42:45], v[192:195], v[46:49], v[42:45]
  s_add_u32 s21, s21, 16384
  s_cmp_eq_u32 s21, s20
  s_cselect_b32 s21, 0, s21
  buffer_load_dwordx4 v[236:239], v5, s[48:51], s21 offen offset:0 nt
  buffer_load_dwordx4 v[240:243], v5, s[48:51], s21 offen offset:256 nt
  s_mov_b32 s96, 39424
  buffer_load_dwordx4 a[180:183], v6, s[56:59], s96 offen offset:256
  v_and_b32_dpp v46, v29, v8 row_newbcast:0 row_mask:0xf bank_mask:0xf
  v_and_b32_dpp v47, v29, v9 row_newbcast:0 row_mask:0xf bank_mask:0xf
  v_and_b32_dpp v48, v29, v10 row_newbcast:0 row_mask:0xf bank_mask:0xf
  v_and_b32_dpp v49, v29, v11 row_newbcast:0 row_mask:0xf bank_mask:0xf
  s_waitcnt vmcnt(17)
  v_mfma_f32_16x16x32_bf16 v[38:41], v[196:199], v[50:53], v[38:41]
  v_mfma_f32_16x16x32_bf16 v[42:45], v[200:203], v[50:53], v[42:45]
  buffer_load_dwordx4 v[244:247], v5, s[48:51], s21 offen offset:2048 nt
  buffer_load_dwordx4 v[248:251], v5, s[48:51], s21 offen offset:2304 nt
  s_mov_b32 s96, 39424
  buffer_load_dwordx4 a[184:187], v6, s[56:59], s96 offen offset:512
  v_and_b32_dpp v50, v29, v8 row_newbcast:4 row_mask:0xf bank_mask:0xf
  v_and_b32_dpp v51, v29, v9 row_newbcast:4 row_mask:0xf bank_mask:0xf
  v_and_b32_dpp v52, v29, v10 row_newbcast:4 row_mask:0xf bank_mask:0xf
  v_and_b32_dpp v53, v29, v11 row_newbcast:4 row_mask:0xf bank_mask:0xf
  s_waitcnt vmcnt(17)
  v_mfma_f32_16x16x32_bf16 v[38:41], v[204:207], v[46:49], v[38:41]
  v_mfma_f32_16x16x32_bf16 v[42:45], v[208:211], v[46:49], v[42:45]
  s_add_u32 s21, s21, 16384
  s_cmp_eq_u32 s21, s20
  s_cselect_b32 s21, 0, s21
  buffer_load_dwordx4 v[252:255], v5, s[48:51], s21 offen offset:0 nt
  buffer_load_dwordx4 v[96:99], v5, s[48:51], s21 offen offset:256 nt
  s_mov_b32 s96, 39424
  buffer_load_dwordx4 a[188:191], v7, s[56:59], s96 offen offset:768
  v_and_b32_dpp v46, v29, v8 row_newbcast:8 row_mask:0xf bank_mask:0xf
  v_and_b32_dpp v47, v29, v9 row_newbcast:8 row_mask:0xf bank_mask:0xf
  v_and_b32_dpp v48, v29, v10 row_newbcast:8 row_mask:0xf bank_mask:0xf
  v_and_b32_dpp v49, v29, v11 row_newbcast:8 row_mask:0xf bank_mask:0xf
  s_waitcnt vmcnt(17)
  v_mfma_f32_16x16x32_bf16 v[38:41], v[212:215], v[50:53], v[38:41]
  v_mfma_f32_16x16x32_bf16 v[42:45], v[216:219], v[50:53], v[42:45]
  buffer_load_dwordx4 v[100:103], v5, s[48:51], s21 offen offset:2048 nt
  buffer_load_dwordx4 v[104:107], v5, s[48:51], s21 offen offset:2304 nt
  s_mov_b32 s96, 43008
  buffer_load_dwordx4 a[192:195], v6, s[56:59], s96 offen offset:0
  v_and_b32_dpp v50, v29, v8 row_newbcast:12 row_mask:0xf bank_mask:0xf
  v_and_b32_dpp v51, v29, v9 row_newbcast:12 row_mask:0xf bank_mask:0xf
  v_and_b32_dpp v52, v29, v10 row_newbcast:12 row_mask:0xf bank_mask:0xf
  v_and_b32_dpp v53, v29, v11 row_newbcast:12 row_mask:0xf bank_mask:0xf
  s_waitcnt vmcnt(17)
  v_mfma_f32_16x16x32_bf16 v[38:41], v[220:223], v[46:49], v[38:41]
  v_mfma_f32_16x16x32_bf16 v[42:45], v[224:227], v[46:49], v[42:45]
  s_add_u32 s21, s21, 16384
  s_cmp_eq_u32 s21, s20
  s_cselect_b32 s21, 0, s21
  buffer_load_dwordx4 v[108:111], v5, s[48:51], s21 offen offset:0 nt
  buffer_load_dwordx4 v[112:115], v5, s[48:51], s21 offen offset:256 nt
  s_mov_b32 s96, 43008
  buffer_load_dwordx4 a[196:199], v6, s[56:59], s96 offen offset:256
  s_mov_b32 s96, 43008
  buffer_load_dwordx4 a[200:203], v6, s[56:59], s96 offen offset:512
  v_and_b32_dpp v46, v30, v8 row_newbcast:0 row_mask:0xf bank_mask:0xf
  v_and_b32_dpp v47, v30, v9 row_newbcast:0 row_mask:0xf bank_mask:0xf
  v_and_b32_dpp v48, v30, v10 row_newbcast:0 row_mask:0xf bank_mask:0xf
  v_and_b32_dpp v49, v30, v11 row_newbcast:0 row_mask:0xf bank_mask:0xf
  s_waitcnt vmcnt(17)
  v_mfma_f32_16x16x32_bf16 v[38:41], v[228:231], v[50:53], v[38:41]
  v_mfma_f32_16x16x32_bf16 v[42:45], v[232:235], v[50:53], v[42:45]
  buffer_load_dwordx4 v[116:119], v5, s[48:51], s21 offen offset:2048 nt
  buffer_load_dwordx4 v[120:123], v5, s[48:51], s21 offen offset:2304 nt
  s_mov_b32 s96, 43008
  buffer_load_dwordx4 a[204:207], v7, s[56:59], s96 offen offset:768
  v_and_b32_dpp v50, v30, v8 row_newbcast:4 row_mask:0xf bank_mask:0xf
  v_and_b32_dpp v51, v30, v9 row_newbcast:4 row_mask:0xf bank_mask:0xf
  v_and_b32_dpp v52, v30, v10 row_newbcast:4 row_mask:0xf bank_mask:0xf
  v_and_b32_dpp v53, v30, v11 row_newbcast:4 row_mask:0xf bank_mask:0xf
  s_waitcnt vmcnt(17)
  v_mfma_f32_16x16x32_bf16 v[38:41], v[236:239], v[46:49], v[38:41]
  v_mfma_f32_16x16x32_bf16 v[42:45], v[240:243], v[46:49], v[42:45]
  s_add_u32 s21, s21, 16384
  s_cmp_eq_u32 s21, s20
  s_cselect_b32 s21, 0, s21
  buffer_load_dwordx4 v[124:127], v5, s[48:51], s21 offen offset:0 nt
  buffer_load_dwordx4 v[128:131], v5, s[48:51], s21 offen offset:256 nt
  s_mov_b32 s96, 46592
  buffer_load_dwordx4 a[208:211], v6, s[56:59], s96 offen offset:0
  v_and_b32_dpp v46, v30, v8 row_newbcast:8 row_mask:0xf bank_mask:0xf
  v_and_b32_dpp v47, v30, v9 row_newbcast:8 row_mask:0xf bank_mask:0xf
  v_and_b32_dpp v48, v30, v10 row_newbcast:8 row_mask:0xf bank_mask:0xf
  v_and_b32_dpp v49, v30, v11 row_newbcast:8 row_mask:0xf bank_mask:0xf
  s_waitcnt vmcnt(17)
  v_mfma_f32_16x16x32_bf16 v[38:41], v[244:247], v[50:53], v[38:41]
  v_mfma_f32_16x16x32_bf16 v[42:45], v[248:251], v[50:53], v[42:45]
  buffer_load_dwordx4 v[132:135], v5, s[48:51], s21 offen offset:2048 nt
  buffer_load_dwordx4 v[136:139], v5, s[48:51], s21 offen offset:2304 nt
  s_mov_b32 s96, 46592
  buffer_load_dwordx4 a[212:215], v6, s[56:59], s96 offen offset:256
  v_and_b32_dpp v50, v30, v8 row_newbcast:12 row_mask:0xf bank_mask:0xf
  v_and_b32_dpp v51, v30, v9 row_newbcast:12 row_mask:0xf bank_mask:0xf
  v_and_b32_dpp v52, v30, v10 row_newbcast:12 row_mask:0xf bank_mask:0xf
  v_and_b32_dpp v53, v30, v11 row_newbcast:12 row_mask:0xf bank_mask:0xf
  s_waitcnt vmcnt(17)
  v_mfma_f32_16x16x32_bf16 v[38:41], v[252:255], v[46:49], v[38:41]
  v_mfma_f32_16x16x32_bf16 v[42:45], v[96:99], v[46:49], v[42:45]
  s_add_u32 s21, s21, 16384
  s_cmp_eq_u32 s21, s20
  s_cselect_b32 s21, 0, s21
  buffer_load_dwordx4 v[140:143], v5, s[48:51], s21 offen offset:0 nt
  buffer_load_dwordx4 v[144:147], v5, s[48:51], s21 offen offset:256 nt
  s_mov_b32 s96, 46592
  buffer_load_dwordx4 a[216:219], v6, s[56:59], s96 offen offset:512
  v_and_b32_dpp v46, v31, v8 row_newbcast:0 row_mask:0xf bank_mask:0xf
  v_and_b32_dpp v47, v31, v9 row_newbcast:0 row_mask:0xf bank_mask:0xf
  v_and_b32_dpp v48, v31, v10 row_newbcast:0 row_mask:0xf bank_mask:0xf
  v_and_b32_dpp v49, v31, v11 row_newbcast:0 row_mask:0xf bank_mask:0xf
  s_waitcnt vmcnt(17)
  v_mfma_f32_16x16x32_bf16 v[38:41], v[100:103], v[50:53], v[38:41]
  v_mfma_f32_16x16x32_bf16 v[42:45], v[104:107], v[50:53], v[42:45]
  buffer_load_dwordx4 v[148:151], v5, s[48:51], s21 offen offset:2048 nt
  buffer_load_dwordx4 v[152:155], v5, s[48:51], s21 offen offset:2304 nt
  s_mov_b32 s96, 46592
  buffer_load_dwordx4 a[220:223], v7, s[56:59], s96 offen offset:768
  v_and_b32_dpp v50, v31, v8 row_newbcast:4 row_mask:0xf bank_mask:0xf
  v_and_b32_dpp v51, v31, v9 row_newbcast:4 row_mask:0xf bank_mask:0xf
  v_and_b32_dpp v52, v31, v10 row_newbcast:4 row_mask:0xf bank_mask:0xf
  v_and_b32_dpp v53, v31, v11 row_newbcast:4 row_mask:0xf bank_mask:0xf
  s_waitcnt vmcnt(17)
  v_mfma_f32_16x16x32_bf16 v[38:41], v[108:111], v[46:49], v[38:41]
  v_mfma_f32_16x16x32_bf16 v[42:45], v[112:115], v[46:49], v[42:45]
  s_add_u32 s21, s21, 16384
  s_cmp_eq_u32 s21, s20
  s_cselect_b32 s21, 0, s21
  buffer_load_dwordx4 v[156:159], v5, s[48:51], s21 offen offset:0 nt
  buffer_load_dwordx4 v[160:163], v5, s[48:51], s21 offen offset:256 nt
  s_mov_b32 s96, 50176
  buffer_load_dwordx4 a[224:227], v6, s[56:59], s96 offen offset:0
  s_mov_b32 s96, 50176
  buffer_load_dwordx4 a[228:231], v6, s[56:59], s96 offen offset:256
  v_and_b32_dpp v46, v31, v8 row_newbcast:8 row_mask:0xf bank_mask:0xf
  v_and_b32_dpp v47, v31, v9 row_newbcast:8 row_mask:0xf bank_mask:0xf
  v_and_b32_dpp v48, v31, v10 row_newbcast:8 row_mask:0xf bank_mask:0xf
  v_and_b32_dpp v49, v31, v11 row_newbcast:8 row_mask:0xf bank_mask:0xf
  s_waitcnt vmcnt(17)
  v_mfma_f32_16x16x32_bf16 v[38:41], v[116:119], v[50:53], v[38:41]
  v_mfma_f32_16x16x32_bf16 v[42:45], v[120:123], v[50:53], v[42:45]
  buffer_load_dwordx4 v[164:167], v5, s[48:51], s21 offen offset:2048 nt
  buffer_load_dwordx4 v[168:171], v5, s[48:51], s21 offen offset:2304 nt
  s_mov_b32 s96, 50176
  buffer_load_dwordx4 a[232:235], v6, s[56:59], s96 offen offset:512
  v_and_b32_dpp v50, v31, v8 row_newbcast:12 row_mask:0xf bank_mask:0xf
  v_and_b32_dpp v51, v31, v9 row_newbcast:12 row_mask:0xf bank_mask:0xf
  v_and_b32_dpp v52, v31, v10 row_newbcast:12 row_mask:0xf bank_mask:0xf
  v_and_b32_dpp v53, v31, v11 row_newbcast:12 row_mask:0xf bank_mask:0xf
  s_waitcnt vmcnt(17)
  v_mfma_f32_16x16x32_bf16 v[38:41], v[124:127], v[46:49], v[38:41]
  v_mfma_f32_16x16x32_bf16 v[42:45], v[128:131], v[46:49], v[42:45]
  s_add_u32 s21, s21, 16384
  s_cmp_eq_u32 s21, s20
  s_cselect_b32 s21, 0, s21
  buffer_load_dwordx4 v[172:175], v5, s[48:51], s21 offen offset:0 nt
  buffer_load_dwordx4 v[176:179], v5, s[48:51], s21 offen offset:256 nt
  s_mov_b32 s96, 50176
  buffer_load_dwordx4 a[236:239], v7, s[56:59], s96 offen offset:768
  v_and_b32_dpp v46, v32, v8 row_newbcast:0 row_mask:0xf bank_mask:0xf
  v_and_b32_dpp v47, v32, v9 row_newbcast:0 row_mask:0xf bank_mask:0xf
  v_and_b32_dpp v48, v32, v10 row_newbcast:0 row_mask:0xf bank_mask:0xf
  v_and_b32_dpp v49, v32, v11 row_newbcast:0 row_mask:0xf bank_mask:0xf
  s_waitcnt vmcnt(17)
  v_mfma_f32_16x16x32_bf16 v[38:41], v[132:135], v[50:53], v[38:41]
  v_mfma_f32_16x16x32_bf16 v[42:45], v[136:139], v[50:53], v[42:45]
  buffer_load_dwordx4 v[180:183], v5, s[48:51], s21 offen offset:2048 nt
  buffer_load_dwordx4 v[184:187], v5, s[48:51], s21 offen offset:2304 nt
  s_mov_b32 s96, 53760
  buffer_load_dwordx4 a[240:243], v6, s[56:59], s96 offen offset:0
  v_and_b32_dpp v50, v32, v8 row_newbcast:4 row_mask:0xf bank_mask:0xf
  v_and_b32_dpp v51, v32, v9 row_newbcast:4 row_mask:0xf bank_mask:0xf
  v_and_b32_dpp v52, v32, v10 row_newbcast:4 row_mask:0xf bank_mask:0xf
  v_and_b32_dpp v53, v32, v11 row_newbcast:4 row_mask:0xf bank_mask:0xf
  s_waitcnt vmcnt(17)
  v_mfma_f32_16x16x32_bf16 v[38:41], v[140:143], v[46:49], v[38:41]
  v_mfma_f32_16x16x32_bf16 v[42:45], v[144:147], v[46:49], v[42:45]
  s_add_u32 s21, s21, 16384
  s_cmp_eq_u32 s21, s20
  s_cselect_b32 s21, 0, s21
  buffer_load_dwordx4 v[188:191], v5, s[48:51], s21 offen offset:0 nt
  buffer_load_dwordx4 v[192:195], v5, s[48:51], s21 offen offset:256 nt
  s_mov_b32 s96, 53760
  buffer_load_dwordx4 a[244:247], v6, s[56:59], s96 offen offset:256
  v_and_b32_dpp v46, v32, v8 row_newbcast:8 row_mask:0xf bank_mask:0xf
  v_and_b32_dpp v47, v32, v9 row_newbcast:8 row_mask:0xf bank_mask:0xf
  v_and_b32_dpp v48, v32, v10 row_newbcast:8 row_mask:0xf bank_mask:0xf
  v_and_b32_dpp v49, v32, v11 row_newbcast:8 row_mask:0xf bank_mask:0xf
  s_waitcnt vmcnt(17)
  v_mfma_f32_16x16x32_bf16 v[38:41], v[148:151], v[50:53], v[38:41]
  v_mfma_f32_16x16x32_bf16 v[42:45], v[152:155], v[50:53], v[42:45]
  buffer_load_dwordx4 v[196:199], v5, s[48:51], s21 offen offset:2048 nt
  buffer_load_dwordx4 v[200:203], v5, s[48:51], s21 offen offset:2304 nt
  s_mov_b32 s96, 53760
  buffer_load_dwordx4 a[248:251], v6, s[56:59], s96 offen offset:512
  v_and_b32_dpp v50, v32, v8 row_newbcast:12 row_mask:0xf bank_mask:0xf
  v_and_b32_dpp v51, v32, v9 row_newbcast:12 row_mask:0xf bank_mask:0xf
  v_and_b32_dpp v52, v32, v10 row_newbcast:12 row_mask:0xf bank_mask:0xf
  v_and_b32_dpp v53, v32, v11 row_newbcast:12 row_mask:0xf bank_mask:0xf
  s_waitcnt vmcnt(17)
  v_mfma_f32_16x16x32_bf16 v[38:41], v[156:159], v[46:49], v[38:41]
  v_mfma_f32_16x16x32_bf16 v[42:45], v[160:163], v[46:49], v[42:45]
  s_add_u32 s21, s21, 16384
  s_cmp_eq_u32 s21, s20
  s_cselect_b32 s21, 0, s21
  buffer_load_dwordx4 v[204:207], v5, s[48:51], s21 offen offset:0 nt
  buffer_load_dwordx4 v[208:211], v5, s[48:51], s21 offen offset:256 nt
  s_mov_b32 s96, 53760
  buffer_load_dwordx4 a[252:255], v7, s[56:59], s96 offen offset:768
  v_and_b32_dpp v46, v33, v8 row_newbcast:0 row_mask:0xf bank_mask:0xf
  v_and_b32_dpp v47, v33, v9 row_newbcast:0 row_mask:0xf bank_mask:0xf
  v_and_b32_dpp v48, v33, v10 row_newbcast:0 row_mask:0xf bank_mask:0xf
  v_and_b32_dpp v49, v33, v11 row_newbcast:0 row_mask:0xf bank_mask:0xf
  s_waitcnt vmcnt(16)
  v_mfma_f32_16x16x32_bf16 v[38:41], v[164:167], v[50:53], v[38:41]
  v_mfma_f32_16x16x32_bf16 v[42:45], v[168:171], v[50:53], v[42:45]
  buffer_load_dwordx4 v[212:215], v5, s[48:51], s21 offen offset:2048 nt
  buffer_load_dwordx4 v[216:219], v5, s[48:51], s21 offen offset:2304 nt
  v_and_b32_dpp v50, v33, v8 row_newbcast:4 row_mask:0xf bank_mask:0xf
  v_and_b32_dpp v51, v33, v9 row_newbcast:4 row_mask:0xf bank_mask:0xf
  v_and_b32_dpp v52, v33, v10 row_newbcast:4 row_mask:0xf bank_mask:0xf
  v_and_b32_dpp v53, v33, v11 row_newbcast:4 row_mask:0xf bank_mask:0xf
  s_waitcnt vmcnt(15)
  v_mfma_f32_16x16x32_bf16 v[38:41], v[172:175], v[46:49], v[38:41]
  v_mfma_f32_16x16x32_bf16 v[42:45], v[176:179], v[46:49], v[42:45]
  s_add_u32 s21, s21, 16384
  s_cmp_eq_u32 s21, s20
  s_cselect_b32 s21, 0, s21
  buffer_load_dwordx4 v[220:223], v5, s[48:51], s21 offen offset:0 nt
  buffer_load_dwordx4 v[224:227], v5, s[48:51], s21 offen offset:256 nt
  v_and_b32_dpp v46, v33, v8 row_newbcast:8 row_mask:0xf bank_mask:0xf
  v_and_b32_dpp v47, v33, v9 row_newbcast:8 row_mask:0xf bank_mask:0xf
  v_and_b32_dpp v48, v33, v10 row_newbcast:8 row_mask:0xf bank_mask:0xf
  v_and_b32_dpp v49, v33, v11 row_newbcast:8 row_mask:0xf bank_mask:0xf
  s_waitcnt vmcnt(14)
  v_mfma_f32_16x16x32_bf16 v[38:41], v[180:183], v[50:53], v[38:41]
  v_mfma_f32_16x16x32_bf16 v[42:45], v[184:187], v[50:53], v[42:45]
  buffer_load_dwordx4 v[228:231], v5, s[48:51], s21 offen offset:2048 nt
  buffer_load_dwordx4 v[232:235], v5, s[48:51], s21 offen offset:2304 nt
  v_and_b32_dpp v50, v33, v8 row_newbcast:12 row_mask:0xf bank_mask:0xf
  v_and_b32_dpp v51, v33, v9 row_newbcast:12 row_mask:0xf bank_mask:0xf
  v_and_b32_dpp v52, v33, v10 row_newbcast:12 row_mask:0xf bank_mask:0xf
  v_and_b32_dpp v53, v33, v11 row_newbcast:12 row_mask:0xf bank_mask:0xf
  s_waitcnt vmcnt(13)
  v_mfma_f32_16x16x32_bf16 v[38:41], v[188:191], v[46:49], v[38:41]
  v_mfma_f32_16x16x32_bf16 v[42:45], v[192:195], v[46:49], v[42:45]
  s_add_u32 s21, s21, 16384
  s_cmp_eq_u32 s21, s20
  s_cselect_b32 s21, 0, s21
  buffer_load_dwordx4 v[236:239], v5, s[48:51], s21 offen offset:0 nt
  buffer_load_dwordx4 v[240:243], v5, s[48:51], s21 offen offset:256 nt
  v_and_b32_dpp v46, v34, v8 row_newbcast:0 row_mask:0xf bank_mask:0xf
  v_and_b32_dpp v47, v34, v9 row_newbcast:0 row_mask:0xf bank_mask:0xf
  v_and_b32_dpp v48, v34, v10 row_newbcast:0 row_mask:0xf bank_mask:0xf
  v_and_b32_dpp v49, v34, v11 row_newbcast:0 row_mask:0xf bank_mask:0xf
  s_waitcnt vmcnt(12)
  v_mfma_f32_16x16x32_bf16 v[38:41], v[196:199], v[50:53], v[38:41]
  v_mfma_f32_16x16x32_bf16 v[42:45], v[200:203], v[50:53], v[42:45]
  buffer_load_dwordx4 v[244:247], v5, s[48:51], s21 offen offset:2048 nt
  buffer_load_dwordx4 v[248:251], v5, s[48:51], s21 offen offset:2304 nt
  v_and_b32_dpp v50, v34, v8 row_newbcast:4 row_mask:0xf bank_mask:0xf
  v_and_b32_dpp v51, v34, v9 row_newbcast:4 row_mask:0xf bank_mask:0xf
  v_and_b32_dpp v52, v34, v10 row_newbcast:4 row_mask:0xf bank_mask:0xf
  v_and_b32_dpp v53, v34, v11 row_newbcast:4 row_mask:0xf bank_mask:0xf
  s_waitcnt vmcnt(11)
  v_mfma_f32_16x16x32_bf16 v[38:41], v[204:207], v[46:49], v[38:41]
  v_mfma_f32_16x16x32_bf16 v[42:45], v[208:211], v[46:49], v[42:45]
  s_add_u32 s21, s21, 16384
  s_cmp_eq_u32 s21, s20
  s_cselect_b32 s21, 0, s21
  buffer_load_dwordx4 v[252:255], v5, s[48:51], s21 offen offset:0 nt
  buffer_load_dwordx4 v[96:99], v5, s[48:51], s21 offen offset:256 nt
  v_and_b32_dpp v46, v34, v8 row_newbcast:8 row_mask:0xf bank_mask:0xf
  v_and_b32_dpp v47, v34, v9 row_newbcast:8 row_mask:0xf bank_mask:0xf
  v_and_b32_dpp v48, v34, v10 row_newbcast:8 row_mask:0xf bank_mask:0xf
  v_and_b32_dpp v49, v34, v11 row_newbcast:8 row_mask:0xf bank_mask:0xf
  s_waitcnt vmcnt(10)
  v_mfma_f32_16x16x32_bf16 v[38:41], v[212:215], v[50:53], v[38:41]
  v_mfma_f32_16x16x32_bf16 v[42:45], v[216:219], v[50:53], v[42:45]
  buffer_load_dwordx4 v[100:103], v5, s[48:51], s21 offen offset:2048 nt
  buffer_load_dwordx4 v[104:107], v5, s[48:51], s21 offen offset:2304 nt
  v_and_b32_dpp v50, v34, v8 row_newbcast:12 row_mask:0xf bank_mask:0xf
  v_and_b32_dpp v51, v34, v9 row_newbcast:12 row_mask:0xf bank_mask:0xf
  v_and_b32_dpp v52, v34, v10 row_newbcast:12 row_mask:0xf bank_mask:0xf
  v_and_b32_dpp v53, v34, v11 row_newbcast:12 row_mask:0xf bank_mask:0xf
  s_waitcnt vmcnt(10)
  v_mfma_f32_16x16x32_bf16 v[38:41], v[220:223], v[46:49], v[38:41]
  v_mfma_f32_16x16x32_bf16 v[42:45], v[224:227], v[46:49], v[42:45]
  s_add_u32 s21, s21, 16384
  s_cmp_eq_u32 s21, s20
  s_cselect_b32 s21, 0, s21
  buffer_load_dwordx4 v[108:111], v5, s[48:51], s21 offen offset:0 nt
  buffer_load_dwordx4 v[112:115], v5, s[48:51], s21 offen offset:256 nt
  v_lshrrev_b32 v80, 1, v2
  v_lshl_add_u32 v80, v3, 4, v80
  v_lshlrev_b32 v80, 5, v80
  v_and_b32 v81, 1, v2
  v_lshl_add_u32 v80, v81, 2, v80
  s_lshl_b32 s12, s3, 3
  s_add_u32 s12, s12, 4096
  v_add_u32 v80, s12, v80
  v_add_u32 v81, 2048, v80
  v_lshrrev_b32 v82, 2, v2
  v_lshlrev_b32 v82, 1, v82
  v_and_b32 v83, 1, v3
  v_add_u32 v82, v82, v83
  v_lshlrev_b32 v82, 5, v82
  s_lshl_b32 s13, s3, 10
  s_add_u32 s13, s13, 4096
  v_add_u32 v82, s13, v82
  v_lshlrev_b32 v83, 4, v1
  s_lshl_b32 s14, s3, 11
  v_add_u32 v83, s14, v83
  v_and_b32 v85, 127, v0
  v_lshlrev_b32 v85, 4, v85
  v_and_b32 v84, 0x68, v0
  v_mov_b32 v86, 0x68
  v_cmp_ne_u32 vcc, v84, v86
  v_mov_b32 v87, 0x7ff00000
  s_nop 0
  v_cndmask_b32 v86, v87, v85, vcc
  v_mov_b32 v84, 128
  v_cmp_gt_u32 vcc, v84, v0
  s_nop 1
  v_cndmask_b32 v86, v87, v86, vcc
  s_lshl_b32 s15, s10, 11
  s_add_u32 s15, s15, 262144
  v_bfe_u32 v90, v2, 2, 1
  v_lshrrev_b32 v87, 1, v3
  v_lshrrev_b32 v88, 3, v2
  v_cmp_eq_u32 s[94:95], v87, v88
  v_cmp_eq_u32 vcc, 0, v90
  s_nop 2
  s_and_b64 vcc, vcc, s[94:95]
  v_mov_b32 v89, 0xffff
  v_cndmask_b32 v62, 0, v89, vcc
  v_cmp_eq_u32 vcc, 1, v90
  s_nop 2
  s_and_b64 vcc, vcc, s[94:95]
  v_mov_b32 v89, 0xffff
  v_cndmask_b32 v63, 0, v89, vcc
  v_cmp_eq_u32 vcc, 0, v90
  s_nop 2
  s_and_b64 vcc, vcc, s[94:95]
  v_mov_b32 v89, 0xffff0000
  v_cndmask_b32 v64, 0, v89, vcc
  v_cmp_eq_u32 vcc, 1, v90
  s_nop 2
  s_and_b64 vcc, vcc, s[94:95]
  v_mov_b32 v89, 0xffff0000
  v_cndmask_b32 v65, 0, v89, vcc
  v_and_b32 v90, 3, v2
  v_add_u32 v87, 1, v90
  v_and_b32 v87, 3, v87
  v_lshl_or_b32 v88, v87, 2, v90
  v_lshl_or_b32 v89, v90, 2, v87
  v_lshl_or_b32 v88, v88, 4, v88
  v_lshl_or_b32 v89, v89, 4, v89
  v_lshl_or_b32 v66, v89, 8, v88
  v_mov_b32 v54, 0
  v_mov_b32 v55, 0
  v_mov_b32 v56, 0
  v_mov_b32 v57, 0
  v_mov_b32 v58, 0
  v_mov_b32 v59, 0
  v_mov_b32 v60, 0
  v_mov_b32 v61, 0
  v_and_b32_dpp v46, v35, v8 row_newbcast:0 row_mask:0xf bank_mask:0xf
  v_and_b32_dpp v47, v35, v9 row_newbcast:0 row_mask:0xf bank_mask:0xf
  v_and_b32_dpp v48, v35, v10 row_newbcast:0 row_mask:0xf bank_mask:0xf
  v_and_b32_dpp v49, v35, v11 row_newbcast:0 row_mask:0xf bank_mask:0xf
  s_waitcnt vmcnt(10)
  v_mfma_f32_16x16x32_bf16 v[38:41], v[228:231], v[50:53], v[38:41]
  v_mfma_f32_16x16x32_bf16 v[42:45], v[232:235], v[50:53], v[42:45]
  buffer_load_dwordx4 v[116:119], v5, s[48:51], s21 offen offset:2048 nt
  buffer_load_dwordx4 v[120:123], v5, s[48:51], s21 offen offset:2304 nt
  v_and_b32_dpp v50, v35, v8 row_newbcast:4 row_mask:0xf bank_mask:0xf
  v_and_b32_dpp v51, v35, v9 row_newbcast:4 row_mask:0xf bank_mask:0xf
  v_and_b32_dpp v52, v35, v10 row_newbcast:4 row_mask:0xf bank_mask:0xf
  v_and_b32_dpp v53, v35, v11 row_newbcast:4 row_mask:0xf bank_mask:0xf
  s_waitcnt vmcnt(10)
  v_mfma_f32_16x16x32_bf16 v[38:41], v[236:239], v[46:49], v[38:41]
  v_mfma_f32_16x16x32_bf16 v[42:45], v[240:243], v[46:49], v[42:45]
  v_and_b32_dpp v46, v35, v8 row_newbcast:8 row_mask:0xf bank_mask:0xf
  v_and_b32_dpp v47, v35, v9 row_newbcast:8 row_mask:0xf bank_mask:0xf
  v_and_b32_dpp v48, v35, v10 row_newbcast:8 row_mask:0xf bank_mask:0xf
  v_and_b32_dpp v49, v35, v11 row_newbcast:8 row_mask:0xf bank_mask:0xf
  s_waitcnt vmcnt(8)
  v_mfma_f32_16x16x32_bf16 v[38:41], v[244:247], v[50:53], v[38:41]
  v_mfma_f32_16x16x32_bf16 v[42:45], v[248:251], v[50:53], v[42:45]
  v_and_b32_dpp v50, v35, v8 row_newbcast:12 row_mask:0xf bank_mask:0xf
  v_and_b32_dpp v51, v35, v9 row_newbcast:12 row_mask:0xf bank_mask:0xf
  v_and_b32_dpp v52, v35, v10 row_newbcast:12 row_mask:0xf bank_mask:0xf
  v_and_b32_dpp v53, v35, v11 row_newbcast:12 row_mask:0xf bank_mask:0xf
  s_waitcnt vmcnt(6)
  v_mfma_f32_16x16x32_bf16 v[38:41], v[252:255], v[46:49], v[38:41]
  v_mfma_f32_16x16x32_bf16 v[42:45], v[96:99], v[46:49], v[42:45]
  v_and_b32_dpp v46, v36, v8 row_newbcast:0 row_mask:0xf bank_mask:0xf
  v_and_b32_dpp v47, v36, v9 row_newbcast:0 row_mask:0xf bank_mask:0xf
  v_and_b32_dpp v48, v36, v10 row_newbcast:0 row_mask:0xf bank_mask:0xf
  v_and_b32_dpp v49, v36, v11 row_newbcast:0 row_mask:0xf bank_mask:0xf
  s_waitcnt vmcnt(4)
  v_mfma_f32_16x16x32_bf16 v[38:41], v[100:103], v[50:53], v[38:41]
  v_mfma_f32_16x16x32_bf16 v[42:45], v[104:107], v[50:53], v[42:45]
  v_and_b32_dpp v50, v36, v8 row_newbcast:4 row_mask:0xf bank_mask:0xf
  v_and_b32_dpp v51, v36, v9 row_newbcast:4 row_mask:0xf bank_mask:0xf
  v_and_b32_dpp v52, v36, v10 row_newbcast:4 row_mask:0xf bank_mask:0xf
  v_and_b32_dpp v53, v36, v11 row_newbcast:4 row_mask:0xf bank_mask:0xf
  s_waitcnt vmcnt(2)
  v_mfma_f32_16x16x32_bf16 v[38:41], v[108:111], v[46:49], v[38:41]
  v_mfma_f32_16x16x32_bf16 v[42:45], v[112:115], v[46:49], v[42:45]
  s_waitcnt vmcnt(0)
  v_mfma_f32_16x16x32_bf16 v[38:41], v[116:119], v[50:53], v[38:41]
  v_mfma_f32_16x16x32_bf16 v[42:45], v[120:123], v[50:53], v[42:45]
  s_mov_b32 exec_lo, 0x00ff00ff
  s_mov_b32 exec_hi, 0x00ff00ff
  s_nop 4
  ds_write2_b32 v80, v38, v39 offset0:0 offset1:32
  ds_write2_b32 v80, v40, v41 offset0:64 offset1:96
  ds_write2_b32 v81, v42, v43 offset0:0 offset1:32
  ds_write2_b32 v81, v44, v45 offset0:64 offset1:96
  s_mov_b64 exec, -1
  s_waitcnt lgkmcnt(0)
  s_barrier
  ds_read_b128 v[20:23], v82 offset:0
  ds_read_b128 v[24:27], v82 offset:16
  ds_read_b128 v[28:31], v82 offset:256
  ds_read_b128 v[32:35], v82 offset:272
  ds_read_b128 v[38:41], v82 offset:512
  ds_read_b128 v[42:45], v82 offset:528
  ds_read_b128 v[46:49], v82 offset:768
  ds_read_b128 v[50:53], v82 offset:784
  s_waitcnt vmcnt(0)
  s_waitcnt lgkmcnt(6)
  v_pk_add_f32 v[20:21], v[20:21], v[22:23]
  v_pk_add_f32 v[24:25], v[24:25], v[26:27]
  v_pk_add_f32 v[20:21], v[20:21], v[24:25]
  v_cvt_pk_bf16_f32 v36, v20, v21
  s_waitcnt lgkmcnt(4)
  v_pk_add_f32 v[28:29], v[28:29], v[30:31]
  v_pk_add_f32 v[32:33], v[32:33], v[34:35]
  v_pk_add_f32 v[28:29], v[28:29], v[32:33]
  v_cvt_pk_bf16_f32 v37, v28, v29
  s_waitcnt lgkmcnt(2)
  v_pk_add_f32 v[38:39], v[38:39], v[40:41]
  v_pk_add_f32 v[42:43], v[42:43], v[44:45]
  v_pk_add_f32 v[38:39], v[38:39], v[42:43]
  v_cvt_pk_bf16_f32 v88, v38, v39
  s_waitcnt lgkmcnt(0)
  v_pk_add_f32 v[46:47], v[46:47], v[48:49]
  v_pk_add_f32 v[50:51], v[50:51], v[52:53]
  v_pk_add_f32 v[46:47], v[46:47], v[50:51]
  v_cvt_pk_bf16_f32 v89, v46, v47
  s_nop 0
  v_and_b32_dpp v46, v36, v62 row_newbcast:0 row_mask:0xf bank_mask:0xf
  v_and_b32_dpp v47, v36, v63 row_newbcast:0 row_mask:0xf bank_mask:0xf
  v_and_b32_dpp v48, v36, v64 row_newbcast:0 row_mask:0xf bank_mask:0xf
  v_and_b32_dpp v49, v36, v65 row_newbcast:0 row_mask:0xf bank_mask:0xf
  v_and_b32_dpp v50, v36, v62 row_newbcast:4 row_mask:0xf bank_mask:0xf
  v_and_b32_dpp v51, v36, v63 row_newbcast:4 row_mask:0xf bank_mask:0xf
  v_smfmac_f32_16x16x64_bf16 v[54:57], v[46:49], a[0:7], v66
  v_and_b32_dpp v52, v36, v64 row_newbcast:4 row_mask:0xf bank_mask:0xf
  v_and_b32_dpp v53, v36, v65 row_newbcast:4 row_mask:0xf bank_mask:0xf
  v_smfmac_f32_16x16x64_bf16 v[58:61], v[46:49], a[8:15], v66
  v_and_b32_dpp v46, v36, v62 row_newbcast:8 row_mask:0xf bank_mask:0xf
  v_and_b32_dpp v47, v36, v63 row_newbcast:8 row_mask:0xf bank_mask:0xf
  v_smfmac_f32_16x16x64_bf16 v[54:57], v[50:53], a[16:23], v66
  v_and_b32_dpp v48, v36, v64 row_newbcast:8 row_mask:0xf bank_mask:0xf
  v_and_b32_dpp v49, v36, v65 row_newbcast:8 row_mask:0xf bank_mask:0xf
  v_smfmac_f32_16x16x64_bf16 v[58:61], v[50:53], a[24:31], v66
  v_and_b32_dpp v50, v36, v62 row_newbcast:12 row_mask:0xf bank_mask:0xf
  v_and_b32_dpp v51, v36, v63 row_newbcast:12 row_mask:0xf bank_mask:0xf
  v_smfmac_f32_16x16x64_bf16 v[54:57], v[46:49], a[32:39], v66
  v_and_b32_dpp v52, v36, v64 row_newbcast:12 row_mask:0xf bank_mask:0xf
  v_and_b32_dpp v53, v36, v65 row_newbcast:12 row_mask:0xf bank_mask:0xf
  v_smfmac_f32_16x16x64_bf16 v[58:61], v[46:49], a[40:47], v66
  v_and_b32_dpp v46, v37, v62 row_newbcast:0 row_mask:0xf bank_mask:0xf
  v_and_b32_dpp v47, v37, v63 row_newbcast:0 row_mask:0xf bank_mask:0xf
  v_smfmac_f32_16x16x64_bf16 v[54:57], v[50:53], a[48:55], v66
  v_and_b32_dpp v48, v37, v64 row_newbcast:0 row_mask:0xf bank_mask:0xf
  v_and_b32_dpp v49, v37, v65 row_newbcast:0 row_mask:0xf bank_mask:0xf
  v_smfmac_f32_16x16x64_bf16 v[58:61], v[50:53], a[56:63], v66
  v_and_b32_dpp v50, v37, v62 row_newbcast:4 row_mask:0xf bank_mask:0xf
  v_and_b32_dpp v51, v37, v63 row_newbcast:4 row_mask:0xf bank_mask:0xf
  v_smfmac_f32_16x16x64_bf16 v[54:57], v[46:49], a[64:71], v66
  v_and_b32_dpp v52, v37, v64 row_newbcast:4 row_mask:0xf bank_mask:0xf
  v_and_b32_dpp v53, v37, v65 row_newbcast:4 row_mask:0xf bank_mask:0xf
  v_smfmac_f32_16x16x64_bf16 v[58:61], v[46:49], a[72:79], v66
  v_and_b32_dpp v46, v37, v62 row_newbcast:8 row_mask:0xf bank_mask:0xf
  v_and_b32_dpp v47, v37, v63 row_newbcast:8 row_mask:0xf bank_mask:0xf
  v_smfmac_f32_16x16x64_bf16 v[54:57], v[50:53], a[80:87], v66
  v_and_b32_dpp v48, v37, v64 row_newbcast:8 row_mask:0xf bank_mask:0xf
  v_and_b32_dpp v49, v37, v65 row_newbcast:8 row_mask:0xf bank_mask:0xf
  v_smfmac_f32_16x16x64_bf16 v[58:61], v[50:53], a[88:95], v66
  v_and_b32_dpp v50, v37, v62 row_newbcast:12 row_mask:0xf bank_mask:0xf
  v_and_b32_dpp v51, v37, v63 row_newbcast:12 row_mask:0xf bank_mask:0xf
  v_smfmac_f32_16x16x64_bf16 v[54:57], v[46:49], a[96:103], v66
  v_and_b32_dpp v52, v37, v64 row_newbcast:12 row_mask:0xf bank_mask:0xf
  v_and_b32_dpp v53, v37, v65 row_newbcast:12 row_mask:0xf bank_mask:0xf
  v_smfmac_f32_16x16x64_bf16 v[58:61], v[46:49], a[104:111], v66
  v_and_b32_dpp v46, v88, v62 row_newbcast:0 row_mask:0xf bank_mask:0xf
  v_and_b32_dpp v47, v88, v63 row_newbcast:0 row_mask:0xf bank_mask:0xf
  v_smfmac_f32_16x16x64_bf16 v[54:57], v[50:53], a[112:119], v66
  v_and_b32_dpp v48, v88, v64 row_newbcast:0 row_mask:0xf bank_mask:0xf
  v_and_b32_dpp v49, v88, v65 row_newbcast:0 row_mask:0xf bank_mask:0xf
  v_smfmac_f32_16x16x64_bf16 v[58:61], v[50:53], a[120:127], v66
  v_and_b32_dpp v50, v88, v62 row_newbcast:4 row_mask:0xf bank_mask:0xf
  v_and_b32_dpp v51, v88, v63 row_newbcast:4 row_mask:0xf bank_mask:0xf
  v_smfmac_f32_16x16x64_bf16 v[54:57], v[46:49], a[128:135], v66
  v_and_b32_dpp v52, v88, v64 row_newbcast:4 row_mask:0xf bank_mask:0xf
  v_and_b32_dpp v53, v88, v65 row_newbcast:4 row_mask:0xf bank_mask:0xf
  v_smfmac_f32_16x16x64_bf16 v[58:61], v[46:49], a[136:143], v66
  v_and_b32_dpp v46, v88, v62 row_newbcast:8 row_mask:0xf bank_mask:0xf
  v_and_b32_dpp v47, v88, v63 row_newbcast:8 row_mask:0xf bank_mask:0xf
  v_smfmac_f32_16x16x64_bf16 v[54:57], v[50:53], a[144:151], v66
  v_and_b32_dpp v48, v88, v64 row_newbcast:8 row_mask:0xf bank_mask:0xf
  v_and_b32_dpp v49, v88, v65 row_newbcast:8 row_mask:0xf bank_mask:0xf
  v_smfmac_f32_16x16x64_bf16 v[58:61], v[50:53], a[152:159], v66
  v_and_b32_dpp v50, v88, v62 row_newbcast:12 row_mask:0xf bank_mask:0xf
  v_and_b32_dpp v51, v88, v63 row_newbcast:12 row_mask:0xf bank_mask:0xf
  v_smfmac_f32_16x16x64_bf16 v[54:57], v[46:49], a[160:167], v66
  v_and_b32_dpp v52, v88, v64 row_newbcast:12 row_mask:0xf bank_mask:0xf
  v_and_b32_dpp v53, v88, v65 row_newbcast:12 row_mask:0xf bank_mask:0xf
  v_smfmac_f32_16x16x64_bf16 v[58:61], v[46:49], a[168:175], v66
  v_and_b32_dpp v46, v89, v62 row_newbcast:0 row_mask:0xf bank_mask:0xf
  v_and_b32_dpp v47, v89, v63 row_newbcast:0 row_mask:0xf bank_mask:0xf
  v_smfmac_f32_16x16x64_bf16 v[54:57], v[50:53], a[176:183], v66
  v_and_b32_dpp v48, v89, v64 row_newbcast:0 row_mask:0xf bank_mask:0xf
  v_and_b32_dpp v49, v89, v65 row_newbcast:0 row_mask:0xf bank_mask:0xf
  v_smfmac_f32_16x16x64_bf16 v[58:61], v[50:53], a[184:191], v66
  v_and_b32_dpp v50, v89, v62 row_newbcast:4 row_mask:0xf bank_mask:0xf
  v_and_b32_dpp v51, v89, v63 row_newbcast:4 row_mask:0xf bank_mask:0xf
  v_smfmac_f32_16x16x64_bf16 v[54:57], v[46:49], a[192:199], v66
  v_and_b32_dpp v52, v89, v64 row_newbcast:4 row_mask:0xf bank_mask:0xf
  v_and_b32_dpp v53, v89, v65 row_newbcast:4 row_mask:0xf bank_mask:0xf
  v_smfmac_f32_16x16x64_bf16 v[58:61], v[46:49], a[200:207], v66
  v_and_b32_dpp v46, v89, v62 row_newbcast:8 row_mask:0xf bank_mask:0xf
  v_and_b32_dpp v47, v89, v63 row_newbcast:8 row_mask:0xf bank_mask:0xf
  v_smfmac_f32_16x16x64_bf16 v[54:57], v[50:53], a[208:215], v66
  v_and_b32_dpp v48, v89, v64 row_newbcast:8 row_mask:0xf bank_mask:0xf
  v_and_b32_dpp v49, v89, v65 row_newbcast:8 row_mask:0xf bank_mask:0xf
  v_smfmac_f32_16x16x64_bf16 v[58:61], v[50:53], a[216:223], v66
  v_and_b32_dpp v50, v89, v62 row_newbcast:12 row_mask:0xf bank_mask:0xf
  v_and_b32_dpp v51, v89, v63 row_newbcast:12 row_mask:0xf bank_mask:0xf
  v_smfmac_f32_16x16x64_bf16 v[54:57], v[46:49], a[224:231], v66
  v_and_b32_dpp v52, v89, v64 row_newbcast:12 row_mask:0xf bank_mask:0xf
  v_and_b32_dpp v53, v89, v65 row_newbcast:12 row_mask:0xf bank_mask:0xf
  v_smfmac_f32_16x16x64_bf16 v[58:61], v[46:49], a[232:239], v66
  s_nop 0
  v_smfmac_f32_16x16x64_bf16 v[54:57], v[50:53], a[240:247], v66
  v_smfmac_f32_16x16x64_bf16 v[58:61], v[50:53], a[248:255], v66
  s_nop 6
  ds_write_b128 v83, v[54:57] offset:16384
  ds_write_b128 v83, v[58:61] offset:17408
  s_waitcnt lgkmcnt(0)
  s_barrier
  ds_read_b128 v[20:23], v85 offset:16384
  ds_read_b128 v[24:27], v85 offset:18432
  ds_read_b128 v[28:31], v85 offset:20480
  ds_read_b128 v[32:35], v85 offset:22528
  s_waitcnt lgkmcnt(2)
  v_pk_add_f32 v[20:21], v[20:21], v[24:25]
  v_pk_add_f32 v[22:23], v[22:23], v[26:27]
  s_waitcnt lgkmcnt(0)
  v_pk_add_f32 v[28:29], v[28:29], v[32:33]
  v_pk_add_f32 v[30:31], v[30:31], v[34:35]
  v_pk_add_f32 v[20:21], v[20:21], v[28:29]
  v_pk_add_f32 v[22:23], v[22:23], v[30:31]
  v_min_u32 v20, -2, v20
  v_min_u32 v21, -2, v21
  v_min_u32 v22, -2, v22
  v_min_u32 v23, -2, v23
  buffer_store_dwordx4 v[20:23], v86, s[64:67], s15 offen sc1
  s_endpgm
L_roleR:
  s_mul_i32 s12, s8, 56
  s_lshr_b32 s13, s3, 1
  s_mul_i32 s13, s13, 28
  s_add_u32 s12, s12, s13
  v_min_u32 v80, 6, v2
  v_lshl_add_u32 v80, v80, 2, v3
  v_add_u32 v80, s12, v80
  v_lshlrev_b32 v80, 1, v80
  s_mul_i32 s13, s7, 896
  buffer_load_ushort v83, v80, s[60:63], s13 offen
  v_lshlrev_b32 v7, 4, v2
  v_lshl_add_u32 v7, v3, 13, v7
  s_lshl_b32 s12, s12, 13
  s_and_b32 s13, s3, 1
  s_lshl_b32 s13, s13, 8
  s_add_u32 s12, s12, s13
  buffer_load_dwordx4 v[96:99], v7, s[52:55], s12 offen nt
  s_add_u32 s12, s12, 32768
  buffer_load_dwordx4 v[100:103], v7, s[52:55], s12 offen nt
  s_add_u32 s12, s12, 32768
  buffer_load_dwordx4 v[104:107], v7, s[52:55], s12 offen nt
  s_add_u32 s12, s12, 32768
  buffer_load_dwordx4 v[108:111], v7, s[52:55], s12 offen nt
  s_add_u32 s12, s12, 32768
  buffer_load_dwordx4 v[112:115], v7, s[52:55], s12 offen nt
  s_add_u32 s12, s12, 32768
  buffer_load_dwordx4 v[116:119], v7, s[52:55], s12 offen nt
  s_add_u32 s12, s12, 32768
  buffer_load_dwordx4 v[120:123], v7, s[52:55], s12 offen nt
  v_mov_b32 v84, -1
  v_mov_b32 v85, -1
  v_mov_b32 v50, -1
  v_mov_b32 v51, -1
  v_mov_b32 v52, -1
  v_mov_b32 v53, -1
  v_lshlrev_b32 v81, 4, v0
  v_mov_b32 v82, 128
  v_cmp_gt_u32 vcc, v82, v0
  v_mov_b32 v82, 0x7ff00000
  s_nop 0
  v_cndmask_b32 v81, v82, v81, vcc
  s_lshl_b32 s12, s10, 11
  s_add_u32 s12, s12, 262144
  buffer_store_dwordx4 v[50:53], v81, s[64:67], s12 offen sc1
  v_cmp_eq_u32 vcc, 0, v0
  v_mov_b32 v82, 0x7ff00000
  v_mov_b32 v86, 0
  v_cndmask_b32 v86, v82, v86, vcc
  s_lshl_b32 s13, s10, 3
  s_add_u32 s13, s13, 786432
  buffer_store_dwordx2 v[84:85], v86, s[64:67], s13 offen sc1
  s_add_u32 s101, s101, 16384
  s_cmp_eq_u32 s101, s20
  s_cselect_b32 s101, 0, s101
  buffer_load_dwordx4 a[32:35], v4, s[44:47], s101 offen offset:0 nt
  buffer_load_dwordx4 a[36:39], v4, s[44:47], s101 offen offset:256 nt
  buffer_load_dwordx4 a[40:43], v4, s[44:47], s101 offen offset:2048 nt
  buffer_load_dwordx4 a[44:47], v4, s[44:47], s101 offen offset:2304 nt
  s_waitcnt vmcnt(13)
  v_lshl_or_b32 v83, v83, 16, v83
  s_nop 1
  v_and_b32_dpp v46, v83, v8 row_newbcast:0 row_mask:0xf bank_mask:0xf
  v_and_b32_dpp v47, v83, v9 row_newbcast:0 row_mask:0xf bank_mask:0xf
  v_and_b32_dpp v48, v83, v10 row_newbcast:0 row_mask:0xf bank_mask:0xf
  v_and_b32_dpp v49, v83, v11 row_newbcast:0 row_mask:0xf bank_mask:0xf
  s_waitcnt vmcnt(12)
  s_nop 0
  v_mfma_f32_16x16x32_bf16 v[38:41], v[96:99], v[46:49], 0
  v_and_b32_dpp v50, v83, v8 row_newbcast:1 row_mask:0xf bank_mask:0xf
  v_and_b32_dpp v51, v83, v9 row_newbcast:1 row_mask:0xf bank_mask:0xf
  v_and_b32_dpp v52, v83, v10 row_newbcast:1 row_mask:0xf bank_mask:0xf
  v_and_b32_dpp v53, v83, v11 row_newbcast:1 row_mask:0xf bank_mask:0xf
  s_waitcnt vmcnt(11)
  s_nop 0
  v_mfma_f32_16x16x32_bf16 v[38:41], v[100:103], v[50:53], v[38:41]
  v_and_b32_dpp v46, v83, v8 row_newbcast:2 row_mask:0xf bank_mask:0xf
  v_and_b32_dpp v47, v83, v9 row_newbcast:2 row_mask:0xf bank_mask:0xf
  v_and_b32_dpp v48, v83, v10 row_newbcast:2 row_mask:0xf bank_mask:0xf
  v_and_b32_dpp v49, v83, v11 row_newbcast:2 row_mask:0xf bank_mask:0xf
  s_waitcnt vmcnt(10)
  s_nop 0
  v_mfma_f32_16x16x32_bf16 v[38:41], v[104:107], v[46:49], v[38:41]
  v_and_b32_dpp v50, v83, v8 row_newbcast:3 row_mask:0xf bank_mask:0xf
  v_and_b32_dpp v51, v83, v9 row_newbcast:3 row_mask:0xf bank_mask:0xf
  v_and_b32_dpp v52, v83, v10 row_newbcast:3 row_mask:0xf bank_mask:0xf
  v_and_b32_dpp v53, v83, v11 row_newbcast:3 row_mask:0xf bank_mask:0xf
  s_waitcnt vmcnt(9)
  s_nop 0
  v_mfma_f32_16x16x32_bf16 v[38:41], v[108:111], v[50:53], v[38:41]
  v_and_b32_dpp v46, v83, v8 row_newbcast:4 row_mask:0xf bank_mask:0xf
  v_and_b32_dpp v47, v83, v9 row_newbcast:4 row_mask:0xf bank_mask:0xf
  v_and_b32_dpp v48, v83, v10 row_newbcast:4 row_mask:0xf bank_mask:0xf
  v_and_b32_dpp v49, v83, v11 row_newbcast:4 row_mask:0xf bank_mask:0xf
  s_waitcnt vmcnt(8)
  s_nop 0
  v_mfma_f32_16x16x32_bf16 v[38:41], v[112:115], v[46:49], v[38:41]
  v_and_b32_dpp v50, v83, v8 row_newbcast:5 row_mask:0xf bank_mask:0xf
  v_and_b32_dpp v51, v83, v9 row_newbcast:5 row_mask:0xf bank_mask:0xf
  v_and_b32_dpp v52, v83, v10 row_newbcast:5 row_mask:0xf bank_mask:0xf
  v_and_b32_dpp v53, v83, v11 row_newbcast:5 row_mask:0xf bank_mask:0xf
  s_waitcnt vmcnt(7)
  s_nop 0
  v_mfma_f32_16x16x32_bf16 v[38:41], v[116:119], v[50:53], v[38:41]
  v_and_b32_dpp v46, v83, v8 row_newbcast:6 row_mask:0xf bank_mask:0xf
  v_and_b32_dpp v47, v83, v9 row_newbcast:6 row_mask:0xf bank_mask:0xf
  v_and_b32_dpp v48, v83, v10 row_newbcast:6 row_mask:0xf bank_mask:0xf
  v_and_b32_dpp v49, v83, v11 row_newbcast:6 row_mask:0xf bank_mask:0xf
  s_waitcnt vmcnt(6)
  s_nop 0
  v_mfma_f32_16x16x32_bf16 v[38:41], v[120:123], v[46:49], v[38:41]
  s_and_b32 s12, s3, 1
  s_lshl_b32 s12, s12, 10
  s_lshr_b32 s13, s3, 1
  s_lshl_b32 s13, s13, 2
  s_add_u32 s12, s12, s13
  v_lshl_add_u32 v80, v3, 5, v2
  v_lshlrev_b32 v80, 3, v80
  v_add_u32 v80, s12, v80
  s_mov_b32 exec_lo, 0x00ff00ff
  s_mov_b32 exec_hi, 0x00ff00ff
  ds_write2_b32 v80, v38, v39 offset0:0 offset1:16
  ds_write2_b32 v80, v40, v41 offset0:32 offset1:48
  s_mov_b64 exec, -1
  s_waitcnt lgkmcnt(0)
  s_barrier
  v_lshlrev_b32 v80, 5, v1
  ds_read_b128 v[46:49], v80 offset:0
  ds_read_b128 v[50:53], v80 offset:16
  v_lshlrev_b32 v81, 4, v0
  v_mov_b32 v82, 0x7ff00000
  v_cmp_gt_u32 vcc, 64, v0
  s_nop 1
  v_cndmask_b32 v81, v82, v81, vcc
  s_lshl_b32 s12, s10, 10
  s_waitcnt lgkmcnt(0)
  v_add_f32 v38, v46, v47
  v_add_f32 v39, v48, v49
  v_add_f32 v40, v50, v51
  v_add_f32 v41, v52, v53
  buffer_store_dwordx4 v[38:41], v81, s[64:67], s12 offen sc1
  s_add_u32 s101, s101, 16384
  s_cmp_eq_u32 s101, s20
  s_cselect_b32 s101, 0, s101
  buffer_load_dwordx4 a[48:51], v4, s[44:47], s101 offen offset:0 nt
  buffer_load_dwordx4 a[52:55], v4, s[44:47], s101 offen offset:256 nt
  buffer_load_dwordx4 a[56:59], v4, s[44:47], s101 offen offset:2048 nt
  buffer_load_dwordx4 a[60:63], v4, s[44:47], s101 offen offset:2304 nt
  s_add_u32 s101, s101, 16384
  s_cmp_eq_u32 s101, s20
  s_cselect_b32 s101, 0, s101
  buffer_load_dwordx4 a[64:67], v4, s[44:47], s101 offen offset:0 nt
  buffer_load_dwordx4 a[68:71], v4, s[44:47], s101 offen offset:256 nt
  buffer_load_dwordx4 a[72:75], v4, s[44:47], s101 offen offset:2048 nt
  buffer_load_dwordx4 a[76:79], v4, s[44:47], s101 offen offset:2304 nt
  s_waitcnt vmcnt(8)
  s_barrier
  v_mov_b32 v84, 1
  s_lshl_b32 s12, s9, 2
  buffer_atomic_add v84, v86, s[68:71], s12 offen
  s_add_u32 s101, s101, 16384
  s_cmp_eq_u32 s101, s20
  s_cselect_b32 s101, 0, s101
  buffer_load_dwordx4 a[80:83], v4, s[44:47], s101 offen offset:0 nt
  buffer_load_dwordx4 a[84:87], v4, s[44:47], s101 offen offset:256 nt
  buffer_load_dwordx4 a[88:91], v4, s[44:47], s101 offen offset:2048 nt
  s_waitcnt vmcnt(11)
  buffer_load_dwordx4 a[92:95], v4, s[44:47], s101 offen offset:2304 nt
  s_waitcnt vmcnt(11)
  s_add_u32 s101, s101, 16384
  s_cmp_eq_u32 s101, s20
  s_cselect_b32 s101, 0, s101
  buffer_load_dwordx4 a[96:99], v4, s[44:47], s101 offen offset:0 nt
  s_waitcnt vmcnt(11)
  buffer_load_dwordx4 a[100:103], v4, s[44:47], s101 offen offset:256 nt
  s_waitcnt vmcnt(11)
  buffer_load_dwordx4 a[104:107], v4, s[44:47], s101 offen offset:2048 nt
  s_waitcnt vmcnt(11)
  buffer_load_dwordx4 a[108:111], v4, s[44:47], s101 offen offset:2304 nt
  s_waitcnt vmcnt(11)
  s_add_u32 s101, s101, 16384
  s_cmp_eq_u32 s101, s20
  s_cselect_b32 s101, 0, s101
  buffer_load_dwordx4 a[112:115], v4, s[44:47], s101 offen offset:0 nt
  s_waitcnt vmcnt(11)
  buffer_load_dwordx4 a[116:119], v4, s[44:47], s101 offen offset:256 nt
  s_waitcnt vmcnt(11)
  buffer_load_dwordx4 a[120:123], v4, s[44:47], s101 offen offset:2048 nt
  s_waitcnt vmcnt(11)
  buffer_load_dwordx4 a[124:127], v4, s[44:47], s101 offen offset:2304 nt
  s_waitcnt vmcnt(11)
  s_add_u32 s101, s101, 16384
  s_cmp_eq_u32 s101, s20
  s_cselect_b32 s101, 0, s101
  buffer_load_dwordx4 a[128:131], v4, s[44:47], s101 offen offset:0 nt
  s_waitcnt vmcnt(11)
  buffer_load_dwordx4 a[132:135], v4, s[44:47], s101 offen offset:256 nt
  s_waitcnt vmcnt(11)
  buffer_load_dwordx4 a[136:139], v4, s[44:47], s101 offen offset:2048 nt
  s_waitcnt vmcnt(11)
  buffer_load_dwordx4 a[140:143], v4, s[44:47], s101 offen offset:2304 nt
  s_waitcnt vmcnt(11)
  s_add_u32 s101, s101, 16384
  s_cmp_eq_u32 s101, s20
  s_cselect_b32 s101, 0, s101
  buffer_load_dwordx4 a[144:147], v4, s[44:47], s101 offen offset:0 nt
  s_waitcnt vmcnt(11)
  buffer_load_dwordx4 a[148:151], v4, s[44:47], s101 offen offset:256 nt
  s_waitcnt vmcnt(11)
  buffer_load_dwordx4 a[152:155], v4, s[44:47], s101 offen offset:2048 nt
  s_waitcnt vmcnt(11)
  buffer_load_dwordx4 a[156:159], v4, s[44:47], s101 offen offset:2304 nt
  s_waitcnt vmcnt(11)
  s_add_u32 s101, s101, 16384
  s_cmp_eq_u32 s101, s20
  s_cselect_b32 s101, 0, s101
  buffer_load_dwordx4 a[160:163], v4, s[44:47], s101 offen offset:0 nt
  s_waitcnt vmcnt(11)
  buffer_load_dwordx4 a[164:167], v4, s[44:47], s101 offen offset:256 nt
  s_waitcnt vmcnt(11)
  buffer_load_dwordx4 a[168:171], v4, s[44:47], s101 offen offset:2048 nt
  s_waitcnt vmcnt(11)
  buffer_load_dwordx4 a[172:175], v4, s[44:47], s101 offen offset:2304 nt
  s_waitcnt vmcnt(11)
  s_add_u32 s101, s101, 16384
  s_cmp_eq_u32 s101, s20
  s_cselect_b32 s101, 0, s101
  buffer_load_dwordx4 a[176:179], v4, s[44:47], s101 offen offset:0 nt
  s_waitcnt vmcnt(11)
  buffer_load_dwordx4 a[180:183], v4, s[44:47], s101 offen offset:256 nt
  s_waitcnt vmcnt(11)
  buffer_load_dwordx4 a[184:187], v4, s[44:47], s101 offen offset:2048 nt
  s_waitcnt vmcnt(11)
  buffer_load_dwordx4 a[188:191], v4, s[44:47], s101 offen offset:2304 nt
  s_waitcnt vmcnt(11)
  s_add_u32 s101, s101, 16384
  s_cmp_eq_u32 s101, s20
  s_cselect_b32 s101, 0, s101
  buffer_load_dwordx4 a[192:195], v4, s[44:47], s101 offen offset:0 nt
  s_waitcnt vmcnt(11)
  buffer_load_dwordx4 a[196:199], v4, s[44:47], s101 offen offset:256 nt
  s_waitcnt vmcnt(11)
  buffer_load_dwordx4 a[200:203], v4, s[44:47], s101 offen offset:2048 nt
  s_waitcnt vmcnt(11)
  buffer_load_dwordx4 a[204:207], v4, s[44:47], s101 offen offset:2304 nt
  v_and_b32 v80, 31, v1
  v_lshlrev_b32 v80, 2, v80
  s_mov_b32 s14, 0
  buffer_load_dword v84, v80, s[68:71], s14 offen sc1
  s_add_u32 s101, s101, 16384
  s_cmp_eq_u32 s101, s20
  s_cselect_b32 s101, 0, s101
  buffer_load_dwordx4 a[208:211], v4, s[44:47], s101 offen offset:0 nt
  buffer_load_dwordx4 a[212:215], v4, s[44:47], s101 offen offset:256 nt
  buffer_load_dwordx4 a[216:219], v4, s[44:47], s101 offen offset:2048 nt
  buffer_load_dwordx4 a[220:223], v4, s[44:47], s101 offen offset:2304 nt
  s_add_u32 s101, s101, 16384
  s_cmp_eq_u32 s101, s20
  s_cselect_b32 s101, 0, s101
  buffer_load_dwordx4 a[224:227], v4, s[44:47], s101 offen offset:0 nt
  buffer_load_dwordx4 a[228:231], v4, s[44:47], s101 offen offset:256 nt
  buffer_load_dwordx4 a[232:235], v4, s[44:47], s101 offen offset:2048 nt
  buffer_load_dwordx4 a[236:239], v4, s[44:47], s101 offen offset:2304 nt
  s_add_u32 s101, s101, 16384
  s_cmp_eq_u32 s101, s20
  s_cselect_b32 s101, 0, s101
  buffer_load_dwordx4 a[240:243], v4, s[44:47], s101 offen offset:0 nt
  buffer_load_dwordx4 a[244:247], v4, s[44:47], s101 offen offset:256 nt
  buffer_load_dwordx4 a[248:251], v4, s[44:47], s101 offen offset:2048 nt
  buffer_load_dwordx4 a[252:255], v4, s[44:47], s101 offen offset:2304 nt
  s_waitcnt vmcnt(12)
  v_cmp_ne_u32 vcc, 8, v84
  s_nop 4
  s_cbranch_vccz L_qokR
  s_mov_b32 s93, 0
L_qspinR:
  buffer_load_dword v84, v80, s[68:71], s14 offen sc1
  s_waitcnt vmcnt(0)
  v_cmp_ne_u32 vcc, 8, v84
  s_nop 4
  s_cbranch_vccz L_qokR
  s_add_u32 s93, s93, 1
  s_cmp_lt_u32 s93, 0x40000
  s_cbranch_scc0 L_qokR
  s_sleep 4
  s_branch L_qspinR
L_qokR:
  v_lshlrev_b32 v80, 10, v3
  v_lshl_add_u32 v80, v2, 4, v80
  s_lshl_b32 s13, s3, 8
  v_add_u32 v80, s13, v80
  s_lshl_b32 s12, s9, 13
  s_add_u32 s14, s12, 4096
  buffer_load_dwordx4 v[54:57], v80, s[64:67], s12 offen sc1
  buffer_load_dwordx4 v[58:61], v80, s[64:67], s14 offen sc1
  s_add_u32 s101, s101, 16384
  s_cmp_eq_u32 s101, s20
  s_cselect_b32 s101, 0, s101
  buffer_load_dwordx4 v[124:127], v4, s[44:47], s101 offen offset:0 nt
  buffer_load_dwordx4 v[128:131], v4, s[44:47], s101 offen offset:256 nt
  buffer_load_dwordx4 v[132:135], v4, s[44:47], s101 offen offset:2048 nt
  buffer_load_dwordx4 v[136:139], v4, s[44:47], s101 offen offset:2304 nt
  s_add_u32 s101, s101, 16384
  s_cmp_eq_u32 s101, s20
  s_cselect_b32 s101, 0, s101
  buffer_load_dwordx4 v[140:143], v4, s[44:47], s101 offen offset:0 nt
  buffer_load_dwordx4 v[144:147], v4, s[44:47], s101 offen offset:256 nt
  buffer_load_dwordx4 v[148:151], v4, s[44:47], s101 offen offset:2048 nt
  buffer_load_dwordx4 v[152:155], v4, s[44:47], s101 offen offset:2304 nt
  s_add_u32 s101, s101, 16384
  s_cmp_eq_u32 s101, s20
  s_cselect_b32 s101, 0, s101
  buffer_load_dwordx4 v[156:159], v4, s[44:47], s101 offen offset:0 nt
  buffer_load_dwordx4 v[160:163], v4, s[44:47], s101 offen offset:256 nt
  buffer_load_dwordx4 v[164:167], v4, s[44:47], s101 offen offset:2048 nt
  buffer_load_dwordx4 v[168:171], v4, s[44:47], s101 offen offset:2304 nt
  v_lshlrev_b32 v80, 3, v2
  s_lshl_b32 s13, s3, 7
  v_add_u32 v80, s13, v80
  s_waitcnt vmcnt(12)
  v_pk_add_f32 v[54:55], v[54:55], v[58:59]
  v_pk_add_f32 v[56:57], v[56:57], v[60:61]
  v_mov_b32 v58, v54
  v_mov_b32 v59, v55
  v_mov_b32 v60, v56
  v_mov_b32 v61, v57
  v_permlane16_swap_b32 v54, v58
  v_permlane16_swap_b32 v55, v59
  v_permlane16_swap_b32 v56, v60
  v_permlane16_swap_b32 v57, v61
  v_add_f32 v54, v54, v58
  v_add_f32 v55, v55, v59
  v_add_f32 v56, v56, v60
  v_add_f32 v57, v57, v61
  v_mov_b32 v58, v54
  v_mov_b32 v59, v55
  v_mov_b32 v60, v56
  v_mov_b32 v61, v57
  v_permlane32_swap_b32 v54, v58
  v_permlane32_swap_b32 v55, v59
  v_permlane32_swap_b32 v56, v60
  v_permlane32_swap_b32 v57, v61
  v_add_f32 v54, v54, v58
  v_add_f32 v55, v55, v59
  v_add_f32 v56, v56, v60
  v_add_f32 v57, v57, v61
  v_cvt_pk_bf16_f32 v58, v54, v55
  v_cvt_pk_bf16_f32 v59, v56, v57
  ds_write_b64 v80, v[58:59] offset:2048
  v_and_b32 v81, 3, v2
  v_lshl_add_u32 v81, v3, 2, v81
  v_lshlrev_b32 v81, 4, v81
  s_waitcnt lgkmcnt(0)
  s_barrier
  ds_read_b128 v[12:15], v81 offset:2048
  ds_read_b128 v[16:19], v81 offset:2304
  s_waitcnt lgkmcnt(0)
  v_and_b32 v7, 8, v2
  v_lshlrev_b32 v7, 4, v7
  v_sub_u32 v7, v6, v7
  v_mfma_f32_16x16x32_bf16 v[38:41], a[0:3], v[12:15], 0
  v_mfma_f32_16x16x32_bf16 v[38:41], a[4:7], v[16:19], v[38:41]
  v_mfma_f32_16x16x32_bf16 v[42:45], a[8:11], v[12:15], 0
  v_mfma_f32_16x16x32_bf16 v[42:45], a[12:15], v[16:19], v[42:45]
  s_waitcnt vmcnt(11)
  s_add_u32 s101, s101, 16384
  s_cmp_eq_u32 s101, s20
  s_cselect_b32 s101, 0, s101
  buffer_load_dwordx4 v[172:175], v4, s[44:47], s101 offen offset:0 nt
  s_nop 0
  v_add_f32_dpp v88, v39, v38 quad_perm:[1,1,1,1] row_mask:0xf bank_mask:0xf
  v_add_f32_dpp v89, v41, v40 quad_perm:[3,3,3,3] row_mask:0xf bank_mask:0xf
  s_nop 1
  v_add_f32_dpp v20, v89, v88 quad_perm:[2,2,2,2] row_mask:0xf bank_mask:0x1
  v_mfma_f32_16x16x32_bf16 v[38:41], a[16:19], v[12:15], 0
  v_mfma_f32_16x16x32_bf16 v[38:41], a[20:23], v[16:19], v[38:41]
  v_add_f32_dpp v88, v43, v42 quad_perm:[1,1,1,1] row_mask:0xf bank_mask:0xf
  v_add_f32_dpp v89, v45, v44 quad_perm:[3,3,3,3] row_mask:0xf bank_mask:0xf
  s_nop 1
  v_add_f32_dpp v20, v89, v88 quad_perm:[2,2,2,2] row_mask:0xf bank_mask:0x2
  v_mfma_f32_16x16x32_bf16 v[42:45], a[24:27], v[12:15], 0
  v_mfma_f32_16x16x32_bf16 v[42:45], a[28:31], v[16:19], v[42:45]
  s_waitcnt vmcnt(11)
  buffer_load_dwordx4 v[176:179], v4, s[44:47], s101 offen offset:256 nt
  v_add_f32_dpp v88, v39, v38 quad_perm:[1,1,1,1] row_mask:0xf bank_mask:0xf
  v_add_f32_dpp v89, v41, v40 quad_perm:[3,3,3,3] row_mask:0xf bank_mask:0xf
  s_nop 1
  v_add_f32_dpp v20, v89, v88 quad_perm:[2,2,2,2] row_mask:0xf bank_mask:0x4
  v_mfma_f32_16x16x32_bf16 v[38:41], a[32:35], v[12:15], 0
  v_mfma_f32_16x16x32_bf16 v[38:41], a[36:39], v[16:19], v[38:41]
  v_add_f32_dpp v88, v43, v42 quad_perm:[1,1,1,1] row_mask:0xf bank_mask:0xf
  v_add_f32_dpp v89, v45, v44 quad_perm:[3,3,3,3] row_mask:0xf bank_mask:0xf
  s_nop 1
  v_add_f32_dpp v20, v89, v88 quad_perm:[2,2,2,2] row_mask:0xf bank_mask:0x8
  v_mfma_f32_16x16x32_bf16 v[42:45], a[40:43], v[12:15], 0
  v_mfma_f32_16x16x32_bf16 v[42:45], a[44:47], v[16:19], v[42:45]
  s_waitcnt vmcnt(11)
  buffer_load_dwordx4 v[180:183], v4, s[44:47], s101 offen offset:2048 nt
  v_add_f32_dpp v88, v39, v38 quad_perm:[1,1,1,1] row_mask:0xf bank_mask:0xf
  v_add_f32_dpp v89, v41, v40 quad_perm:[3,3,3,3] row_mask:0xf bank_mask:0xf
  s_nop 1
  v_add_f32_dpp v21, v89, v88 quad_perm:[2,2,2,2] row_mask:0xf bank_mask:0x1
  v_mfma_f32_16x16x32_bf16 v[38:41], a[48:51], v[12:15], 0
  v_mfma_f32_16x16x32_bf16 v[38:41], a[52:55], v[16:19], v[38:41]
  v_add_f32_dpp v88, v43, v42 quad_perm:[1,1,1,1] row_mask:0xf bank_mask:0xf
  v_add_f32_dpp v89, v45, v44 quad_perm:[3,3,3,3] row_mask:0xf bank_mask:0xf
  s_nop 1
  v_add_f32_dpp v21, v89, v88 quad_perm:[2,2,2,2] row_mask:0xf bank_mask:0x2
  v_mfma_f32_16x16x32_bf16 v[42:45], a[56:59], v[12:15], 0
  v_mfma_f32_16x16x32_bf16 v[42:45], a[60:63], v[16:19], v[42:45]
  s_waitcnt vmcnt(11)
  buffer_load_dwordx4 v[184:187], v4, s[44:47], s101 offen offset:2304 nt
  v_add_f32_dpp v88, v39, v38 quad_perm:[1,1,1,1] row_mask:0xf bank_mask:0xf
  v_add_f32_dpp v89, v41, v40 quad_perm:[3,3,3,3] row_mask:0xf bank_mask:0xf
  s_nop 1
  v_add_f32_dpp v21, v89, v88 quad_perm:[2,2,2,2] row_mask:0xf bank_mask:0x4
  v_mfma_f32_16x16x32_bf16 v[38:41], a[64:67], v[12:15], 0
  v_mfma_f32_16x16x32_bf16 v[38:41], a[68:71], v[16:19], v[38:41]
  v_add_f32_dpp v88, v43, v42 quad_perm:[1,1,1,1] row_mask:0xf bank_mask:0xf
  v_add_f32_dpp v89, v45, v44 quad_perm:[3,3,3,3] row_mask:0xf bank_mask:0xf
  s_nop 1
  v_add_f32_dpp v21, v89, v88 quad_perm:[2,2,2,2] row_mask:0xf bank_mask:0x8
  v_mfma_f32_16x16x32_bf16 v[42:45], a[72:75], v[12:15], 0
  v_mfma_f32_16x16x32_bf16 v[42:45], a[76:79], v[16:19], v[42:45]
  s_waitcnt vmcnt(11)
  s_add_u32 s101, s101, 16384
  s_cmp_eq_u32 s101, s20
  s_cselect_b32 s101, 0, s101
  buffer_load_dwordx4 v[188:191], v4, s[44:47], s101 offen offset:0 nt
  v_add_f32_dpp v88, v39, v38 quad_perm:[1,1,1,1] row_mask:0xf bank_mask:0xf
  v_add_f32_dpp v89, v41, v40 quad_perm:[3,3,3,3] row_mask:0xf bank_mask:0xf
  s_nop 1
  v_add_f32_dpp v22, v89, v88 quad_perm:[2,2,2,2] row_mask:0xf bank_mask:0x1
  v_mfma_f32_16x16x32_bf16 v[38:41], a[80:83], v[12:15], 0
  v_mfma_f32_16x16x32_bf16 v[38:41], a[84:87], v[16:19], v[38:41]
  v_add_f32_dpp v88, v43, v42 quad_perm:[1,1,1,1] row_mask:0xf bank_mask:0xf
  v_add_f32_dpp v89, v45, v44 quad_perm:[3,3,3,3] row_mask:0xf bank_mask:0xf
  s_nop 1
  v_add_f32_dpp v22, v89, v88 quad_perm:[2,2,2,2] row_mask:0xf bank_mask:0x2
  v_mfma_f32_16x16x32_bf16 v[42:45], a[88:91], v[12:15], 0
  v_mfma_f32_16x16x32_bf16 v[42:45], a[92:95], v[16:19], v[42:45]
  s_waitcnt vmcnt(11)
  buffer_load_dwordx4 v[192:195], v4, s[44:47], s101 offen offset:256 nt
  v_add_f32_dpp v88, v39, v38 quad_perm:[1,1,1,1] row_mask:0xf bank_mask:0xf
  v_add_f32_dpp v89, v41, v40 quad_perm:[3,3,3,3] row_mask:0xf bank_mask:0xf
  s_nop 1
  v_add_f32_dpp v22, v89, v88 quad_perm:[2,2,2,2] row_mask:0xf bank_mask:0x4
  v_mfma_f32_16x16x32_bf16 v[38:41], a[96:99], v[12:15], 0
  v_mfma_f32_16x16x32_bf16 v[38:41], a[100:103], v[16:19], v[38:41]
  v_add_f32_dpp v88, v43, v42 quad_perm:[1,1,1,1] row_mask:0xf bank_mask:0xf
  v_add_f32_dpp v89, v45, v44 quad_perm:[3,3,3,3] row_mask:0xf bank_mask:0xf
  s_nop 1
  v_add_f32_dpp v22, v89, v88 quad_perm:[2,2,2,2] row_mask:0xf bank_mask:0x8
  v_mfma_f32_16x16x32_bf16 v[42:45], a[104:107], v[12:15], 0
  v_mfma_f32_16x16x32_bf16 v[42:45], a[108:111], v[16:19], v[42:45]
  s_waitcnt vmcnt(11)
  buffer_load_dwordx4 v[196:199], v4, s[44:47], s101 offen offset:2048 nt
  v_add_f32_dpp v88, v39, v38 quad_perm:[1,1,1,1] row_mask:0xf bank_mask:0xf
  v_add_f32_dpp v89, v41, v40 quad_perm:[3,3,3,3] row_mask:0xf bank_mask:0xf
  s_nop 1
  v_add_f32_dpp v23, v89, v88 quad_perm:[2,2,2,2] row_mask:0xf bank_mask:0x1
  v_mfma_f32_16x16x32_bf16 v[38:41], a[112:115], v[12:15], 0
  v_mfma_f32_16x16x32_bf16 v[38:41], a[116:119], v[16:19], v[38:41]
  v_add_f32_dpp v88, v43, v42 quad_perm:[1,1,1,1] row_mask:0xf bank_mask:0xf
  v_add_f32_dpp v89, v45, v44 quad_perm:[3,3,3,3] row_mask:0xf bank_mask:0xf
  s_nop 1
  v_add_f32_dpp v23, v89, v88 quad_perm:[2,2,2,2] row_mask:0xf bank_mask:0x2
  v_mfma_f32_16x16x32_bf16 v[42:45], a[120:123], v[12:15], 0
  v_mfma_f32_16x16x32_bf16 v[42:45], a[124:127], v[16:19], v[42:45]
  s_waitcnt vmcnt(11)
  buffer_load_dwordx4 v[200:203], v4, s[44:47], s101 offen offset:2304 nt
  v_add_f32_dpp v88, v39, v38 quad_perm:[1,1,1,1] row_mask:0xf bank_mask:0xf
  v_add_f32_dpp v89, v41, v40 quad_perm:[3,3,3,3] row_mask:0xf bank_mask:0xf
  s_nop 1
  v_add_f32_dpp v23, v89, v88 quad_perm:[2,2,2,2] row_mask:0xf bank_mask:0x4
  v_mfma_f32_16x16x32_bf16 v[38:41], a[128:131], v[12:15], 0
  v_mfma_f32_16x16x32_bf16 v[38:41], a[132:135], v[16:19], v[38:41]
  v_add_f32_dpp v88, v43, v42 quad_perm:[1,1,1,1] row_mask:0xf bank_mask:0xf
  v_add_f32_dpp v89, v45, v44 quad_perm:[3,3,3,3] row_mask:0xf bank_mask:0xf
  s_nop 1
  v_add_f32_dpp v23, v89, v88 quad_perm:[2,2,2,2] row_mask:0xf bank_mask:0x8
  v_mfma_f32_16x16x32_bf16 v[42:45], a[136:139], v[12:15], 0
  v_mfma_f32_16x16x32_bf16 v[42:45], a[140:143], v[16:19], v[42:45]
  s_waitcnt vmcnt(11)
  s_add_u32 s101, s101, 16384
  s_cmp_eq_u32 s101, s20
  s_cselect_b32 s101, 0, s101
  buffer_load_dwordx4 v[204:207], v4, s[44:47], s101 offen offset:0 nt
  v_add_f32_dpp v88, v39, v38 quad_perm:[1,1,1,1] row_mask:0xf bank_mask:0xf
  v_add_f32_dpp v89, v41, v40 quad_perm:[3,3,3,3] row_mask:0xf bank_mask:0xf
  s_nop 1
  v_add_f32_dpp v24, v89, v88 quad_perm:[2,2,2,2] row_mask:0xf bank_mask:0x1
  v_mfma_f32_16x16x32_bf16 v[38:41], a[144:147], v[12:15], 0
  v_mfma_f32_16x16x32_bf16 v[38:41], a[148:151], v[16:19], v[38:41]
  v_add_f32_dpp v88, v43, v42 quad_perm:[1,1,1,1] row_mask:0xf bank_mask:0xf
  v_add_f32_dpp v89, v45, v44 quad_perm:[3,3,3,3] row_mask:0xf bank_mask:0xf
  s_nop 1
  v_add_f32_dpp v24, v89, v88 quad_perm:[2,2,2,2] row_mask:0xf bank_mask:0x2
  v_mfma_f32_16x16x32_bf16 v[42:45], a[152:155], v[12:15], 0
  v_mfma_f32_16x16x32_bf16 v[42:45], a[156:159], v[16:19], v[42:45]
  s_waitcnt vmcnt(11)
  buffer_load_dwordx4 v[208:211], v4, s[44:47], s101 offen offset:256 nt
  v_add_f32_dpp v88, v39, v38 quad_perm:[1,1,1,1] row_mask:0xf bank_mask:0xf
  v_add_f32_dpp v89, v41, v40 quad_perm:[3,3,3,3] row_mask:0xf bank_mask:0xf
  s_nop 1
  v_add_f32_dpp v24, v89, v88 quad_perm:[2,2,2,2] row_mask:0xf bank_mask:0x4
  v_mfma_f32_16x16x32_bf16 v[38:41], a[160:163], v[12:15], 0
  v_mfma_f32_16x16x32_bf16 v[38:41], a[164:167], v[16:19], v[38:41]
  v_add_f32_dpp v88, v43, v42 quad_perm:[1,1,1,1] row_mask:0xf bank_mask:0xf
  v_add_f32_dpp v89, v45, v44 quad_perm:[3,3,3,3] row_mask:0xf bank_mask:0xf
  s_nop 1
  v_add_f32_dpp v24, v89, v88 quad_perm:[2,2,2,2] row_mask:0xf bank_mask:0x8
  v_mfma_f32_16x16x32_bf16 v[42:45], a[168:171], v[12:15], 0
  v_mfma_f32_16x16x32_bf16 v[42:45], a[172:175], v[16:19], v[42:45]
  s_waitcnt vmcnt(11)
  buffer_load_dwordx4 v[212:215], v4, s[44:47], s101 offen offset:2048 nt
  v_add_f32_dpp v88, v39, v38 quad_perm:[1,1,1,1] row_mask:0xf bank_mask:0xf
  v_add_f32_dpp v89, v41, v40 quad_perm:[3,3,3,3] row_mask:0xf bank_mask:0xf
  s_nop 1
  v_add_f32_dpp v25, v89, v88 quad_perm:[2,2,2,2] row_mask:0xf bank_mask:0x1
  v_mfma_f32_16x16x32_bf16 v[38:41], a[176:179], v[12:15], 0
  v_mfma_f32_16x16x32_bf16 v[38:41], a[180:183], v[16:19], v[38:41]
  v_add_f32_dpp v88, v43, v42 quad_perm:[1,1,1,1] row_mask:0xf bank_mask:0xf
  v_add_f32_dpp v89, v45, v44 quad_perm:[3,3,3,3] row_mask:0xf bank_mask:0xf
  s_nop 1
  v_add_f32_dpp v25, v89, v88 quad_perm:[2,2,2,2] row_mask:0xf bank_mask:0x2
  v_mfma_f32_16x16x32_bf16 v[42:45], a[184:187], v[12:15], 0
  v_mfma_f32_16x16x32_bf16 v[42:45], a[188:191], v[16:19], v[42:45]
  s_waitcnt vmcnt(11)
  buffer_load_dwordx4 v[216:219], v4, s[44:47], s101 offen offset:2304 nt
  v_add_f32_dpp v88, v39, v38 quad_perm:[1,1,1,1] row_mask:0xf bank_mask:0xf
  v_add_f32_dpp v89, v41, v40 quad_perm:[3,3,3,3] row_mask:0xf bank_mask:0xf
  s_nop 1
  v_add_f32_dpp v25, v89, v88 quad_perm:[2,2,2,2] row_mask:0xf bank_mask:0x4
  v_mfma_f32_16x16x32_bf16 v[38:41], a[192:195], v[12:15], 0
  v_mfma_f32_16x16x32_bf16 v[38:41], a[196:199], v[16:19], v[38:41]
  v_add_f32_dpp v88, v43, v42 quad_perm:[1,1,1,1] row_mask:0xf bank_mask:0xf
  v_add_f32_dpp v89, v45, v44 quad_perm:[3,3,3,3] row_mask:0xf bank_mask:0xf
  s_nop 1
  v_add_f32_dpp v25, v89, v88 quad_perm:[2,2,2,2] row_mask:0xf bank_mask:0x8
  v_mfma_f32_16x16x32_bf16 v[42:45], a[200:203], v[12:15], 0
  v_mfma_f32_16x16x32_bf16 v[42:45], a[204:207], v[16:19], v[42:45]
  s_waitcnt vmcnt(11)
  s_add_u32 s101, s101, 16384
  s_cmp_eq_u32 s101, s20
  s_cselect_b32 s101, 0, s101
  buffer_load_dwordx4 v[220:223], v4, s[44:47], s101 offen offset:0 nt
  v_add_f32_dpp v88, v39, v38 quad_perm:[1,1,1,1] row_mask:0xf bank_mask:0xf
  v_add_f32_dpp v89, v41, v40 quad_perm:[3,3,3,3] row_mask:0xf bank_mask:0xf
  s_nop 1
  v_add_f32_dpp v26, v89, v88 quad_perm:[2,2,2,2] row_mask:0xf bank_mask:0x1
  v_mfma_f32_16x16x32_bf16 v[38:41], a[208:211], v[12:15], 0
  v_mfma_f32_16x16x32_bf16 v[38:41], a[212:215], v[16:19], v[38:41]
  v_add_f32_dpp v88, v43, v42 quad_perm:[1,1,1,1] row_mask:0xf bank_mask:0xf
  v_add_f32_dpp v89, v45, v44 quad_perm:[3,3,3,3] row_mask:0xf bank_mask:0xf
  s_nop 1
  v_add_f32_dpp v26, v89, v88 quad_perm:[2,2,2,2] row_mask:0xf bank_mask:0x2
  v_mfma_f32_16x16x32_bf16 v[42:45], a[216:219], v[12:15], 0
  v_mfma_f32_16x16x32_bf16 v[42:45], a[220:223], v[16:19], v[42:45]
  s_waitcnt vmcnt(11)
  buffer_load_dwordx4 v[224:227], v4, s[44:47], s101 offen offset:256 nt
  v_add_f32_dpp v88, v39, v38 quad_perm:[1,1,1,1] row_mask:0xf bank_mask:0xf
  v_add_f32_dpp v89, v41, v40 quad_perm:[3,3,3,3] row_mask:0xf bank_mask:0xf
  s_nop 1
  v_add_f32_dpp v26, v89, v88 quad_perm:[2,2,2,2] row_mask:0xf bank_mask:0x4
  v_mfma_f32_16x16x32_bf16 v[38:41], a[224:227], v[12:15], 0
  v_mfma_f32_16x16x32_bf16 v[38:41], a[228:231], v[16:19], v[38:41]
  v_add_f32_dpp v88, v43, v42 quad_perm:[1,1,1,1] row_mask:0xf bank_mask:0xf
  v_add_f32_dpp v89, v45, v44 quad_perm:[3,3,3,3] row_mask:0xf bank_mask:0xf
  s_nop 1
  v_add_f32_dpp v26, v89, v88 quad_perm:[2,2,2,2] row_mask:0xf bank_mask:0x8
  v_mfma_f32_16x16x32_bf16 v[42:45], a[232:235], v[12:15], 0
  v_mfma_f32_16x16x32_bf16 v[42:45], a[236:239], v[16:19], v[42:45]
  s_waitcnt vmcnt(11)
  buffer_load_dwordx4 v[228:231], v4, s[44:47], s101 offen offset:2048 nt
  v_add_f32_dpp v88, v39, v38 quad_perm:[1,1,1,1] row_mask:0xf bank_mask:0xf
  v_add_f32_dpp v89, v41, v40 quad_perm:[3,3,3,3] row_mask:0xf bank_mask:0xf
  s_nop 1
  v_add_f32_dpp v27, v89, v88 quad_perm:[2,2,2,2] row_mask:0xf bank_mask:0x1
  v_mfma_f32_16x16x32_bf16 v[38:41], a[240:243], v[12:15], 0
  v_mfma_f32_16x16x32_bf16 v[38:41], a[244:247], v[16:19], v[38:41]
  v_add_f32_dpp v88, v43, v42 quad_perm:[1,1,1,1] row_mask:0xf bank_mask:0xf
  v_add_f32_dpp v89, v45, v44 quad_perm:[3,3,3,3] row_mask:0xf bank_mask:0xf
  s_nop 1
  v_add_f32_dpp v27, v89, v88 quad_perm:[2,2,2,2] row_mask:0xf bank_mask:0x2
  v_mfma_f32_16x16x32_bf16 v[42:45], a[248:251], v[12:15], 0
  v_mfma_f32_16x16x32_bf16 v[42:45], a[252:255], v[16:19], v[42:45]
  s_waitcnt vmcnt(11)
  buffer_load_dwordx4 v[232:235], v4, s[44:47], s101 offen offset:2304 nt
  v_add_f32_dpp v88, v39, v38 quad_perm:[1,1,1,1] row_mask:0xf bank_mask:0xf
  v_add_f32_dpp v89, v41, v40 quad_perm:[3,3,3,3] row_mask:0xf bank_mask:0xf
  s_nop 1
  v_add_f32_dpp v27, v89, v88 quad_perm:[2,2,2,2] row_mask:0xf bank_mask:0x4
  v_mfma_f32_16x16x32_bf16 v[38:41], v[124:127], v[12:15], 0
  v_mfma_f32_16x16x32_bf16 v[38:41], v[128:131], v[16:19], v[38:41]
  v_add_f32_dpp v88, v43, v42 quad_perm:[1,1,1,1] row_mask:0xf bank_mask:0xf
  v_add_f32_dpp v89, v45, v44 quad_perm:[3,3,3,3] row_mask:0xf bank_mask:0xf
  s_nop 1
  v_add_f32_dpp v27, v89, v88 quad_perm:[2,2,2,2] row_mask:0xf bank_mask:0x8
  v_mfma_f32_16x16x32_bf16 v[42:45], v[132:135], v[12:15], 0
  v_mfma_f32_16x16x32_bf16 v[42:45], v[136:139], v[16:19], v[42:45]
  s_waitcnt vmcnt(11)
  s_add_u32 s101, s101, 16384
  s_cmp_eq_u32 s101, s20
  s_cselect_b32 s101, 0, s101
  buffer_load_dwordx4 v[236:239], v4, s[44:47], s101 offen offset:0 nt
  v_add_f32_dpp v88, v39, v38 quad_perm:[1,1,1,1] row_mask:0xf bank_mask:0xf
  v_add_f32_dpp v89, v41, v40 quad_perm:[3,3,3,3] row_mask:0xf bank_mask:0xf
  s_nop 1
  v_add_f32_dpp v28, v89, v88 quad_perm:[2,2,2,2] row_mask:0xf bank_mask:0x1
  v_mfma_f32_16x16x32_bf16 v[38:41], v[140:143], v[12:15], 0
  v_mfma_f32_16x16x32_bf16 v[38:41], v[144:147], v[16:19], v[38:41]
  v_add_f32_dpp v88, v43, v42 quad_perm:[1,1,1,1] row_mask:0xf bank_mask:0xf
  v_add_f32_dpp v89, v45, v44 quad_perm:[3,3,3,3] row_mask:0xf bank_mask:0xf
  s_nop 1
  v_add_f32_dpp v28, v89, v88 quad_perm:[2,2,2,2] row_mask:0xf bank_mask:0x2
  v_mfma_f32_16x16x32_bf16 v[42:45], v[148:151], v[12:15], 0
  v_mfma_f32_16x16x32_bf16 v[42:45], v[152:155], v[16:19], v[42:45]
  s_waitcnt vmcnt(11)
  buffer_load_dwordx4 v[240:243], v4, s[44:47], s101 offen offset:256 nt
  v_add_f32_dpp v88, v39, v38 quad_perm:[1,1,1,1] row_mask:0xf bank_mask:0xf
  v_add_f32_dpp v89, v41, v40 quad_perm:[3,3,3,3] row_mask:0xf bank_mask:0xf
  s_nop 1
  v_add_f32_dpp v28, v89, v88 quad_perm:[2,2,2,2] row_mask:0xf bank_mask:0x4
  v_mfma_f32_16x16x32_bf16 v[38:41], v[156:159], v[12:15], 0
  v_mfma_f32_16x16x32_bf16 v[38:41], v[160:163], v[16:19], v[38:41]
  v_add_f32_dpp v88, v43, v42 quad_perm:[1,1,1,1] row_mask:0xf bank_mask:0xf
  v_add_f32_dpp v89, v45, v44 quad_perm:[3,3,3,3] row_mask:0xf bank_mask:0xf
  s_nop 1
  v_add_f32_dpp v28, v89, v88 quad_perm:[2,2,2,2] row_mask:0xf bank_mask:0x8
  v_mfma_f32_16x16x32_bf16 v[42:45], v[164:167], v[12:15], 0
  v_mfma_f32_16x16x32_bf16 v[42:45], v[168:171], v[16:19], v[42:45]
  s_waitcnt vmcnt(11)
  buffer_load_dwordx4 v[244:247], v4, s[44:47], s101 offen offset:2048 nt
  v_add_f32_dpp v88, v39, v38 quad_perm:[1,1,1,1] row_mask:0xf bank_mask:0xf
  v_add_f32_dpp v89, v41, v40 quad_perm:[3,3,3,3] row_mask:0xf bank_mask:0xf
  s_nop 1
  v_add_f32_dpp v29, v89, v88 quad_perm:[2,2,2,2] row_mask:0xf bank_mask:0x1
  v_mfma_f32_16x16x32_bf16 v[38:41], v[172:175], v[12:15], 0
  v_mfma_f32_16x16x32_bf16 v[38:41], v[176:179], v[16:19], v[38:41]
  v_add_f32_dpp v88, v43, v42 quad_perm:[1,1,1,1] row_mask:0xf bank_mask:0xf
  v_add_f32_dpp v89, v45, v44 quad_perm:[3,3,3,3] row_mask:0xf bank_mask:0xf
  s_nop 1
  v_add_f32_dpp v29, v89, v88 quad_perm:[2,2,2,2] row_mask:0xf bank_mask:0x2
  v_mfma_f32_16x16x32_bf16 v[42:45], v[180:183], v[12:15], 0
  v_mfma_f32_16x16x32_bf16 v[42:45], v[184:187], v[16:19], v[42:45]
  s_waitcnt vmcnt(11)
  buffer_load_dwordx4 v[248:251], v4, s[44:47], s101 offen offset:2304 nt
  v_add_f32_dpp v88, v39, v38 quad_perm:[1,1,1,1] row_mask:0xf bank_mask:0xf
  v_add_f32_dpp v89, v41, v40 quad_perm:[3,3,3,3] row_mask:0xf bank_mask:0xf
  s_nop 1
  v_add_f32_dpp v29, v89, v88 quad_perm:[2,2,2,2] row_mask:0xf bank_mask:0x4
  v_mfma_f32_16x16x32_bf16 v[38:41], v[188:191], v[12:15], 0
  v_mfma_f32_16x16x32_bf16 v[38:41], v[192:195], v[16:19], v[38:41]
  v_add_f32_dpp v88, v43, v42 quad_perm:[1,1,1,1] row_mask:0xf bank_mask:0xf
  v_add_f32_dpp v89, v45, v44 quad_perm:[3,3,3,3] row_mask:0xf bank_mask:0xf
  s_nop 1
  v_add_f32_dpp v29, v89, v88 quad_perm:[2,2,2,2] row_mask:0xf bank_mask:0x8
  v_mfma_f32_16x16x32_bf16 v[42:45], v[196:199], v[12:15], 0
  v_mfma_f32_16x16x32_bf16 v[42:45], v[200:203], v[16:19], v[42:45]
  s_waitcnt vmcnt(11)
  s_add_u32 s101, s101, 16384
  s_cmp_eq_u32 s101, s20
  s_cselect_b32 s101, 0, s101
  buffer_load_dwordx4 v[252:255], v4, s[44:47], s101 offen offset:0 nt
  v_add_f32_dpp v88, v39, v38 quad_perm:[1,1,1,1] row_mask:0xf bank_mask:0xf
  v_add_f32_dpp v89, v41, v40 quad_perm:[3,3,3,3] row_mask:0xf bank_mask:0xf
  s_nop 1
  v_add_f32_dpp v30, v89, v88 quad_perm:[2,2,2,2] row_mask:0xf bank_mask:0x1
  s_waitcnt vmcnt(11)
  v_mfma_f32_16x16x32_bf16 v[38:41], v[204:207], v[12:15], 0
  v_mfma_f32_16x16x32_bf16 v[38:41], v[208:211], v[16:19], v[38:41]
  buffer_load_dwordx4 v[96:99], v4, s[44:47], s101 offen offset:256 nt
  v_add_f32_dpp v88, v43, v42 quad_perm:[1,1,1,1] row_mask:0xf bank_mask:0xf
  v_add_f32_dpp v89, v45, v44 quad_perm:[3,3,3,3] row_mask:0xf bank_mask:0xf
  s_nop 1
  v_add_f32_dpp v30, v89, v88 quad_perm:[2,2,2,2] row_mask:0xf bank_mask:0x2
  s_waitcnt vmcnt(10)
  v_mfma_f32_16x16x32_bf16 v[42:45], v[212:215], v[12:15], 0
  v_mfma_f32_16x16x32_bf16 v[42:45], v[216:219], v[16:19], v[42:45]
  buffer_load_dwordx4 v[100:103], v4, s[44:47], s101 offen offset:2048 nt
  buffer_load_dwordx4 v[104:107], v4, s[44:47], s101 offen offset:2304 nt
  v_add_f32_dpp v88, v39, v38 quad_perm:[1,1,1,1] row_mask:0xf bank_mask:0xf
  v_add_f32_dpp v89, v41, v40 quad_perm:[3,3,3,3] row_mask:0xf bank_mask:0xf
  s_nop 1
  v_add_f32_dpp v30, v89, v88 quad_perm:[2,2,2,2] row_mask:0xf bank_mask:0x4
  s_waitcnt vmcnt(10)
  v_mfma_f32_16x16x32_bf16 v[38:41], v[220:223], v[12:15], 0
  v_mfma_f32_16x16x32_bf16 v[38:41], v[224:227], v[16:19], v[38:41]
  s_add_u32 s101, s101, 16384
  s_cmp_eq_u32 s101, s20
  s_cselect_b32 s101, 0, s101
  buffer_load_dwordx4 v[108:111], v4, s[44:47], s101 offen offset:0 nt
  buffer_load_dwordx4 v[112:115], v4, s[44:47], s101 offen offset:256 nt
  v_add_f32_dpp v88, v43, v42 quad_perm:[1,1,1,1] row_mask:0xf bank_mask:0xf
  v_add_f32_dpp v89, v45, v44 quad_perm:[3,3,3,3] row_mask:0xf bank_mask:0xf
  s_nop 1
  v_add_f32_dpp v30, v89, v88 quad_perm:[2,2,2,2] row_mask:0xf bank_mask:0x8
  s_waitcnt vmcnt(10)
  v_mfma_f32_16x16x32_bf16 v[42:45], v[228:231], v[12:15], 0
  v_mfma_f32_16x16x32_bf16 v[42:45], v[232:235], v[16:19], v[42:45]
  buffer_load_dwordx4 v[116:119], v4, s[44:47], s101 offen offset:2048 nt
  buffer_load_dwordx4 v[120:123], v4, s[44:47], s101 offen offset:2304 nt
  v_add_f32_dpp v88, v39, v38 quad_perm:[1,1,1,1] row_mask:0xf bank_mask:0xf
  v_add_f32_dpp v89, v41, v40 quad_perm:[3,3,3,3] row_mask:0xf bank_mask:0xf
  s_nop 1
  v_add_f32_dpp v31, v89, v88 quad_perm:[2,2,2,2] row_mask:0xf bank_mask:0x1
  s_waitcnt vmcnt(10)
  v_mfma_f32_16x16x32_bf16 v[38:41], v[236:239], v[12:15], 0
  v_mfma_f32_16x16x32_bf16 v[38:41], v[240:243], v[16:19], v[38:41]
  s_add_u32 s101, s101, 16384
  s_cmp_eq_u32 s101, s20
  s_cselect_b32 s101, 0, s101
  buffer_load_dwordx4 v[124:127], v4, s[44:47], s101 offen offset:0 nt
  buffer_load_dwordx4 v[128:131], v4, s[44:47], s101 offen offset:256 nt
  v_add_f32_dpp v88, v43, v42 quad_perm:[1,1,1,1] row_mask:0xf bank_mask:0xf
  v_add_f32_dpp v89, v45, v44 quad_perm:[3,3,3,3] row_mask:0xf bank_mask:0xf
  s_nop 1
  v_add_f32_dpp v31, v89, v88 quad_perm:[2,2,2,2] row_mask:0xf bank_mask:0x2
  s_waitcnt vmcnt(10)
  v_mfma_f32_16x16x32_bf16 v[42:45], v[244:247], v[12:15], 0
  v_mfma_f32_16x16x32_bf16 v[42:45], v[248:251], v[16:19], v[42:45]
  buffer_load_dwordx4 v[132:135], v4, s[44:47], s101 offen offset:2048 nt
  buffer_load_dwordx4 v[136:139], v4, s[44:47], s101 offen offset:2304 nt
  v_add_f32_dpp v88, v39, v38 quad_perm:[1,1,1,1] row_mask:0xf bank_mask:0xf
  v_add_f32_dpp v89, v41, v40 quad_perm:[3,3,3,3] row_mask:0xf bank_mask:0xf
  s_nop 1
  v_add_f32_dpp v31, v89, v88 quad_perm:[2,2,2,2] row_mask:0xf bank_mask:0x4
  s_waitcnt vmcnt(10)
  v_mfma_f32_16x16x32_bf16 v[38:41], v[252:255], v[12:15], 0
  v_mfma_f32_16x16x32_bf16 v[38:41], v[96:99], v[16:19], v[38:41]
  s_add_u32 s101, s101, 16384
  s_cmp_eq_u32 s101, s20
  s_cselect_b32 s101, 0, s101
  buffer_load_dwordx4 v[140:143], v4, s[44:47], s101 offen offset:0 nt
  buffer_load_dwordx4 v[144:147], v4, s[44:47], s101 offen offset:256 nt
  v_add_f32_dpp v88, v43, v42 quad_perm:[1,1,1,1] row_mask:0xf bank_mask:0xf
  v_add_f32_dpp v89, v45, v44 quad_perm:[3,3,3,3] row_mask:0xf bank_mask:0xf
  s_nop 1
  v_add_f32_dpp v31, v89, v88 quad_perm:[2,2,2,2] row_mask:0xf bank_mask:0x8
  s_waitcnt vmcnt(10)
  v_mfma_f32_16x16x32_bf16 v[42:45], v[100:103], v[12:15], 0
  v_mfma_f32_16x16x32_bf16 v[42:45], v[104:107], v[16:19], v[42:45]
  buffer_load_dwordx4 v[148:151], v4, s[44:47], s101 offen offset:2048 nt
  buffer_load_dwordx4 v[152:155], v4, s[44:47], s101 offen offset:2304 nt
  v_add_f32_dpp v88, v39, v38 quad_perm:[1,1,1,1] row_mask:0xf bank_mask:0xf
  v_add_f32_dpp v89, v41, v40 quad_perm:[3,3,3,3] row_mask:0xf bank_mask:0xf
  s_nop 1
  v_add_f32_dpp v32, v89, v88 quad_perm:[2,2,2,2] row_mask:0xf bank_mask:0x1
  s_waitcnt vmcnt(10)
  v_mfma_f32_16x16x32_bf16 v[38:41], v[108:111], v[12:15], 0
  v_mfma_f32_16x16x32_bf16 v[38:41], v[112:115], v[16:19], v[38:41]
  s_add_u32 s101, s101, 16384
  s_cmp_eq_u32 s101, s20
  s_cselect_b32 s101, 0, s101
  buffer_load_dwordx4 v[156:159], v4, s[44:47], s101 offen offset:0 nt
  buffer_load_dwordx4 v[160:163], v4, s[44:47], s101 offen offset:256 nt
  v_add_f32_dpp v88, v43, v42 quad_perm:[1,1,1,1] row_mask:0xf bank_mask:0xf
  v_add_f32_dpp v89, v45, v44 quad_perm:[3,3,3,3] row_mask:0xf bank_mask:0xf
  s_nop 1
  v_add_f32_dpp v32, v89, v88 quad_perm:[2,2,2,2] row_mask:0xf bank_mask:0x2
  s_waitcnt vmcnt(10)
  v_mfma_f32_16x16x32_bf16 v[42:45], v[116:119], v[12:15], 0
  v_mfma_f32_16x16x32_bf16 v[42:45], v[120:123], v[16:19], v[42:45]
  buffer_load_dwordx4 v[164:167], v4, s[44:47], s101 offen offset:2048 nt
  buffer_load_dwordx4 v[168:171], v4, s[44:47], s101 offen offset:2304 nt
  v_add_f32_dpp v88, v39, v38 quad_perm:[1,1,1,1] row_mask:0xf bank_mask:0xf
  v_add_f32_dpp v89, v41, v40 quad_perm:[3,3,3,3] row_mask:0xf bank_mask:0xf
  s_nop 1
  v_add_f32_dpp v32, v89, v88 quad_perm:[2,2,2,2] row_mask:0xf bank_mask:0x4
  s_waitcnt vmcnt(10)
  v_mfma_f32_16x16x32_bf16 v[38:41], v[124:127], v[12:15], 0
  v_mfma_f32_16x16x32_bf16 v[38:41], v[128:131], v[16:19], v[38:41]
  s_add_u32 s101, s101, 16384
  s_cmp_eq_u32 s101, s20
  s_cselect_b32 s101, 0, s101
  buffer_load_dwordx4 v[172:175], v4, s[44:47], s101 offen offset:0 nt
  buffer_load_dwordx4 v[176:179], v4, s[44:47], s101 offen offset:256 nt
  v_add_f32_dpp v88, v43, v42 quad_perm:[1,1,1,1] row_mask:0xf bank_mask:0xf
  v_add_f32_dpp v89, v45, v44 quad_perm:[3,3,3,3] row_mask:0xf bank_mask:0xf
  s_nop 1
  v_add_f32_dpp v32, v89, v88 quad_perm:[2,2,2,2] row_mask:0xf bank_mask:0x8
  s_waitcnt vmcnt(10)
  v_mfma_f32_16x16x32_bf16 v[42:45], v[132:135], v[12:15], 0
  v_mfma_f32_16x16x32_bf16 v[42:45], v[136:139], v[16:19], v[42:45]
  buffer_load_dwordx4 v[180:183], v4, s[44:47], s101 offen offset:2048 nt
  buffer_load_dwordx4 v[184:187], v4, s[44:47], s101 offen offset:2304 nt
  v_add_f32_dpp v88, v39, v38 quad_perm:[1,1,1,1] row_mask:0xf bank_mask:0xf
  v_add_f32_dpp v89, v41, v40 quad_perm:[3,3,3,3] row_mask:0xf bank_mask:0xf
  s_nop 1
  v_add_f32_dpp v33, v89, v88 quad_perm:[2,2,2,2] row_mask:0xf bank_mask:0x1
  s_waitcnt vmcnt(10)
  v_mfma_f32_16x16x32_bf16 v[38:41], v[140:143], v[12:15], 0
  v_mfma_f32_16x16x32_bf16 v[38:41], v[144:147], v[16:19], v[38:41]
  s_add_u32 s101, s101, 16384
  s_cmp_eq_u32 s101, s20
  s_cselect_b32 s101, 0, s101
  buffer_load_dwordx4 v[188:191], v4, s[44:47], s101 offen offset:0 nt
  buffer_load_dwordx4 v[192:195], v4, s[44:47], s101 offen offset:256 nt
  v_add_f32_dpp v88, v43, v42 quad_perm:[1,1,1,1] row_mask:0xf bank_mask:0xf
  v_add_f32_dpp v89, v45, v44 quad_perm:[3,3,3,3] row_mask:0xf bank_mask:0xf
  s_nop 1
  v_add_f32_dpp v33, v89, v88 quad_perm:[2,2,2,2] row_mask:0xf bank_mask:0x2
  s_waitcnt vmcnt(10)
  v_mfma_f32_16x16x32_bf16 v[42:45], v[148:151], v[12:15], 0
  v_mfma_f32_16x16x32_bf16 v[42:45], v[152:155], v[16:19], v[42:45]
  buffer_load_dwordx4 v[196:199], v4, s[44:47], s101 offen offset:2048 nt
  buffer_load_dwordx4 v[200:203], v4, s[44:47], s101 offen offset:2304 nt
  v_add_f32_dpp v88, v39, v38 quad_perm:[1,1,1,1] row_mask:0xf bank_mask:0xf
  v_add_f32_dpp v89, v41, v40 quad_perm:[3,3,3,3] row_mask:0xf bank_mask:0xf
  s_nop 1
  v_add_f32_dpp v33, v89, v88 quad_perm:[2,2,2,2] row_mask:0xf bank_mask:0x4
  s_waitcnt vmcnt(10)
  v_mfma_f32_16x16x32_bf16 v[38:41], v[156:159], v[12:15], 0
  v_mfma_f32_16x16x32_bf16 v[38:41], v[160:163], v[16:19], v[38:41]
  s_add_u32 s101, s101, 16384
  s_cmp_eq_u32 s101, s20
  s_cselect_b32 s101, 0, s101
  buffer_load_dwordx4 v[204:207], v4, s[44:47], s101 offen offset:0 nt
  buffer_load_dwordx4 v[208:211], v4, s[44:47], s101 offen offset:256 nt
  v_add_f32_dpp v88, v43, v42 quad_perm:[1,1,1,1] row_mask:0xf bank_mask:0xf
  v_add_f32_dpp v89, v45, v44 quad_perm:[3,3,3,3] row_mask:0xf bank_mask:0xf
  s_nop 1
  v_add_f32_dpp v33, v89, v88 quad_perm:[2,2,2,2] row_mask:0xf bank_mask:0x8
  s_waitcnt vmcnt(10)
  v_mfma_f32_16x16x32_bf16 v[42:45], v[164:167], v[12:15], 0
  v_mfma_f32_16x16x32_bf16 v[42:45], v[168:171], v[16:19], v[42:45]
  buffer_load_dwordx4 v[212:215], v4, s[44:47], s101 offen offset:2048 nt
  buffer_load_dwordx4 v[216:219], v4, s[44:47], s101 offen offset:2304 nt
  v_add_f32_dpp v88, v39, v38 quad_perm:[1,1,1,1] row_mask:0xf bank_mask:0xf
  v_add_f32_dpp v89, v41, v40 quad_perm:[3,3,3,3] row_mask:0xf bank_mask:0xf
  s_nop 1
  v_add_f32_dpp v34, v89, v88 quad_perm:[2,2,2,2] row_mask:0xf bank_mask:0x1
  s_waitcnt vmcnt(10)
  v_mfma_f32_16x16x32_bf16 v[38:41], v[172:175], v[12:15], 0
  v_mfma_f32_16x16x32_bf16 v[38:41], v[176:179], v[16:19], v[38:41]
  buffer_load_dwordx4 v[220:223], v5, s[48:51], s21 offen offset:0 nt
  buffer_load_dwordx4 v[224:227], v5, s[48:51], s21 offen offset:256 nt
  v_add_f32_dpp v88, v43, v42 quad_perm:[1,1,1,1] row_mask:0xf bank_mask:0xf
  v_add_f32_dpp v89, v45, v44 quad_perm:[3,3,3,3] row_mask:0xf bank_mask:0xf
  s_nop 1
  v_add_f32_dpp v34, v89, v88 quad_perm:[2,2,2,2] row_mask:0xf bank_mask:0x2
  s_waitcnt vmcnt(10)
  v_mfma_f32_16x16x32_bf16 v[42:45], v[180:183], v[12:15], 0
  v_mfma_f32_16x16x32_bf16 v[42:45], v[184:187], v[16:19], v[42:45]
  buffer_load_dwordx4 v[228:231], v5, s[48:51], s21 offen offset:2048 nt
  buffer_load_dwordx4 v[232:235], v5, s[48:51], s21 offen offset:2304 nt
  v_add_f32_dpp v88, v39, v38 quad_perm:[1,1,1,1] row_mask:0xf bank_mask:0xf
  v_add_f32_dpp v89, v41, v40 quad_perm:[3,3,3,3] row_mask:0xf bank_mask:0xf
  s_nop 1
  v_add_f32_dpp v34, v89, v88 quad_perm:[2,2,2,2] row_mask:0xf bank_mask:0x4
  s_waitcnt vmcnt(10)
  v_mfma_f32_16x16x32_bf16 v[38:41], v[188:191], v[12:15], 0
  v_mfma_f32_16x16x32_bf16 v[38:41], v[192:195], v[16:19], v[38:41]
  s_add_u32 s21, s21, 16384
  s_cmp_eq_u32 s21, s20
  s_cselect_b32 s21, 0, s21
  buffer_load_dwordx4 v[236:239], v5, s[48:51], s21 offen offset:0 nt
  buffer_load_dwordx4 v[240:243], v5, s[48:51], s21 offen offset:256 nt
  s_mov_b32 s96, 0
  buffer_load_dwordx4 a[0:3], v6, s[56:59], s96 offen offset:0
  s_mov_b32 s96, 0
  buffer_load_dwordx4 a[4:7], v6, s[56:59], s96 offen offset:256
  v_add_f32_dpp v88, v43, v42 quad_perm:[1,1,1,1] row_mask:0xf bank_mask:0xf
  v_add_f32_dpp v89, v45, v44 quad_perm:[3,3,3,3] row_mask:0xf bank_mask:0xf
  s_nop 1
  v_add_f32_dpp v34, v89, v88 quad_perm:[2,2,2,2] row_mask:0xf bank_mask:0x8
  s_waitcnt vmcnt(12)
  v_mfma_f32_16x16x32_bf16 v[42:45], v[196:199], v[12:15], 0
  v_mfma_f32_16x16x32_bf16 v[42:45], v[200:203], v[16:19], v[42:45]
  s_waitcnt vmcnt(11)
  buffer_load_dwordx4 v[244:247], v5, s[48:51], s21 offen offset:2048 nt
  s_waitcnt vmcnt(11)
  buffer_load_dwordx4 v[248:251], v5, s[48:51], s21 offen offset:2304 nt
  s_mov_b32 s96, 0
  buffer_load_dwordx4 a[8:11], v6, s[56:59], s96 offen offset:512
  v_add_f32_dpp v88, v39, v38 quad_perm:[1,1,1,1] row_mask:0xf bank_mask:0xf
  v_add_f32_dpp v89, v41, v40 quad_perm:[3,3,3,3] row_mask:0xf bank_mask:0xf
  s_nop 1
  v_add_f32_dpp v35, v89, v88 quad_perm:[2,2,2,2] row_mask:0xf bank_mask:0x1
  v_mfma_f32_16x16x32_bf16 v[38:41], v[204:207], v[12:15], 0
  v_mfma_f32_16x16x32_bf16 v[38:41], v[208:211], v[16:19], v[38:41]
  s_waitcnt vmcnt(11)
  s_add_u32 s21, s21, 16384
  s_cmp_eq_u32 s21, s20
  s_cselect_b32 s21, 0, s21
  buffer_load_dwordx4 v[252:255], v5, s[48:51], s21 offen offset:0 nt
  s_waitcnt vmcnt(11)
  buffer_load_dwordx4 v[96:99], v5, s[48:51], s21 offen offset:256 nt
  s_mov_b32 s96, 0
  buffer_load_dwordx4 a[12:15], v7, s[56:59], s96 offen offset:768
  v_add_f32_dpp v88, v43, v42 quad_perm:[1,1,1,1] row_mask:0xf bank_mask:0xf
  v_add_f32_dpp v89, v45, v44 quad_perm:[3,3,3,3] row_mask:0xf bank_mask:0xf
  s_nop 1
  v_add_f32_dpp v35, v89, v88 quad_perm:[2,2,2,2] row_mask:0xf bank_mask:0x2
  v_mfma_f32_16x16x32_bf16 v[42:45], v[212:215], v[12:15], 0
  v_mfma_f32_16x16x32_bf16 v[42:45], v[216:219], v[16:19], v[42:45]
  s_waitcnt vmcnt(11)
  buffer_load_dwordx4 v[100:103], v5, s[48:51], s21 offen offset:2048 nt
  s_waitcnt vmcnt(11)
  buffer_load_dwordx4 v[104:107], v5, s[48:51], s21 offen offset:2304 nt
  s_mov_b32 s96, 3584
  buffer_load_dwordx4 a[16:19], v6, s[56:59], s96 offen offset:0
  v_add_f32_dpp v88, v39, v38 quad_perm:[1,1,1,1] row_mask:0xf bank_mask:0xf
  v_add_f32_dpp v89, v41, v40 quad_perm:[3,3,3,3] row_mask:0xf bank_mask:0xf
  s_nop 1
  v_add_f32_dpp v35, v89, v88 quad_perm:[2,2,2,2] row_mask:0xf bank_mask:0x4
  v_add_f32_dpp v88, v43, v42 quad_perm:[1,1,1,1] row_mask:0xf bank_mask:0xf
  v_add_f32_dpp v89, v45, v44 quad_perm:[3,3,3,3] row_mask:0xf bank_mask:0xf
  s_nop 1
  v_add_f32_dpp v35, v89, v88 quad_perm:[2,2,2,2] row_mask:0xf bank_mask:0x8
  v_max3_f32 v80, v20, v21, v22
  v_max3_f32 v80, v80, v23, v24
  v_max3_f32 v80, v80, v25, v26
  v_max3_f32 v80, v80, v27, v28
  v_max3_f32 v80, v80, v29, v30
  v_max3_f32 v80, v80, v31, v32
  v_max3_f32 v80, v80, v33, v34
  v_max_f32 v80, v80, v35
  s_nop 1
  v_mov_b32_dpp v81, v80 quad_perm:[0,0,0,0] row_mask:0xf bank_mask:0xf
  s_nop 1
  v_max_f32_dpp v80, v81, v81 row_ror:4 row_mask:0xf bank_mask:0xf
  s_nop 1
  v_max_f32_dpp v81, v80, v80 row_ror:8 row_mask:0xf bank_mask:0xf
  s_lshl_b32 s12, s3, 4
  v_lshlrev_b32 v82, 2, v3
  v_add_u32 v82, s12, v82
  ds_write_b32 v82, v81 offset:2560
  s_waitcnt lgkmcnt(0)
  s_barrier
  v_mov_b32 v83, 0
  ds_read_b128 v[54:57], v83 offset:2560
  ds_read_b128 v[58:61], v83 offset:2576
  ds_read_b128 v[62:65], v83 offset:2592
  ds_read_b128 v[66:69], v83 offset:2608
  s_waitcnt lgkmcnt(0)
  v_max3_f32 v80, v54, v55, v56
  v_max3_f32 v80, v80, v57, v58
  v_max3_f32 v80, v80, v59, v60
  v_max3_f32 v80, v80, v61, v62
  v_max3_f32 v80, v80, v63, v64
  v_max3_f32 v80, v80, v65, v66
  v_max3_f32 v80, v80, v67, v68
  v_max_f32 v80, v80, v69
  v_mul_f32 v80, s92, v80
  v_fma_f32 v20, v20, s92, -v80
  v_fma_f32 v21, v21, s92, -v80
  v_fma_f32 v22, v22, s92, -v80
  v_fma_f32 v23, v23, s92, -v80
  v_fma_f32 v24, v24, s92, -v80
  v_fma_f32 v25, v25, s92, -v80
  v_fma_f32 v26, v26, s92, -v80
  v_fma_f32 v27, v27, s92, -v80
  v_fma_f32 v28, v28, s92, -v80
  v_fma_f32 v29, v29, s92, -v80
  v_fma_f32 v30, v30, s92, -v80
  v_fma_f32 v31, v31, s92, -v80
  v_fma_f32 v32, v32, s92, -v80
  v_fma_f32 v33, v33, s92, -v80
  v_fma_f32 v34, v34, s92, -v80
  v_fma_f32 v35, v35, s92, -v80
  v_exp_f32 v20, v20
  v_exp_f32 v21, v21
  v_exp_f32 v22, v22
  v_exp_f32 v23, v23
  v_exp_f32 v24, v24
  v_exp_f32 v25, v25
  v_exp_f32 v26, v26
  v_exp_f32 v27, v27
  v_exp_f32 v28, v28
  v_exp_f32 v29, v29
  v_exp_f32 v30, v30
  v_exp_f32 v31, v31
  v_exp_f32 v32, v32
  v_exp_f32 v33, v33
  v_exp_f32 v34, v34
  v_exp_f32 v35, v35
  v_add_f32 v81, v20, v21
  v_add_f32 v81, v81, v22
  v_add_f32 v81, v81, v23
  v_add_f32 v81, v81, v24
  v_add_f32 v81, v81, v25
  v_add_f32 v81, v81, v26
  v_add_f32 v81, v81, v27
  v_add_f32 v81, v81, v28
  v_add_f32 v81, v81, v29
  v_add_f32 v81, v81, v30
  v_add_f32 v81, v81, v31
  v_add_f32 v81, v81, v32
  v_add_f32 v81, v81, v33
  v_add_f32 v81, v81, v34
  v_add_f32 v81, v81, v35
  v_cvt_pk_bf16_f32 v20, v20, v20
  v_cvt_pk_bf16_f32 v21, v21, v21
  v_cvt_pk_bf16_f32 v22, v22, v22
  v_cvt_pk_bf16_f32 v23, v23, v23
  v_cvt_pk_bf16_f32 v24, v24, v24
  v_cvt_pk_bf16_f32 v25, v25, v25
  v_cvt_pk_bf16_f32 v26, v26, v26
  v_cvt_pk_bf16_f32 v27, v27, v27
  v_cvt_pk_bf16_f32 v28, v28, v28
  v_cvt_pk_bf16_f32 v29, v29, v29
  v_cvt_pk_bf16_f32 v30, v30, v30
  v_cvt_pk_bf16_f32 v31, v31, v31
  v_cvt_pk_bf16_f32 v32, v32, v32
  v_cvt_pk_bf16_f32 v33, v33, v33
  v_cvt_pk_bf16_f32 v34, v34, v34
  v_cvt_pk_bf16_f32 v35, v35, v35
  v_mov_b32_dpp v83, v81 quad_perm:[0,0,0,0] row_mask:0xf bank_mask:0xf
  s_nop 1
  v_add_f32_dpp v81, v83, v83 row_ror:4 row_mask:0xf bank_mask:0xf
  s_nop 1
  v_add_f32_dpp v83, v81, v81 row_ror:8 row_mask:0xf bank_mask:0xf
  ds_write_b32 v82, v83 offset:2688
  s_waitcnt lgkmcnt(0)
  s_barrier
  v_mov_b32 v83, 0
  ds_read_b128 v[54:57], v83 offset:2688
  ds_read_b128 v[58:61], v83 offset:2704
  ds_read_b128 v[62:65], v83 offset:2720
  ds_read_b128 v[66:69], v83 offset:2736
  s_waitcnt lgkmcnt(0)
  v_add_f32 v54, v54, v55
  v_add_f32 v56, v56, v57
  v_add_f32 v58, v58, v59
  v_add_f32 v60, v60, v61
  v_add_f32 v62, v62, v63
  v_add_f32 v64, v64, v65
  v_add_f32 v66, v66, v67
  v_add_f32 v68, v68, v69
  v_add_f32 v54, v54, v56
  v_add_f32 v58, v58, v60
  v_add_f32 v62, v62, v64
  v_add_f32 v66, v66, v68
  v_add_f32 v54, v54, v58
  v_add_f32 v62, v62, v66
  v_add_f32 v54, v54, v62
  v_min_u32 v46, -2, v80
  v_min_u32 v47, -2, v54
  v_cmp_eq_u32 vcc, 0, v0
  v_mov_b32 v84, 0x7ff00000
  v_mov_b32 v85, 0
  v_cndmask_b32 v84, v84, v85, vcc
  s_lshl_b32 s13, s10, 3
  s_add_u32 s13, s13, 786432
  buffer_store_dwordx2 v[46:47], v84, s[64:67], s13 offen sc1
  v_and_b32_dpp v46, v20, v8 row_newbcast:0 row_mask:0xf bank_mask:0xf
  v_and_b32_dpp v47, v20, v9 row_newbcast:0 row_mask:0xf bank_mask:0xf
  v_and_b32_dpp v48, v20, v10 row_newbcast:0 row_mask:0xf bank_mask:0xf
  v_and_b32_dpp v49, v20, v11 row_newbcast:0 row_mask:0xf bank_mask:0xf
  v_and_b32_dpp v50, v20, v8 row_newbcast:4 row_mask:0xf bank_mask:0xf
  v_and_b32_dpp v51, v20, v9 row_newbcast:4 row_mask:0xf bank_mask:0xf
  v_and_b32_dpp v52, v20, v10 row_newbcast:4 row_mask:0xf bank_mask:0xf
  v_and_b32_dpp v53, v20, v11 row_newbcast:4 row_mask:0xf bank_mask:0xf
  v_mfma_f32_16x16x32_bf16 v[38:41], v[220:223], v[46:49], 0
  v_mfma_f32_16x16x32_bf16 v[42:45], v[224:227], v[46:49], 0
  s_add_u32 s21, s21, 16384
  s_cmp_eq_u32 s21, s20
  s_cselect_b32 s21, 0, s21
  buffer_load_dwordx4 v[108:111], v5, s[48:51], s21 offen offset:0 nt
  buffer_load_dwordx4 v[112:115], v5, s[48:51], s21 offen offset:256 nt
  s_mov_b32 s96, 3584
  buffer_load_dwordx4 a[20:23], v6, s[56:59], s96 offen offset:256
  s_mov_b32 s96, 3584
  buffer_load_dwordx4 a[24:27], v6, s[56:59], s96 offen offset:512
  v_and_b32_dpp v46, v20, v8 row_newbcast:8 row_mask:0xf bank_mask:0xf
  v_and_b32_dpp v47, v20, v9 row_newbcast:8 row_mask:0xf bank_mask:0xf
  v_and_b32_dpp v48, v20, v10 row_newbcast:8 row_mask:0xf bank_mask:0xf
  v_and_b32_dpp v49, v20, v11 row_newbcast:8 row_mask:0xf bank_mask:0xf
  v_mfma_f32_16x16x32_bf16 v[38:41], v[228:231], v[50:53], v[38:41]
  v_mfma_f32_16x16x32_bf16 v[42:45], v[232:235], v[50:53], v[42:45]
  buffer_load_dwordx4 v[116:119], v5, s[48:51], s21 offen offset:2048 nt
  buffer_load_dwordx4 v[120:123], v5, s[48:51], s21 offen offset:2304 nt
  s_mov_b32 s96, 3584
  buffer_load_dwordx4 a[28:31], v7, s[56:59], s96 offen offset:768
  v_and_b32_dpp v50, v20, v8 row_newbcast:12 row_mask:0xf bank_mask:0xf
  v_and_b32_dpp v51, v20, v9 row_newbcast:12 row_mask:0xf bank_mask:0xf
  v_and_b32_dpp v52, v20, v10 row_newbcast:12 row_mask:0xf bank_mask:0xf
  v_and_b32_dpp v53, v20, v11 row_newbcast:12 row_mask:0xf bank_mask:0xf
  s_waitcnt vmcnt(19)
  v_mfma_f32_16x16x32_bf16 v[38:41], v[236:239], v[46:49], v[38:41]
  v_mfma_f32_16x16x32_bf16 v[42:45], v[240:243], v[46:49], v[42:45]
  s_add_u32 s21, s21, 16384
  s_cmp_eq_u32 s21, s20
  s_cselect_b32 s21, 0, s21
  buffer_load_dwordx4 v[124:127], v5, s[48:51], s21 offen offset:0 nt
  buffer_load_dwordx4 v[128:131], v5, s[48:51], s21 offen offset:256 nt
  s_mov_b32 s96, 7168
  buffer_load_dwordx4 a[32:35], v6, s[56:59], s96 offen offset:0
  s_cmp_ge_u32 s11, 28
  s_cselect_b32 s97, 1, 0
  s_mul_i32 s12, s97, 28
  s_sub_u32 s12, s11, s12
  s_cmp_ge_u32 s12, 26
  s_cselect_b32 s13, 2, 0
  s_add_u32 s12, s12, s13
  s_lshl_b32 s98, s97, 18
  s_lshl_b32 s96, s12, 6
  s_add_u32 s98, s98, s96
  s_add_u32 s98, s98, 262144
  s_lshr_b32 s13, s12, 4
  s_lshl_b32 s13, s13, 1
  s_bfe_u32 s14, s12, 0x10003
  s_add_u32 s13, s13, s14
  s_lshl_b32 s100, s13, 7
  s_and_b32 s13, s12, 3
  s_lshl_b32 s13, s13, 5
  s_add_u32 s100, s100, s13
  s_bfe_u32 s13, s12, 0x10002
  s_lshl_b32 s13, s13, 2
  s_add_u32 s100, s100, s13
  v_and_b32 v81, 3, v1
  v_lshlrev_b32 v81, 3, v81
  v_add_u32 v81, s100, v81
  v_mov_b32 v82, 384
  v_cmp_gt_u32 vcc, v82, v81
  v_lshrrev_b32 v83, 7, v81
  s_nop 0
  v_cndmask_b32 v83, 3, v83, vcc
  v_and_b32 v84, 127, v81
  v_subrev_u32 v85, 320, v81
  v_cndmask_b32 v84, v85, v84, vcc
  v_lshlrev_b32 v83, 10, v83
  v_and_b32 v85, 7, v84
  s_lshl_b32 s13, s97, 3
  v_add_u32 v85, s13, v85
  v_lshl_add_u32 v83, v85, 4, v83
  v_lshrrev_b32 v84, 3, v84
  v_lshrrev_b32 v85, 2, v84
  v_lshl_add_u32 v83, v85, 8, v83
  v_and_b32 v84, 3, v84
  v_lshl_add_u32 v94, v84, 2, v83
  s_mov_b32 s99, 794624
  v_lshrrev_b32 v80, 2, v1
  v_lshlrev_b32 v92, 14, v80
  v_and_b32 v82, 3, v1
  v_lshl_add_u32 v92, v82, 4, v92
  s_mul_i32 s15, s97, 448
  v_add_u32 v81, s15, v81
  v_lshlrev_b32 v81, 1, v81
  v_mov_b32 v82, 0x7ff00000
  v_cmp_gt_u32 vcc, 4, v1
  s_nop 1
  v_cndmask_b32 v93, v82, v81, vcc
  s_mov_b32 s72, s36
  s_and_b32 s73, s37, 0xffff
  s_mov_b32 s74, 1792
  s_mov_b32 s75, 0x20000
  v_and_b32_dpp v46, v21, v8 row_newbcast:0 row_mask:0xf bank_mask:0xf
  v_and_b32_dpp v47, v21, v9 row_newbcast:0 row_mask:0xf bank_mask:0xf
  v_and_b32_dpp v48, v21, v10 row_newbcast:0 row_mask:0xf bank_mask:0xf
  v_and_b32_dpp v49, v21, v11 row_newbcast:0 row_mask:0xf bank_mask:0xf
  s_waitcnt vmcnt(18)
  v_mfma_f32_16x16x32_bf16 v[38:41], v[244:247], v[50:53], v[38:41]
  v_mfma_f32_16x16x32_bf16 v[42:45], v[248:251], v[50:53], v[42:45]
  buffer_load_dwordx4 v[132:135], v5, s[48:51], s21 offen offset:2048 nt
  buffer_load_dwordx4 v[136:139], v5, s[48:51], s21 offen offset:2304 nt
  s_mov_b32 s96, 7168
  buffer_load_dwordx4 a[36:39], v6, s[56:59], s96 offen offset:256
  v_and_b32_dpp v50, v21, v8 row_newbcast:4 row_mask:0xf bank_mask:0xf
  v_and_b32_dpp v51, v21, v9 row_newbcast:4 row_mask:0xf bank_mask:0xf
  v_and_b32_dpp v52, v21, v10 row_newbcast:4 row_mask:0xf bank_mask:0xf
  v_and_b32_dpp v53, v21, v11 row_newbcast:4 row_mask:0xf bank_mask:0xf
  s_waitcnt vmcnt(18)
  v_mfma_f32_16x16x32_bf16 v[38:41], v[252:255], v[46:49], v[38:41]
  v_mfma_f32_16x16x32_bf16 v[42:45], v[96:99], v[46:49], v[42:45]
  s_add_u32 s21, s21, 16384
  s_cmp_eq_u32 s21, s20
  s_cselect_b32 s21, 0, s21
  buffer_load_dwordx4 v[140:143], v5, s[48:51], s21 offen offset:0 nt
  buffer_load_dwordx4 v[144:147], v5, s[48:51], s21 offen offset:256 nt
  s_mov_b32 s96, 7168
  buffer_load_dwordx4 a[40:43], v6, s[56:59], s96 offen offset:512
  s_mul_i32 s12, s97, 896
  s_add_u32 s88, s16, s12
  s_addc_u32 s89, s17, 0
  s_and_b32 s89, s89, 0xffff
  s_mov_b32 s90, 896
  s_mov_b32 s91, 0x20000
  s_mov_b32 s84, s34
  s_and_b32 s85, s35, 0xffff
  s_mov_b32 s86, 896
  s_mov_b32 s87, 0x20000
  v_lshlrev_b32 v80, 4, v1
  buffer_load_dwordx4 v[54:57], v80, s[88:91], 0 offen
  buffer_load_dwordx4 v[58:61], v80, s[84:87], 0 offen
  v_and_b32_dpp v46, v21, v8 row_newbcast:8 row_mask:0xf bank_mask:0xf
  v_and_b32_dpp v47, v21, v9 row_newbcast:8 row_mask:0xf bank_mask:0xf
  v_and_b32_dpp v48, v21, v10 row_newbcast:8 row_mask:0xf bank_mask:0xf
  v_and_b32_dpp v49, v21, v11 row_newbcast:8 row_mask:0xf bank_mask:0xf
  s_waitcnt vmcnt(20)
  v_mfma_f32_16x16x32_bf16 v[38:41], v[100:103], v[50:53], v[38:41]
  v_mfma_f32_16x16x32_bf16 v[42:45], v[104:107], v[50:53], v[42:45]
  buffer_load_dwordx4 v[148:151], v5, s[48:51], s21 offen offset:2048 nt
  buffer_load_dwordx4 v[152:155], v5, s[48:51], s21 offen offset:2304 nt
  s_mov_b32 s96, 7168
  buffer_load_dwordx4 a[44:47], v7, s[56:59], s96 offen offset:768
  s_mov_b32 s96, 10752
  buffer_load_dwordx4 a[48:51], v6, s[56:59], s96 offen offset:0
  v_and_b32_dpp v50, v21, v8 row_newbcast:12 row_mask:0xf bank_mask:0xf
  v_and_b32_dpp v51, v21, v9 row_newbcast:12 row_mask:0xf bank_mask:0xf
  v_and_b32_dpp v52, v21, v10 row_newbcast:12 row_mask:0xf bank_mask:0xf
  v_and_b32_dpp v53, v21, v11 row_newbcast:12 row_mask:0xf bank_mask:0xf
  s_waitcnt vmcnt(20)
  v_mfma_f32_16x16x32_bf16 v[38:41], v[108:111], v[46:49], v[38:41]
  v_mfma_f32_16x16x32_bf16 v[42:45], v[112:115], v[46:49], v[42:45]
  s_add_u32 s21, s21, 16384
  s_cmp_eq_u32 s21, s20
  s_cselect_b32 s21, 0, s21
  buffer_load_dwordx4 v[156:159], v5, s[48:51], s21 offen offset:0 nt
  buffer_load_dwordx4 v[160:163], v5, s[48:51], s21 offen offset:256 nt
  s_mov_b32 s96, 10752
  buffer_load_dwordx4 a[52:55], v6, s[56:59], s96 offen offset:256
  v_and_b32_dpp v46, v22, v8 row_newbcast:0 row_mask:0xf bank_mask:0xf
  v_and_b32_dpp v47, v22, v9 row_newbcast:0 row_mask:0xf bank_mask:0xf
  v_and_b32_dpp v48, v22, v10 row_newbcast:0 row_mask:0xf bank_mask:0xf
  v_and_b32_dpp v49, v22, v11 row_newbcast:0 row_mask:0xf bank_mask:0xf
  s_waitcnt vmcnt(19)
  v_mfma_f32_16x16x32_bf16 v[38:41], v[116:119], v[50:53], v[38:41]
  v_mfma_f32_16x16x32_bf16 v[42:45], v[120:123], v[50:53], v[42:45]
  buffer_load_dwordx4 v[164:167], v5, s[48:51], s21 offen offset:2048 nt
  buffer_load_dwordx4 v[168:171], v5, s[48:51], s21 offen offset:2304 nt
  s_mov_b32 s96, 10752
  buffer_load_dwordx4 a[56:59], v6, s[56:59], s96 offen offset:512
  v_and_b32_dpp v50, v22, v8 row_newbcast:4 row_mask:0xf bank_mask:0xf
  v_and_b32_dpp v51, v22, v9 row_newbcast:4 row_mask:0xf bank_mask:0xf
  v_and_b32_dpp v52, v22, v10 row_newbcast:4 row_mask:0xf bank_mask:0xf
  v_and_b32_dpp v53, v22, v11 row_newbcast:4 row_mask:0xf bank_mask:0xf
  s_waitcnt vmcnt(19)
  v_mfma_f32_16x16x32_bf16 v[38:41], v[124:127], v[46:49], v[38:41]
  v_mfma_f32_16x16x32_bf16 v[42:45], v[128:131], v[46:49], v[42:45]
  s_add_u32 s21, s21, 16384
  s_cmp_eq_u32 s21, s20
  s_cselect_b32 s21, 0, s21
  buffer_load_dwordx4 v[172:175], v5, s[48:51], s21 offen offset:0 nt
  buffer_load_dwordx4 v[176:179], v5, s[48:51], s21 offen offset:256 nt
  s_mov_b32 s96, 10752
  buffer_load_dwordx4 a[60:63], v7, s[56:59], s96 offen offset:768
  s_waitcnt vmcnt(13)
  v_mov_b32 v80, 0
  v_dot2_f32_bf16 v80, v54, v58, v80
  v_dot2_f32_bf16 v80, v55, v59, v80
  v_dot2_f32_bf16 v80, v56, v60, v80
  v_dot2_f32_bf16 v80, v57, v61, v80
  s_nop 2
  v_add_f32_dpp v80, v80, v80 row_ror:8 row_mask:0xf bank_mask:0xf
  s_nop 1
  v_add_f32_dpp v80, v80, v80 row_ror:4 row_mask:0xf bank_mask:0xf
  s_nop 1
  v_add_f32_dpp v80, v80, v80 row_ror:2 row_mask:0xf bank_mask:0xf
  s_nop 1
  v_add_f32_dpp v80, v80, v80 row_ror:1 row_mask:0xf bank_mask:0xf
  v_mov_b32 v81, v80
  s_nop 1
  v_permlane16_swap_b32 v80, v81
  v_add_f32 v80, v80, v81
  v_mov_b32 v81, v80
  s_nop 1
  v_permlane32_swap_b32 v80, v81
  v_add_f32 v80, v80, v81
  v_mul_f32 v80, 0xbfb8aa3b, v80
  v_exp_f32 v80, v80
  s_nop 0
  v_add_f32 v80, 1.0, v80
  v_rcp_f32 v70, v80
  v_and_b32_dpp v46, v22, v8 row_newbcast:8 row_mask:0xf bank_mask:0xf
  v_and_b32_dpp v47, v22, v9 row_newbcast:8 row_mask:0xf bank_mask:0xf
  v_and_b32_dpp v48, v22, v10 row_newbcast:8 row_mask:0xf bank_mask:0xf
  v_and_b32_dpp v49, v22, v11 row_newbcast:8 row_mask:0xf bank_mask:0xf
  v_mfma_f32_16x16x32_bf16 v[38:41], v[132:135], v[50:53], v[38:41]
  v_mfma_f32_16x16x32_bf16 v[42:45], v[136:139], v[50:53], v[42:45]
  buffer_load_dwordx4 v[180:183], v5, s[48:51], s21 offen offset:2048 nt
  buffer_load_dwordx4 v[184:187], v5, s[48:51], s21 offen offset:2304 nt
  s_mov_b32 s96, 14336
  buffer_load_dwordx4 a[64:67], v6, s[56:59], s96 offen offset:0
  v_and_b32_dpp v50, v22, v8 row_newbcast:12 row_mask:0xf bank_mask:0xf
  v_and_b32_dpp v51, v22, v9 row_newbcast:12 row_mask:0xf bank_mask:0xf
  v_and_b32_dpp v52, v22, v10 row_newbcast:12 row_mask:0xf bank_mask:0xf
  v_and_b32_dpp v53, v22, v11 row_newbcast:12 row_mask:0xf bank_mask:0xf
  v_mfma_f32_16x16x32_bf16 v[38:41], v[140:143], v[46:49], v[38:41]
  v_mfma_f32_16x16x32_bf16 v[42:45], v[144:147], v[46:49], v[42:45]
  s_add_u32 s21, s21, 16384
  s_cmp_eq_u32 s21, s20
  s_cselect_b32 s21, 0, s21
  buffer_load_dwordx4 v[188:191], v5, s[48:51], s21 offen offset:0 nt
  buffer_load_dwordx4 v[192:195], v5, s[48:51], s21 offen offset:256 nt
  s_mov_b32 s96, 14336
  buffer_load_dwordx4 a[68:71], v6, s[56:59], s96 offen offset:256
  s_mov_b32 s96, 14336
  buffer_load_dwordx4 a[72:75], v6, s[56:59], s96 offen offset:512
  v_and_b32_dpp v46, v23, v8 row_newbcast:0 row_mask:0xf bank_mask:0xf
  v_and_b32_dpp v47, v23, v9 row_newbcast:0 row_mask:0xf bank_mask:0xf
  v_and_b32_dpp v48, v23, v10 row_newbcast:0 row_mask:0xf bank_mask:0xf
  v_and_b32_dpp v49, v23, v11 row_newbcast:0 row_mask:0xf bank_mask:0xf
  s_waitcnt vmcnt(18)
  v_mfma_f32_16x16x32_bf16 v[38:41], v[148:151], v[50:53], v[38:41]
  v_mfma_f32_16x16x32_bf16 v[42:45], v[152:155], v[50:53], v[42:45]
  buffer_load_dwordx4 v[196:199], v5, s[48:51], s21 offen offset:2048 nt
  buffer_load_dwordx4 v[200:203], v5, s[48:51], s21 offen offset:2304 nt
  s_mov_b32 s96, 14336
  buffer_load_dwordx4 a[76:79], v7, s[56:59], s96 offen offset:768
  v_and_b32_dpp v50, v23, v8 row_newbcast:4 row_mask:0xf bank_mask:0xf
  v_and_b32_dpp v51, v23, v9 row_newbcast:4 row_mask:0xf bank_mask:0xf
  v_and_b32_dpp v52, v23, v10 row_newbcast:4 row_mask:0xf bank_mask:0xf
  v_and_b32_dpp v53, v23, v11 row_newbcast:4 row_mask:0xf bank_mask:0xf
  s_waitcnt vmcnt(17)
  v_mfma_f32_16x16x32_bf16 v[38:41], v[156:159], v[46:49], v[38:41]
  v_mfma_f32_16x16x32_bf16 v[42:45], v[160:163], v[46:49], v[42:45]
  s_add_u32 s21, s21, 16384
  s_cmp_eq_u32 s21, s20
  s_cselect_b32 s21, 0, s21
  buffer_load_dwordx4 v[204:207], v5, s[48:51], s21 offen offset:0 nt
  buffer_load_dwordx4 v[208:211], v5, s[48:51], s21 offen offset:256 nt
  s_mov_b32 s96, 17920
  buffer_load_dwordx4 a[80:83], v6, s[56:59], s96 offen offset:0
  v_and_b32_dpp v46, v23, v8 row_newbcast:8 row_mask:0xf bank_mask:0xf
  v_and_b32_dpp v47, v23, v9 row_newbcast:8 row_mask:0xf bank_mask:0xf
  v_and_b32_dpp v48, v23, v10 row_newbcast:8 row_mask:0xf bank_mask:0xf
  v_and_b32_dpp v49, v23, v11 row_newbcast:8 row_mask:0xf bank_mask:0xf
  s_waitcnt vmcnt(17)
  v_mfma_f32_16x16x32_bf16 v[38:41], v[164:167], v[50:53], v[38:41]
  v_mfma_f32_16x16x32_bf16 v[42:45], v[168:171], v[50:53], v[42:45]
  buffer_load_dwordx4 v[212:215], v5, s[48:51], s21 offen offset:2048 nt
  buffer_load_dwordx4 v[216:219], v5, s[48:51], s21 offen offset:2304 nt
  s_mov_b32 s96, 17920
  buffer_load_dwordx4 a[84:87], v6, s[56:59], s96 offen offset:256
  v_and_b32_dpp v50, v23, v8 row_newbcast:12 row_mask:0xf bank_mask:0xf
  v_and_b32_dpp v51, v23, v9 row_newbcast:12 row_mask:0xf bank_mask:0xf
  v_and_b32_dpp v52, v23, v10 row_newbcast:12 row_mask:0xf bank_mask:0xf
  v_and_b32_dpp v53, v23, v11 row_newbcast:12 row_mask:0xf bank_mask:0xf
  s_waitcnt vmcnt(17)
  v_mfma_f32_16x16x32_bf16 v[38:41], v[172:175], v[46:49], v[38:41]
  v_mfma_f32_16x16x32_bf16 v[42:45], v[176:179], v[46:49], v[42:45]
  s_add_u32 s21, s21, 16384
  s_cmp_eq_u32 s21, s20
  s_cselect_b32 s21, 0, s21
  buffer_load_dwordx4 v[220:223], v5, s[48:51], s21 offen offset:0 nt
  buffer_load_dwordx4 v[224:227], v5, s[48:51], s21 offen offset:256 nt
  s_mov_b32 s96, 17920
  buffer_load_dwordx4 a[88:91], v6, s[56:59], s96 offen offset:512
  v_and_b32_dpp v46, v24, v8 row_newbcast:0 row_mask:0xf bank_mask:0xf
  v_and_b32_dpp v47, v24, v9 row_newbcast:0 row_mask:0xf bank_mask:0xf
  v_and_b32_dpp v48, v24, v10 row_newbcast:0 row_mask:0xf bank_mask:0xf
  v_and_b32_dpp v49, v24, v11 row_newbcast:0 row_mask:0xf bank_mask:0xf
  s_waitcnt vmcnt(17)
  v_mfma_f32_16x16x32_bf16 v[38:41], v[180:183], v[50:53], v[38:41]
  v_mfma_f32_16x16x32_bf16 v[42:45], v[184:187], v[50:53], v[42:45]
  buffer_load_dwordx4 v[228:231], v5, s[48:51], s21 offen offset:2048 nt
  buffer_load_dwordx4 v[232:235], v5, s[48:51], s21 offen offset:2304 nt
  s_mov_b32 s96, 17920
  buffer_load_dwordx4 a[92:95], v7, s[56:59], s96 offen offset:768
  s_mov_b32 s96, 21504
  buffer_load_dwordx4 a[96:99], v6, s[56:59], s96 offen offset:0
  v_and_b32_dpp v50, v24, v8 row_newbcast:4 row_mask:0xf bank_mask:0xf
  v_and_b32_dpp v51, v24, v9 row_newbcast:4 row_mask:0xf bank_mask:0xf
  v_and_b32_dpp v52, v24, v10 row_newbcast:4 row_mask:0xf bank_mask:0xf
  v_and_b32_dpp v53, v24, v11 row_newbcast:4 row_mask:0xf bank_mask:0xf
  s_waitcnt vmcnt(18)
  v_mfma_f32_16x16x32_bf16 v[38:41], v[188:191], v[46:49], v[38:41]
  v_mfma_f32_16x16x32_bf16 v[42:45], v[192:195], v[46:49], v[42:45]
  s_add_u32 s21, s21, 16384
  s_cmp_eq_u32 s21, s20
  s_cselect_b32 s21, 0, s21
  buffer_load_dwordx4 v[236:239], v5, s[48:51], s21 offen offset:0 nt
  buffer_load_dwordx4 v[240:243], v5, s[48:51], s21 offen offset:256 nt
  s_mov_b32 s96, 21504
  buffer_load_dwordx4 a[100:103], v6, s[56:59], s96 offen offset:256
  v_and_b32_dpp v46, v24, v8 row_newbcast:8 row_mask:0xf bank_mask:0xf
  v_and_b32_dpp v47, v24, v9 row_newbcast:8 row_mask:0xf bank_mask:0xf
  v_and_b32_dpp v48, v24, v10 row_newbcast:8 row_mask:0xf bank_mask:0xf
  v_and_b32_dpp v49, v24, v11 row_newbcast:8 row_mask:0xf bank_mask:0xf
  s_waitcnt vmcnt(17)
  v_mfma_f32_16x16x32_bf16 v[38:41], v[196:199], v[50:53], v[38:41]
  v_mfma_f32_16x16x32_bf16 v[42:45], v[200:203], v[50:53], v[42:45]
  buffer_load_dwordx4 v[244:247], v5, s[48:51], s21 offen offset:2048 nt
  buffer_load_dwordx4 v[248:251], v5, s[48:51], s21 offen offset:2304 nt
  s_mov_b32 s96, 21504
  buffer_load_dwordx4 a[104:107], v6, s[56:59], s96 offen offset:512
  v_and_b32_dpp v50, v24, v8 row_newbcast:12 row_mask:0xf bank_mask:0xf
  v_and_b32_dpp v51, v24, v9 row_newbcast:12 row_mask:0xf bank_mask:0xf
  v_and_b32_dpp v52, v24, v10 row_newbcast:12 row_mask:0xf bank_mask:0xf
  v_and_b32_dpp v53, v24, v11 row_newbcast:12 row_mask:0xf bank_mask:0xf
  s_waitcnt vmcnt(17)
  v_mfma_f32_16x16x32_bf16 v[38:41], v[204:207], v[46:49], v[38:41]
  v_mfma_f32_16x16x32_bf16 v[42:45], v[208:211], v[46:49], v[42:45]
  s_add_u32 s21, s21, 16384
  s_cmp_eq_u32 s21, s20
  s_cselect_b32 s21, 0, s21
  buffer_load_dwordx4 v[252:255], v5, s[48:51], s21 offen offset:0 nt
  buffer_load_dwordx4 v[96:99], v5, s[48:51], s21 offen offset:256 nt
  s_mov_b32 s96, 21504
  buffer_load_dwordx4 a[108:111], v7, s[56:59], s96 offen offset:768
  v_and_b32_dpp v46, v25, v8 row_newbcast:0 row_mask:0xf bank_mask:0xf
  v_and_b32_dpp v47, v25, v9 row_newbcast:0 row_mask:0xf bank_mask:0xf
  v_and_b32_dpp v48, v25, v10 row_newbcast:0 row_mask:0xf bank_mask:0xf
  v_and_b32_dpp v49, v25, v11 row_newbcast:0 row_mask:0xf bank_mask:0xf
  s_waitcnt vmcnt(17)
  v_mfma_f32_16x16x32_bf16 v[38:41], v[212:215], v[50:53], v[38:41]
  v_mfma_f32_16x16x32_bf16 v[42:45], v[216:219], v[50:53], v[42:45]
  buffer_load_dwordx4 v[100:103], v5, s[48:51], s21 offen offset:2048 nt
  buffer_load_dwordx4 v[104:107], v5, s[48:51], s21 offen offset:2304 nt
  s_mov_b32 s96, 25088
  buffer_load_dwordx4 a[112:115], v6, s[56:59], s96 offen offset:0
  v_and_b32_dpp v50, v25, v8 row_newbcast:4 row_mask:0xf bank_mask:0xf
  v_and_b32_dpp v51, v25, v9 row_newbcast:4 row_mask:0xf bank_mask:0xf
  v_and_b32_dpp v52, v25, v10 row_newbcast:4 row_mask:0xf bank_mask:0xf
  v_and_b32_dpp v53, v25, v11 row_newbcast:4 row_mask:0xf bank_mask:0xf
  s_waitcnt vmcnt(17)
  v_mfma_f32_16x16x32_bf16 v[38:41], v[220:223], v[46:49], v[38:41]
  v_mfma_f32_16x16x32_bf16 v[42:45], v[224:227], v[46:49], v[42:45]
  s_add_u32 s21, s21, 16384
  s_cmp_eq_u32 s21, s20
  s_cselect_b32 s21, 0, s21
  buffer_load_dwordx4 v[108:111], v5, s[48:51], s21 offen offset:0 nt
  buffer_load_dwordx4 v[112:115], v5, s[48:51], s21 offen offset:256 nt
  s_mov_b32 s96, 25088
  buffer_load_dwordx4 a[116:119], v6, s[56:59], s96 offen offset:256
  s_mov_b32 s96, 25088
  buffer_load_dwordx4 a[120:123], v6, s[56:59], s96 offen offset:512
  v_and_b32_dpp v46, v25, v8 row_newbcast:8 row_mask:0xf bank_mask:0xf
  v_and_b32_dpp v47, v25, v9 row_newbcast:8 row_mask:0xf bank_mask:0xf
  v_and_b32_dpp v48, v25, v10 row_newbcast:8 row_mask:0xf bank_mask:0xf
  v_and_b32_dpp v49, v25, v11 row_newbcast:8 row_mask:0xf bank_mask:0xf
  s_waitcnt vmcnt(18)
  v_mfma_f32_16x16x32_bf16 v[38:41], v[228:231], v[50:53], v[38:41]
  v_mfma_f32_16x16x32_bf16 v[42:45], v[232:235], v[50:53], v[42:45]
  buffer_load_dwordx4 v[116:119], v5, s[48:51], s21 offen offset:2048 nt
  buffer_load_dwordx4 v[120:123], v5, s[48:51], s21 offen offset:2304 nt
  s_mov_b32 s96, 25088
  buffer_load_dwordx4 a[124:127], v7, s[56:59], s96 offen offset:768
  v_and_b32_dpp v50, v25, v8 row_newbcast:12 row_mask:0xf bank_mask:0xf
  v_and_b32_dpp v51, v25, v9 row_newbcast:12 row_mask:0xf bank_mask:0xf
  v_and_b32_dpp v52, v25, v10 row_newbcast:12 row_mask:0xf bank_mask:0xf
  v_and_b32_dpp v53, v25, v11 row_newbcast:12 row_mask:0xf bank_mask:0xf
  s_waitcnt vmcnt(17)
  v_mfma_f32_16x16x32_bf16 v[38:41], v[236:239], v[46:49], v[38:41]
  v_mfma_f32_16x16x32_bf16 v[42:45], v[240:243], v[46:49], v[42:45]
  s_add_u32 s21, s21, 16384
  s_cmp_eq_u32 s21, s20
  s_cselect_b32 s21, 0, s21
  buffer_load_dwordx4 v[124:127], v5, s[48:51], s21 offen offset:0 nt
  buffer_load_dwordx4 v[128:131], v5, s[48:51], s21 offen offset:256 nt
  s_mov_b32 s96, 28672
  buffer_load_dwordx4 a[128:131], v6, s[56:59], s96 offen offset:0
  v_and_b32_dpp v46, v26, v8 row_newbcast:0 row_mask:0xf bank_mask:0xf
  v_and_b32_dpp v47, v26, v9 row_newbcast:0 row_mask:0xf bank_mask:0xf
  v_and_b32_dpp v48, v26, v10 row_newbcast:0 row_mask:0xf bank_mask:0xf
  v_and_b32_dpp v49, v26, v11 row_newbcast:0 row_mask:0xf bank_mask:0xf
  s_waitcnt vmcnt(17)
  v_mfma_f32_16x16x32_bf16 v[38:41], v[244:247], v[50:53], v[38:41]
  v_mfma_f32_16x16x32_bf16 v[42:45], v[248:251], v[50:53], v[42:45]
  buffer_load_dwordx4 v[132:135], v5, s[48:51], s21 offen offset:2048 nt
  buffer_load_dwordx4 v[136:139], v5, s[48:51], s21 offen offset:2304 nt
  s_mov_b32 s96, 28672
  buffer_load_dwordx4 a[132:135], v6, s[56:59], s96 offen offset:256
  v_and_b32_dpp v50, v26, v8 row_newbcast:4 row_mask:0xf bank_mask:0xf
  v_and_b32_dpp v51, v26, v9 row_newbcast:4 row_mask:0xf bank_mask:0xf
  v_and_b32_dpp v52, v26, v10 row_newbcast:4 row_mask:0xf bank_mask:0xf
  v_and_b32_dpp v53, v26, v11 row_newbcast:4 row_mask:0xf bank_mask:0xf
  s_waitcnt vmcnt(17)
  v_mfma_f32_16x16x32_bf16 v[38:41], v[252:255], v[46:49], v[38:41]
  v_mfma_f32_16x16x32_bf16 v[42:45], v[96:99], v[46:49], v[42:45]
  s_add_u32 s21, s21, 16384
  s_cmp_eq_u32 s21, s20
  s_cselect_b32 s21, 0, s21
  buffer_load_dwordx4 v[140:143], v5, s[48:51], s21 offen offset:0 nt
  buffer_load_dwordx4 v[144:147], v5, s[48:51], s21 offen offset:256 nt
  s_mov_b32 s96, 28672
  buffer_load_dwordx4 a[136:139], v6, s[56:59], s96 offen offset:512
  s_mov_b32 s96, 28672
  buffer_load_dwordx4 a[140:143], v7, s[56:59], s96 offen offset:768
  v_and_b32_dpp v46, v26, v8 row_newbcast:8 row_mask:0xf bank_mask:0xf
  v_and_b32_dpp v47, v26, v9 row_newbcast:8 row_mask:0xf bank_mask:0xf
  v_and_b32_dpp v48, v26, v10 row_newbcast:8 row_mask:0xf bank_mask:0xf
  v_and_b32_dpp v49, v26, v11 row_newbcast:8 row_mask:0xf bank_mask:0xf
  s_waitcnt vmcnt(18)
  v_mfma_f32_16x16x32_bf16 v[38:41], v[100:103], v[50:53], v[38:41]
  v_mfma_f32_16x16x32_bf16 v[42:45], v[104:107], v[50:53], v[42:45]
  buffer_load_dwordx4 v[148:151], v5, s[48:51], s21 offen offset:2048 nt
  buffer_load_dwordx4 v[152:155], v5, s[48:51], s21 offen offset:2304 nt
  s_mov_b32 s96, 32256
  buffer_load_dwordx4 a[144:147], v6, s[56:59], s96 offen offset:0
  v_and_b32_dpp v50, v26, v8 row_newbcast:12 row_mask:0xf bank_mask:0xf
  v_and_b32_dpp v51, v26, v9 row_newbcast:12 row_mask:0xf bank_mask:0xf
  v_and_b32_dpp v52, v26, v10 row_newbcast:12 row_mask:0xf bank_mask:0xf
  v_and_b32_dpp v53, v26, v11 row_newbcast:12 row_mask:0xf bank_mask:0xf
  s_waitcnt vmcnt(18)
  v_mfma_f32_16x16x32_bf16 v[38:41], v[108:111], v[46:49], v[38:41]
  v_mfma_f32_16x16x32_bf16 v[42:45], v[112:115], v[46:49], v[42:45]
  s_add_u32 s21, s21, 16384
  s_cmp_eq_u32 s21, s20
  s_cselect_b32 s21, 0, s21
  buffer_load_dwordx4 v[156:159], v5, s[48:51], s21 offen offset:0 nt
  buffer_load_dwordx4 v[160:163], v5, s[48:51], s21 offen offset:256 nt
  s_mov_b32 s96, 32256
  buffer_load_dwordx4 a[148:151], v6, s[56:59], s96 offen offset:256
  v_and_b32_dpp v46, v27, v8 row_newbcast:0 row_mask:0xf bank_mask:0xf
  v_and_b32_dpp v47, v27, v9 row_newbcast:0 row_mask:0xf bank_mask:0xf
  v_and_b32_dpp v48, v27, v10 row_newbcast:0 row_mask:0xf bank_mask:0xf
  v_and_b32_dpp v49, v27, v11 row_newbcast:0 row_mask:0xf bank_mask:0xf
  s_waitcnt vmcnt(17)
  v_mfma_f32_16x16x32_bf16 v[38:41], v[116:119], v[50:53], v[38:41]
  v_mfma_f32_16x16x32_bf16 v[42:45], v[120:123], v[50:53], v[42:45]
  buffer_load_dwordx4 v[164:167], v5, s[48:51], s21 offen offset:2048 nt
  buffer_load_dwordx4 v[168:171], v5, s[48:51], s21 offen offset:2304 nt
  s_mov_b32 s96, 32256
  buffer_load_dwordx4 a[152:155], v6, s[56:59], s96 offen offset:512
  v_and_b32_dpp v50, v27, v8 row_newbcast:4 row_mask:0xf bank_mask:0xf
  v_and_b32_dpp v51, v27, v9 row_newbcast:4 row_mask:0xf bank_mask:0xf
  v_and_b32_dpp v52, v27, v10 row_newbcast:4 row_mask:0xf bank_mask:0xf
  v_and_b32_dpp v53, v27, v11 row_newbcast:4 row_mask:0xf bank_mask:0xf
  s_waitcnt vmcnt(17)
  v_mfma_f32_16x16x32_bf16 v[38:41], v[124:127], v[46:49], v[38:41]
  v_mfma_f32_16x16x32_bf16 v[42:45], v[128:131], v[46:49], v[42:45]
  s_add_u32 s21, s21, 16384
  s_cmp_eq_u32 s21, s20
  s_cselect_b32 s21, 0, s21
  buffer_load_dwordx4 v[172:175], v5, s[48:51], s21 offen offset:0 nt
  buffer_load_dwordx4 v[176:179], v5, s[48:51], s21 offen offset:256 nt
  s_mov_b32 s96, 32256
  buffer_load_dwordx4 a[156:159], v7, s[56:59], s96 offen offset:768
  v_and_b32_dpp v46, v27, v8 row_newbcast:8 row_mask:0xf bank_mask:0xf
  v_and_b32_dpp v47, v27, v9 row_newbcast:8 row_mask:0xf bank_mask:0xf
  v_and_b32_dpp v48, v27, v10 row_newbcast:8 row_mask:0xf bank_mask:0xf
  v_and_b32_dpp v49, v27, v11 row_newbcast:8 row_mask:0xf bank_mask:0xf
  s_waitcnt vmcnt(17)
  v_mfma_f32_16x16x32_bf16 v[38:41], v[132:135], v[50:53], v[38:41]
  v_mfma_f32_16x16x32_bf16 v[42:45], v[136:139], v[50:53], v[42:45]
  buffer_load_dwordx4 v[180:183], v5, s[48:51], s21 offen offset:2048 nt
  buffer_load_dwordx4 v[184:187], v5, s[48:51], s21 offen offset:2304 nt
  s_mov_b32 s96, 35840
  buffer_load_dwordx4 a[160:163], v6, s[56:59], s96 offen offset:0
  s_mov_b32 s96, 35840
  buffer_load_dwordx4 a[164:167], v6, s[56:59], s96 offen offset:256
  v_and_b32_dpp v50, v27, v8 row_newbcast:12 row_mask:0xf bank_mask:0xf
  v_and_b32_dpp v51, v27, v9 row_newbcast:12 row_mask:0xf bank_mask:0xf
  v_and_b32_dpp v52, v27, v10 row_newbcast:12 row_mask:0xf bank_mask:0xf
  v_and_b32_dpp v53, v27, v11 row_newbcast:12 row_mask:0xf bank_mask:0xf
  s_waitcnt vmcnt(18)
  v_mfma_f32_16x16x32_bf16 v[38:41], v[140:143], v[46:49], v[38:41]
  v_mfma_f32_16x16x32_bf16 v[42:45], v[144:147], v[46:49], v[42:45]
  s_add_u32 s21, s21, 16384
  s_cmp_eq_u32 s21, s20
  s_cselect_b32 s21, 0, s21
  buffer_load_dwordx4 v[188:191], v5, s[48:51], s21 offen offset:0 nt
  buffer_load_dwordx4 v[192:195], v5, s[48:51], s21 offen offset:256 nt
  s_mov_b32 s96, 35840
  buffer_load_dwordx4 a[168:171], v6, s[56:59], s96 offen offset:512
  v_and_b32_dpp v46, v28, v8 row_newbcast:0 row_mask:0xf bank_mask:0xf
  v_and_b32_dpp v47, v28, v9 row_newbcast:0 row_mask:0xf bank_mask:0xf
  v_and_b32_dpp v48, v28, v10 row_newbcast:0 row_mask:0xf bank_mask:0xf
  v_and_b32_dpp v49, v28, v11 row_newbcast:0 row_mask:0xf bank_mask:0xf
  s_waitcnt vmcnt(17)
  v_mfma_f32_16x16x32_bf16 v[38:41], v[148:151], v[50:53], v[38:41]
  v_mfma_f32_16x16x32_bf16 v[42:45], v[152:155], v[50:53], v[42:45]
  buffer_load_dwordx4 v[196:199], v5, s[48:51], s21 offen offset:2048 nt
  buffer_load_dwordx4 v[200:203], v5, s[48:51], s21 offen offset:2304 nt
  s_mov_b32 s96, 35840
  buffer_load_dwordx4 a[172:175], v7, s[56:59], s96 offen offset:768
  v_and_b32_dpp v50, v28, v8 row_newbcast:4 row_mask:0xf bank_mask:0xf
  v_and_b32_dpp v51, v28, v9 row_newbcast:4 row_mask:0xf bank_mask:0xf
  v_and_b32_dpp v52, v28, v10 row_newbcast:4 row_mask:0xf bank_mask:0xf
  v_and_b32_dpp v53, v28, v11 row_newbcast:4 row_mask:0xf bank_mask:0xf
  s_waitcnt vmcnt(17)
  v_mfma_f32_16x16x32_bf16 v[38:41], v[156:159], v[46:49], v[38:41]
  v_mfma_f32_16x16x32_bf16 v[42:45], v[160:163], v[46:49], v[42:45]
  s_add_u32 s21, s21, 16384
  s_cmp_eq_u32 s21, s20
  s_cselect_b32 s21, 0, s21
  buffer_load_dwordx4 v[204:207], v5, s[48:51], s21 offen offset:0 nt
  buffer_load_dwordx4 v[208:211], v5, s[48:51], s21 offen offset:256 nt
  s_mov_b32 s96, 39424
  buffer_load_dwordx4 a[176:179], v6, s[56:59], s96 offen offset:0
  v_and_b32_dpp v46, v28, v8 row_newbcast:8 row_mask:0xf bank_mask:0xf
  v_and_b32_dpp v47, v28, v9 row_newbcast:8 row_mask:0xf bank_mask:0xf
  v_and_b32_dpp v48, v28, v10 row_newbcast:8 row_mask:0xf bank_mask:0xf
  v_and_b32_dpp v49, v28, v11 row_newbcast:8 row_mask:0xf bank_mask:0xf
  s_waitcnt vmcnt(17)
  v_mfma_f32_16x16x32_bf16 v[38:41], v[164:167], v[50:53], v[38:41]
  v_mfma_f32_16x16x32_bf16 v[42:45], v[168:171], v[50:53], v[42:45]
  buffer_load_dwordx4 v[212:215], v5, s[48:51], s21 offen offset:2048 nt
  buffer_load_dwordx4 v[216:219], v5, s[48:51], s21 offen offset:2304 nt
  s_mov_b32 s96, 39424
  buffer_load_dwordx4 a[180:183], v6, s[56:59], s96 offen offset:256
  v_and_b32_dpp v50, v28, v8 row_newbcast:12 row_mask:0xf bank_mask:0xf
  v_and_b32_dpp v51, v28, v9 row_newbcast:12 row_mask:0xf bank_mask:0xf
  v_and_b32_dpp v52, v28, v10 row_newbcast:12 row_mask:0xf bank_mask:0xf
  v_and_b32_dpp v53, v28, v11 row_newbcast:12 row_mask:0xf bank_mask:0xf
  s_waitcnt vmcnt(17)
  v_mfma_f32_16x16x32_bf16 v[38:41], v[172:175], v[46:49], v[38:41]
  v_mfma_f32_16x16x32_bf16 v[42:45], v[176:179], v[46:49], v[42:45]
  s_add_u32 s21, s21, 16384
  s_cmp_eq_u32 s21, s20
  s_cselect_b32 s21, 0, s21
  buffer_load_dwordx4 v[220:223], v5, s[48:51], s21 offen offset:0 nt
  buffer_load_dwordx4 v[224:227], v5, s[48:51], s21 offen offset:256 nt
  s_mov_b32 s96, 39424
  buffer_load_dwordx4 a[184:187], v6, s[56:59], s96 offen offset:512
  s_mov_b32 s96, 39424
  buffer_load_dwordx4 a[188:191], v7, s[56:59], s96 offen offset:768
  v_and_b32_dpp v46, v29, v8 row_newbcast:0 row_mask:0xf bank_mask:0xf
  v_and_b32_dpp v47, v29, v9 row_newbcast:0 row_mask:0xf bank_mask:0xf
  v_and_b32_dpp v48, v29, v10 row_newbcast:0 row_mask:0xf bank_mask:0xf
  v_and_b32_dpp v49, v29, v11 row_newbcast:0 row_mask:0xf bank_mask:0xf
  s_waitcnt vmcnt(18)
  v_mfma_f32_16x16x32_bf16 v[38:41], v[180:183], v[50:53], v[38:41]
  v_mfma_f32_16x16x32_bf16 v[42:45], v[184:187], v[50:53], v[42:45]
  buffer_load_dwordx4 v[228:231], v5, s[48:51], s21 offen offset:2048 nt
  buffer_load_dwordx4 v[232:235], v5, s[48:51], s21 offen offset:2304 nt
  s_mov_b32 s96, 43008
  buffer_load_dwordx4 a[192:195], v6, s[56:59], s96 offen offset:0
  v_and_b32_dpp v50, v29, v8 row_newbcast:4 row_mask:0xf bank_mask:0xf
  v_and_b32_dpp v51, v29, v9 row_newbcast:4 row_mask:0xf bank_mask:0xf
  v_and_b32_dpp v52, v29, v10 row_newbcast:4 row_mask:0xf bank_mask:0xf
  v_and_b32_dpp v53, v29, v11 row_newbcast:4 row_mask:0xf bank_mask:0xf
  s_waitcnt vmcnt(17)
  v_mfma_f32_16x16x32_bf16 v[38:41], v[188:191], v[46:49], v[38:41]
  v_mfma_f32_16x16x32_bf16 v[42:45], v[192:195], v[46:49], v[42:45]
  s_add_u32 s21, s21, 16384
  s_cmp_eq_u32 s21, s20
  s_cselect_b32 s21, 0, s21
  buffer_load_dwordx4 v[236:239], v5, s[48:51], s21 offen offset:0 nt
  buffer_load_dwordx4 v[240:243], v5, s[48:51], s21 offen offset:256 nt
  s_mov_b32 s96, 43008
  buffer_load_dwordx4 a[196:199], v6, s[56:59], s96 offen offset:256
  v_and_b32_dpp v46, v29, v8 row_newbcast:8 row_mask:0xf bank_mask:0xf
  v_and_b32_dpp v47, v29, v9 row_newbcast:8 row_mask:0xf bank_mask:0xf
  v_and_b32_dpp v48, v29, v10 row_newbcast:8 row_mask:0xf bank_mask:0xf
  v_and_b32_dpp v49, v29, v11 row_newbcast:8 row_mask:0xf bank_mask:0xf
  s_waitcnt vmcnt(17)
  v_mfma_f32_16x16x32_bf16 v[38:41], v[196:199], v[50:53], v[38:41]
  v_mfma_f32_16x16x32_bf16 v[42:45], v[200:203], v[50:53], v[42:45]
  buffer_load_dwordx4 v[244:247], v5, s[48:51], s21 offen offset:2048 nt
  buffer_load_dwordx4 v[248:251], v5, s[48:51], s21 offen offset:2304 nt
  s_mov_b32 s96, 43008
  buffer_load_dwordx4 a[200:203], v6, s[56:59], s96 offen offset:512
  v_and_b32_dpp v50, v29, v8 row_newbcast:12 row_mask:0xf bank_mask:0xf
  v_and_b32_dpp v51, v29, v9 row_newbcast:12 row_mask:0xf bank_mask:0xf
  v_and_b32_dpp v52, v29, v10 row_newbcast:12 row_mask:0xf bank_mask:0xf
  v_and_b32_dpp v53, v29, v11 row_newbcast:12 row_mask:0xf bank_mask:0xf
  s_waitcnt vmcnt(17)
  v_mfma_f32_16x16x32_bf16 v[38:41], v[204:207], v[46:49], v[38:41]
  v_mfma_f32_16x16x32_bf16 v[42:45], v[208:211], v[46:49], v[42:45]
  s_add_u32 s21, s21, 16384
  s_cmp_eq_u32 s21, s20
  s_cselect_b32 s21, 0, s21
  buffer_load_dwordx4 v[252:255], v5, s[48:51], s21 offen offset:0 nt
  buffer_load_dwordx4 v[96:99], v5, s[48:51], s21 offen offset:256 nt
  s_mov_b32 s96, 43008
  buffer_load_dwordx4 a[204:207], v7, s[56:59], s96 offen offset:768
  v_and_b32_dpp v46, v30, v8 row_newbcast:0 row_mask:0xf bank_mask:0xf
  v_and_b32_dpp v47, v30, v9 row_newbcast:0 row_mask:0xf bank_mask:0xf
  v_and_b32_dpp v48, v30, v10 row_newbcast:0 row_mask:0xf bank_mask:0xf
  v_and_b32_dpp v49, v30, v11 row_newbcast:0 row_mask:0xf bank_mask:0xf
  s_waitcnt vmcnt(17)
  v_mfma_f32_16x16x32_bf16 v[38:41], v[212:215], v[50:53], v[38:41]
  v_mfma_f32_16x16x32_bf16 v[42:45], v[216:219], v[50:53], v[42:45]
  buffer_load_dwordx4 v[100:103], v5, s[48:51], s21 offen offset:2048 nt
  buffer_load_dwordx4 v[104:107], v5, s[48:51], s21 offen offset:2304 nt
  s_mov_b32 s96, 46592
  buffer_load_dwordx4 a[208:211], v6, s[56:59], s96 offen offset:0
  s_mov_b32 s96, 46592
  buffer_load_dwordx4 a[212:215], v6, s[56:59], s96 offen offset:256
  v_and_b32_dpp v50, v30, v8 row_newbcast:4 row_mask:0xf bank_mask:0xf
  v_and_b32_dpp v51, v30, v9 row_newbcast:4 row_mask:0xf bank_mask:0xf
  v_and_b32_dpp v52, v30, v10 row_newbcast:4 row_mask:0xf bank_mask:0xf
  v_and_b32_dpp v53, v30, v11 row_newbcast:4 row_mask:0xf bank_mask:0xf
  s_waitcnt vmcnt(18)
  v_mfma_f32_16x16x32_bf16 v[38:41], v[220:223], v[46:49], v[38:41]
  v_mfma_f32_16x16x32_bf16 v[42:45], v[224:227], v[46:49], v[42:45]
  s_add_u32 s21, s21, 16384
  s_cmp_eq_u32 s21, s20
  s_cselect_b32 s21, 0, s21
  buffer_load_dwordx4 v[108:111], v5, s[48:51], s21 offen offset:0 nt
  buffer_load_dwordx4 v[112:115], v5, s[48:51], s21 offen offset:256 nt
  s_mov_b32 s96, 46592
  buffer_load_dwordx4 a[216:219], v6, s[56:59], s96 offen offset:512
  v_and_b32_dpp v46, v30, v8 row_newbcast:8 row_mask:0xf bank_mask:0xf
  v_and_b32_dpp v47, v30, v9 row_newbcast:8 row_mask:0xf bank_mask:0xf
  v_and_b32_dpp v48, v30, v10 row_newbcast:8 row_mask:0xf bank_mask:0xf
  v_and_b32_dpp v49, v30, v11 row_newbcast:8 row_mask:0xf bank_mask:0xf
  s_waitcnt vmcnt(17)
  v_mfma_f32_16x16x32_bf16 v[38:41], v[228:231], v[50:53], v[38:41]
  v_mfma_f32_16x16x32_bf16 v[42:45], v[232:235], v[50:53], v[42:45]
  buffer_load_dwordx4 v[116:119], v5, s[48:51], s21 offen offset:2048 nt
  buffer_load_dwordx4 v[120:123], v5, s[48:51], s21 offen offset:2304 nt
  s_mov_b32 s96, 46592
  buffer_load_dwordx4 a[220:223], v7, s[56:59], s96 offen offset:768
  v_and_b32_dpp v50, v30, v8 row_newbcast:12 row_mask:0xf bank_mask:0xf
  v_and_b32_dpp v51, v30, v9 row_newbcast:12 row_mask:0xf bank_mask:0xf
  v_and_b32_dpp v52, v30, v10 row_newbcast:12 row_mask:0xf bank_mask:0xf
  v_and_b32_dpp v53, v30, v11 row_newbcast:12 row_mask:0xf bank_mask:0xf
  s_waitcnt vmcnt(17)
  v_mfma_f32_16x16x32_bf16 v[38:41], v[236:239], v[46:49], v[38:41]
  v_mfma_f32_16x16x32_bf16 v[42:45], v[240:243], v[46:49], v[42:45]
  s_add_u32 s21, s21, 16384
  s_cmp_eq_u32 s21, s20
  s_cselect_b32 s21, 0, s21
  buffer_load_dwordx4 v[124:127], v5, s[48:51], s21 offen offset:0 nt
  buffer_load_dwordx4 v[128:131], v5, s[48:51], s21 offen offset:256 nt
  s_mov_b32 s96, 50176
  buffer_load_dwordx4 a[224:227], v6, s[56:59], s96 offen offset:0
  v_and_b32_dpp v46, v31, v8 row_newbcast:0 row_mask:0xf bank_mask:0xf
  v_and_b32_dpp v47, v31, v9 row_newbcast:0 row_mask:0xf bank_mask:0xf
  v_and_b32_dpp v48, v31, v10 row_newbcast:0 row_mask:0xf bank_mask:0xf
  v_and_b32_dpp v49, v31, v11 row_newbcast:0 row_mask:0xf bank_mask:0xf
  s_waitcnt vmcnt(17)
  v_mfma_f32_16x16x32_bf16 v[38:41], v[244:247], v[50:53], v[38:41]
  v_mfma_f32_16x16x32_bf16 v[42:45], v[248:251], v[50:53], v[42:45]
  buffer_load_dwordx4 v[132:135], v5, s[48:51], s21 offen offset:2048 nt
  buffer_load_dwordx4 v[136:139], v5, s[48:51], s21 offen offset:2304 nt
  s_mov_b32 s96, 50176
  buffer_load_dwordx4 a[228:231], v6, s[56:59], s96 offen offset:256
  v_and_b32_dpp v50, v31, v8 row_newbcast:4 row_mask:0xf bank_mask:0xf
  v_and_b32_dpp v51, v31, v9 row_newbcast:4 row_mask:0xf bank_mask:0xf
  v_and_b32_dpp v52, v31, v10 row_newbcast:4 row_mask:0xf bank_mask:0xf
  v_and_b32_dpp v53, v31, v11 row_newbcast:4 row_mask:0xf bank_mask:0xf
  s_waitcnt vmcnt(17)
  v_mfma_f32_16x16x32_bf16 v[38:41], v[252:255], v[46:49], v[38:41]
  v_mfma_f32_16x16x32_bf16 v[42:45], v[96:99], v[46:49], v[42:45]
  s_add_u32 s21, s21, 16384
  s_cmp_eq_u32 s21, s20
  s_cselect_b32 s21, 0, s21
  buffer_load_dwordx4 v[140:143], v5, s[48:51], s21 offen offset:0 nt
  buffer_load_dwordx4 v[144:147], v5, s[48:51], s21 offen offset:256 nt
  s_mov_b32 s96, 50176
  buffer_load_dwordx4 a[232:235], v6, s[56:59], s96 offen offset:512
  s_mov_b32 s96, 50176
  buffer_load_dwordx4 a[236:239], v7, s[56:59], s96 offen offset:768
  v_and_b32_dpp v46, v31, v8 row_newbcast:8 row_mask:0xf bank_mask:0xf
  v_and_b32_dpp v47, v31, v9 row_newbcast:8 row_mask:0xf bank_mask:0xf
  v_and_b32_dpp v48, v31, v10 row_newbcast:8 row_mask:0xf bank_mask:0xf
  v_and_b32_dpp v49, v31, v11 row_newbcast:8 row_mask:0xf bank_mask:0xf
  s_waitcnt vmcnt(18)
  v_mfma_f32_16x16x32_bf16 v[38:41], v[100:103], v[50:53], v[38:41]
  v_mfma_f32_16x16x32_bf16 v[42:45], v[104:107], v[50:53], v[42:45]
  buffer_load_dwordx4 v[148:151], v5, s[48:51], s21 offen offset:2048 nt
  buffer_load_dwordx4 v[152:155], v5, s[48:51], s21 offen offset:2304 nt
  s_mov_b32 s96, 53760
  buffer_load_dwordx4 a[240:243], v6, s[56:59], s96 offen offset:0
  v_and_b32_dpp v50, v31, v8 row_newbcast:12 row_mask:0xf bank_mask:0xf
  v_and_b32_dpp v51, v31, v9 row_newbcast:12 row_mask:0xf bank_mask:0xf
  v_and_b32_dpp v52, v31, v10 row_newbcast:12 row_mask:0xf bank_mask:0xf
  v_and_b32_dpp v53, v31, v11 row_newbcast:12 row_mask:0xf bank_mask:0xf
  s_waitcnt vmcnt(17)
  v_mfma_f32_16x16x32_bf16 v[38:41], v[108:111], v[46:49], v[38:41]
  v_mfma_f32_16x16x32_bf16 v[42:45], v[112:115], v[46:49], v[42:45]
  s_add_u32 s21, s21, 16384
  s_cmp_eq_u32 s21, s20
  s_cselect_b32 s21, 0, s21
  buffer_load_dwordx4 v[156:159], v5, s[48:51], s21 offen offset:0 nt
  buffer_load_dwordx4 v[160:163], v5, s[48:51], s21 offen offset:256 nt
  s_mov_b32 s96, 53760
  buffer_load_dwordx4 a[244:247], v6, s[56:59], s96 offen offset:256
  v_lshrrev_b32 v80, 2, v1
  v_lshl_add_u32 v87, v80, 12, v94
  s_cmp_eq_u32 s3, 0
  s_cselect_b32 s12, 0, 0x40000000
  v_add_u32 v87, s12, v87
  v_add_u32 v88, 65536, v87
  v_mov_b32 v83, 0x7ff00000
  v_cmp_gt_u32 vcc, 12, v80
  s_nop 1
  v_cndmask_b32 v88, v83, v88, vcc
  buffer_load_dword v12, v87, s[64:67], s99 offen offset:0 sc1
  buffer_load_dword v13, v87, s[64:67], s99 offen offset:16 sc1
  buffer_load_dword v14, v87, s[64:67], s99 offen offset:32 sc1
  buffer_load_dword v15, v87, s[64:67], s99 offen offset:48 sc1
  buffer_load_dword v16, v88, s[64:67], s99 offen offset:0 sc1
  buffer_load_dword v17, v88, s[64:67], s99 offen offset:16 sc1
  buffer_load_dword v18, v88, s[64:67], s99 offen offset:32 sc1
  buffer_load_dword v19, v88, s[64:67], s99 offen offset:48 sc1
  v_lshrrev_b32 v80, 2, v1
  v_lshlrev_b32 v80, 6, v80
  s_cmp_eq_u32 s3, 0
  s_cselect_b32 s12, 0, 0x40000000
  v_add_u32 v80, s12, v80
  s_lshl_b32 s12, s97, 10
  s_add_u32 s12, s12, 786432
  buffer_load_dwordx4 v[54:57], v80, s[64:67], s12 offen offset:0 sc1
  buffer_load_dwordx4 v[58:61], v80, s[64:67], s12 offen offset:16 sc1
  buffer_load_dwordx4 v[62:65], v80, s[64:67], s12 offen offset:32 sc1
  buffer_load_dwordx4 v[66:69], v80, s[64:67], s12 offen offset:48 sc1
  v_and_b32_dpp v46, v32, v8 row_newbcast:0 row_mask:0xf bank_mask:0xf
  v_and_b32_dpp v47, v32, v9 row_newbcast:0 row_mask:0xf bank_mask:0xf
  v_and_b32_dpp v48, v32, v10 row_newbcast:0 row_mask:0xf bank_mask:0xf
  v_and_b32_dpp v49, v32, v11 row_newbcast:0 row_mask:0xf bank_mask:0xf
  s_waitcnt vmcnt(29)
  v_mfma_f32_16x16x32_bf16 v[38:41], v[116:119], v[50:53], v[38:41]
  v_mfma_f32_16x16x32_bf16 v[42:45], v[120:123], v[50:53], v[42:45]
  buffer_load_dwordx4 v[164:167], v5, s[48:51], s21 offen offset:2048 nt
  buffer_load_dwordx4 v[168:171], v5, s[48:51], s21 offen offset:2304 nt
  s_mov_b32 s96, 53760
  buffer_load_dwordx4 a[248:251], v6, s[56:59], s96 offen offset:512
  v_and_b32_dpp v50, v32, v8 row_newbcast:4 row_mask:0xf bank_mask:0xf
  v_and_b32_dpp v51, v32, v9 row_newbcast:4 row_mask:0xf bank_mask:0xf
  v_and_b32_dpp v52, v32, v10 row_newbcast:4 row_mask:0xf bank_mask:0xf
  v_and_b32_dpp v53, v32, v11 row_newbcast:4 row_mask:0xf bank_mask:0xf
  s_waitcnt vmcnt(29)
  v_mfma_f32_16x16x32_bf16 v[38:41], v[124:127], v[46:49], v[38:41]
  v_mfma_f32_16x16x32_bf16 v[42:45], v[128:131], v[46:49], v[42:45]
  s_add_u32 s21, s21, 16384
  s_cmp_eq_u32 s21, s20
  s_cselect_b32 s21, 0, s21
  buffer_load_dwordx4 v[172:175], v5, s[48:51], s21 offen offset:0 nt
  buffer_load_dwordx4 v[176:179], v5, s[48:51], s21 offen offset:256 nt
  s_mov_b32 s96, 53760
  buffer_load_dwordx4 a[252:255], v7, s[56:59], s96 offen offset:768
  v_and_b32_dpp v46, v32, v8 row_newbcast:8 row_mask:0xf bank_mask:0xf
  v_and_b32_dpp v47, v32, v9 row_newbcast:8 row_mask:0xf bank_mask:0xf
  v_and_b32_dpp v48, v32, v10 row_newbcast:8 row_mask:0xf bank_mask:0xf
  v_and_b32_dpp v49, v32, v11 row_newbcast:8 row_mask:0xf bank_mask:0xf
  s_waitcnt vmcnt(29)
  v_mfma_f32_16x16x32_bf16 v[38:41], v[132:135], v[50:53], v[38:41]
  v_mfma_f32_16x16x32_bf16 v[42:45], v[136:139], v[50:53], v[42:45]
  buffer_load_dwordx4 v[180:183], v5, s[48:51], s21 offen offset:2048 nt
  buffer_load_dwordx4 v[184:187], v5, s[48:51], s21 offen offset:2304 nt
  v_and_b32_dpp v50, v32, v8 row_newbcast:12 row_mask:0xf bank_mask:0xf
  v_and_b32_dpp v51, v32, v9 row_newbcast:12 row_mask:0xf bank_mask:0xf
  v_and_b32_dpp v52, v32, v10 row_newbcast:12 row_mask:0xf bank_mask:0xf
  v_and_b32_dpp v53, v32, v11 row_newbcast:12 row_mask:0xf bank_mask:0xf
  s_waitcnt vmcnt(28)
  v_mfma_f32_16x16x32_bf16 v[38:41], v[140:143], v[46:49], v[38:41]
  v_mfma_f32_16x16x32_bf16 v[42:45], v[144:147], v[46:49], v[42:45]
  s_add_u32 s21, s21, 16384
  s_cmp_eq_u32 s21, s20
  s_cselect_b32 s21, 0, s21
  buffer_load_dwordx4 v[188:191], v5, s[48:51], s21 offen offset:0 nt
  buffer_load_dwordx4 v[192:195], v5, s[48:51], s21 offen offset:256 nt
  s_waitcnt vmcnt(14)
  v_max3_u32 v86, v12, v13, v14
  v_max3_u32 v86, v86, v15, v16
  v_max3_u32 v86, v86, v17, v18
  v_max_u32 v86, v86, v19
  v_cmp_eq_u32 vcc, -1, v86
  s_nop 4
  s_cbranch_vccz L_ryb_okR
  s_mov_b32 s93, 0
L_ryb_spinR:
  buffer_load_dword v12, v87, s[64:67], s99 offen offset:0 sc1
  buffer_load_dword v13, v87, s[64:67], s99 offen offset:16 sc1
  buffer_load_dword v14, v87, s[64:67], s99 offen offset:32 sc1
  buffer_load_dword v15, v87, s[64:67], s99 offen offset:48 sc1
  buffer_load_dword v16, v88, s[64:67], s99 offen offset:0 sc1
  buffer_load_dword v17, v88, s[64:67], s99 offen offset:16 sc1
  buffer_load_dword v18, v88, s[64:67], s99 offen offset:32 sc1
  buffer_load_dword v19, v88, s[64:67], s99 offen offset:48 sc1
  s_waitcnt vmcnt(0)
  v_max3_u32 v86, v12, v13, v14
  v_max3_u32 v86, v86, v15, v16
  v_max3_u32 v86, v86, v17, v18
  v_max_u32 v86, v86, v19
  v_cmp_eq_u32 vcc, -1, v86
  s_nop 4
  s_cbranch_vccz L_ryb_okR
  s_add_u32 s93, s93, 1
  s_cmp_lt_u32 s93, 0x40000
  s_cbranch_scc0 L_ryb_okR
  s_sleep 4
  s_branch L_ryb_spinR
L_ryb_okR:
  v_sub_f32 v85, 1.0, v70
  v_add_f32 v12, v12, v16
  v_add_f32 v13, v13, v17
  v_add_f32 v14, v14, v18
  v_add_f32 v15, v15, v19
  v_mul_f32 v12, v12, v85
  v_mul_f32 v13, v13, v85
  v_mul_f32 v14, v14, v85
  v_mul_f32 v15, v15, v85
  s_waitcnt vmcnt(10)
  v_max3_u32 v81, v54, v55, v56
  v_max3_u32 v81, v81, v57, v58
  v_max3_u32 v81, v81, v59, v60
  v_max3_u32 v81, v81, v61, v62
  v_max3_u32 v81, v81, v63, v64
  v_max3_u32 v81, v81, v65, v66
  v_max3_u32 v81, v81, v67, v68
  v_max_u32 v81, v81, v69
  v_cmp_eq_u32 vcc, -1, v81
  s_nop 4
  s_cbranch_vccz L_rml_okR
  s_mov_b32 s93, 0
L_rml_spinR:
  s_lshl_b32 s12, s97, 10
  s_add_u32 s12, s12, 786432
  buffer_load_dwordx4 v[54:57], v80, s[64:67], s12 offen offset:0 sc1
  buffer_load_dwordx4 v[58:61], v80, s[64:67], s12 offen offset:16 sc1
  buffer_load_dwordx4 v[62:65], v80, s[64:67], s12 offen offset:32 sc1
  buffer_load_dwordx4 v[66:69], v80, s[64:67], s12 offen offset:48 sc1
  s_waitcnt vmcnt(0)
  v_max3_u32 v81, v54, v55, v56
  v_max3_u32 v81, v81, v57, v58
  v_max3_u32 v81, v81, v59, v60
  v_max3_u32 v81, v81, v61, v62
  v_max3_u32 v81, v81, v63, v64
  v_max3_u32 v81, v81, v65, v66
  v_max3_u32 v81, v81, v67, v68
  v_max_u32 v81, v81, v69
  v_cmp_eq_u32 vcc, -1, v81
  s_nop 4
  s_cbranch_vccz L_rml_okR
  s_add_u32 s93, s93, 1
  s_cmp_lt_u32 s93, 0x40000
  s_cbranch_scc0 L_rml_okR
  s_sleep 4
  s_branch L_rml_spinR
L_rml_okR:
  v_max3_f32 v81, v54, v56, v58
  v_max3_f32 v81, v81, v60, v62
  v_max3_f32 v81, v81, v64, v66
  v_max_f32 v81, v81, v68
  v_sub_f32 v54, v54, v81
  v_sub_f32 v56, v56, v81
  v_sub_f32 v58, v58, v81
  v_sub_f32 v60, v60, v81
  v_sub_f32 v62, v62, v81
  v_sub_f32 v64, v64, v81
  v_sub_f32 v66, v66, v81
  v_sub_f32 v68, v68, v81
  v_exp_f32 v54, v54
  v_exp_f32 v56, v56
  v_exp_f32 v58, v58
  v_exp_f32 v60, v60
  v_exp_f32 v62, v62
  v_exp_f32 v64, v64
  v_exp_f32 v66, v66
  v_exp_f32 v68, v68
  v_mul_f32 v82, v54, v55
  v_fmac_f32 v82, v56, v57
  v_fmac_f32 v82, v58, v59
  v_fmac_f32 v82, v60, v61
  v_fmac_f32 v82, v62, v63
  v_fmac_f32 v82, v64, v65
  v_fmac_f32 v82, v66, v67
  v_fmac_f32 v82, v68, v69
  v_rcp_f32 v82, v82
  s_nop 0
  v_mul_f32 v82, v82, v70
  v_mul_f32 v70, v54, v82
  v_mul_f32 v71, v56, v82
  v_mul_f32 v72, v58, v82
  v_mul_f32 v73, v60, v82
  v_mul_f32 v74, v62, v82
  v_mul_f32 v75, v64, v82
  v_mul_f32 v76, v66, v82
  v_mul_f32 v77, v68, v82
  v_and_b32_dpp v46, v33, v8 row_newbcast:0 row_mask:0xf bank_mask:0xf
  v_and_b32_dpp v47, v33, v9 row_newbcast:0 row_mask:0xf bank_mask:0xf
  v_and_b32_dpp v48, v33, v10 row_newbcast:0 row_mask:0xf bank_mask:0xf
  v_and_b32_dpp v49, v33, v11 row_newbcast:0 row_mask:0xf bank_mask:0xf
  v_mfma_f32_16x16x32_bf16 v[38:41], v[148:151], v[50:53], v[38:41]
  v_mfma_f32_16x16x32_bf16 v[42:45], v[152:155], v[50:53], v[42:45]
  buffer_load_dwordx4 v[196:199], v5, s[48:51], s21 offen offset:2048 nt
  buffer_load_dwordx4 v[200:203], v5, s[48:51], s21 offen offset:2304 nt
  v_and_b32_dpp v50, v33, v8 row_newbcast:4 row_mask:0xf bank_mask:0xf
  v_and_b32_dpp v51, v33, v9 row_newbcast:4 row_mask:0xf bank_mask:0xf
  v_and_b32_dpp v52, v33, v10 row_newbcast:4 row_mask:0xf bank_mask:0xf
  v_and_b32_dpp v53, v33, v11 row_newbcast:4 row_mask:0xf bank_mask:0xf
  v_mfma_f32_16x16x32_bf16 v[38:41], v[156:159], v[46:49], v[38:41]
  v_mfma_f32_16x16x32_bf16 v[42:45], v[160:163], v[46:49], v[42:45]
  s_add_u32 s21, s21, 16384
  s_cmp_eq_u32 s21, s20
  s_cselect_b32 s21, 0, s21
  buffer_load_dwordx4 v[204:207], v5, s[48:51], s21 offen offset:0 nt
  buffer_load_dwordx4 v[208:211], v5, s[48:51], s21 offen offset:256 nt
  v_and_b32_dpp v46, v33, v8 row_newbcast:8 row_mask:0xf bank_mask:0xf
  v_and_b32_dpp v47, v33, v9 row_newbcast:8 row_mask:0xf bank_mask:0xf
  v_and_b32_dpp v48, v33, v10 row_newbcast:8 row_mask:0xf bank_mask:0xf
  v_and_b32_dpp v49, v33, v11 row_newbcast:8 row_mask:0xf bank_mask:0xf
  s_waitcnt vmcnt(12)
  v_mfma_f32_16x16x32_bf16 v[38:41], v[164:167], v[50:53], v[38:41]
  v_mfma_f32_16x16x32_bf16 v[42:45], v[168:171], v[50:53], v[42:45]
  buffer_load_dwordx4 v[212:215], v5, s[48:51], s21 offen offset:2048 nt
  buffer_load_dwordx4 v[216:219], v5, s[48:51], s21 offen offset:2304 nt
  v_and_b32_dpp v50, v33, v8 row_newbcast:12 row_mask:0xf bank_mask:0xf
  v_and_b32_dpp v51, v33, v9 row_newbcast:12 row_mask:0xf bank_mask:0xf
  v_and_b32_dpp v52, v33, v10 row_newbcast:12 row_mask:0xf bank_mask:0xf
  v_and_b32_dpp v53, v33, v11 row_newbcast:12 row_mask:0xf bank_mask:0xf
  s_waitcnt vmcnt(11)
  v_mfma_f32_16x16x32_bf16 v[38:41], v[172:175], v[46:49], v[38:41]
  v_mfma_f32_16x16x32_bf16 v[42:45], v[176:179], v[46:49], v[42:45]
  s_add_u32 s21, s21, 16384
  s_cmp_eq_u32 s21, s20
  s_cselect_b32 s21, 0, s21
  buffer_load_dwordx4 v[220:223], v5, s[48:51], s21 offen offset:0 nt
  buffer_load_dwordx4 v[224:227], v5, s[48:51], s21 offen offset:256 nt
  v_and_b32_dpp v46, v34, v8 row_newbcast:0 row_mask:0xf bank_mask:0xf
  v_and_b32_dpp v47, v34, v9 row_newbcast:0 row_mask:0xf bank_mask:0xf
  v_and_b32_dpp v48, v34, v10 row_newbcast:0 row_mask:0xf bank_mask:0xf
  v_and_b32_dpp v49, v34, v11 row_newbcast:0 row_mask:0xf bank_mask:0xf
  s_waitcnt vmcnt(10)
  v_mfma_f32_16x16x32_bf16 v[38:41], v[180:183], v[50:53], v[38:41]
  v_mfma_f32_16x16x32_bf16 v[42:45], v[184:187], v[50:53], v[42:45]
  buffer_load_dwordx4 v[228:231], v5, s[48:51], s21 offen offset:2048 nt
  buffer_load_dwordx4 v[232:235], v5, s[48:51], s21 offen offset:2304 nt
  v_and_b32_dpp v50, v34, v8 row_newbcast:4 row_mask:0xf bank_mask:0xf
  v_and_b32_dpp v51, v34, v9 row_newbcast:4 row_mask:0xf bank_mask:0xf
  v_and_b32_dpp v52, v34, v10 row_newbcast:4 row_mask:0xf bank_mask:0xf
  v_and_b32_dpp v53, v34, v11 row_newbcast:4 row_mask:0xf bank_mask:0xf
  s_waitcnt vmcnt(10)
  v_mfma_f32_16x16x32_bf16 v[38:41], v[188:191], v[46:49], v[38:41]
  v_mfma_f32_16x16x32_bf16 v[42:45], v[192:195], v[46:49], v[42:45]
  s_add_u32 s21, s21, 16384
  s_cmp_eq_u32 s21, s20
  s_cselect_b32 s21, 0, s21
  buffer_load_dwordx4 v[236:239], v5, s[48:51], s21 offen offset:0 nt
  buffer_load_dwordx4 v[240:243], v5, s[48:51], s21 offen offset:256 nt
  v_lshrrev_b32 v80, 1, v2
  v_lshl_add_u32 v80, v3, 4, v80
  v_lshlrev_b32 v80, 5, v80
  v_and_b32 v81, 1, v2
  v_lshl_add_u32 v80, v81, 2, v80
  s_lshl_b32 s12, s3, 3
  s_add_u32 s12, s12, 4096
  v_add_u32 v80, s12, v80
  v_add_u32 v81, 2048, v80
  v_lshrrev_b32 v82, 2, v2
  v_lshlrev_b32 v82, 1, v82
  v_and_b32 v83, 1, v3
  v_add_u32 v82, v82, v83
  v_lshlrev_b32 v82, 5, v82
  s_lshl_b32 s13, s3, 10
  s_add_u32 s13, s13, 4096
  v_add_u32 v82, s13, v82
  v_lshlrev_b32 v83, 4, v1
  s_lshl_b32 s14, s3, 11
  v_add_u32 v83, s14, v83
  v_and_b32 v85, 127, v0
  v_lshlrev_b32 v85, 4, v85
  v_and_b32 v84, 0x68, v0
  v_mov_b32 v86, 0x68
  v_cmp_ne_u32 vcc, v84, v86
  v_mov_b32 v87, 0x7ff00000
  s_nop 0
  v_cndmask_b32 v86, v87, v85, vcc
  v_mov_b32 v84, 128
  v_cmp_gt_u32 vcc, v84, v0
  s_nop 1
  v_cndmask_b32 v86, v87, v86, vcc
  s_lshl_b32 s15, s10, 11
  s_add_u32 s15, s15, 262144
  v_bfe_u32 v90, v2, 2, 1
  v_lshrrev_b32 v87, 1, v3
  v_lshrrev_b32 v88, 3, v2
  v_cmp_eq_u32 s[94:95], v87, v88
  v_cmp_eq_u32 vcc, 0, v90
  s_nop 2
  s_and_b64 vcc, vcc, s[94:95]
  v_mov_b32 v89, 0xffff
  v_cndmask_b32 v62, 0, v89, vcc
  v_cmp_eq_u32 vcc, 1, v90
  s_nop 2
  s_and_b64 vcc, vcc, s[94:95]
  v_mov_b32 v89, 0xffff
  v_cndmask_b32 v63, 0, v89, vcc
  v_cmp_eq_u32 vcc, 0, v90
  s_nop 2
  s_and_b64 vcc, vcc, s[94:95]
  v_mov_b32 v89, 0xffff0000
  v_cndmask_b32 v64, 0, v89, vcc
  v_cmp_eq_u32 vcc, 1, v90
  s_nop 2
  s_and_b64 vcc, vcc, s[94:95]
  v_mov_b32 v89, 0xffff0000
  v_cndmask_b32 v65, 0, v89, vcc
  v_and_b32 v90, 3, v2
  v_add_u32 v87, 1, v90
  v_and_b32 v87, 3, v87
  v_lshl_or_b32 v88, v87, 2, v90
  v_lshl_or_b32 v89, v90, 2, v87
  v_lshl_or_b32 v88, v88, 4, v88
  v_lshl_or_b32 v89, v89, 4, v89
  v_lshl_or_b32 v66, v89, 8, v88
  v_mov_b32 v54, 0
  v_mov_b32 v55, 0
  v_mov_b32 v56, 0
  v_mov_b32 v57, 0
  v_mov_b32 v58, 0
  v_mov_b32 v59, 0
  v_mov_b32 v60, 0
  v_mov_b32 v61, 0
  v_and_b32_dpp v46, v34, v8 row_newbcast:8 row_mask:0xf bank_mask:0xf
  v_and_b32_dpp v47, v34, v9 row_newbcast:8 row_mask:0xf bank_mask:0xf
  v_and_b32_dpp v48, v34, v10 row_newbcast:8 row_mask:0xf bank_mask:0xf
  v_and_b32_dpp v49, v34, v11 row_newbcast:8 row_mask:0xf bank_mask:0xf
  s_waitcnt vmcnt(10)
  v_mfma_f32_16x16x32_bf16 v[38:41], v[196:199], v[50:53], v[38:41]
  v_mfma_f32_16x16x32_bf16 v[42:45], v[200:203], v[50:53], v[42:45]
  buffer_load_dwordx4 v[244:247], v5, s[48:51], s21 offen offset:2048 nt
  buffer_load_dwordx4 v[248:251], v5, s[48:51], s21 offen offset:2304 nt
  v_and_b32_dpp v50, v34, v8 row_newbcast:12 row_mask:0xf bank_mask:0xf
  v_and_b32_dpp v51, v34, v9 row_newbcast:12 row_mask:0xf bank_mask:0xf
  v_and_b32_dpp v52, v34, v10 row_newbcast:12 row_mask:0xf bank_mask:0xf
  v_and_b32_dpp v53, v34, v11 row_newbcast:12 row_mask:0xf bank_mask:0xf
  s_waitcnt vmcnt(10)
  v_mfma_f32_16x16x32_bf16 v[38:41], v[204:207], v[46:49], v[38:41]
  v_mfma_f32_16x16x32_bf16 v[42:45], v[208:211], v[46:49], v[42:45]
  v_and_b32_dpp v46, v35, v8 row_newbcast:0 row_mask:0xf bank_mask:0xf
  v_and_b32_dpp v47, v35, v9 row_newbcast:0 row_mask:0xf bank_mask:0xf
  v_and_b32_dpp v48, v35, v10 row_newbcast:0 row_mask:0xf bank_mask:0xf
  v_and_b32_dpp v49, v35, v11 row_newbcast:0 row_mask:0xf bank_mask:0xf
  s_waitcnt vmcnt(8)
  v_mfma_f32_16x16x32_bf16 v[38:41], v[212:215], v[50:53], v[38:41]
  v_mfma_f32_16x16x32_bf16 v[42:45], v[216:219], v[50:53], v[42:45]
  v_and_b32_dpp v50, v35, v8 row_newbcast:4 row_mask:0xf bank_mask:0xf
  v_and_b32_dpp v51, v35, v9 row_newbcast:4 row_mask:0xf bank_mask:0xf
  v_and_b32_dpp v52, v35, v10 row_newbcast:4 row_mask:0xf bank_mask:0xf
  v_and_b32_dpp v53, v35, v11 row_newbcast:4 row_mask:0xf bank_mask:0xf
  s_waitcnt vmcnt(6)
  v_mfma_f32_16x16x32_bf16 v[38:41], v[220:223], v[46:49], v[38:41]
  v_mfma_f32_16x16x32_bf16 v[42:45], v[224:227], v[46:49], v[42:45]
  v_and_b32_dpp v46, v35, v8 row_newbcast:8 row_mask:0xf bank_mask:0xf
  v_and_b32_dpp v47, v35, v9 row_newbcast:8 row_mask:0xf bank_mask:0xf
  v_and_b32_dpp v48, v35, v10 row_newbcast:8 row_mask:0xf bank_mask:0xf
  v_and_b32_dpp v49, v35, v11 row_newbcast:8 row_mask:0xf bank_mask:0xf
  s_waitcnt vmcnt(4)
  v_mfma_f32_16x16x32_bf16 v[38:41], v[228:231], v[50:53], v[38:41]
  v_mfma_f32_16x16x32_bf16 v[42:45], v[232:235], v[50:53], v[42:45]
  v_and_b32_dpp v50, v35, v8 row_newbcast:12 row_mask:0xf bank_mask:0xf
  v_and_b32_dpp v51, v35, v9 row_newbcast:12 row_mask:0xf bank_mask:0xf
  v_and_b32_dpp v52, v35, v10 row_newbcast:12 row_mask:0xf bank_mask:0xf
  v_and_b32_dpp v53, v35, v11 row_newbcast:12 row_mask:0xf bank_mask:0xf
  s_waitcnt vmcnt(2)
  v_mfma_f32_16x16x32_bf16 v[38:41], v[236:239], v[46:49], v[38:41]
  v_mfma_f32_16x16x32_bf16 v[42:45], v[240:243], v[46:49], v[42:45]
  s_waitcnt vmcnt(0)
  v_mfma_f32_16x16x32_bf16 v[38:41], v[244:247], v[50:53], v[38:41]
  v_mfma_f32_16x16x32_bf16 v[42:45], v[248:251], v[50:53], v[42:45]
  s_mov_b32 exec_lo, 0x00ff00ff
  s_mov_b32 exec_hi, 0x00ff00ff
  s_nop 4
  ds_write2_b32 v80, v38, v39 offset0:0 offset1:32
  ds_write2_b32 v80, v40, v41 offset0:64 offset1:96
  ds_write2_b32 v81, v42, v43 offset0:0 offset1:32
  ds_write2_b32 v81, v44, v45 offset0:64 offset1:96
  s_mov_b64 exec, -1
  s_waitcnt lgkmcnt(0)
  s_barrier
  ds_read_b128 v[20:23], v82 offset:0
  ds_read_b128 v[24:27], v82 offset:16
  ds_read_b128 v[28:31], v82 offset:256
  ds_read_b128 v[32:35], v82 offset:272
  ds_read_b128 v[38:41], v82 offset:512
  ds_read_b128 v[42:45], v82 offset:528
  ds_read_b128 v[46:49], v82 offset:768
  ds_read_b128 v[50:53], v82 offset:784
  s_waitcnt vmcnt(0)
  s_waitcnt lgkmcnt(6)
  v_pk_add_f32 v[20:21], v[20:21], v[22:23]
  v_pk_add_f32 v[24:25], v[24:25], v[26:27]
  v_pk_add_f32 v[20:21], v[20:21], v[24:25]
  v_cvt_pk_bf16_f32 v36, v20, v21
  s_waitcnt lgkmcnt(4)
  v_pk_add_f32 v[28:29], v[28:29], v[30:31]
  v_pk_add_f32 v[32:33], v[32:33], v[34:35]
  v_pk_add_f32 v[28:29], v[28:29], v[32:33]
  v_cvt_pk_bf16_f32 v37, v28, v29
  s_waitcnt lgkmcnt(2)
  v_pk_add_f32 v[38:39], v[38:39], v[40:41]
  v_pk_add_f32 v[42:43], v[42:43], v[44:45]
  v_pk_add_f32 v[38:39], v[38:39], v[42:43]
  v_cvt_pk_bf16_f32 v88, v38, v39
  s_waitcnt lgkmcnt(0)
  v_pk_add_f32 v[46:47], v[46:47], v[48:49]
  v_pk_add_f32 v[50:51], v[50:51], v[52:53]
  v_pk_add_f32 v[46:47], v[46:47], v[50:51]
  v_cvt_pk_bf16_f32 v89, v46, v47
  s_nop 0
  v_and_b32_dpp v46, v36, v62 row_newbcast:0 row_mask:0xf bank_mask:0xf
  v_and_b32_dpp v47, v36, v63 row_newbcast:0 row_mask:0xf bank_mask:0xf
  v_and_b32_dpp v48, v36, v64 row_newbcast:0 row_mask:0xf bank_mask:0xf
  v_and_b32_dpp v49, v36, v65 row_newbcast:0 row_mask:0xf bank_mask:0xf
  v_and_b32_dpp v50, v36, v62 row_newbcast:4 row_mask:0xf bank_mask:0xf
  v_and_b32_dpp v51, v36, v63 row_newbcast:4 row_mask:0xf bank_mask:0xf
  v_smfmac_f32_16x16x64_bf16 v[54:57], v[46:49], a[0:7], v66
  v_and_b32_dpp v52, v36, v64 row_newbcast:4 row_mask:0xf bank_mask:0xf
  v_and_b32_dpp v53, v36, v65 row_newbcast:4 row_mask:0xf bank_mask:0xf
  v_smfmac_f32_16x16x64_bf16 v[58:61], v[46:49], a[8:15], v66
  v_and_b32_dpp v46, v36, v62 row_newbcast:8 row_mask:0xf bank_mask:0xf
  v_and_b32_dpp v47, v36, v63 row_newbcast:8 row_mask:0xf bank_mask:0xf
  v_smfmac_f32_16x16x64_bf16 v[54:57], v[50:53], a[16:23], v66
  v_and_b32_dpp v48, v36, v64 row_newbcast:8 row_mask:0xf bank_mask:0xf
  v_and_b32_dpp v49, v36, v65 row_newbcast:8 row_mask:0xf bank_mask:0xf
  v_smfmac_f32_16x16x64_bf16 v[58:61], v[50:53], a[24:31], v66
  v_and_b32_dpp v50, v36, v62 row_newbcast:12 row_mask:0xf bank_mask:0xf
  v_and_b32_dpp v51, v36, v63 row_newbcast:12 row_mask:0xf bank_mask:0xf
  v_smfmac_f32_16x16x64_bf16 v[54:57], v[46:49], a[32:39], v66
  v_and_b32_dpp v52, v36, v64 row_newbcast:12 row_mask:0xf bank_mask:0xf
  v_and_b32_dpp v53, v36, v65 row_newbcast:12 row_mask:0xf bank_mask:0xf
  v_smfmac_f32_16x16x64_bf16 v[58:61], v[46:49], a[40:47], v66
  v_and_b32_dpp v46, v37, v62 row_newbcast:0 row_mask:0xf bank_mask:0xf
  v_and_b32_dpp v47, v37, v63 row_newbcast:0 row_mask:0xf bank_mask:0xf
  v_smfmac_f32_16x16x64_bf16 v[54:57], v[50:53], a[48:55], v66
  v_and_b32_dpp v48, v37, v64 row_newbcast:0 row_mask:0xf bank_mask:0xf
  v_and_b32_dpp v49, v37, v65 row_newbcast:0 row_mask:0xf bank_mask:0xf
  v_smfmac_f32_16x16x64_bf16 v[58:61], v[50:53], a[56:63], v66
  v_and_b32_dpp v50, v37, v62 row_newbcast:4 row_mask:0xf bank_mask:0xf
  v_and_b32_dpp v51, v37, v63 row_newbcast:4 row_mask:0xf bank_mask:0xf
  v_smfmac_f32_16x16x64_bf16 v[54:57], v[46:49], a[64:71], v66
  v_and_b32_dpp v52, v37, v64 row_newbcast:4 row_mask:0xf bank_mask:0xf
  v_and_b32_dpp v53, v37, v65 row_newbcast:4 row_mask:0xf bank_mask:0xf
  v_smfmac_f32_16x16x64_bf16 v[58:61], v[46:49], a[72:79], v66
  v_and_b32_dpp v46, v37, v62 row_newbcast:8 row_mask:0xf bank_mask:0xf
  v_and_b32_dpp v47, v37, v63 row_newbcast:8 row_mask:0xf bank_mask:0xf
  v_smfmac_f32_16x16x64_bf16 v[54:57], v[50:53], a[80:87], v66
  v_and_b32_dpp v48, v37, v64 row_newbcast:8 row_mask:0xf bank_mask:0xf
  v_and_b32_dpp v49, v37, v65 row_newbcast:8 row_mask:0xf bank_mask:0xf
  v_smfmac_f32_16x16x64_bf16 v[58:61], v[50:53], a[88:95], v66
  v_and_b32_dpp v50, v37, v62 row_newbcast:12 row_mask:0xf bank_mask:0xf
  v_and_b32_dpp v51, v37, v63 row_newbcast:12 row_mask:0xf bank_mask:0xf
  v_smfmac_f32_16x16x64_bf16 v[54:57], v[46:49], a[96:103], v66
  v_and_b32_dpp v52, v37, v64 row_newbcast:12 row_mask:0xf bank_mask:0xf
  v_and_b32_dpp v53, v37, v65 row_newbcast:12 row_mask:0xf bank_mask:0xf
  v_smfmac_f32_16x16x64_bf16 v[58:61], v[46:49], a[104:111], v66
  v_and_b32_dpp v46, v88, v62 row_newbcast:0 row_mask:0xf bank_mask:0xf
  v_and_b32_dpp v47, v88, v63 row_newbcast:0 row_mask:0xf bank_mask:0xf
  v_smfmac_f32_16x16x64_bf16 v[54:57], v[50:53], a[112:119], v66
  v_and_b32_dpp v48, v88, v64 row_newbcast:0 row_mask:0xf bank_mask:0xf
  v_and_b32_dpp v49, v88, v65 row_newbcast:0 row_mask:0xf bank_mask:0xf
  v_smfmac_f32_16x16x64_bf16 v[58:61], v[50:53], a[120:127], v66
  v_and_b32_dpp v50, v88, v62 row_newbcast:4 row_mask:0xf bank_mask:0xf
  v_and_b32_dpp v51, v88, v63 row_newbcast:4 row_mask:0xf bank_mask:0xf
  v_smfmac_f32_16x16x64_bf16 v[54:57], v[46:49], a[128:135], v66
  v_and_b32_dpp v52, v88, v64 row_newbcast:4 row_mask:0xf bank_mask:0xf
  v_and_b32_dpp v53, v88, v65 row_newbcast:4 row_mask:0xf bank_mask:0xf
  v_smfmac_f32_16x16x64_bf16 v[58:61], v[46:49], a[136:143], v66
  v_and_b32_dpp v46, v88, v62 row_newbcast:8 row_mask:0xf bank_mask:0xf
  v_and_b32_dpp v47, v88, v63 row_newbcast:8 row_mask:0xf bank_mask:0xf
  v_smfmac_f32_16x16x64_bf16 v[54:57], v[50:53], a[144:151], v66
  v_and_b32_dpp v48, v88, v64 row_newbcast:8 row_mask:0xf bank_mask:0xf
  v_and_b32_dpp v49, v88, v65 row_newbcast:8 row_mask:0xf bank_mask:0xf
  v_smfmac_f32_16x16x64_bf16 v[58:61], v[50:53], a[152:159], v66
  v_and_b32_dpp v50, v88, v62 row_newbcast:12 row_mask:0xf bank_mask:0xf
  v_and_b32_dpp v51, v88, v63 row_newbcast:12 row_mask:0xf bank_mask:0xf
  v_smfmac_f32_16x16x64_bf16 v[54:57], v[46:49], a[160:167], v66
  v_and_b32_dpp v52, v88, v64 row_newbcast:12 row_mask:0xf bank_mask:0xf
  v_and_b32_dpp v53, v88, v65 row_newbcast:12 row_mask:0xf bank_mask:0xf
  v_smfmac_f32_16x16x64_bf16 v[58:61], v[46:49], a[168:175], v66
  v_and_b32_dpp v46, v89, v62 row_newbcast:0 row_mask:0xf bank_mask:0xf
  v_and_b32_dpp v47, v89, v63 row_newbcast:0 row_mask:0xf bank_mask:0xf
  v_smfmac_f32_16x16x64_bf16 v[54:57], v[50:53], a[176:183], v66
  v_and_b32_dpp v48, v89, v64 row_newbcast:0 row_mask:0xf bank_mask:0xf
  v_and_b32_dpp v49, v89, v65 row_newbcast:0 row_mask:0xf bank_mask:0xf
  v_smfmac_f32_16x16x64_bf16 v[58:61], v[50:53], a[184:191], v66
  v_and_b32_dpp v50, v89, v62 row_newbcast:4 row_mask:0xf bank_mask:0xf
  v_and_b32_dpp v51, v89, v63 row_newbcast:4 row_mask:0xf bank_mask:0xf
  v_smfmac_f32_16x16x64_bf16 v[54:57], v[46:49], a[192:199], v66
  v_and_b32_dpp v52, v89, v64 row_newbcast:4 row_mask:0xf bank_mask:0xf
  v_and_b32_dpp v53, v89, v65 row_newbcast:4 row_mask:0xf bank_mask:0xf
  v_smfmac_f32_16x16x64_bf16 v[58:61], v[46:49], a[200:207], v66
  v_and_b32_dpp v46, v89, v62 row_newbcast:8 row_mask:0xf bank_mask:0xf
  v_and_b32_dpp v47, v89, v63 row_newbcast:8 row_mask:0xf bank_mask:0xf
  v_smfmac_f32_16x16x64_bf16 v[54:57], v[50:53], a[208:215], v66
  v_and_b32_dpp v48, v89, v64 row_newbcast:8 row_mask:0xf bank_mask:0xf
  v_and_b32_dpp v49, v89, v65 row_newbcast:8 row_mask:0xf bank_mask:0xf
  v_smfmac_f32_16x16x64_bf16 v[58:61], v[50:53], a[216:223], v66
  v_and_b32_dpp v50, v89, v62 row_newbcast:12 row_mask:0xf bank_mask:0xf
  v_and_b32_dpp v51, v89, v63 row_newbcast:12 row_mask:0xf bank_mask:0xf
  v_smfmac_f32_16x16x64_bf16 v[54:57], v[46:49], a[224:231], v66
  v_and_b32_dpp v52, v89, v64 row_newbcast:12 row_mask:0xf bank_mask:0xf
  v_and_b32_dpp v53, v89, v65 row_newbcast:12 row_mask:0xf bank_mask:0xf
  v_smfmac_f32_16x16x64_bf16 v[58:61], v[46:49], a[232:239], v66
  s_nop 0
  v_smfmac_f32_16x16x64_bf16 v[54:57], v[50:53], a[240:247], v66
  v_smfmac_f32_16x16x64_bf16 v[58:61], v[50:53], a[248:255], v66
  s_nop 6
  ds_write_b128 v83, v[54:57] offset:16384
  ds_write_b128 v83, v[58:61] offset:17408
  s_waitcnt lgkmcnt(0)
  s_barrier
  ds_read_b128 v[20:23], v85 offset:16384
  ds_read_b128 v[24:27], v85 offset:18432
  ds_read_b128 v[28:31], v85 offset:20480
  ds_read_b128 v[32:35], v85 offset:22528
  s_waitcnt lgkmcnt(2)
  v_pk_add_f32 v[20:21], v[20:21], v[24:25]
  v_pk_add_f32 v[22:23], v[22:23], v[26:27]
  s_waitcnt lgkmcnt(0)
  v_pk_add_f32 v[28:29], v[28:29], v[32:33]
  v_pk_add_f32 v[30:31], v[30:31], v[34:35]
  v_pk_add_f32 v[20:21], v[20:21], v[28:29]
  v_pk_add_f32 v[22:23], v[22:23], v[30:31]
  v_min_u32 v20, -2, v20
  v_min_u32 v21, -2, v21
  v_min_u32 v22, -2, v22
  v_min_u32 v23, -2, v23
  buffer_store_dwordx4 v[20:23], v86, s[64:67], s15 offen sc1
  s_cmp_eq_u32 s3, 0
  s_cbranch_scc0 L_ry_endR
  s_add_u32 s12, s98, 4096
  s_add_u32 s13, s98, 8192
  s_add_u32 s14, s98, 12288
  s_mov_b32 s93, 0
  buffer_load_dwordx4 v[20:23], v92, s[64:67], s98 offen offset:0 sc1
  buffer_load_dwordx4 v[24:27], v92, s[64:67], s98 offen offset:2048 sc1
  buffer_load_dwordx4 v[28:31], v92, s[64:67], s12 offen offset:0 sc1
  buffer_load_dwordx4 v[32:35], v92, s[64:67], s12 offen offset:2048 sc1
  buffer_load_dwordx4 v[36:39], v92, s[64:67], s13 offen offset:0 sc1
  buffer_load_dwordx4 v[40:43], v92, s[64:67], s13 offen offset:2048 sc1
  buffer_load_dwordx4 v[44:47], v92, s[64:67], s14 offen offset:0 sc1
  buffer_load_dwordx4 v[48:51], v92, s[64:67], s14 offen offset:2048 sc1
L_ry_spinR:
  s_waitcnt vmcnt(0)
  v_max3_u32 v80, v20, v21, v22
  v_max3_u32 v81, v24, v25, v26
  v_max3_u32 v82, v28, v29, v30
  v_max3_u32 v83, v32, v33, v34
  v_max3_u32 v84, v36, v37, v38
  v_max3_u32 v85, v40, v41, v42
  v_max3_u32 v86, v44, v45, v46
  v_max3_u32 v87, v48, v49, v50
  v_max_u32 v80, v80, v23
  v_max_u32 v81, v81, v27
  v_max_u32 v82, v82, v31
  v_max_u32 v83, v83, v35
  v_max_u32 v84, v84, v39
  v_max_u32 v85, v85, v43
  v_max_u32 v86, v86, v47
  v_max_u32 v87, v87, v51
  v_cmp_eq_u32 s[16:17], -1, v80
  v_cmp_eq_u32 s[18:19], -1, v81
  v_cmp_eq_u32 s[20:21], -1, v82
  v_cmp_eq_u32 s[22:23], -1, v83
  v_cmp_eq_u32 s[24:25], -1, v84
  v_cmp_eq_u32 s[26:27], -1, v85
  v_cmp_eq_u32 s[28:29], -1, v86
  v_cmp_eq_u32 s[30:31], -1, v87
  s_or_b64 s[94:95], s[16:17], s[18:19]
  s_or_b64 s[94:95], s[94:95], s[20:21]
  s_or_b64 s[94:95], s[94:95], s[22:23]
  s_or_b64 s[94:95], s[94:95], s[24:25]
  s_or_b64 s[94:95], s[94:95], s[26:27]
  s_or_b64 s[94:95], s[94:95], s[28:29]
  s_or_b64 s[94:95], s[94:95], s[30:31]
  s_cbranch_scc0 L_ry_okR
  s_add_u32 s93, s93, 1
  s_cmp_lt_u32 s93, 0x40000
  s_cbranch_scc0 L_ry_okR
  s_bcnt1_i32_b64 s15, s[94:95]
  s_cmp_gt_u32 s15, 32
  s_cbranch_scc0 L_ry_shortR
  s_sleep 5
L_ry_shortR:
  s_sleep 1
  s_mov_b64 exec, s[16:17]
  s_cbranch_execz L_ry_skip0R
  buffer_load_dwordx4 v[20:23], v92, s[64:67], s98 offen offset:0 sc1
L_ry_skip0R:
  s_mov_b64 exec, s[18:19]
  s_cbranch_execz L_ry_skip1R
  buffer_load_dwordx4 v[24:27], v92, s[64:67], s98 offen offset:2048 sc1
L_ry_skip1R:
  s_mov_b64 exec, s[20:21]
  s_cbranch_execz L_ry_skip2R
  buffer_load_dwordx4 v[28:31], v92, s[64:67], s12 offen offset:0 sc1
L_ry_skip2R:
  s_mov_b64 exec, s[22:23]
  s_cbranch_execz L_ry_skip3R
  buffer_load_dwordx4 v[32:35], v92, s[64:67], s12 offen offset:2048 sc1
L_ry_skip3R:
  s_mov_b64 exec, s[24:25]
  s_cbranch_execz L_ry_skip4R
  buffer_load_dwordx4 v[36:39], v92, s[64:67], s13 offen offset:0 sc1
L_ry_skip4R:
  s_mov_b64 exec, s[26:27]
  s_cbranch_execz L_ry_skip5R
  buffer_load_dwordx4 v[40:43], v92, s[64:67], s13 offen offset:2048 sc1
L_ry_skip5R:
  s_mov_b64 exec, s[28:29]
  s_cbranch_execz L_ry_skip6R
  buffer_load_dwordx4 v[44:47], v92, s[64:67], s14 offen offset:0 sc1
L_ry_skip6R:
  s_mov_b64 exec, s[30:31]
  s_cbranch_execz L_ry_skip7R
  buffer_load_dwordx4 v[48:51], v92, s[64:67], s14 offen offset:2048 sc1
L_ry_skip7R:
  s_mov_b64 exec, -1
  s_branch L_ry_spinR
L_ry_okR:
  v_fmac_f32 v12, v20, v70
  v_fmac_f32 v13, v21, v70
  v_fmac_f32 v14, v22, v70
  v_fmac_f32 v15, v23, v70
  v_fmac_f32 v12, v24, v71
  v_fmac_f32 v13, v25, v71
  v_fmac_f32 v14, v26, v71
  v_fmac_f32 v15, v27, v71
  v_fmac_f32 v12, v28, v72
  v_fmac_f32 v13, v29, v72
  v_fmac_f32 v14, v30, v72
  v_fmac_f32 v15, v31, v72
  v_fmac_f32 v12, v32, v73
  v_fmac_f32 v13, v33, v73
  v_fmac_f32 v14, v34, v73
  v_fmac_f32 v15, v35, v73
  v_fmac_f32 v12, v36, v74
  v_fmac_f32 v13, v37, v74
  v_fmac_f32 v14, v38, v74
  v_fmac_f32 v15, v39, v74
  v_fmac_f32 v12, v40, v75
  v_fmac_f32 v13, v41, v75
  v_fmac_f32 v14, v42, v75
  v_fmac_f32 v15, v43, v75
  v_fmac_f32 v12, v44, v76
  v_fmac_f32 v13, v45, v76
  v_fmac_f32 v14, v46, v76
  v_fmac_f32 v15, v47, v76
  v_fmac_f32 v12, v48, v77
  v_fmac_f32 v13, v49, v77
  v_fmac_f32 v14, v50, v77
  v_fmac_f32 v15, v51, v77
  v_add_f32_dpp v12, v12, v12 row_ror:4 row_mask:0xf bank_mask:0xf
  v_add_f32_dpp v13, v13, v13 row_ror:4 row_mask:0xf bank_mask:0xf
  v_add_f32_dpp v14, v14, v14 row_ror:4 row_mask:0xf bank_mask:0xf
  v_add_f32_dpp v15, v15, v15 row_ror:4 row_mask:0xf bank_mask:0xf
  v_add_f32_dpp v12, v12, v12 row_ror:8 row_mask:0xf bank_mask:0xf
  v_add_f32_dpp v13, v13, v13 row_ror:8 row_mask:0xf bank_mask:0xf
  v_add_f32_dpp v14, v14, v14 row_ror:8 row_mask:0xf bank_mask:0xf
  v_add_f32_dpp v15, v15, v15 row_ror:8 row_mask:0xf bank_mask:0xf
  v_mov_b32 v16, v12
  v_mov_b32 v17, v13
  v_mov_b32 v18, v14
  v_mov_b32 v19, v15
  v_permlane16_swap_b32 v12, v16
  v_permlane16_swap_b32 v13, v17
  v_permlane16_swap_b32 v14, v18
  v_permlane16_swap_b32 v15, v19
  v_add_f32 v12, v12, v16
  v_add_f32 v13, v13, v17
  v_add_f32 v14, v14, v18
  v_add_f32 v15, v15, v19
  v_mov_b32 v16, v12
  v_mov_b32 v17, v13
  v_mov_b32 v18, v14
  v_mov_b32 v19, v15
  v_permlane32_swap_b32 v12, v16
  v_permlane32_swap_b32 v13, v17
  v_permlane32_swap_b32 v14, v18
  v_permlane32_swap_b32 v15, v19
  v_add_f32 v12, v12, v16
  v_add_f32 v13, v13, v17
  v_add_f32 v14, v14, v18
  v_add_f32 v15, v15, v19
  v_cvt_pk_bf16_f32 v16, v12, v13
  v_cvt_pk_bf16_f32 v17, v14, v15
  buffer_store_dwordx2 v[16:17], v93, s[72:75], 0 offen
L_ry_endR:
  s_endpgm
L_roleB:
  s_mul_i32 s12, s8, 56
  s_lshr_b32 s13, s3, 1
  s_mul_i32 s13, s13, 28
  s_add_u32 s12, s12, s13
  v_min_u32 v80, 6, v2
  v_lshl_add_u32 v80, v80, 2, v3
  v_add_u32 v80, s12, v80
  v_lshlrev_b32 v80, 1, v80
  s_mul_i32 s13, s7, 896
  buffer_load_ushort v83, v80, s[60:63], s13 offen
  v_lshlrev_b32 v7, 4, v2
  v_lshl_add_u32 v7, v3, 13, v7
  s_lshl_b32 s12, s12, 13
  s_and_b32 s13, s3, 1
  s_lshl_b32 s13, s13, 8
  s_add_u32 s12, s12, s13
  buffer_load_dwordx4 v[96:99], v7, s[52:55], s12 offen nt
  s_add_u32 s12, s12, 32768
  buffer_load_dwordx4 v[100:103], v7, s[52:55], s12 offen nt
  s_add_u32 s12, s12, 32768
  buffer_load_dwordx4 v[104:107], v7, s[52:55], s12 offen nt
  s_add_u32 s12, s12, 32768
  buffer_load_dwordx4 v[108:111], v7, s[52:55], s12 offen nt
  s_add_u32 s12, s12, 32768
  buffer_load_dwordx4 v[112:115], v7, s[52:55], s12 offen nt
  s_add_u32 s12, s12, 32768
  buffer_load_dwordx4 v[116:119], v7, s[52:55], s12 offen nt
  s_add_u32 s12, s12, 32768
  buffer_load_dwordx4 v[120:123], v7, s[52:55], s12 offen nt
  v_mov_b32 v84, -1
  v_mov_b32 v85, -1
  v_mov_b32 v50, -1
  v_mov_b32 v51, -1
  v_mov_b32 v52, -1
  v_mov_b32 v53, -1
  v_lshlrev_b32 v81, 4, v0
  v_mov_b32 v82, 128
  v_cmp_gt_u32 vcc, v82, v0
  v_mov_b32 v82, 0x7ff00000
  s_nop 0
  v_cndmask_b32 v81, v82, v81, vcc
  s_lshl_b32 s12, s10, 11
  s_add_u32 s12, s12, 262144
  buffer_store_dwordx4 v[50:53], v81, s[64:67], s12 offen sc1
  v_cmp_eq_u32 vcc, 0, v0
  v_mov_b32 v82, 0x7ff00000
  v_mov_b32 v86, 0
  v_cndmask_b32 v86, v82, v86, vcc
  s_lshl_b32 s13, s10, 3
  s_add_u32 s13, s13, 786432
  buffer_store_dwordx2 v[84:85], v86, s[64:67], s13 offen sc1
  v_mov_b32 v46, -1
  v_mov_b32 v47, -1
  v_mov_b32 v48, -1
  v_mov_b32 v49, -1
  v_lshlrev_b32 v81, 4, v0
  s_lshl_b32 s12, s11, 12
  s_add_u32 s12, s12, 794624
  buffer_store_dwordx4 v[46:49], v81, s[64:67], s12 offen sc1
  s_add_u32 s101, s101, 16384
  s_cmp_eq_u32 s101, s20
  s_cselect_b32 s101, 0, s101
  buffer_load_dwordx4 a[32:35], v4, s[44:47], s101 offen offset:0 nt
  buffer_load_dwordx4 a[36:39], v4, s[44:47], s101 offen offset:256 nt
  buffer_load_dwordx4 a[40:43], v4, s[44:47], s101 offen offset:2048 nt
  buffer_load_dwordx4 a[44:47], v4, s[44:47], s101 offen offset:2304 nt
  s_waitcnt vmcnt(14)
  v_lshl_or_b32 v83, v83, 16, v83
  s_nop 1
  v_and_b32_dpp v46, v83, v8 row_newbcast:0 row_mask:0xf bank_mask:0xf
  v_and_b32_dpp v47, v83, v9 row_newbcast:0 row_mask:0xf bank_mask:0xf
  v_and_b32_dpp v48, v83, v10 row_newbcast:0 row_mask:0xf bank_mask:0xf
  v_and_b32_dpp v49, v83, v11 row_newbcast:0 row_mask:0xf bank_mask:0xf
  s_waitcnt vmcnt(13)
  s_nop 0
  v_mfma_f32_16x16x32_bf16 v[38:41], v[96:99], v[46:49], 0
  v_and_b32_dpp v50, v83, v8 row_newbcast:1 row_mask:0xf bank_mask:0xf
  v_and_b32_dpp v51, v83, v9 row_newbcast:1 row_mask:0xf bank_mask:0xf
  v_and_b32_dpp v52, v83, v10 row_newbcast:1 row_mask:0xf bank_mask:0xf
  v_and_b32_dpp v53, v83, v11 row_newbcast:1 row_mask:0xf bank_mask:0xf
  s_waitcnt vmcnt(12)
  s_nop 0
  v_mfma_f32_16x16x32_bf16 v[38:41], v[100:103], v[50:53], v[38:41]
  v_and_b32_dpp v46, v83, v8 row_newbcast:2 row_mask:0xf bank_mask:0xf
  v_and_b32_dpp v47, v83, v9 row_newbcast:2 row_mask:0xf bank_mask:0xf
  v_and_b32_dpp v48, v83, v10 row_newbcast:2 row_mask:0xf bank_mask:0xf
  v_and_b32_dpp v49, v83, v11 row_newbcast:2 row_mask:0xf bank_mask:0xf
  s_waitcnt vmcnt(11)
  s_nop 0
  v_mfma_f32_16x16x32_bf16 v[38:41], v[104:107], v[46:49], v[38:41]
  v_and_b32_dpp v50, v83, v8 row_newbcast:3 row_mask:0xf bank_mask:0xf
  v_and_b32_dpp v51, v83, v9 row_newbcast:3 row_mask:0xf bank_mask:0xf
  v_and_b32_dpp v52, v83, v10 row_newbcast:3 row_mask:0xf bank_mask:0xf
  v_and_b32_dpp v53, v83, v11 row_newbcast:3 row_mask:0xf bank_mask:0xf
  s_waitcnt vmcnt(10)
  s_nop 0
  v_mfma_f32_16x16x32_bf16 v[38:41], v[108:111], v[50:53], v[38:41]
  v_and_b32_dpp v46, v83, v8 row_newbcast:4 row_mask:0xf bank_mask:0xf
  v_and_b32_dpp v47, v83, v9 row_newbcast:4 row_mask:0xf bank_mask:0xf
  v_and_b32_dpp v48, v83, v10 row_newbcast:4 row_mask:0xf bank_mask:0xf
  v_and_b32_dpp v49, v83, v11 row_newbcast:4 row_mask:0xf bank_mask:0xf
  s_waitcnt vmcnt(9)
  s_nop 0
  v_mfma_f32_16x16x32_bf16 v[38:41], v[112:115], v[46:49], v[38:41]
  v_and_b32_dpp v50, v83, v8 row_newbcast:5 row_mask:0xf bank_mask:0xf
  v_and_b32_dpp v51, v83, v9 row_newbcast:5 row_mask:0xf bank_mask:0xf
  v_and_b32_dpp v52, v83, v10 row_newbcast:5 row_mask:0xf bank_mask:0xf
  v_and_b32_dpp v53, v83, v11 row_newbcast:5 row_mask:0xf bank_mask:0xf
  s_waitcnt vmcnt(8)
  s_nop 0
  v_mfma_f32_16x16x32_bf16 v[38:41], v[116:119], v[50:53], v[38:41]
  v_and_b32_dpp v46, v83, v8 row_newbcast:6 row_mask:0xf bank_mask:0xf
  v_and_b32_dpp v47, v83, v9 row_newbcast:6 row_mask:0xf bank_mask:0xf
  v_and_b32_dpp v48, v83, v10 row_newbcast:6 row_mask:0xf bank_mask:0xf
  v_and_b32_dpp v49, v83, v11 row_newbcast:6 row_mask:0xf bank_mask:0xf
  s_waitcnt vmcnt(7)
  s_nop 0
  v_mfma_f32_16x16x32_bf16 v[38:41], v[120:123], v[46:49], v[38:41]
  s_and_b32 s12, s3, 1
  s_lshl_b32 s12, s12, 10
  s_lshr_b32 s13, s3, 1
  s_lshl_b32 s13, s13, 2
  s_add_u32 s12, s12, s13
  v_lshl_add_u32 v80, v3, 5, v2
  v_lshlrev_b32 v80, 3, v80
  v_add_u32 v80, s12, v80
  s_mov_b32 exec_lo, 0x00ff00ff
  s_mov_b32 exec_hi, 0x00ff00ff
  ds_write2_b32 v80, v38, v39 offset0:0 offset1:16
  ds_write2_b32 v80, v40, v41 offset0:32 offset1:48
  s_mov_b64 exec, -1
  s_waitcnt lgkmcnt(0)
  s_barrier
  v_lshlrev_b32 v80, 5, v1
  ds_read_b128 v[46:49], v80 offset:0
  ds_read_b128 v[50:53], v80 offset:16
  v_lshlrev_b32 v81, 4, v0
  v_mov_b32 v82, 0x7ff00000
  v_cmp_gt_u32 vcc, 64, v0
  s_nop 1
  v_cndmask_b32 v81, v82, v81, vcc
  s_lshl_b32 s12, s10, 10
  s_waitcnt lgkmcnt(0)
  v_add_f32 v38, v46, v47
  v_add_f32 v39, v48, v49
  v_add_f32 v40, v50, v51
  v_add_f32 v41, v52, v53
  buffer_store_dwordx4 v[38:41], v81, s[64:67], s12 offen sc1
  s_mov_b32 s80, s16
  s_and_b32 s81, s17, 0xffff
  s_mov_b32 s82, 1792
  s_mov_b32 s83, 0x20000
  s_mov_b32 s76, s32
  s_and_b32 s77, s33, 0xffff
  s_mov_b32 s78, 1605632
  s_mov_b32 s79, 0x20000
  v_and_b32 v80, 1, v2
  v_mov_b32 v81, 0xffff
  v_lshlrev_b32 v80, 4, v80
  v_lshlrev_b32 v81, v80, v81
  v_bfe_u32 v82, v2, 1, 2
  v_cmp_eq_u32 vcc, 0, v82
  s_nop 1
  v_cndmask_b32 v70, 0, v81, vcc
  v_cmp_eq_u32 vcc, 1, v82
  s_nop 1
  v_cndmask_b32 v71, 0, v81, vcc
  v_cmp_eq_u32 vcc, 2, v82
  s_nop 1
  v_cndmask_b32 v72, 0, v81, vcc
  v_cmp_eq_u32 vcc, 3, v82
  s_nop 1
  v_cndmask_b32 v73, 0, v81, vcc
  s_mul_i32 s12, s3, 112
  v_lshl_add_u32 v80, v2, 2, v3
  v_add_u32 v80, s12, v80
  v_lshlrev_b32 v80, 1, v80
  buffer_load_ushort v74, v80, s[80:83], 0 offen offset:0
  buffer_load_ushort v75, v80, s[80:83], 0 offen offset:896
  v_min_u32 v80, 11, v2
  v_add_u32 v80, 16, v80
  v_lshl_add_u32 v80, v80, 2, v3
  v_add_u32 v80, s12, v80
  v_lshlrev_b32 v80, 1, v80
  buffer_load_ushort v76, v80, s[80:83], 0 offen offset:0
  buffer_load_ushort v77, v80, s[80:83], 0 offen offset:896
  v_mov_b32 v62, s30
  v_mov_b32 v63, s31
  v_mov_b32 v80, s28
  v_mov_b32 v81, s29
  v_cmp_gt_u32 vcc, 8, v2
  s_nop 1
  v_cndmask_b32 v62, v62, v80, vcc
  v_cndmask_b32 v63, v63, v81, vcc
  v_add_u32 v80, s12, v3
  v_mul_u32_u24 v80, 3584, v80
  v_and_b32 v81, 7, v2
  v_lshl_add_u32 v80, v81, 4, v80
  s_lshl_b32 s13, s11, 7
  v_add_u32 v80, s13, v80
  v_add_co_u32 v62, vcc, v62, v80
  s_nop 1
  v_addc_co_u32 v63, vcc, 0, v63, vcc
  global_load_dwordx4 v[124:127], v[62:63], off nt
  v_add_co_u32 v62, vcc, 14336, v62
  s_nop 1
  v_addc_co_u32 v63, vcc, 0, v63, vcc
  global_load_dwordx4 v[128:131], v[62:63], off nt
  v_add_co_u32 v62, vcc, 14336, v62
  s_nop 1
  v_addc_co_u32 v63, vcc, 0, v63, vcc
  global_load_dwordx4 v[132:135], v[62:63], off nt
  v_add_co_u32 v62, vcc, 14336, v62
  s_nop 1
  v_addc_co_u32 v63, vcc, 0, v63, vcc
  global_load_dwordx4 v[136:139], v[62:63], off nt
  v_add_co_u32 v62, vcc, 14336, v62
  s_nop 1
  v_addc_co_u32 v63, vcc, 0, v63, vcc
  global_load_dwordx4 v[140:143], v[62:63], off nt
  v_add_co_u32 v62, vcc, 14336, v62
  s_nop 1
  v_addc_co_u32 v63, vcc, 0, v63, vcc
  global_load_dwordx4 v[144:147], v[62:63], off nt
  v_add_co_u32 v62, vcc, 14336, v62
  s_nop 1
  v_addc_co_u32 v63, vcc, 0, v63, vcc
  global_load_dwordx4 v[148:151], v[62:63], off nt
  v_add_co_u32 v62, vcc, 14336, v62
  s_nop 1
  v_addc_co_u32 v63, vcc, 0, v63, vcc
  global_load_dwordx4 v[152:155], v[62:63], off nt
  v_add_co_u32 v62, vcc, 14336, v62
  s_nop 1
  v_addc_co_u32 v63, vcc, 0, v63, vcc
  global_load_dwordx4 v[156:159], v[62:63], off nt
  v_add_co_u32 v62, vcc, 14336, v62
  s_nop 1
  v_addc_co_u32 v63, vcc, 0, v63, vcc
  global_load_dwordx4 v[160:163], v[62:63], off nt
  v_add_co_u32 v62, vcc, 14336, v62
  s_nop 1
  v_addc_co_u32 v63, vcc, 0, v63, vcc
  global_load_dwordx4 v[164:167], v[62:63], off nt
  v_add_co_u32 v62, vcc, 14336, v62
  s_nop 1
  v_addc_co_u32 v63, vcc, 0, v63, vcc
  global_load_dwordx4 v[168:171], v[62:63], off nt
  v_add_co_u32 v62, vcc, 14336, v62
  s_nop 1
  v_addc_co_u32 v63, vcc, 0, v63, vcc
  s_waitcnt vmcnt(16)
  s_barrier
  v_mov_b32 v84, 1
  s_lshl_b32 s12, s9, 2
  buffer_atomic_add v84, v86, s[68:71], s12 offen
  s_lshl_b32 s12, s11, 6
  s_lshl_b32 s13, s3, 4
  s_add_u32 s12, s12, s13
  v_add_u32 v65, s12, v3
  v_mul_u32_u24 v65, 896, v65
  v_lshl_add_u32 v65, v2, 4, v65
  s_waitcnt vmcnt(13)
  v_lshl_or_b32 v74, v74, 16, v74
  v_lshl_or_b32 v75, v75, 16, v75
  v_lshl_or_b32 v76, v76, 16, v76
  v_lshl_or_b32 v77, v77, 16, v77
  v_mov_b32_dpp v64, v74 row_newbcast:0 row_mask:0xf bank_mask:0x3
  s_nop 1
  v_mov_b32_dpp v64, v75 row_newbcast:0 row_mask:0xf bank_mask:0xc
  v_and_b32 v66, v64, v70
  v_and_b32 v67, v64, v71
  v_and_b32 v68, v64, v72
  v_and_b32 v69, v64, v73
  s_waitcnt vmcnt(12)
  s_nop 0
  v_mfma_f32_16x16x32_bf16 v[54:57], v[124:127], v[66:69], 0
  global_load_dwordx4 v[172:175], v[62:63], off nt
  v_add_co_u32 v62, vcc, 14336, v62
  s_nop 1
  v_addc_co_u32 v63, vcc, 0, v63, vcc
  v_mov_b32_dpp v64, v74 row_newbcast:1 row_mask:0xf bank_mask:0x3
  s_nop 1
  v_mov_b32_dpp v64, v75 row_newbcast:1 row_mask:0xf bank_mask:0xc
  v_and_b32 v66, v64, v70
  v_and_b32 v67, v64, v71
  v_and_b32 v68, v64, v72
  v_and_b32 v69, v64, v73
  s_waitcnt vmcnt(12)
  s_nop 0
  v_mfma_f32_16x16x32_bf16 v[54:57], v[128:131], v[66:69], v[54:57]
  global_load_dwordx4 v[176:179], v[62:63], off nt
  v_add_co_u32 v62, vcc, 14336, v62
  s_nop 1
  v_addc_co_u32 v63, vcc, 0, v63, vcc
  v_mov_b32_dpp v64, v74 row_newbcast:2 row_mask:0xf bank_mask:0x3
  s_nop 1
  v_mov_b32_dpp v64, v75 row_newbcast:2 row_mask:0xf bank_mask:0xc
  v_and_b32 v66, v64, v70
  v_and_b32 v67, v64, v71
  v_and_b32 v68, v64, v72
  v_and_b32 v69, v64, v73
  s_waitcnt vmcnt(12)
  s_nop 0
  v_mfma_f32_16x16x32_bf16 v[54:57], v[132:135], v[66:69], v[54:57]
  global_load_dwordx4 v[180:183], v[62:63], off nt
  v_add_co_u32 v62, vcc, 14336, v62
  s_nop 1
  v_addc_co_u32 v63, vcc, 0, v63, vcc
  v_mov_b32_dpp v64, v74 row_newbcast:3 row_mask:0xf bank_mask:0x3
  s_nop 1
  v_mov_b32_dpp v64, v75 row_newbcast:3 row_mask:0xf bank_mask:0xc
  v_and_b32 v66, v64, v70
  v_and_b32 v67, v64, v71
  v_and_b32 v68, v64, v72
  v_and_b32 v69, v64, v73
  s_waitcnt vmcnt(12)
  s_nop 0
  v_mfma_f32_16x16x32_bf16 v[54:57], v[136:139], v[66:69], v[54:57]
  global_load_dwordx4 v[184:187], v[62:63], off nt
  v_add_co_u32 v62, vcc, 14336, v62
  s_nop 1
  v_addc_co_u32 v63, vcc, 0, v63, vcc
  v_mov_b32_dpp v64, v74 row_newbcast:4 row_mask:0xf bank_mask:0x3
  s_nop 1
  v_mov_b32_dpp v64, v75 row_newbcast:4 row_mask:0xf bank_mask:0xc
  v_and_b32 v66, v64, v70
  v_and_b32 v67, v64, v71
  v_and_b32 v68, v64, v72
  v_and_b32 v69, v64, v73
  s_waitcnt vmcnt(12)
  s_nop 0
  v_mfma_f32_16x16x32_bf16 v[54:57], v[140:143], v[66:69], v[54:57]
  global_load_dwordx4 v[188:191], v[62:63], off nt
  v_add_co_u32 v62, vcc, 14336, v62
  s_nop 1
  v_addc_co_u32 v63, vcc, 0, v63, vcc
  v_mov_b32_dpp v64, v74 row_newbcast:5 row_mask:0xf bank_mask:0x3
  s_nop 1
  v_mov_b32_dpp v64, v75 row_newbcast:5 row_mask:0xf bank_mask:0xc
  v_and_b32 v66, v64, v70
  v_and_b32 v67, v64, v71
  v_and_b32 v68, v64, v72
  v_and_b32 v69, v64, v73
  s_waitcnt vmcnt(12)
  s_nop 0
  v_mfma_f32_16x16x32_bf16 v[54:57], v[144:147], v[66:69], v[54:57]
  global_load_dwordx4 v[192:195], v[62:63], off nt
  v_add_co_u32 v62, vcc, 14336, v62
  s_nop 1
  v_addc_co_u32 v63, vcc, 0, v63, vcc
  v_mov_b32_dpp v64, v74 row_newbcast:6 row_mask:0xf bank_mask:0x3
  s_nop 1
  v_mov_b32_dpp v64, v75 row_newbcast:6 row_mask:0xf bank_mask:0xc
  v_and_b32 v66, v64, v70
  v_and_b32 v67, v64, v71
  v_and_b32 v68, v64, v72
  v_and_b32 v69, v64, v73
  s_waitcnt vmcnt(12)
  s_nop 0
  v_mfma_f32_16x16x32_bf16 v[54:57], v[148:151], v[66:69], v[54:57]
  global_load_dwordx4 v[196:199], v[62:63], off nt
  v_add_co_u32 v62, vcc, 14336, v62
  s_nop 1
  v_addc_co_u32 v63, vcc, 0, v63, vcc
  v_mov_b32_dpp v64, v74 row_newbcast:7 row_mask:0xf bank_mask:0x3
  s_nop 1
  v_mov_b32_dpp v64, v75 row_newbcast:7 row_mask:0xf bank_mask:0xc
  v_and_b32 v66, v64, v70
  v_and_b32 v67, v64, v71
  v_and_b32 v68, v64, v72
  v_and_b32 v69, v64, v73
  s_waitcnt vmcnt(12)
  s_nop 0
  v_mfma_f32_16x16x32_bf16 v[54:57], v[152:155], v[66:69], v[54:57]
  global_load_dwordx4 v[200:203], v[62:63], off nt
  v_add_co_u32 v62, vcc, 14336, v62
  s_nop 1
  v_addc_co_u32 v63, vcc, 0, v63, vcc
  v_mov_b32_dpp v64, v74 row_newbcast:8 row_mask:0xf bank_mask:0x3
  s_nop 1
  v_mov_b32_dpp v64, v75 row_newbcast:8 row_mask:0xf bank_mask:0xc
  v_and_b32 v66, v64, v70
  v_and_b32 v67, v64, v71
  v_and_b32 v68, v64, v72
  v_and_b32 v69, v64, v73
  s_waitcnt vmcnt(12)
  s_nop 0
  v_mfma_f32_16x16x32_bf16 v[54:57], v[156:159], v[66:69], v[54:57]
  global_load_dwordx4 v[204:207], v[62:63], off nt
  v_add_co_u32 v62, vcc, 14336, v62
  s_nop 1
  v_addc_co_u32 v63, vcc, 0, v63, vcc
  v_mov_b32_dpp v64, v74 row_newbcast:9 row_mask:0xf bank_mask:0x3
  s_nop 1
  v_mov_b32_dpp v64, v75 row_newbcast:9 row_mask:0xf bank_mask:0xc
  v_and_b32 v66, v64, v70
  v_and_b32 v67, v64, v71
  v_and_b32 v68, v64, v72
  v_and_b32 v69, v64, v73
  s_waitcnt vmcnt(12)
  s_nop 0
  v_mfma_f32_16x16x32_bf16 v[54:57], v[160:163], v[66:69], v[54:57]
  global_load_dwordx4 v[208:211], v[62:63], off nt
  v_add_co_u32 v62, vcc, 14336, v62
  s_nop 1
  v_addc_co_u32 v63, vcc, 0, v63, vcc
  v_mov_b32_dpp v64, v74 row_newbcast:10 row_mask:0xf bank_mask:0x3
  s_nop 1
  v_mov_b32_dpp v64, v75 row_newbcast:10 row_mask:0xf bank_mask:0xc
  v_and_b32 v66, v64, v70
  v_and_b32 v67, v64, v71
  v_and_b32 v68, v64, v72
  v_and_b32 v69, v64, v73
  s_waitcnt vmcnt(12)
  s_nop 0
  v_mfma_f32_16x16x32_bf16 v[54:57], v[164:167], v[66:69], v[54:57]
  global_load_dwordx4 v[212:215], v[62:63], off nt
  v_add_co_u32 v62, vcc, 14336, v62
  s_nop 1
  v_addc_co_u32 v63, vcc, 0, v63, vcc
  v_mov_b32_dpp v64, v74 row_newbcast:11 row_mask:0xf bank_mask:0x3
  s_nop 1
  v_mov_b32_dpp v64, v75 row_newbcast:11 row_mask:0xf bank_mask:0xc
  v_and_b32 v66, v64, v70
  v_and_b32 v67, v64, v71
  v_and_b32 v68, v64, v72
  v_and_b32 v69, v64, v73
  s_waitcnt vmcnt(12)
  s_nop 0
  v_mfma_f32_16x16x32_bf16 v[54:57], v[168:171], v[66:69], v[54:57]
  global_load_dwordx4 v[216:219], v[62:63], off nt
  v_add_co_u32 v62, vcc, 14336, v62
  s_nop 1
  v_addc_co_u32 v63, vcc, 0, v63, vcc
  v_mov_b32_dpp v64, v74 row_newbcast:12 row_mask:0xf bank_mask:0x3
  s_nop 1
  v_mov_b32_dpp v64, v75 row_newbcast:12 row_mask:0xf bank_mask:0xc
  v_and_b32 v66, v64, v70
  v_and_b32 v67, v64, v71
  v_and_b32 v68, v64, v72
  v_and_b32 v69, v64, v73
  s_waitcnt vmcnt(11)
  s_nop 0
  v_mfma_f32_16x16x32_bf16 v[54:57], v[172:175], v[66:69], v[54:57]
  global_load_dwordx4 v[220:223], v[62:63], off nt
  v_add_co_u32 v62, vcc, 14336, v62
  s_nop 1
  v_addc_co_u32 v63, vcc, 0, v63, vcc
  v_mov_b32_dpp v64, v74 row_newbcast:13 row_mask:0xf bank_mask:0x3
  s_nop 1
  v_mov_b32_dpp v64, v75 row_newbcast:13 row_mask:0xf bank_mask:0xc
  v_and_b32 v66, v64, v70
  v_and_b32 v67, v64, v71
  v_and_b32 v68, v64, v72
  v_and_b32 v69, v64, v73
  s_waitcnt vmcnt(11)
  s_nop 0
  v_mfma_f32_16x16x32_bf16 v[54:57], v[176:179], v[66:69], v[54:57]
  global_load_dwordx4 v[224:227], v[62:63], off nt
  v_add_co_u32 v62, vcc, 14336, v62
  s_nop 1
  v_addc_co_u32 v63, vcc, 0, v63, vcc
  v_mov_b32_dpp v64, v74 row_newbcast:14 row_mask:0xf bank_mask:0x3
  s_nop 1
  v_mov_b32_dpp v64, v75 row_newbcast:14 row_mask:0xf bank_mask:0xc
  v_and_b32 v66, v64, v70
  v_and_b32 v67, v64, v71
  v_and_b32 v68, v64, v72
  v_and_b32 v69, v64, v73
  s_waitcnt vmcnt(11)
  s_nop 0
  v_mfma_f32_16x16x32_bf16 v[54:57], v[180:183], v[66:69], v[54:57]
  global_load_dwordx4 v[228:231], v[62:63], off nt
  v_add_co_u32 v62, vcc, 14336, v62
  s_nop 1
  v_addc_co_u32 v63, vcc, 0, v63, vcc
  v_mov_b32_dpp v64, v74 row_newbcast:15 row_mask:0xf bank_mask:0x3
  s_nop 1
  v_mov_b32_dpp v64, v75 row_newbcast:15 row_mask:0xf bank_mask:0xc
  v_and_b32 v66, v64, v70
  v_and_b32 v67, v64, v71
  v_and_b32 v68, v64, v72
  v_and_b32 v69, v64, v73
  s_waitcnt vmcnt(11)
  s_nop 0
  v_mfma_f32_16x16x32_bf16 v[54:57], v[184:187], v[66:69], v[54:57]
  global_load_dwordx4 v[232:235], v[62:63], off nt
  v_mov_b32_dpp v64, v76 row_newbcast:0 row_mask:0xf bank_mask:0x3
  s_nop 1
  v_mov_b32_dpp v64, v77 row_newbcast:0 row_mask:0xf bank_mask:0xc
  v_and_b32 v66, v64, v70
  v_and_b32 v67, v64, v71
  v_and_b32 v68, v64, v72
  v_and_b32 v69, v64, v73
  s_waitcnt vmcnt(11)
  s_nop 0
  v_mfma_f32_16x16x32_bf16 v[54:57], v[188:191], v[66:69], v[54:57]
  s_mov_b32 s96, 0
  buffer_load_dwordx4 v[236:239], v65, s[76:79], s96 offen offset:0 nt
  v_mov_b32_dpp v64, v76 row_newbcast:1 row_mask:0xf bank_mask:0x3
  s_nop 1
  v_mov_b32_dpp v64, v77 row_newbcast:1 row_mask:0xf bank_mask:0xc
  v_and_b32 v66, v64, v70
  v_and_b32 v67, v64, v71
  v_and_b32 v68, v64, v72
  v_and_b32 v69, v64, v73
  s_waitcnt vmcnt(11)
  s_nop 0
  v_mfma_f32_16x16x32_bf16 v[54:57], v[192:195], v[66:69], v[54:57]
  s_mov_b32 s96, 0
  buffer_load_dwordx4 v[240:243], v65, s[76:79], s96 offen offset:256 nt
  v_mov_b32_dpp v64, v76 row_newbcast:2 row_mask:0xf bank_mask:0x3
  s_nop 1
  v_mov_b32_dpp v64, v77 row_newbcast:2 row_mask:0xf bank_mask:0xc
  v_and_b32 v66, v64, v70
  v_and_b32 v67, v64, v71
  v_and_b32 v68, v64, v72
  v_and_b32 v69, v64, v73
  s_waitcnt vmcnt(11)
  s_nop 0
  v_mfma_f32_16x16x32_bf16 v[54:57], v[196:199], v[66:69], v[54:57]
  s_mov_b32 s96, 0
  buffer_load_dwordx4 v[244:247], v65, s[76:79], s96 offen offset:512 nt
  v_mov_b32_dpp v64, v76 row_newbcast:3 row_mask:0xf bank_mask:0x3
  s_nop 1
  v_mov_b32_dpp v64, v77 row_newbcast:3 row_mask:0xf bank_mask:0xc
  v_and_b32 v66, v64, v70
  v_and_b32 v67, v64, v71
  v_and_b32 v68, v64, v72
  v_and_b32 v69, v64, v73
  s_waitcnt vmcnt(11)
  s_nop 0
  v_mfma_f32_16x16x32_bf16 v[54:57], v[200:203], v[66:69], v[54:57]
  s_mov_b32 s96, 0
  buffer_load_dwordx4 v[248:251], v65, s[76:79], s96 offen offset:640 nt
  v_mov_b32_dpp v64, v76 row_newbcast:4 row_mask:0xf bank_mask:0x3
  s_nop 1
  v_mov_b32_dpp v64, v77 row_newbcast:4 row_mask:0xf bank_mask:0xc
  v_and_b32 v66, v64, v70
  v_and_b32 v67, v64, v71
  v_and_b32 v68, v64, v72
  v_and_b32 v69, v64, v73
  s_waitcnt vmcnt(11)
  s_nop 0
  v_mfma_f32_16x16x32_bf16 v[54:57], v[204:207], v[66:69], v[54:57]
  s_mov_b32 s96, 3584
  buffer_load_dwordx4 v[252:255], v65, s[76:79], s96 offen offset:0 nt
  v_mov_b32_dpp v64, v76 row_newbcast:5 row_mask:0xf bank_mask:0x3
  s_nop 1
  v_mov_b32_dpp v64, v77 row_newbcast:5 row_mask:0xf bank_mask:0xc
  v_and_b32 v66, v64, v70
  v_and_b32 v67, v64, v71
  v_and_b32 v68, v64, v72
  v_and_b32 v69, v64, v73
  s_waitcnt vmcnt(11)
  s_nop 0
  v_mfma_f32_16x16x32_bf16 v[54:57], v[208:211], v[66:69], v[54:57]
  s_mov_b32 s96, 3584
  buffer_load_dwordx4 v[96:99], v65, s[76:79], s96 offen offset:256 nt
  v_mov_b32_dpp v64, v76 row_newbcast:6 row_mask:0xf bank_mask:0x3
  s_nop 1
  v_mov_b32_dpp v64, v77 row_newbcast:6 row_mask:0xf bank_mask:0xc
  v_and_b32 v66, v64, v70
  v_and_b32 v67, v64, v71
  v_and_b32 v68, v64, v72
  v_and_b32 v69, v64, v73
  s_waitcnt vmcnt(11)
  s_nop 0
  v_mfma_f32_16x16x32_bf16 v[54:57], v[212:215], v[66:69], v[54:57]
  s_mov_b32 s96, 3584
  buffer_load_dwordx4 v[100:103], v65, s[76:79], s96 offen offset:512 nt
  v_mov_b32_dpp v64, v76 row_newbcast:7 row_mask:0xf bank_mask:0x3
  s_nop 1
  v_mov_b32_dpp v64, v77 row_newbcast:7 row_mask:0xf bank_mask:0xc
  v_and_b32 v66, v64, v70
  v_and_b32 v67, v64, v71
  v_and_b32 v68, v64, v72
  v_and_b32 v69, v64, v73
  s_waitcnt vmcnt(11)
  s_nop 0
  v_mfma_f32_16x16x32_bf16 v[54:57], v[216:219], v[66:69], v[54:57]
  s_mov_b32 s96, 3584
  buffer_load_dwordx4 v[104:107], v65, s[76:79], s96 offen offset:640 nt
  v_mov_b32_dpp v64, v76 row_newbcast:8 row_mask:0xf bank_mask:0x3
  s_nop 1
  v_mov_b32_dpp v64, v77 row_newbcast:8 row_mask:0xf bank_mask:0xc
  v_and_b32 v66, v64, v70
  v_and_b32 v67, v64, v71
  v_and_b32 v68, v64, v72
  v_and_b32 v69, v64, v73
  s_waitcnt vmcnt(11)
  s_nop 0
  v_mfma_f32_16x16x32_bf16 v[54:57], v[220:223], v[66:69], v[54:57]
  s_mov_b32 s96, 7168
  buffer_load_dwordx4 v[108:111], v65, s[76:79], s96 offen offset:0 nt
  v_mov_b32_dpp v64, v76 row_newbcast:9 row_mask:0xf bank_mask:0x3
  s_nop 1
  v_mov_b32_dpp v64, v77 row_newbcast:9 row_mask:0xf bank_mask:0xc
  v_and_b32 v66, v64, v70
  v_and_b32 v67, v64, v71
  v_and_b32 v68, v64, v72
  v_and_b32 v69, v64, v73
  s_waitcnt vmcnt(11)
  s_nop 0
  v_mfma_f32_16x16x32_bf16 v[54:57], v[224:227], v[66:69], v[54:57]
  s_mov_b32 s96, 7168
  buffer_load_dwordx4 v[112:115], v65, s[76:79], s96 offen offset:256 nt
  v_mov_b32_dpp v64, v76 row_newbcast:10 row_mask:0xf bank_mask:0x3
  s_nop 1
  v_mov_b32_dpp v64, v77 row_newbcast:10 row_mask:0xf bank_mask:0xc
  v_and_b32 v66, v64, v70
  v_and_b32 v67, v64, v71
  v_and_b32 v68, v64, v72
  v_and_b32 v69, v64, v73
  s_waitcnt vmcnt(11)
  s_nop 0
  v_mfma_f32_16x16x32_bf16 v[54:57], v[228:231], v[66:69], v[54:57]
  s_mov_b32 s96, 7168
  buffer_load_dwordx4 v[116:119], v65, s[76:79], s96 offen offset:512 nt
  v_mov_b32_dpp v64, v76 row_newbcast:11 row_mask:0xf bank_mask:0x3
  s_nop 1
  v_mov_b32_dpp v64, v77 row_newbcast:11 row_mask:0xf bank_mask:0xc
  v_and_b32 v66, v64, v70
  v_and_b32 v67, v64, v71
  v_and_b32 v68, v64, v72
  v_and_b32 v69, v64, v73
  s_waitcnt vmcnt(11)
  s_nop 0
  v_mfma_f32_16x16x32_bf16 v[54:57], v[232:235], v[66:69], v[54:57]
  s_mov_b32 s96, 7168
  buffer_load_dwordx4 v[120:123], v65, s[76:79], s96 offen offset:640 nt
  s_mov_b32 s96, 10752
  buffer_load_dwordx4 v[124:127], v65, s[76:79], s96 offen offset:0 nt
  s_mov_b32 s96, 10752
  buffer_load_dwordx4 v[128:131], v65, s[76:79], s96 offen offset:256 nt
  s_mov_b32 s96, 10752
  buffer_load_dwordx4 v[132:135], v65, s[76:79], s96 offen offset:512 nt
  s_mov_b32 s96, 10752
  buffer_load_dwordx4 v[136:139], v65, s[76:79], s96 offen offset:640 nt
  s_add_u32 s101, s101, 16384
  s_cmp_eq_u32 s101, s20
  s_cselect_b32 s101, 0, s101
  buffer_load_dwordx4 a[48:51], v4, s[44:47], s101 offen offset:0 nt
  buffer_load_dwordx4 a[52:55], v4, s[44:47], s101 offen offset:256 nt
  buffer_load_dwordx4 a[56:59], v4, s[44:47], s101 offen offset:2048 nt
  buffer_load_dwordx4 a[60:63], v4, s[44:47], s101 offen offset:2304 nt
  s_add_u32 s101, s101, 16384
  s_cmp_eq_u32 s101, s20
  s_cselect_b32 s101, 0, s101
  buffer_load_dwordx4 a[64:67], v4, s[44:47], s101 offen offset:0 nt
  buffer_load_dwordx4 a[68:71], v4, s[44:47], s101 offen offset:256 nt
  buffer_load_dwordx4 a[72:75], v4, s[44:47], s101 offen offset:2048 nt
  buffer_load_dwordx4 a[76:79], v4, s[44:47], s101 offen offset:2304 nt
  s_add_u32 s101, s101, 16384
  s_cmp_eq_u32 s101, s20
  s_cselect_b32 s101, 0, s101
  buffer_load_dwordx4 a[80:83], v4, s[44:47], s101 offen offset:0 nt
  buffer_load_dwordx4 a[84:87], v4, s[44:47], s101 offen offset:256 nt
  buffer_load_dwordx4 a[88:91], v4, s[44:47], s101 offen offset:2048 nt
  buffer_load_dwordx4 a[92:95], v4, s[44:47], s101 offen offset:2304 nt
  v_lshlrev_b32 v80, 4, v1
  s_lshl_b32 s12, s3, 10
  v_add_u32 v80, s12, v80
  ds_write_b128 v80, v[54:57] offset:16384
  v_and_b32 v81, 3, v2
  v_lshl_add_u32 v81, v81, 2, v3
  s_lshl_b32 s12, s3, 4
  v_add_u32 v81, s12, v81
  v_and_b32 v82, 7, v81
  v_and_b32 v83, 8, v2
  v_add_u32 v82, v82, v83
  v_lshrrev_b32 v83, 5, v81
  v_lshl_add_u32 v82, v83, 4, v82
  v_lshlrev_b32 v82, 4, v82
  v_bfe_u32 v83, v81, 3, 2
  v_lshl_add_u32 v82, v83, 2, v82
  s_waitcnt lgkmcnt(0)
  s_barrier
  ds_read_b32 v54, v82 offset:16384
  ds_read_b32 v58, v82 offset:16896
  ds_read_b32 v55, v82 offset:17408
  ds_read_b32 v59, v82 offset:17920
  ds_read_b32 v56, v82 offset:18432
  ds_read_b32 v60, v82 offset:18944
  ds_read_b32 v57, v82 offset:19456
  ds_read_b32 v61, v82 offset:19968
  s_waitcnt lgkmcnt(0)
  v_add_f32 v54, v54, v55
  v_add_f32 v56, v56, v57
  v_add_f32 v54, v54, v56
  v_add_f32 v58, v58, v59
  v_add_f32 v60, v60, v61
  v_add_f32 v58, v58, v60
  v_mul_f32 v54, 0xbfb8aa3b, v54
  v_exp_f32 v54, v54
  s_nop 0
  v_add_f32 v54, 1.0, v54
  v_rcp_f32 v54, v54
  s_nop 0
  v_mul_f32 v54, v54, v58
  v_cvt_pk_bf16_f32 v62, v54, v54
  s_barrier
  s_nop 0
  v_mov_b32_dpp v63, v62 row_newbcast:0 row_mask:0xf bank_mask:0x3
  s_nop 1
  v_mov_b32_dpp v63, v62 row_newbcast:8 row_mask:0xf bank_mask:0xc
  v_and_b32 v46, v63, v70
  v_and_b32 v47, v63, v71
  v_and_b32 v48, v63, v72
  v_and_b32 v49, v63, v73
  s_waitcnt vmcnt(27)
  s_nop 0
  v_mfma_f32_16x16x32_bf16 v[20:23], v[236:239], v[46:49], 0
  s_waitcnt vmcnt(26)
  v_mfma_f32_16x16x32_bf16 v[24:27], v[240:243], v[46:49], 0
  s_waitcnt vmcnt(25)
  v_mfma_f32_16x16x32_bf16 v[28:31], v[244:247], v[46:49], 0
  s_waitcnt vmcnt(24)
  v_mfma_f32_16x16x32_bf16 v[32:35], v[248:251], v[46:49], 0
  v_mov_b32_dpp v63, v62 row_newbcast:1 row_mask:0xf bank_mask:0x3
  s_nop 1
  v_mov_b32_dpp v63, v62 row_newbcast:9 row_mask:0xf bank_mask:0xc
  v_and_b32 v50, v63, v70
  v_and_b32 v51, v63, v71
  v_and_b32 v52, v63, v72
  v_and_b32 v53, v63, v73
  s_waitcnt vmcnt(23)
  s_nop 0
  v_mfma_f32_16x16x32_bf16 v[20:23], v[252:255], v[50:53], v[20:23]
  s_waitcnt vmcnt(22)
  v_mfma_f32_16x16x32_bf16 v[24:27], v[96:99], v[50:53], v[24:27]
  s_waitcnt vmcnt(21)
  v_mfma_f32_16x16x32_bf16 v[28:31], v[100:103], v[50:53], v[28:31]
  s_waitcnt vmcnt(20)
  v_mfma_f32_16x16x32_bf16 v[32:35], v[104:107], v[50:53], v[32:35]
  v_mov_b32_dpp v63, v62 row_newbcast:2 row_mask:0xf bank_mask:0x3
  s_nop 1
  v_mov_b32_dpp v63, v62 row_newbcast:10 row_mask:0xf bank_mask:0xc
  v_and_b32 v46, v63, v70
  v_and_b32 v47, v63, v71
  v_and_b32 v48, v63, v72
  v_and_b32 v49, v63, v73
  s_waitcnt vmcnt(19)
  s_nop 0
  v_mfma_f32_16x16x32_bf16 v[20:23], v[108:111], v[46:49], v[20:23]
  s_waitcnt vmcnt(18)
  v_mfma_f32_16x16x32_bf16 v[24:27], v[112:115], v[46:49], v[24:27]
  s_waitcnt vmcnt(17)
  v_mfma_f32_16x16x32_bf16 v[28:31], v[116:119], v[46:49], v[28:31]
  s_waitcnt vmcnt(16)
  v_mfma_f32_16x16x32_bf16 v[32:35], v[120:123], v[46:49], v[32:35]
  v_mov_b32_dpp v63, v62 row_newbcast:3 row_mask:0xf bank_mask:0x3
  s_nop 1
  v_mov_b32_dpp v63, v62 row_newbcast:11 row_mask:0xf bank_mask:0xc
  v_and_b32 v50, v63, v70
  v_and_b32 v51, v63, v71
  v_and_b32 v52, v63, v72
  v_and_b32 v53, v63, v73
  s_waitcnt vmcnt(15)
  s_nop 0
  v_mfma_f32_16x16x32_bf16 v[20:23], v[124:127], v[50:53], v[20:23]
  s_waitcnt vmcnt(14)
  v_mfma_f32_16x16x32_bf16 v[24:27], v[128:131], v[50:53], v[24:27]
  s_waitcnt vmcnt(13)
  v_mfma_f32_16x16x32_bf16 v[28:31], v[132:135], v[50:53], v[28:31]
  s_waitcnt vmcnt(12)
  v_mfma_f32_16x16x32_bf16 v[32:35], v[136:139], v[50:53], v[32:35]
  s_add_u32 s101, s101, 16384
  s_cmp_eq_u32 s101, s20
  s_cselect_b32 s101, 0, s101
  buffer_load_dwordx4 a[96:99], v4, s[44:47], s101 offen offset:0 nt
  buffer_load_dwordx4 a[100:103], v4, s[44:47], s101 offen offset:256 nt
  buffer_load_dwordx4 a[104:107], v4, s[44:47], s101 offen offset:2048 nt
  buffer_load_dwordx4 a[108:111], v4, s[44:47], s101 offen offset:2304 nt
  s_add_u32 s101, s101, 16384
  s_cmp_eq_u32 s101, s20
  s_cselect_b32 s101, 0, s101
  buffer_load_dwordx4 a[112:115], v4, s[44:47], s101 offen offset:0 nt
  buffer_load_dwordx4 a[116:119], v4, s[44:47], s101 offen offset:256 nt
  buffer_load_dwordx4 a[120:123], v4, s[44:47], s101 offen offset:2048 nt
  buffer_load_dwordx4 a[124:127], v4, s[44:47], s101 offen offset:2304 nt
  s_add_u32 s101, s101, 16384
  s_cmp_eq_u32 s101, s20
  s_cselect_b32 s101, 0, s101
  buffer_load_dwordx4 a[128:131], v4, s[44:47], s101 offen offset:0 nt
  buffer_load_dwordx4 a[132:135], v4, s[44:47], s101 offen offset:256 nt
  v_lshlrev_b32 v80, 4, v1
  s_lshl_b32 s12, s3, 12
  v_add_u32 v81, s12, v80
  ds_write_b128 v81, v[20:23] offset:16384
  ds_write_b128 v81, v[24:27] offset:17408
  ds_write_b128 v81, v[28:31] offset:18432
  ds_write_b128 v81, v[32:35] offset:19456
  s_lshl_b32 s12, s3, 10
  v_add_u32 v80, s12, v80
  s_waitcnt lgkmcnt(0)
  s_barrier
  ds_read_b128 v[20:23], v80 offset:16384
  ds_read_b128 v[24:27], v80 offset:20480
  ds_read_b128 v[28:31], v80 offset:24576
  ds_read_b128 v[32:35], v80 offset:28672
  s_waitcnt lgkmcnt(0)
  v_add_f32 v20, v20, v24
  v_add_f32 v28, v28, v32
  v_add_f32 v21, v21, v25
  v_add_f32 v29, v29, v33
  v_add_f32 v22, v22, v26
  v_add_f32 v30, v30, v34
  v_add_f32 v23, v23, v27
  v_add_f32 v31, v31, v35
  v_add_f32 v20, v20, v28
  v_add_f32 v21, v21, v29
  v_add_f32 v22, v22, v30
  v_add_f32 v23, v23, v31
  v_min_u32 v20, -2, v20
  v_min_u32 v21, -2, v21
  v_min_u32 v22, -2, v22
  v_min_u32 v23, -2, v23
  s_lshl_b32 s12, s11, 12
  s_add_u32 s12, s12, 794624
  buffer_store_dwordx4 v[20:23], v80, s[64:67], s12 offen sc1
  s_waitcnt vmcnt(11)
  buffer_load_dwordx4 a[136:139], v4, s[44:47], s101 offen offset:2048 nt
  s_waitcnt vmcnt(11)
  buffer_load_dwordx4 a[140:143], v4, s[44:47], s101 offen offset:2304 nt
  s_waitcnt vmcnt(11)
  s_add_u32 s101, s101, 16384
  s_cmp_eq_u32 s101, s20
  s_cselect_b32 s101, 0, s101
  buffer_load_dwordx4 a[144:147], v4, s[44:47], s101 offen offset:0 nt
  s_waitcnt vmcnt(11)
  buffer_load_dwordx4 a[148:151], v4, s[44:47], s101 offen offset:256 nt
  s_waitcnt vmcnt(11)
  buffer_load_dwordx4 a[152:155], v4, s[44:47], s101 offen offset:2048 nt
  s_waitcnt vmcnt(11)
  buffer_load_dwordx4 a[156:159], v4, s[44:47], s101 offen offset:2304 nt
  s_waitcnt vmcnt(11)
  s_add_u32 s101, s101, 16384
  s_cmp_eq_u32 s101, s20
  s_cselect_b32 s101, 0, s101
  buffer_load_dwordx4 a[160:163], v4, s[44:47], s101 offen offset:0 nt
  s_waitcnt vmcnt(11)
  buffer_load_dwordx4 a[164:167], v4, s[44:47], s101 offen offset:256 nt
  s_waitcnt vmcnt(11)
  buffer_load_dwordx4 a[168:171], v4, s[44:47], s101 offen offset:2048 nt
  s_waitcnt vmcnt(11)
  buffer_load_dwordx4 a[172:175], v4, s[44:47], s101 offen offset:2304 nt
  s_waitcnt vmcnt(11)
  s_add_u32 s101, s101, 16384
  s_cmp_eq_u32 s101, s20
  s_cselect_b32 s101, 0, s101
  buffer_load_dwordx4 a[176:179], v4, s[44:47], s101 offen offset:0 nt
  s_waitcnt vmcnt(11)
  buffer_load_dwordx4 a[180:183], v4, s[44:47], s101 offen offset:256 nt
  s_waitcnt vmcnt(11)
  buffer_load_dwordx4 a[184:187], v4, s[44:47], s101 offen offset:2048 nt
  s_waitcnt vmcnt(11)
  buffer_load_dwordx4 a[188:191], v4, s[44:47], s101 offen offset:2304 nt
  s_waitcnt vmcnt(11)
  s_add_u32 s101, s101, 16384
  s_cmp_eq_u32 s101, s20
  s_cselect_b32 s101, 0, s101
  buffer_load_dwordx4 a[192:195], v4, s[44:47], s101 offen offset:0 nt
  s_waitcnt vmcnt(11)
  buffer_load_dwordx4 a[196:199], v4, s[44:47], s101 offen offset:256 nt
  s_waitcnt vmcnt(11)
  buffer_load_dwordx4 a[200:203], v4, s[44:47], s101 offen offset:2048 nt
  s_waitcnt vmcnt(11)
  buffer_load_dwordx4 a[204:207], v4, s[44:47], s101 offen offset:2304 nt
  v_and_b32 v80, 31, v1
  v_lshlrev_b32 v80, 2, v80
  s_mov_b32 s14, 0
  buffer_load_dword v84, v80, s[68:71], s14 offen sc1
  s_add_u32 s101, s101, 16384
  s_cmp_eq_u32 s101, s20
  s_cselect_b32 s101, 0, s101
  buffer_load_dwordx4 a[208:211], v4, s[44:47], s101 offen offset:0 nt
  buffer_load_dwordx4 a[212:215], v4, s[44:47], s101 offen offset:256 nt
  buffer_load_dwordx4 a[216:219], v4, s[44:47], s101 offen offset:2048 nt
  buffer_load_dwordx4 a[220:223], v4, s[44:47], s101 offen offset:2304 nt
  s_add_u32 s101, s101, 16384
  s_cmp_eq_u32 s101, s20
  s_cselect_b32 s101, 0, s101
  buffer_load_dwordx4 a[224:227], v4, s[44:47], s101 offen offset:0 nt
  buffer_load_dwordx4 a[228:231], v4, s[44:47], s101 offen offset:256 nt
  buffer_load_dwordx4 a[232:235], v4, s[44:47], s101 offen offset:2048 nt
  buffer_load_dwordx4 a[236:239], v4, s[44:47], s101 offen offset:2304 nt
  s_add_u32 s101, s101, 16384
  s_cmp_eq_u32 s101, s20
  s_cselect_b32 s101, 0, s101
  buffer_load_dwordx4 a[240:243], v4, s[44:47], s101 offen offset:0 nt
  buffer_load_dwordx4 a[244:247], v4, s[44:47], s101 offen offset:256 nt
  buffer_load_dwordx4 a[248:251], v4, s[44:47], s101 offen offset:2048 nt
  buffer_load_dwordx4 a[252:255], v4, s[44:47], s101 offen offset:2304 nt
  s_waitcnt vmcnt(12)
  v_cmp_ne_u32 vcc, 8, v84
  s_nop 4
  s_cbranch_vccz L_qokB
  s_mov_b32 s93, 0
L_qspinB:
  buffer_load_dword v84, v80, s[68:71], s14 offen sc1
  s_waitcnt vmcnt(0)
  v_cmp_ne_u32 vcc, 8, v84
  s_nop 4
  s_cbranch_vccz L_qokB
  s_add_u32 s93, s93, 1
  s_cmp_lt_u32 s93, 0x40000
  s_cbranch_scc0 L_qokB
  s_sleep 4
  s_branch L_qspinB
L_qokB:
  v_lshlrev_b32 v80, 10, v3
  v_lshl_add_u32 v80, v2, 4, v80
  s_lshl_b32 s13, s3, 8
  v_add_u32 v80, s13, v80
  s_lshl_b32 s12, s9, 13
  s_add_u32 s14, s12, 4096
  buffer_load_dwordx4 v[54:57], v80, s[64:67], s12 offen sc1
  buffer_load_dwordx4 v[58:61], v80, s[64:67], s14 offen sc1
  s_add_u32 s101, s101, 16384
  s_cmp_eq_u32 s101, s20
  s_cselect_b32 s101, 0, s101
  buffer_load_dwordx4 v[140:143], v4, s[44:47], s101 offen offset:0 nt
  buffer_load_dwordx4 v[144:147], v4, s[44:47], s101 offen offset:256 nt
  buffer_load_dwordx4 v[148:151], v4, s[44:47], s101 offen offset:2048 nt
  buffer_load_dwordx4 v[152:155], v4, s[44:47], s101 offen offset:2304 nt
  s_add_u32 s101, s101, 16384
  s_cmp_eq_u32 s101, s20
  s_cselect_b32 s101, 0, s101
  buffer_load_dwordx4 v[156:159], v4, s[44:47], s101 offen offset:0 nt
  buffer_load_dwordx4 v[160:163], v4, s[44:47], s101 offen offset:256 nt
  buffer_load_dwordx4 v[164:167], v4, s[44:47], s101 offen offset:2048 nt
  buffer_load_dwordx4 v[168:171], v4, s[44:47], s101 offen offset:2304 nt
  s_add_u32 s101, s101, 16384
  s_cmp_eq_u32 s101, s20
  s_cselect_b32 s101, 0, s101
  buffer_load_dwordx4 v[172:175], v4, s[44:47], s101 offen offset:0 nt
  buffer_load_dwordx4 v[176:179], v4, s[44:47], s101 offen offset:256 nt
  buffer_load_dwordx4 v[180:183], v4, s[44:47], s101 offen offset:2048 nt
  buffer_load_dwordx4 v[184:187], v4, s[44:47], s101 offen offset:2304 nt
  v_lshlrev_b32 v80, 3, v2
  s_lshl_b32 s13, s3, 7
  v_add_u32 v80, s13, v80
  s_waitcnt vmcnt(12)
  v_pk_add_f32 v[54:55], v[54:55], v[58:59]
  v_pk_add_f32 v[56:57], v[56:57], v[60:61]
  v_mov_b32 v58, v54
  v_mov_b32 v59, v55
  v_mov_b32 v60, v56
  v_mov_b32 v61, v57
  v_permlane16_swap_b32 v54, v58
  v_permlane16_swap_b32 v55, v59
  v_permlane16_swap_b32 v56, v60
  v_permlane16_swap_b32 v57, v61
  v_add_f32 v54, v54, v58
  v_add_f32 v55, v55, v59
  v_add_f32 v56, v56, v60
  v_add_f32 v57, v57, v61
  v_mov_b32 v58, v54
  v_mov_b32 v59, v55
  v_mov_b32 v60, v56
  v_mov_b32 v61, v57
  v_permlane32_swap_b32 v54, v58
  v_permlane32_swap_b32 v55, v59
  v_permlane32_swap_b32 v56, v60
  v_permlane32_swap_b32 v57, v61
  v_add_f32 v54, v54, v58
  v_add_f32 v55, v55, v59
  v_add_f32 v56, v56, v60
  v_add_f32 v57, v57, v61
  v_cvt_pk_bf16_f32 v58, v54, v55
  v_cvt_pk_bf16_f32 v59, v56, v57
  ds_write_b64 v80, v[58:59] offset:2048
  v_and_b32 v81, 3, v2
  v_lshl_add_u32 v81, v3, 2, v81
  v_lshlrev_b32 v81, 4, v81
  s_waitcnt lgkmcnt(0)
  s_barrier
  ds_read_b128 v[12:15], v81 offset:2048
  ds_read_b128 v[16:19], v81 offset:2304
  s_waitcnt lgkmcnt(0)
  v_and_b32 v7, 8, v2
  v_lshlrev_b32 v7, 4, v7
  v_sub_u32 v7, v6, v7
  v_mov_b32 v32, 0xff800000
  v_mfma_f32_16x16x32_bf16 v[38:41], a[0:3], v[12:15], 0
  v_mfma_f32_16x16x32_bf16 v[38:41], a[4:7], v[16:19], v[38:41]
  v_mfma_f32_16x16x32_bf16 v[42:45], a[8:11], v[12:15], 0
  v_mfma_f32_16x16x32_bf16 v[42:45], a[12:15], v[16:19], v[42:45]
  s_waitcnt vmcnt(11)
  s_add_u32 s101, s101, 16384
  s_cmp_eq_u32 s101, s20
  s_cselect_b32 s101, 0, s101
  buffer_load_dwordx4 v[188:191], v4, s[44:47], s101 offen offset:0 nt
  s_nop 0
  v_add_f32_dpp v88, v39, v38 quad_perm:[1,1,1,1] row_mask:0xf bank_mask:0xf
  v_add_f32_dpp v89, v41, v40 quad_perm:[3,3,3,3] row_mask:0xf bank_mask:0xf
  s_nop 1
  v_add_f32_dpp v20, v89, v88 quad_perm:[2,2,2,2] row_mask:0xf bank_mask:0x1
  v_mfma_f32_16x16x32_bf16 v[38:41], a[16:19], v[12:15], 0
  v_mfma_f32_16x16x32_bf16 v[38:41], a[20:23], v[16:19], v[38:41]
  v_add_f32_dpp v88, v43, v42 quad_perm:[1,1,1,1] row_mask:0xf bank_mask:0xf
  v_add_f32_dpp v89, v45, v44 quad_perm:[3,3,3,3] row_mask:0xf bank_mask:0xf
  s_nop 1
  v_add_f32_dpp v20, v89, v88 quad_perm:[2,2,2,2] row_mask:0xf bank_mask:0x2
  v_mfma_f32_16x16x32_bf16 v[42:45], a[24:27], v[12:15], 0
  v_mfma_f32_16x16x32_bf16 v[42:45], a[28:31], v[16:19], v[42:45]
  s_waitcnt vmcnt(11)
  buffer_load_dwordx4 v[192:195], v4, s[44:47], s101 offen offset:256 nt
  v_add_f32_dpp v88, v39, v38 quad_perm:[1,1,1,1] row_mask:0xf bank_mask:0xf
  v_add_f32_dpp v89, v41, v40 quad_perm:[3,3,3,3] row_mask:0xf bank_mask:0xf
  s_nop 1
  v_add_f32_dpp v20, v89, v88 quad_perm:[2,2,2,2] row_mask:0xf bank_mask:0x4
  v_mfma_f32_16x16x32_bf16 v[38:41], a[32:35], v[12:15], 0
  v_mfma_f32_16x16x32_bf16 v[38:41], a[36:39], v[16:19], v[38:41]
  v_add_f32_dpp v88, v43, v42 quad_perm:[1,1,1,1] row_mask:0xf bank_mask:0xf
  v_add_f32_dpp v89, v45, v44 quad_perm:[3,3,3,3] row_mask:0xf bank_mask:0xf
  s_nop 1
  v_add_f32_dpp v20, v89, v88 quad_perm:[2,2,2,2] row_mask:0xf bank_mask:0x8
  v_mfma_f32_16x16x32_bf16 v[42:45], a[40:43], v[12:15], 0
  v_mfma_f32_16x16x32_bf16 v[42:45], a[44:47], v[16:19], v[42:45]
  s_waitcnt vmcnt(11)
  buffer_load_dwordx4 v[196:199], v4, s[44:47], s101 offen offset:2048 nt
  v_add_f32_dpp v88, v39, v38 quad_perm:[1,1,1,1] row_mask:0xf bank_mask:0xf
  v_add_f32_dpp v89, v41, v40 quad_perm:[3,3,3,3] row_mask:0xf bank_mask:0xf
  s_nop 1
  v_add_f32_dpp v21, v89, v88 quad_perm:[2,2,2,2] row_mask:0xf bank_mask:0x1
  v_mfma_f32_16x16x32_bf16 v[38:41], a[48:51], v[12:15], 0
  v_mfma_f32_16x16x32_bf16 v[38:41], a[52:55], v[16:19], v[38:41]
  v_add_f32_dpp v88, v43, v42 quad_perm:[1,1,1,1] row_mask:0xf bank_mask:0xf
  v_add_f32_dpp v89, v45, v44 quad_perm:[3,3,3,3] row_mask:0xf bank_mask:0xf
  s_nop 1
  v_add_f32_dpp v21, v89, v88 quad_perm:[2,2,2,2] row_mask:0xf bank_mask:0x2
  v_mfma_f32_16x16x32_bf16 v[42:45], a[56:59], v[12:15], 0
  v_mfma_f32_16x16x32_bf16 v[42:45], a[60:63], v[16:19], v[42:45]
  s_waitcnt vmcnt(11)
  buffer_load_dwordx4 v[200:203], v4, s[44:47], s101 offen offset:2304 nt
  v_add_f32_dpp v88, v39, v38 quad_perm:[1,1,1,1] row_mask:0xf bank_mask:0xf
  v_add_f32_dpp v89, v41, v40 quad_perm:[3,3,3,3] row_mask:0xf bank_mask:0xf
  s_nop 1
  v_add_f32_dpp v21, v89, v88 quad_perm:[2,2,2,2] row_mask:0xf bank_mask:0x4
  v_mfma_f32_16x16x32_bf16 v[38:41], a[64:67], v[12:15], 0
  v_mfma_f32_16x16x32_bf16 v[38:41], a[68:71], v[16:19], v[38:41]
  v_add_f32_dpp v88, v43, v42 quad_perm:[1,1,1,1] row_mask:0xf bank_mask:0xf
  v_add_f32_dpp v89, v45, v44 quad_perm:[3,3,3,3] row_mask:0xf bank_mask:0xf
  s_nop 1
  v_add_f32_dpp v21, v89, v88 quad_perm:[2,2,2,2] row_mask:0xf bank_mask:0x8
  v_mfma_f32_16x16x32_bf16 v[42:45], a[72:75], v[12:15], 0
  v_mfma_f32_16x16x32_bf16 v[42:45], a[76:79], v[16:19], v[42:45]
  s_waitcnt vmcnt(11)
  s_add_u32 s101, s101, 16384
  s_cmp_eq_u32 s101, s20
  s_cselect_b32 s101, 0, s101
  buffer_load_dwordx4 v[204:207], v4, s[44:47], s101 offen offset:0 nt
  v_add_f32_dpp v88, v39, v38 quad_perm:[1,1,1,1] row_mask:0xf bank_mask:0xf
  v_add_f32_dpp v89, v41, v40 quad_perm:[3,3,3,3] row_mask:0xf bank_mask:0xf
  s_nop 1
  v_add_f32_dpp v22, v89, v88 quad_perm:[2,2,2,2] row_mask:0xf bank_mask:0x1
  v_mfma_f32_16x16x32_bf16 v[38:41], a[80:83], v[12:15], 0
  v_mfma_f32_16x16x32_bf16 v[38:41], a[84:87], v[16:19], v[38:41]
  v_add_f32_dpp v88, v43, v42 quad_perm:[1,1,1,1] row_mask:0xf bank_mask:0xf
  v_add_f32_dpp v89, v45, v44 quad_perm:[3,3,3,3] row_mask:0xf bank_mask:0xf
  s_nop 1
  v_add_f32_dpp v22, v89, v88 quad_perm:[2,2,2,2] row_mask:0xf bank_mask:0x2
  v_mfma_f32_16x16x32_bf16 v[42:45], a[88:91], v[12:15], 0
  v_mfma_f32_16x16x32_bf16 v[42:45], a[92:95], v[16:19], v[42:45]
  s_waitcnt vmcnt(11)
  buffer_load_dwordx4 v[208:211], v4, s[44:47], s101 offen offset:256 nt
  v_add_f32_dpp v88, v39, v38 quad_perm:[1,1,1,1] row_mask:0xf bank_mask:0xf
  v_add_f32_dpp v89, v41, v40 quad_perm:[3,3,3,3] row_mask:0xf bank_mask:0xf
  s_nop 1
  v_add_f32_dpp v22, v89, v88 quad_perm:[2,2,2,2] row_mask:0xf bank_mask:0x4
  v_mfma_f32_16x16x32_bf16 v[38:41], a[96:99], v[12:15], 0
  v_mfma_f32_16x16x32_bf16 v[38:41], a[100:103], v[16:19], v[38:41]
  v_add_f32_dpp v88, v43, v42 quad_perm:[1,1,1,1] row_mask:0xf bank_mask:0xf
  v_add_f32_dpp v89, v45, v44 quad_perm:[3,3,3,3] row_mask:0xf bank_mask:0xf
  s_nop 1
  v_add_f32_dpp v22, v89, v88 quad_perm:[2,2,2,2] row_mask:0xf bank_mask:0x8
  v_mfma_f32_16x16x32_bf16 v[42:45], a[104:107], v[12:15], 0
  v_mfma_f32_16x16x32_bf16 v[42:45], a[108:111], v[16:19], v[42:45]
  s_waitcnt vmcnt(11)
  buffer_load_dwordx4 v[212:215], v4, s[44:47], s101 offen offset:2048 nt
  v_add_f32_dpp v88, v39, v38 quad_perm:[1,1,1,1] row_mask:0xf bank_mask:0xf
  v_add_f32_dpp v89, v41, v40 quad_perm:[3,3,3,3] row_mask:0xf bank_mask:0xf
  s_nop 1
  v_add_f32_dpp v23, v89, v88 quad_perm:[2,2,2,2] row_mask:0xf bank_mask:0x1
  v_mfma_f32_16x16x32_bf16 v[38:41], a[112:115], v[12:15], 0
  v_mfma_f32_16x16x32_bf16 v[38:41], a[116:119], v[16:19], v[38:41]
  v_add_f32_dpp v88, v43, v42 quad_perm:[1,1,1,1] row_mask:0xf bank_mask:0xf
  v_add_f32_dpp v89, v45, v44 quad_perm:[3,3,3,3] row_mask:0xf bank_mask:0xf
  s_nop 1
  v_add_f32_dpp v23, v89, v88 quad_perm:[2,2,2,2] row_mask:0xf bank_mask:0x2
  v_mfma_f32_16x16x32_bf16 v[42:45], a[120:123], v[12:15], 0
  v_mfma_f32_16x16x32_bf16 v[42:45], a[124:127], v[16:19], v[42:45]
  s_waitcnt vmcnt(11)
  buffer_load_dwordx4 v[216:219], v4, s[44:47], s101 offen offset:2304 nt
  v_add_f32_dpp v88, v39, v38 quad_perm:[1,1,1,1] row_mask:0xf bank_mask:0xf
  v_add_f32_dpp v89, v41, v40 quad_perm:[3,3,3,3] row_mask:0xf bank_mask:0xf
  s_nop 1
  v_add_f32_dpp v23, v89, v88 quad_perm:[2,2,2,2] row_mask:0xf bank_mask:0x4
  v_mfma_f32_16x16x32_bf16 v[38:41], a[128:131], v[12:15], 0
  v_mfma_f32_16x16x32_bf16 v[38:41], a[132:135], v[16:19], v[38:41]
  v_add_f32_dpp v88, v43, v42 quad_perm:[1,1,1,1] row_mask:0xf bank_mask:0xf
  v_add_f32_dpp v89, v45, v44 quad_perm:[3,3,3,3] row_mask:0xf bank_mask:0xf
  s_nop 1
  v_add_f32_dpp v23, v89, v88 quad_perm:[2,2,2,2] row_mask:0xf bank_mask:0x8
  v_mfma_f32_16x16x32_bf16 v[42:45], a[136:139], v[12:15], 0
  v_mfma_f32_16x16x32_bf16 v[42:45], a[140:143], v[16:19], v[42:45]
  s_waitcnt vmcnt(11)
  s_add_u32 s101, s101, 16384
  s_cmp_eq_u32 s101, s20
  s_cselect_b32 s101, 0, s101
  buffer_load_dwordx4 v[220:223], v4, s[44:47], s101 offen offset:0 nt
  v_add_f32_dpp v88, v39, v38 quad_perm:[1,1,1,1] row_mask:0xf bank_mask:0xf
  v_add_f32_dpp v89, v41, v40 quad_perm:[3,3,3,3] row_mask:0xf bank_mask:0xf
  s_nop 1
  v_add_f32_dpp v24, v89, v88 quad_perm:[2,2,2,2] row_mask:0xf bank_mask:0x1
  v_mfma_f32_16x16x32_bf16 v[38:41], a[144:147], v[12:15], 0
  v_mfma_f32_16x16x32_bf16 v[38:41], a[148:151], v[16:19], v[38:41]
  v_add_f32_dpp v88, v43, v42 quad_perm:[1,1,1,1] row_mask:0xf bank_mask:0xf
  v_add_f32_dpp v89, v45, v44 quad_perm:[3,3,3,3] row_mask:0xf bank_mask:0xf
  s_nop 1
  v_add_f32_dpp v24, v89, v88 quad_perm:[2,2,2,2] row_mask:0xf bank_mask:0x2
  v_mfma_f32_16x16x32_bf16 v[42:45], a[152:155], v[12:15], 0
  v_mfma_f32_16x16x32_bf16 v[42:45], a[156:159], v[16:19], v[42:45]
  s_waitcnt vmcnt(11)
  buffer_load_dwordx4 v[224:227], v4, s[44:47], s101 offen offset:256 nt
  v_add_f32_dpp v88, v39, v38 quad_perm:[1,1,1,1] row_mask:0xf bank_mask:0xf
  v_add_f32_dpp v89, v41, v40 quad_perm:[3,3,3,3] row_mask:0xf bank_mask:0xf
  s_nop 1
  v_add_f32_dpp v24, v89, v88 quad_perm:[2,2,2,2] row_mask:0xf bank_mask:0x4
  v_mfma_f32_16x16x32_bf16 v[38:41], a[160:163], v[12:15], 0
  v_mfma_f32_16x16x32_bf16 v[38:41], a[164:167], v[16:19], v[38:41]
  v_add_f32_dpp v88, v43, v42 quad_perm:[1,1,1,1] row_mask:0xf bank_mask:0xf
  v_add_f32_dpp v89, v45, v44 quad_perm:[3,3,3,3] row_mask:0xf bank_mask:0xf
  s_nop 1
  v_add_f32_dpp v24, v89, v88 quad_perm:[2,2,2,2] row_mask:0xf bank_mask:0x8
  v_mfma_f32_16x16x32_bf16 v[42:45], a[168:171], v[12:15], 0
  v_mfma_f32_16x16x32_bf16 v[42:45], a[172:175], v[16:19], v[42:45]
  s_waitcnt vmcnt(11)
  buffer_load_dwordx4 v[228:231], v4, s[44:47], s101 offen offset:2048 nt
  v_add_f32_dpp v88, v39, v38 quad_perm:[1,1,1,1] row_mask:0xf bank_mask:0xf
  v_add_f32_dpp v89, v41, v40 quad_perm:[3,3,3,3] row_mask:0xf bank_mask:0xf
  s_nop 1
  v_add_f32_dpp v25, v89, v88 quad_perm:[2,2,2,2] row_mask:0xf bank_mask:0x1
  v_mfma_f32_16x16x32_bf16 v[38:41], a[176:179], v[12:15], 0
  v_mfma_f32_16x16x32_bf16 v[38:41], a[180:183], v[16:19], v[38:41]
  v_add_f32_dpp v88, v43, v42 quad_perm:[1,1,1,1] row_mask:0xf bank_mask:0xf
  v_add_f32_dpp v89, v45, v44 quad_perm:[3,3,3,3] row_mask:0xf bank_mask:0xf
  s_nop 1
  v_add_f32_dpp v25, v89, v88 quad_perm:[2,2,2,2] row_mask:0xf bank_mask:0x2
  v_mfma_f32_16x16x32_bf16 v[42:45], a[184:187], v[12:15], 0
  v_mfma_f32_16x16x32_bf16 v[42:45], a[188:191], v[16:19], v[42:45]
  s_waitcnt vmcnt(11)
  buffer_load_dwordx4 v[232:235], v4, s[44:47], s101 offen offset:2304 nt
  v_add_f32_dpp v88, v39, v38 quad_perm:[1,1,1,1] row_mask:0xf bank_mask:0xf
  v_add_f32_dpp v89, v41, v40 quad_perm:[3,3,3,3] row_mask:0xf bank_mask:0xf
  s_nop 1
  v_add_f32_dpp v25, v89, v88 quad_perm:[2,2,2,2] row_mask:0xf bank_mask:0x4
  v_mfma_f32_16x16x32_bf16 v[38:41], a[192:195], v[12:15], 0
  v_mfma_f32_16x16x32_bf16 v[38:41], a[196:199], v[16:19], v[38:41]
  v_add_f32_dpp v88, v43, v42 quad_perm:[1,1,1,1] row_mask:0xf bank_mask:0xf
  v_add_f32_dpp v89, v45, v44 quad_perm:[3,3,3,3] row_mask:0xf bank_mask:0xf
  s_nop 1
  v_add_f32_dpp v25, v89, v88 quad_perm:[2,2,2,2] row_mask:0xf bank_mask:0x8
  v_mfma_f32_16x16x32_bf16 v[42:45], a[200:203], v[12:15], 0
  v_mfma_f32_16x16x32_bf16 v[42:45], a[204:207], v[16:19], v[42:45]
  s_waitcnt vmcnt(11)
  s_add_u32 s101, s101, 16384
  s_cmp_eq_u32 s101, s20
  s_cselect_b32 s101, 0, s101
  buffer_load_dwordx4 v[236:239], v4, s[44:47], s101 offen offset:0 nt
  v_add_f32_dpp v88, v39, v38 quad_perm:[1,1,1,1] row_mask:0xf bank_mask:0xf
  v_add_f32_dpp v89, v41, v40 quad_perm:[3,3,3,3] row_mask:0xf bank_mask:0xf
  s_nop 1
  v_add_f32_dpp v26, v89, v88 quad_perm:[2,2,2,2] row_mask:0xf bank_mask:0x1
  v_mfma_f32_16x16x32_bf16 v[38:41], a[208:211], v[12:15], 0
  v_mfma_f32_16x16x32_bf16 v[38:41], a[212:215], v[16:19], v[38:41]
  v_add_f32_dpp v88, v43, v42 quad_perm:[1,1,1,1] row_mask:0xf bank_mask:0xf
  v_add_f32_dpp v89, v45, v44 quad_perm:[3,3,3,3] row_mask:0xf bank_mask:0xf
  s_nop 1
  v_add_f32_dpp v26, v89, v88 quad_perm:[2,2,2,2] row_mask:0xf bank_mask:0x2
  v_mfma_f32_16x16x32_bf16 v[42:45], a[216:219], v[12:15], 0
  v_mfma_f32_16x16x32_bf16 v[42:45], a[220:223], v[16:19], v[42:45]
  s_waitcnt vmcnt(11)
  buffer_load_dwordx4 v[240:243], v4, s[44:47], s101 offen offset:256 nt
  v_add_f32_dpp v88, v39, v38 quad_perm:[1,1,1,1] row_mask:0xf bank_mask:0xf
  v_add_f32_dpp v89, v41, v40 quad_perm:[3,3,3,3] row_mask:0xf bank_mask:0xf
  s_nop 1
  v_add_f32_dpp v26, v89, v88 quad_perm:[2,2,2,2] row_mask:0xf bank_mask:0x4
  v_mfma_f32_16x16x32_bf16 v[38:41], a[224:227], v[12:15], 0
  v_mfma_f32_16x16x32_bf16 v[38:41], a[228:231], v[16:19], v[38:41]
  v_add_f32_dpp v88, v43, v42 quad_perm:[1,1,1,1] row_mask:0xf bank_mask:0xf
  v_add_f32_dpp v89, v45, v44 quad_perm:[3,3,3,3] row_mask:0xf bank_mask:0xf
  s_nop 1
  v_add_f32_dpp v26, v89, v88 quad_perm:[2,2,2,2] row_mask:0xf bank_mask:0x8
  v_mfma_f32_16x16x32_bf16 v[42:45], a[232:235], v[12:15], 0
  v_mfma_f32_16x16x32_bf16 v[42:45], a[236:239], v[16:19], v[42:45]
  s_waitcnt vmcnt(11)
  buffer_load_dwordx4 v[244:247], v4, s[44:47], s101 offen offset:2048 nt
  v_add_f32_dpp v88, v39, v38 quad_perm:[1,1,1,1] row_mask:0xf bank_mask:0xf
  v_add_f32_dpp v89, v41, v40 quad_perm:[3,3,3,3] row_mask:0xf bank_mask:0xf
  s_nop 1
  v_add_f32_dpp v27, v89, v88 quad_perm:[2,2,2,2] row_mask:0xf bank_mask:0x1
  v_mfma_f32_16x16x32_bf16 v[38:41], a[240:243], v[12:15], 0
  v_mfma_f32_16x16x32_bf16 v[38:41], a[244:247], v[16:19], v[38:41]
  v_add_f32_dpp v88, v43, v42 quad_perm:[1,1,1,1] row_mask:0xf bank_mask:0xf
  v_add_f32_dpp v89, v45, v44 quad_perm:[3,3,3,3] row_mask:0xf bank_mask:0xf
  s_nop 1
  v_add_f32_dpp v27, v89, v88 quad_perm:[2,2,2,2] row_mask:0xf bank_mask:0x2
  v_mfma_f32_16x16x32_bf16 v[42:45], a[248:251], v[12:15], 0
  v_mfma_f32_16x16x32_bf16 v[42:45], a[252:255], v[16:19], v[42:45]
  s_waitcnt vmcnt(11)
  buffer_load_dwordx4 v[248:251], v4, s[44:47], s101 offen offset:2304 nt
  v_add_f32_dpp v88, v39, v38 quad_perm:[1,1,1,1] row_mask:0xf bank_mask:0xf
  v_add_f32_dpp v89, v41, v40 quad_perm:[3,3,3,3] row_mask:0xf bank_mask:0xf
  s_nop 1
  v_add_f32_dpp v27, v89, v88 quad_perm:[2,2,2,2] row_mask:0xf bank_mask:0x4
  v_mfma_f32_16x16x32_bf16 v[38:41], v[140:143], v[12:15], 0
  v_mfma_f32_16x16x32_bf16 v[38:41], v[144:147], v[16:19], v[38:41]
  v_add_f32_dpp v88, v43, v42 quad_perm:[1,1,1,1] row_mask:0xf bank_mask:0xf
  v_add_f32_dpp v89, v45, v44 quad_perm:[3,3,3,3] row_mask:0xf bank_mask:0xf
  s_nop 1
  v_add_f32_dpp v27, v89, v88 quad_perm:[2,2,2,2] row_mask:0xf bank_mask:0x8
  v_mfma_f32_16x16x32_bf16 v[42:45], v[148:151], v[12:15], 0
  v_mfma_f32_16x16x32_bf16 v[42:45], v[152:155], v[16:19], v[42:45]
  s_waitcnt vmcnt(11)
  s_add_u32 s101, s101, 16384
  s_cmp_eq_u32 s101, s20
  s_cselect_b32 s101, 0, s101
  buffer_load_dwordx4 v[252:255], v4, s[44:47], s101 offen offset:0 nt
  v_add_f32_dpp v88, v39, v38 quad_perm:[1,1,1,1] row_mask:0xf bank_mask:0xf
  v_add_f32_dpp v89, v41, v40 quad_perm:[3,3,3,3] row_mask:0xf bank_mask:0xf
  s_nop 1
  v_add_f32_dpp v28, v89, v88 quad_perm:[2,2,2,2] row_mask:0xf bank_mask:0x1
  v_mfma_f32_16x16x32_bf16 v[38:41], v[156:159], v[12:15], 0
  v_mfma_f32_16x16x32_bf16 v[38:41], v[160:163], v[16:19], v[38:41]
  v_add_f32_dpp v88, v43, v42 quad_perm:[1,1,1,1] row_mask:0xf bank_mask:0xf
  v_add_f32_dpp v89, v45, v44 quad_perm:[3,3,3,3] row_mask:0xf bank_mask:0xf
  s_nop 1
  v_add_f32_dpp v28, v89, v88 quad_perm:[2,2,2,2] row_mask:0xf bank_mask:0x2
  v_mfma_f32_16x16x32_bf16 v[42:45], v[164:167], v[12:15], 0
  v_mfma_f32_16x16x32_bf16 v[42:45], v[168:171], v[16:19], v[42:45]
  s_waitcnt vmcnt(11)
  buffer_load_dwordx4 v[96:99], v4, s[44:47], s101 offen offset:256 nt
  v_add_f32_dpp v88, v39, v38 quad_perm:[1,1,1,1] row_mask:0xf bank_mask:0xf
  v_add_f32_dpp v89, v41, v40 quad_perm:[3,3,3,3] row_mask:0xf bank_mask:0xf
  s_nop 1
  v_add_f32_dpp v28, v89, v88 quad_perm:[2,2,2,2] row_mask:0xf bank_mask:0x4
  v_mfma_f32_16x16x32_bf16 v[38:41], v[172:175], v[12:15], 0
  v_mfma_f32_16x16x32_bf16 v[38:41], v[176:179], v[16:19], v[38:41]
  v_add_f32_dpp v88, v43, v42 quad_perm:[1,1,1,1] row_mask:0xf bank_mask:0xf
  v_add_f32_dpp v89, v45, v44 quad_perm:[3,3,3,3] row_mask:0xf bank_mask:0xf
  s_nop 1
  v_add_f32_dpp v28, v89, v88 quad_perm:[2,2,2,2] row_mask:0xf bank_mask:0x8
  v_mfma_f32_16x16x32_bf16 v[42:45], v[180:183], v[12:15], 0
  v_mfma_f32_16x16x32_bf16 v[42:45], v[184:187], v[16:19], v[42:45]
  s_waitcnt vmcnt(11)
  buffer_load_dwordx4 v[100:103], v4, s[44:47], s101 offen offset:2048 nt
  v_add_f32_dpp v88, v39, v38 quad_perm:[1,1,1,1] row_mask:0xf bank_mask:0xf
  v_add_f32_dpp v89, v41, v40 quad_perm:[3,3,3,3] row_mask:0xf bank_mask:0xf
  s_nop 1
  v_add_f32_dpp v29, v89, v88 quad_perm:[2,2,2,2] row_mask:0xf bank_mask:0x1
  v_mfma_f32_16x16x32_bf16 v[38:41], v[188:191], v[12:15], 0
  v_mfma_f32_16x16x32_bf16 v[38:41], v[192:195], v[16:19], v[38:41]
  v_add_f32_dpp v88, v43, v42 quad_perm:[1,1,1,1] row_mask:0xf bank_mask:0xf
  v_add_f32_dpp v89, v45, v44 quad_perm:[3,3,3,3] row_mask:0xf bank_mask:0xf
  s_nop 1
  v_add_f32_dpp v29, v89, v88 quad_perm:[2,2,2,2] row_mask:0xf bank_mask:0x2
  v_mfma_f32_16x16x32_bf16 v[42:45], v[196:199], v[12:15], 0
  v_mfma_f32_16x16x32_bf16 v[42:45], v[200:203], v[16:19], v[42:45]
  s_waitcnt vmcnt(11)
  buffer_load_dwordx4 v[104:107], v4, s[44:47], s101 offen offset:2304 nt
  v_add_f32_dpp v88, v39, v38 quad_perm:[1,1,1,1] row_mask:0xf bank_mask:0xf
  v_add_f32_dpp v89, v41, v40 quad_perm:[3,3,3,3] row_mask:0xf bank_mask:0xf
  s_nop 1
  v_add_f32_dpp v29, v89, v88 quad_perm:[2,2,2,2] row_mask:0xf bank_mask:0x4
  v_mfma_f32_16x16x32_bf16 v[38:41], v[204:207], v[12:15], 0
  v_mfma_f32_16x16x32_bf16 v[38:41], v[208:211], v[16:19], v[38:41]
  v_add_f32_dpp v88, v43, v42 quad_perm:[1,1,1,1] row_mask:0xf bank_mask:0xf
  v_add_f32_dpp v89, v45, v44 quad_perm:[3,3,3,3] row_mask:0xf bank_mask:0xf
  s_nop 1
  v_add_f32_dpp v29, v89, v88 quad_perm:[2,2,2,2] row_mask:0xf bank_mask:0x8
  v_mfma_f32_16x16x32_bf16 v[42:45], v[212:215], v[12:15], 0
  v_mfma_f32_16x16x32_bf16 v[42:45], v[216:219], v[16:19], v[42:45]
  s_waitcnt vmcnt(11)
  s_add_u32 s101, s101, 16384
  s_cmp_eq_u32 s101, s20
  s_cselect_b32 s101, 0, s101
  buffer_load_dwordx4 v[108:111], v4, s[44:47], s101 offen offset:0 nt
  v_add_f32_dpp v88, v39, v38 quad_perm:[1,1,1,1] row_mask:0xf bank_mask:0xf
  v_add_f32_dpp v89, v41, v40 quad_perm:[3,3,3,3] row_mask:0xf bank_mask:0xf
  s_nop 1
  v_add_f32_dpp v30, v89, v88 quad_perm:[2,2,2,2] row_mask:0xf bank_mask:0x1
  s_waitcnt vmcnt(11)
  v_mfma_f32_16x16x32_bf16 v[38:41], v[220:223], v[12:15], 0
  v_mfma_f32_16x16x32_bf16 v[38:41], v[224:227], v[16:19], v[38:41]
  buffer_load_dwordx4 v[112:115], v4, s[44:47], s101 offen offset:256 nt
  v_add_f32_dpp v88, v43, v42 quad_perm:[1,1,1,1] row_mask:0xf bank_mask:0xf
  v_add_f32_dpp v89, v45, v44 quad_perm:[3,3,3,3] row_mask:0xf bank_mask:0xf
  s_nop 1
  v_add_f32_dpp v30, v89, v88 quad_perm:[2,2,2,2] row_mask:0xf bank_mask:0x2
  s_waitcnt vmcnt(10)
  v_mfma_f32_16x16x32_bf16 v[42:45], v[228:231], v[12:15], 0
  v_mfma_f32_16x16x32_bf16 v[42:45], v[232:235], v[16:19], v[42:45]
  buffer_load_dwordx4 v[116:119], v4, s[44:47], s101 offen offset:2048 nt
  buffer_load_dwordx4 v[120:123], v4, s[44:47], s101 offen offset:2304 nt
  v_add_f32_dpp v88, v39, v38 quad_perm:[1,1,1,1] row_mask:0xf bank_mask:0xf
  v_add_f32_dpp v89, v41, v40 quad_perm:[3,3,3,3] row_mask:0xf bank_mask:0xf
  s_nop 1
  v_add_f32_dpp v30, v89, v88 quad_perm:[2,2,2,2] row_mask:0xf bank_mask:0x4
  s_waitcnt vmcnt(10)
  v_mfma_f32_16x16x32_bf16 v[38:41], v[236:239], v[12:15], 0
  v_mfma_f32_16x16x32_bf16 v[38:41], v[240:243], v[16:19], v[38:41]
  buffer_load_dwordx4 v[124:127], v5, s[48:51], s21 offen offset:0 nt
  buffer_load_dwordx4 v[128:131], v5, s[48:51], s21 offen offset:256 nt
  v_add_f32_dpp v88, v43, v42 quad_perm:[1,1,1,1] row_mask:0xf bank_mask:0xf
  v_add_f32_dpp v89, v45, v44 quad_perm:[3,3,3,3] row_mask:0xf bank_mask:0xf
  s_nop 1
  v_add_f32_dpp v30, v89, v88 quad_perm:[2,2,2,2] row_mask:0xf bank_mask:0x8
  s_waitcnt vmcnt(10)
  v_mfma_f32_16x16x32_bf16 v[42:45], v[244:247], v[12:15], 0
  v_mfma_f32_16x16x32_bf16 v[42:45], v[248:251], v[16:19], v[42:45]
  buffer_load_dwordx4 v[132:135], v5, s[48:51], s21 offen offset:2048 nt
  buffer_load_dwordx4 v[136:139], v5, s[48:51], s21 offen offset:2304 nt
  v_add_f32_dpp v88, v39, v38 quad_perm:[1,1,1,1] row_mask:0xf bank_mask:0xf
  v_add_f32_dpp v89, v41, v40 quad_perm:[3,3,3,3] row_mask:0xf bank_mask:0xf
  s_nop 1
  v_add_f32_dpp v31, v89, v88 quad_perm:[2,2,2,2] row_mask:0xf bank_mask:0x1
  s_waitcnt vmcnt(10)
  v_mfma_f32_16x16x32_bf16 v[38:41], v[252:255], v[12:15], 0
  v_mfma_f32_16x16x32_bf16 v[38:41], v[96:99], v[16:19], v[38:41]
  s_add_u32 s21, s21, 16384
  s_cmp_eq_u32 s21, s20
  s_cselect_b32 s21, 0, s21
  buffer_load_dwordx4 v[140:143], v5, s[48:51], s21 offen offset:0 nt
  buffer_load_dwordx4 v[144:147], v5, s[48:51], s21 offen offset:256 nt
  s_mov_b32 s96, 0
  buffer_load_dwordx4 a[0:3], v6, s[56:59], s96 offen offset:0
  s_mov_b32 s96, 0
  buffer_load_dwordx4 a[4:7], v6, s[56:59], s96 offen offset:256
  v_add_f32_dpp v88, v43, v42 quad_perm:[1,1,1,1] row_mask:0xf bank_mask:0xf
  v_add_f32_dpp v89, v45, v44 quad_perm:[3,3,3,3] row_mask:0xf bank_mask:0xf
  s_nop 1
  v_add_f32_dpp v31, v89, v88 quad_perm:[2,2,2,2] row_mask:0xf bank_mask:0x2
  s_waitcnt vmcnt(12)
  v_mfma_f32_16x16x32_bf16 v[42:45], v[100:103], v[12:15], 0
  v_mfma_f32_16x16x32_bf16 v[42:45], v[104:107], v[16:19], v[42:45]
  s_waitcnt vmcnt(11)
  buffer_load_dwordx4 v[148:151], v5, s[48:51], s21 offen offset:2048 nt
  s_waitcnt vmcnt(11)
  buffer_load_dwordx4 v[152:155], v5, s[48:51], s21 offen offset:2304 nt
  s_mov_b32 s96, 0
  buffer_load_dwordx4 a[8:11], v6, s[56:59], s96 offen offset:512
  s_mov_b32 s96, 0
  buffer_load_dwordx4 a[12:15], v7, s[56:59], s96 offen offset:768
  v_add_f32_dpp v88, v39, v38 quad_perm:[1,1,1,1] row_mask:0xf bank_mask:0xf
  v_add_f32_dpp v89, v41, v40 quad_perm:[3,3,3,3] row_mask:0xf bank_mask:0xf
  s_nop 1
  v_add_f32_dpp v31, v89, v88 quad_perm:[2,2,2,2] row_mask:0xf bank_mask:0x4
  v_mfma_f32_16x16x32_bf16 v[38:41], v[108:111], v[12:15], 0
  v_mfma_f32_16x16x32_bf16 v[38:41], v[112:115], v[16:19], v[38:41]
  s_waitcnt vmcnt(11)
  s_add_u32 s21, s21, 16384
  s_cmp_eq_u32 s21, s20
  s_cselect_b32 s21, 0, s21
  buffer_load_dwordx4 v[156:159], v5, s[48:51], s21 offen offset:0 nt
  s_waitcnt vmcnt(11)
  buffer_load_dwordx4 v[160:163], v5, s[48:51], s21 offen offset:256 nt
  s_mov_b32 s96, 3584
  buffer_load_dwordx4 a[16:19], v6, s[56:59], s96 offen offset:0
  v_add_f32_dpp v88, v43, v42 quad_perm:[1,1,1,1] row_mask:0xf bank_mask:0xf
  v_add_f32_dpp v89, v45, v44 quad_perm:[3,3,3,3] row_mask:0xf bank_mask:0xf
  s_nop 1
  v_add_f32_dpp v31, v89, v88 quad_perm:[2,2,2,2] row_mask:0xf bank_mask:0x8
  v_mfma_f32_16x16x32_bf16 v[42:45], v[116:119], v[12:15], 0
  v_mfma_f32_16x16x32_bf16 v[42:45], v[120:123], v[16:19], v[42:45]
  s_waitcnt vmcnt(11)
  buffer_load_dwordx4 v[164:167], v5, s[48:51], s21 offen offset:2048 nt
  s_waitcnt vmcnt(11)
  buffer_load_dwordx4 v[168:171], v5, s[48:51], s21 offen offset:2304 nt
  s_mov_b32 s96, 3584
  buffer_load_dwordx4 a[20:23], v6, s[56:59], s96 offen offset:256
  s_mov_b32 s96, 3584
  buffer_load_dwordx4 a[24:27], v6, s[56:59], s96 offen offset:512
  v_add_f32_dpp v88, v39, v38 quad_perm:[1,1,1,1] row_mask:0xf bank_mask:0xf
  v_add_f32_dpp v89, v41, v40 quad_perm:[3,3,3,3] row_mask:0xf bank_mask:0xf
  s_nop 1
  v_add_f32_dpp v32, v89, v88 quad_perm:[2,2,2,2] row_mask:0xf bank_mask:0x1
  v_add_f32_dpp v88, v43, v42 quad_perm:[1,1,1,1] row_mask:0xf bank_mask:0xf
  v_add_f32_dpp v89, v45, v44 quad_perm:[3,3,3,3] row_mask:0xf bank_mask:0xf
  s_nop 1
  v_add_f32_dpp v32, v89, v88 quad_perm:[2,2,2,2] row_mask:0xf bank_mask:0x2
  v_max3_f32 v80, v20, v21, v22
  v_max3_f32 v80, v80, v23, v24
  v_max3_f32 v80, v80, v25, v26
  v_max3_f32 v80, v80, v27, v28
  v_max3_f32 v80, v80, v29, v30
  v_max3_f32 v80, v80, v31, v32
  s_nop 1
  v_mov_b32_dpp v81, v80 quad_perm:[0,0,0,0] row_mask:0xf bank_mask:0xf
  s_nop 1
  v_max_f32_dpp v80, v81, v81 row_ror:4 row_mask:0xf bank_mask:0xf
  s_nop 1
  v_max_f32_dpp v81, v80, v80 row_ror:8 row_mask:0xf bank_mask:0xf
  s_lshl_b32 s12, s3, 4
  v_lshlrev_b32 v82, 2, v3
  v_add_u32 v82, s12, v82
  ds_write_b32 v82, v81 offset:2560
  s_waitcnt lgkmcnt(0)
  s_barrier
  v_mov_b32 v83, 0
  ds_read_b128 v[54:57], v83 offset:2560
  ds_read_b128 v[58:61], v83 offset:2576
  ds_read_b128 v[62:65], v83 offset:2592
  ds_read_b128 v[66:69], v83 offset:2608
  s_waitcnt lgkmcnt(0)
  v_max3_f32 v80, v54, v55, v56
  v_max3_f32 v80, v80, v57, v58
  v_max3_f32 v80, v80, v59, v60
  v_max3_f32 v80, v80, v61, v62
  v_max3_f32 v80, v80, v63, v64
  v_max3_f32 v80, v80, v65, v66
  v_max3_f32 v80, v80, v67, v68
  v_max_f32 v80, v80, v69
  v_mul_f32 v80, s92, v80
  v_fma_f32 v20, v20, s92, -v80
  v_fma_f32 v21, v21, s92, -v80
  v_fma_f32 v22, v22, s92, -v80
  v_fma_f32 v23, v23, s92, -v80
  v_fma_f32 v24, v24, s92, -v80
  v_fma_f32 v25, v25, s92, -v80
  v_fma_f32 v26, v26, s92, -v80
  v_fma_f32 v27, v27, s92, -v80
  v_fma_f32 v28, v28, s92, -v80
  v_fma_f32 v29, v29, s92, -v80
  v_fma_f32 v30, v30, s92, -v80
  v_fma_f32 v31, v31, s92, -v80
  v_fma_f32 v32, v32, s92, -v80
  v_exp_f32 v20, v20
  v_exp_f32 v21, v21
  v_exp_f32 v22, v22
  v_exp_f32 v23, v23
  v_exp_f32 v24, v24
  v_exp_f32 v25, v25
  v_exp_f32 v26, v26
  v_exp_f32 v27, v27
  v_exp_f32 v28, v28
  v_exp_f32 v29, v29
  v_exp_f32 v30, v30
  v_exp_f32 v31, v31
  v_exp_f32 v32, v32
  v_add_f32 v81, v20, v21
  v_add_f32 v81, v81, v22
  v_add_f32 v81, v81, v23
  v_add_f32 v81, v81, v24
  v_add_f32 v81, v81, v25
  v_add_f32 v81, v81, v26
  v_add_f32 v81, v81, v27
  v_add_f32 v81, v81, v28
  v_add_f32 v81, v81, v29
  v_add_f32 v81, v81, v30
  v_add_f32 v81, v81, v31
  v_add_f32 v81, v81, v32
  v_cvt_pk_bf16_f32 v20, v20, v20
  v_cvt_pk_bf16_f32 v21, v21, v21
  v_cvt_pk_bf16_f32 v22, v22, v22
  v_cvt_pk_bf16_f32 v23, v23, v23
  v_cvt_pk_bf16_f32 v24, v24, v24
  v_cvt_pk_bf16_f32 v25, v25, v25
  v_cvt_pk_bf16_f32 v26, v26, v26
  v_cvt_pk_bf16_f32 v27, v27, v27
  v_cvt_pk_bf16_f32 v28, v28, v28
  v_cvt_pk_bf16_f32 v29, v29, v29
  v_cvt_pk_bf16_f32 v30, v30, v30
  v_cvt_pk_bf16_f32 v31, v31, v31
  v_cvt_pk_bf16_f32 v32, v32, v32
  v_mov_b32_dpp v83, v81 quad_perm:[0,0,0,0] row_mask:0xf bank_mask:0xf
  s_nop 1
  v_add_f32_dpp v81, v83, v83 row_ror:4 row_mask:0xf bank_mask:0xf
  s_nop 1
  v_add_f32_dpp v83, v81, v81 row_ror:8 row_mask:0xf bank_mask:0xf
  ds_write_b32 v82, v83 offset:2688
  s_waitcnt lgkmcnt(0)
  s_barrier
  v_mov_b32 v83, 0
  ds_read_b128 v[54:57], v83 offset:2688
  ds_read_b128 v[58:61], v83 offset:2704
  ds_read_b128 v[62:65], v83 offset:2720
  ds_read_b128 v[66:69], v83 offset:2736
  s_waitcnt lgkmcnt(0)
  v_add_f32 v54, v54, v55
  v_add_f32 v56, v56, v57
  v_add_f32 v58, v58, v59
  v_add_f32 v60, v60, v61
  v_add_f32 v62, v62, v63
  v_add_f32 v64, v64, v65
  v_add_f32 v66, v66, v67
  v_add_f32 v68, v68, v69
  v_add_f32 v54, v54, v56
  v_add_f32 v58, v58, v60
  v_add_f32 v62, v62, v64
  v_add_f32 v66, v66, v68
  v_add_f32 v54, v54, v58
  v_add_f32 v62, v62, v66
  v_add_f32 v54, v54, v62
  v_min_u32 v46, -2, v80
  v_min_u32 v47, -2, v54
  v_cmp_eq_u32 vcc, 0, v0
  v_mov_b32 v84, 0x7ff00000
  v_mov_b32 v85, 0
  v_cndmask_b32 v84, v84, v85, vcc
  s_lshl_b32 s13, s10, 3
  s_add_u32 s13, s13, 786432
  buffer_store_dwordx2 v[46:47], v84, s[64:67], s13 offen sc1
  v_and_b32_dpp v46, v20, v8 row_newbcast:0 row_mask:0xf bank_mask:0xf
  v_and_b32_dpp v47, v20, v9 row_newbcast:0 row_mask:0xf bank_mask:0xf
  v_and_b32_dpp v48, v20, v10 row_newbcast:0 row_mask:0xf bank_mask:0xf
  v_and_b32_dpp v49, v20, v11 row_newbcast:0 row_mask:0xf bank_mask:0xf
  v_and_b32_dpp v50, v20, v8 row_newbcast:4 row_mask:0xf bank_mask:0xf
  v_and_b32_dpp v51, v20, v9 row_newbcast:4 row_mask:0xf bank_mask:0xf
  v_and_b32_dpp v52, v20, v10 row_newbcast:4 row_mask:0xf bank_mask:0xf
  v_and_b32_dpp v53, v20, v11 row_newbcast:4 row_mask:0xf bank_mask:0xf
  v_mfma_f32_16x16x32_bf16 v[38:41], v[124:127], v[46:49], 0
  v_mfma_f32_16x16x32_bf16 v[42:45], v[128:131], v[46:49], 0
  s_add_u32 s21, s21, 16384
  s_cmp_eq_u32 s21, s20
  s_cselect_b32 s21, 0, s21
  buffer_load_dwordx4 v[172:175], v5, s[48:51], s21 offen offset:0 nt
  buffer_load_dwordx4 v[176:179], v5, s[48:51], s21 offen offset:256 nt
  s_mov_b32 s96, 3584
  buffer_load_dwordx4 a[28:31], v7, s[56:59], s96 offen offset:768
  s_mov_b32 s96, 7168
  buffer_load_dwordx4 a[32:35], v6, s[56:59], s96 offen offset:0
  v_and_b32_dpp v46, v20, v8 row_newbcast:8 row_mask:0xf bank_mask:0xf
  v_and_b32_dpp v47, v20, v9 row_newbcast:8 row_mask:0xf bank_mask:0xf
  v_and_b32_dpp v48, v20, v10 row_newbcast:8 row_mask:0xf bank_mask:0xf
  v_and_b32_dpp v49, v20, v11 row_newbcast:8 row_mask:0xf bank_mask:0xf
  v_mfma_f32_16x16x32_bf16 v[38:41], v[132:135], v[50:53], v[38:41]
  v_mfma_f32_16x16x32_bf16 v[42:45], v[136:139], v[50:53], v[42:45]
  buffer_load_dwordx4 v[180:183], v5, s[48:51], s21 offen offset:2048 nt
  buffer_load_dwordx4 v[184:187], v5, s[48:51], s21 offen offset:2304 nt
  s_mov_b32 s96, 7168
  buffer_load_dwordx4 a[36:39], v6, s[56:59], s96 offen offset:256
  v_and_b32_dpp v50, v20, v8 row_newbcast:12 row_mask:0xf bank_mask:0xf
  v_and_b32_dpp v51, v20, v9 row_newbcast:12 row_mask:0xf bank_mask:0xf
  v_and_b32_dpp v52, v20, v10 row_newbcast:12 row_mask:0xf bank_mask:0xf
  v_and_b32_dpp v53, v20, v11 row_newbcast:12 row_mask:0xf bank_mask:0xf
  s_waitcnt vmcnt(21)
  v_mfma_f32_16x16x32_bf16 v[38:41], v[140:143], v[46:49], v[38:41]
  v_mfma_f32_16x16x32_bf16 v[42:45], v[144:147], v[46:49], v[42:45]
  s_add_u32 s21, s21, 16384
  s_cmp_eq_u32 s21, s20
  s_cselect_b32 s21, 0, s21
  buffer_load_dwordx4 v[188:191], v5, s[48:51], s21 offen offset:0 nt
  buffer_load_dwordx4 v[192:195], v5, s[48:51], s21 offen offset:256 nt
  s_mov_b32 s96, 7168
  buffer_load_dwordx4 a[40:43], v6, s[56:59], s96 offen offset:512
  s_mov_b32 s96, 7168
  buffer_load_dwordx4 a[44:47], v7, s[56:59], s96 offen offset:768
  s_cmp_ge_u32 s11, 28
  s_cselect_b32 s97, 1, 0
  s_mul_i32 s12, s97, 28
  s_sub_u32 s12, s11, s12
  s_cmp_ge_u32 s12, 26
  s_cselect_b32 s13, 2, 0
  s_add_u32 s12, s12, s13
  s_lshl_b32 s98, s97, 18
  s_lshl_b32 s96, s12, 6
  s_add_u32 s98, s98, s96
  s_add_u32 s98, s98, 262144
  s_lshr_b32 s13, s12, 4
  s_lshl_b32 s13, s13, 1
  s_bfe_u32 s14, s12, 0x10003
  s_add_u32 s13, s13, s14
  s_lshl_b32 s100, s13, 7
  s_and_b32 s13, s12, 3
  s_lshl_b32 s13, s13, 5
  s_add_u32 s100, s100, s13
  s_bfe_u32 s13, s12, 0x10002
  s_lshl_b32 s13, s13, 2
  s_add_u32 s100, s100, s13
  v_and_b32 v81, 3, v1
  v_lshlrev_b32 v81, 3, v81
  v_add_u32 v81, s100, v81
  v_mov_b32 v82, 384
  v_cmp_gt_u32 vcc, v82, v81
  v_lshrrev_b32 v83, 7, v81
  s_nop 0
  v_cndmask_b32 v83, 3, v83, vcc
  v_and_b32 v84, 127, v81
  v_subrev_u32 v85, 320, v81
  v_cndmask_b32 v84, v85, v84, vcc
  v_lshlrev_b32 v83, 10, v83
  v_and_b32 v85, 7, v84
  s_lshl_b32 s13, s97, 3
  v_add_u32 v85, s13, v85
  v_lshl_add_u32 v83, v85, 4, v83
  v_lshrrev_b32 v84, 3, v84
  v_lshrrev_b32 v85, 2, v84
  v_lshl_add_u32 v83, v85, 8, v83
  v_and_b32 v84, 3, v84
  v_lshl_add_u32 v94, v84, 2, v83
  s_mov_b32 s99, 794624
  v_lshrrev_b32 v80, 2, v1
  v_lshlrev_b32 v92, 14, v80
  v_and_b32 v82, 3, v1
  v_lshl_add_u32 v92, v82, 4, v92
  s_mul_i32 s15, s97, 448
  v_add_u32 v81, s15, v81
  v_lshlrev_b32 v81, 1, v81
  v_mov_b32 v82, 0x7ff00000
  v_cmp_gt_u32 vcc, 4, v1
  s_nop 1
  v_cndmask_b32 v93, v82, v81, vcc
  s_mov_b32 s72, s36
  s_and_b32 s73, s37, 0xffff
  s_mov_b32 s74, 1792
  s_mov_b32 s75, 0x20000
  v_and_b32_dpp v46, v21, v8 row_newbcast:0 row_mask:0xf bank_mask:0xf
  v_and_b32_dpp v47, v21, v9 row_newbcast:0 row_mask:0xf bank_mask:0xf
  v_and_b32_dpp v48, v21, v10 row_newbcast:0 row_mask:0xf bank_mask:0xf
  v_and_b32_dpp v49, v21, v11 row_newbcast:0 row_mask:0xf bank_mask:0xf
  s_waitcnt vmcnt(21)
  v_mfma_f32_16x16x32_bf16 v[38:41], v[148:151], v[50:53], v[38:41]
  v_mfma_f32_16x16x32_bf16 v[42:45], v[152:155], v[50:53], v[42:45]
  buffer_load_dwordx4 v[196:199], v5, s[48:51], s21 offen offset:2048 nt
  buffer_load_dwordx4 v[200:203], v5, s[48:51], s21 offen offset:2304 nt
  s_mov_b32 s96, 10752
  buffer_load_dwordx4 a[48:51], v6, s[56:59], s96 offen offset:0
  s_mov_b32 s96, 10752
  buffer_load_dwordx4 a[52:55], v6, s[56:59], s96 offen offset:256
  v_and_b32_dpp v50, v21, v8 row_newbcast:4 row_mask:0xf bank_mask:0xf
  v_and_b32_dpp v51, v21, v9 row_newbcast:4 row_mask:0xf bank_mask:0xf
  v_and_b32_dpp v52, v21, v10 row_newbcast:4 row_mask:0xf bank_mask:0xf
  v_and_b32_dpp v53, v21, v11 row_newbcast:4 row_mask:0xf bank_mask:0xf
  s_waitcnt vmcnt(21)
  v_mfma_f32_16x16x32_bf16 v[38:41], v[156:159], v[46:49], v[38:41]
  v_mfma_f32_16x16x32_bf16 v[42:45], v[160:163], v[46:49], v[42:45]
  s_add_u32 s21, s21, 16384
  s_cmp_eq_u32 s21, s20
  s_cselect_b32 s21, 0, s21
  buffer_load_dwordx4 v[204:207], v5, s[48:51], s21 offen offset:0 nt
  buffer_load_dwordx4 v[208:211], v5, s[48:51], s21 offen offset:256 nt
  s_mov_b32 s96, 10752
  buffer_load_dwordx4 a[56:59], v6, s[56:59], s96 offen offset:512
  s_mul_i32 s12, s97, 896
  s_add_u32 s88, s16, s12
  s_addc_u32 s89, s17, 0
  s_and_b32 s89, s89, 0xffff
  s_mov_b32 s90, 896
  s_mov_b32 s91, 0x20000
  s_mov_b32 s84, s34
  s_and_b32 s85, s35, 0xffff
  s_mov_b32 s86, 896
  s_mov_b32 s87, 0x20000
  v_lshlrev_b32 v80, 4, v1
  buffer_load_dwordx4 v[54:57], v80, s[88:91], 0 offen
  buffer_load_dwordx4 v[58:61], v80, s[84:87], 0 offen
  v_and_b32_dpp v46, v21, v8 row_newbcast:8 row_mask:0xf bank_mask:0xf
  v_and_b32_dpp v47, v21, v9 row_newbcast:8 row_mask:0xf bank_mask:0xf
  v_and_b32_dpp v48, v21, v10 row_newbcast:8 row_mask:0xf bank_mask:0xf
  v_and_b32_dpp v49, v21, v11 row_newbcast:8 row_mask:0xf bank_mask:0xf
  s_waitcnt vmcnt(23)
  v_mfma_f32_16x16x32_bf16 v[38:41], v[164:167], v[50:53], v[38:41]
  v_mfma_f32_16x16x32_bf16 v[42:45], v[168:171], v[50:53], v[42:45]
  buffer_load_dwordx4 v[212:215], v5, s[48:51], s21 offen offset:2048 nt
  buffer_load_dwordx4 v[216:219], v5, s[48:51], s21 offen offset:2304 nt
  s_mov_b32 s96, 10752
  buffer_load_dwordx4 a[60:63], v7, s[56:59], s96 offen offset:768
  s_mov_b32 s96, 14336
  buffer_load_dwordx4 a[64:67], v6, s[56:59], s96 offen offset:0
  v_and_b32_dpp v50, v21, v8 row_newbcast:12 row_mask:0xf bank_mask:0xf
  v_and_b32_dpp v51, v21, v9 row_newbcast:12 row_mask:0xf bank_mask:0xf
  v_and_b32_dpp v52, v21, v10 row_newbcast:12 row_mask:0xf bank_mask:0xf
  v_and_b32_dpp v53, v21, v11 row_newbcast:12 row_mask:0xf bank_mask:0xf
  s_waitcnt vmcnt(22)
  v_mfma_f32_16x16x32_bf16 v[38:41], v[172:175], v[46:49], v[38:41]
  v_mfma_f32_16x16x32_bf16 v[42:45], v[176:179], v[46:49], v[42:45]
  s_add_u32 s21, s21, 16384
  s_cmp_eq_u32 s21, s20
  s_cselect_b32 s21, 0, s21
  buffer_load_dwordx4 v[220:223], v5, s[48:51], s21 offen offset:0 nt
  buffer_load_dwordx4 v[224:227], v5, s[48:51], s21 offen offset:256 nt
  s_mov_b32 s96, 14336
  buffer_load_dwordx4 a[68:71], v6, s[56:59], s96 offen offset:256
  s_mov_b32 s96, 14336
  buffer_load_dwordx4 a[72:75], v6, s[56:59], s96 offen offset:512
  v_and_b32_dpp v46, v22, v8 row_newbcast:0 row_mask:0xf bank_mask:0xf
  v_and_b32_dpp v47, v22, v9 row_newbcast:0 row_mask:0xf bank_mask:0xf
  v_and_b32_dpp v48, v22, v10 row_newbcast:0 row_mask:0xf bank_mask:0xf
  v_and_b32_dpp v49, v22, v11 row_newbcast:0 row_mask:0xf bank_mask:0xf
  s_waitcnt vmcnt(22)
  v_mfma_f32_16x16x32_bf16 v[38:41], v[180:183], v[50:53], v[38:41]
  v_mfma_f32_16x16x32_bf16 v[42:45], v[184:187], v[50:53], v[42:45]
  buffer_load_dwordx4 v[228:231], v5, s[48:51], s21 offen offset:2048 nt
  buffer_load_dwordx4 v[232:235], v5, s[48:51], s21 offen offset:2304 nt
  s_mov_b32 s96, 14336
  buffer_load_dwordx4 a[76:79], v7, s[56:59], s96 offen offset:768
  v_and_b32_dpp v50, v22, v8 row_newbcast:4 row_mask:0xf bank_mask:0xf
  v_and_b32_dpp v51, v22, v9 row_newbcast:4 row_mask:0xf bank_mask:0xf
  v_and_b32_dpp v52, v22, v10 row_newbcast:4 row_mask:0xf bank_mask:0xf
  v_and_b32_dpp v53, v22, v11 row_newbcast:4 row_mask:0xf bank_mask:0xf
  s_waitcnt vmcnt(22)
  v_mfma_f32_16x16x32_bf16 v[38:41], v[188:191], v[46:49], v[38:41]
  v_mfma_f32_16x16x32_bf16 v[42:45], v[192:195], v[46:49], v[42:45]
  s_add_u32 s21, s21, 16384
  s_cmp_eq_u32 s21, s20
  s_cselect_b32 s21, 0, s21
  buffer_load_dwordx4 v[236:239], v5, s[48:51], s21 offen offset:0 nt
  buffer_load_dwordx4 v[240:243], v5, s[48:51], s21 offen offset:256 nt
  s_mov_b32 s96, 17920
  buffer_load_dwordx4 a[80:83], v6, s[56:59], s96 offen offset:0
  s_mov_b32 s96, 17920
  buffer_load_dwordx4 a[84:87], v6, s[56:59], s96 offen offset:256
  s_waitcnt vmcnt(15)
  v_mov_b32 v80, 0
  v_dot2_f32_bf16 v80, v54, v58, v80
  v_dot2_f32_bf16 v80, v55, v59, v80
  v_dot2_f32_bf16 v80, v56, v60, v80
  v_dot2_f32_bf16 v80, v57, v61, v80
  s_nop 2
  v_add_f32_dpp v80, v80, v80 row_ror:8 row_mask:0xf bank_mask:0xf
  s_nop 1
  v_add_f32_dpp v80, v80, v80 row_ror:4 row_mask:0xf bank_mask:0xf
  s_nop 1
  v_add_f32_dpp v80, v80, v80 row_ror:2 row_mask:0xf bank_mask:0xf
  s_nop 1
  v_add_f32_dpp v80, v80, v80 row_ror:1 row_mask:0xf bank_mask:0xf
  v_mov_b32 v81, v80
  s_nop 1
  v_permlane16_swap_b32 v80, v81
  v_add_f32 v80, v80, v81
  v_mov_b32 v81, v80
  s_nop 1
  v_permlane32_swap_b32 v80, v81
  v_add_f32 v80, v80, v81
  v_mul_f32 v80, 0xbfb8aa3b, v80
  v_exp_f32 v80, v80
  s_nop 0
  v_add_f32 v80, 1.0, v80
  v_rcp_f32 v70, v80
  v_and_b32_dpp v46, v22, v8 row_newbcast:8 row_mask:0xf bank_mask:0xf
  v_and_b32_dpp v47, v22, v9 row_newbcast:8 row_mask:0xf bank_mask:0xf
  v_and_b32_dpp v48, v22, v10 row_newbcast:8 row_mask:0xf bank_mask:0xf
  v_and_b32_dpp v49, v22, v11 row_newbcast:8 row_mask:0xf bank_mask:0xf
  v_mfma_f32_16x16x32_bf16 v[38:41], v[196:199], v[50:53], v[38:41]
  v_mfma_f32_16x16x32_bf16 v[42:45], v[200:203], v[50:53], v[42:45]
  buffer_load_dwordx4 v[244:247], v5, s[48:51], s21 offen offset:2048 nt
  buffer_load_dwordx4 v[248:251], v5, s[48:51], s21 offen offset:2304 nt
  s_mov_b32 s96, 17920
  buffer_load_dwordx4 a[88:91], v6, s[56:59], s96 offen offset:512
  v_and_b32_dpp v50, v22, v8 row_newbcast:12 row_mask:0xf bank_mask:0xf
  v_and_b32_dpp v51, v22, v9 row_newbcast:12 row_mask:0xf bank_mask:0xf
  v_and_b32_dpp v52, v22, v10 row_newbcast:12 row_mask:0xf bank_mask:0xf
  v_and_b32_dpp v53, v22, v11 row_newbcast:12 row_mask:0xf bank_mask:0xf
  v_mfma_f32_16x16x32_bf16 v[38:41], v[204:207], v[46:49], v[38:41]
  v_mfma_f32_16x16x32_bf16 v[42:45], v[208:211], v[46:49], v[42:45]
  s_add_u32 s21, s21, 16384
  s_cmp_eq_u32 s21, s20
  s_cselect_b32 s21, 0, s21
  buffer_load_dwordx4 v[252:255], v5, s[48:51], s21 offen offset:0 nt
  buffer_load_dwordx4 v[96:99], v5, s[48:51], s21 offen offset:256 nt
  s_mov_b32 s96, 17920
  buffer_load_dwordx4 a[92:95], v7, s[56:59], s96 offen offset:768
  s_mov_b32 s96, 21504
  buffer_load_dwordx4 a[96:99], v6, s[56:59], s96 offen offset:0
  v_and_b32_dpp v46, v23, v8 row_newbcast:0 row_mask:0xf bank_mask:0xf
  v_and_b32_dpp v47, v23, v9 row_newbcast:0 row_mask:0xf bank_mask:0xf
  v_and_b32_dpp v48, v23, v10 row_newbcast:0 row_mask:0xf bank_mask:0xf
  v_and_b32_dpp v49, v23, v11 row_newbcast:0 row_mask:0xf bank_mask:0xf
  s_waitcnt vmcnt(20)
  v_mfma_f32_16x16x32_bf16 v[38:41], v[212:215], v[50:53], v[38:41]
  v_mfma_f32_16x16x32_bf16 v[42:45], v[216:219], v[50:53], v[42:45]
  buffer_load_dwordx4 v[100:103], v5, s[48:51], s21 offen offset:2048 nt
  buffer_load_dwordx4 v[104:107], v5, s[48:51], s21 offen offset:2304 nt
  s_mov_b32 s96, 21504
  buffer_load_dwordx4 a[100:103], v6, s[56:59], s96 offen offset:256
  s_mov_b32 s96, 21504
  buffer_load_dwordx4 a[104:107], v6, s[56:59], s96 offen offset:512
  v_and_b32_dpp v50, v23, v8 row_newbcast:4 row_mask:0xf bank_mask:0xf
  v_and_b32_dpp v51, v23, v9 row_newbcast:4 row_mask:0xf bank_mask:0xf
  v_and_b32_dpp v52, v23, v10 row_newbcast:4 row_mask:0xf bank_mask:0xf
  v_and_b32_dpp v53, v23, v11 row_newbcast:4 row_mask:0xf bank_mask:0xf
  s_waitcnt vmcnt(20)
  v_mfma_f32_16x16x32_bf16 v[38:41], v[220:223], v[46:49], v[38:41]
  v_mfma_f32_16x16x32_bf16 v[42:45], v[224:227], v[46:49], v[42:45]
  s_add_u32 s21, s21, 16384
  s_cmp_eq_u32 s21, s20
  s_cselect_b32 s21, 0, s21
  buffer_load_dwordx4 v[108:111], v5, s[48:51], s21 offen offset:0 nt
  buffer_load_dwordx4 v[112:115], v5, s[48:51], s21 offen offset:256 nt
  s_mov_b32 s96, 21504
  buffer_load_dwordx4 a[108:111], v7, s[56:59], s96 offen offset:768
  v_and_b32_dpp v46, v23, v8 row_newbcast:8 row_mask:0xf bank_mask:0xf
  v_and_b32_dpp v47, v23, v9 row_newbcast:8 row_mask:0xf bank_mask:0xf
  v_and_b32_dpp v48, v23, v10 row_newbcast:8 row_mask:0xf bank_mask:0xf
  v_and_b32_dpp v49, v23, v11 row_newbcast:8 row_mask:0xf bank_mask:0xf
  s_waitcnt vmcnt(19)
  v_mfma_f32_16x16x32_bf16 v[38:41], v[228:231], v[50:53], v[38:41]
  v_mfma_f32_16x16x32_bf16 v[42:45], v[232:235], v[50:53], v[42:45]
  buffer_load_dwordx4 v[116:119], v5, s[48:51], s21 offen offset:2048 nt
  buffer_load_dwordx4 v[120:123], v5, s[48:51], s21 offen offset:2304 nt
  s_mov_b32 s96, 25088
  buffer_load_dwordx4 a[112:115], v6, s[56:59], s96 offen offset:0
  s_mov_b32 s96, 25088
  buffer_load_dwordx4 a[116:119], v6, s[56:59], s96 offen offset:256
  v_and_b32_dpp v50, v23, v8 row_newbcast:12 row_mask:0xf bank_mask:0xf
  v_and_b32_dpp v51, v23, v9 row_newbcast:12 row_mask:0xf bank_mask:0xf
  v_and_b32_dpp v52, v23, v10 row_newbcast:12 row_mask:0xf bank_mask:0xf
  v_and_b32_dpp v53, v23, v11 row_newbcast:12 row_mask:0xf bank_mask:0xf
  s_waitcnt vmcnt(20)
  v_mfma_f32_16x16x32_bf16 v[38:41], v[236:239], v[46:49], v[38:41]
  v_mfma_f32_16x16x32_bf16 v[42:45], v[240:243], v[46:49], v[42:45]
  s_add_u32 s21, s21, 16384
  s_cmp_eq_u32 s21, s20
  s_cselect_b32 s21, 0, s21
  buffer_load_dwordx4 v[124:127], v5, s[48:51], s21 offen offset:0 nt
  buffer_load_dwordx4 v[128:131], v5, s[48:51], s21 offen offset:256 nt
  s_mov_b32 s96, 25088
  buffer_load_dwordx4 a[120:123], v6, s[56:59], s96 offen offset:512
  s_mov_b32 s96, 25088
  buffer_load_dwordx4 a[124:127], v7, s[56:59], s96 offen offset:768
  v_and_b32_dpp v46, v24, v8 row_newbcast:0 row_mask:0xf bank_mask:0xf
  v_and_b32_dpp v47, v24, v9 row_newbcast:0 row_mask:0xf bank_mask:0xf
  v_and_b32_dpp v48, v24, v10 row_newbcast:0 row_mask:0xf bank_mask:0xf
  v_and_b32_dpp v49, v24, v11 row_newbcast:0 row_mask:0xf bank_mask:0xf
  s_waitcnt vmcnt(20)
  v_mfma_f32_16x16x32_bf16 v[38:41], v[244:247], v[50:53], v[38:41]
  v_mfma_f32_16x16x32_bf16 v[42:45], v[248:251], v[50:53], v[42:45]
  buffer_load_dwordx4 v[132:135], v5, s[48:51], s21 offen offset:2048 nt
  buffer_load_dwordx4 v[136:139], v5, s[48:51], s21 offen offset:2304 nt
  s_mov_b32 s96, 28672
  buffer_load_dwordx4 a[128:131], v6, s[56:59], s96 offen offset:0
  v_and_b32_dpp v50, v24, v8 row_newbcast:4 row_mask:0xf bank_mask:0xf
  v_and_b32_dpp v51, v24, v9 row_newbcast:4 row_mask:0xf bank_mask:0xf
  v_and_b32_dpp v52, v24, v10 row_newbcast:4 row_mask:0xf bank_mask:0xf
  v_and_b32_dpp v53, v24, v11 row_newbcast:4 row_mask:0xf bank_mask:0xf
  s_waitcnt vmcnt(20)
  v_mfma_f32_16x16x32_bf16 v[38:41], v[252:255], v[46:49], v[38:41]
  v_mfma_f32_16x16x32_bf16 v[42:45], v[96:99], v[46:49], v[42:45]
  s_add_u32 s21, s21, 16384
  s_cmp_eq_u32 s21, s20
  s_cselect_b32 s21, 0, s21
  buffer_load_dwordx4 v[140:143], v5, s[48:51], s21 offen offset:0 nt
  buffer_load_dwordx4 v[144:147], v5, s[48:51], s21 offen offset:256 nt
  s_mov_b32 s96, 28672
  buffer_load_dwordx4 a[132:135], v6, s[56:59], s96 offen offset:256
  s_mov_b32 s96, 28672
  buffer_load_dwordx4 a[136:139], v6, s[56:59], s96 offen offset:512
  v_and_b32_dpp v46, v24, v8 row_newbcast:8 row_mask:0xf bank_mask:0xf
  v_and_b32_dpp v47, v24, v9 row_newbcast:8 row_mask:0xf bank_mask:0xf
  v_and_b32_dpp v48, v24, v10 row_newbcast:8 row_mask:0xf bank_mask:0xf
  v_and_b32_dpp v49, v24, v11 row_newbcast:8 row_mask:0xf bank_mask:0xf
  s_waitcnt vmcnt(20)
  v_mfma_f32_16x16x32_bf16 v[38:41], v[100:103], v[50:53], v[38:41]
  v_mfma_f32_16x16x32_bf16 v[42:45], v[104:107], v[50:53], v[42:45]
  buffer_load_dwordx4 v[148:151], v5, s[48:51], s21 offen offset:2048 nt
  buffer_load_dwordx4 v[152:155], v5, s[48:51], s21 offen offset:2304 nt
  s_mov_b32 s96, 28672
  buffer_load_dwordx4 a[140:143], v7, s[56:59], s96 offen offset:768
  s_mov_b32 s96, 32256
  buffer_load_dwordx4 a[144:147], v6, s[56:59], s96 offen offset:0
  v_and_b32_dpp v50, v24, v8 row_newbcast:12 row_mask:0xf bank_mask:0xf
  v_and_b32_dpp v51, v24, v9 row_newbcast:12 row_mask:0xf bank_mask:0xf
  v_and_b32_dpp v52, v24, v10 row_newbcast:12 row_mask:0xf bank_mask:0xf
  v_and_b32_dpp v53, v24, v11 row_newbcast:12 row_mask:0xf bank_mask:0xf
  s_waitcnt vmcnt(20)
  v_mfma_f32_16x16x32_bf16 v[38:41], v[108:111], v[46:49], v[38:41]
  v_mfma_f32_16x16x32_bf16 v[42:45], v[112:115], v[46:49], v[42:45]
  s_add_u32 s21, s21, 16384
  s_cmp_eq_u32 s21, s20
  s_cselect_b32 s21, 0, s21
  buffer_load_dwordx4 v[156:159], v5, s[48:51], s21 offen offset:0 nt
  buffer_load_dwordx4 v[160:163], v5, s[48:51], s21 offen offset:256 nt
  s_mov_b32 s96, 32256
  buffer_load_dwordx4 a[148:151], v6, s[56:59], s96 offen offset:256
  v_and_b32_dpp v46, v25, v8 row_newbcast:0 row_mask:0xf bank_mask:0xf
  v_and_b32_dpp v47, v25, v9 row_newbcast:0 row_mask:0xf bank_mask:0xf
  v_and_b32_dpp v48, v25, v10 row_newbcast:0 row_mask:0xf bank_mask:0xf
  v_and_b32_dpp v49, v25, v11 row_newbcast:0 row_mask:0xf bank_mask:0xf
  s_waitcnt vmcnt(20)
  v_mfma_f32_16x16x32_bf16 v[38:41], v[116:119], v[50:53], v[38:41]
  v_mfma_f32_16x16x32_bf16 v[42:45], v[120:123], v[50:53], v[42:45]
  buffer_load_dwordx4 v[164:167], v5, s[48:51], s21 offen offset:2048 nt
  buffer_load_dwordx4 v[168:171], v5, s[48:51], s21 offen offset:2304 nt
  s_mov_b32 s96, 32256
  buffer_load_dwordx4 a[152:155], v6, s[56:59], s96 offen offset:512
  s_mov_b32 s96, 32256
  buffer_load_dwordx4 a[156:159], v7, s[56:59], s96 offen offset:768
  v_and_b32_dpp v50, v25, v8 row_newbcast:4 row_mask:0xf bank_mask:0xf
  v_and_b32_dpp v51, v25, v9 row_newbcast:4 row_mask:0xf bank_mask:0xf
  v_and_b32_dpp v52, v25, v10 row_newbcast:4 row_mask:0xf bank_mask:0xf
  v_and_b32_dpp v53, v25, v11 row_newbcast:4 row_mask:0xf bank_mask:0xf
  s_waitcnt vmcnt(20)
  v_mfma_f32_16x16x32_bf16 v[38:41], v[124:127], v[46:49], v[38:41]
  v_mfma_f32_16x16x32_bf16 v[42:45], v[128:131], v[46:49], v[42:45]
  s_add_u32 s21, s21, 16384
  s_cmp_eq_u32 s21, s20
  s_cselect_b32 s21, 0, s21
  buffer_load_dwordx4 v[172:175], v5, s[48:51], s21 offen offset:0 nt
  buffer_load_dwordx4 v[176:179], v5, s[48:51], s21 offen offset:256 nt
  s_mov_b32 s96, 35840
  buffer_load_dwordx4 a[160:163], v6, s[56:59], s96 offen offset:0
  s_mov_b32 s96, 35840
  buffer_load_dwordx4 a[164:167], v6, s[56:59], s96 offen offset:256
  v_and_b32_dpp v46, v25, v8 row_newbcast:8 row_mask:0xf bank_mask:0xf
  v_and_b32_dpp v47, v25, v9 row_newbcast:8 row_mask:0xf bank_mask:0xf
  v_and_b32_dpp v48, v25, v10 row_newbcast:8 row_mask:0xf bank_mask:0xf
  v_and_b32_dpp v49, v25, v11 row_newbcast:8 row_mask:0xf bank_mask:0xf
  s_waitcnt vmcnt(20)
  v_mfma_f32_16x16x32_bf16 v[38:41], v[132:135], v[50:53], v[38:41]
  v_mfma_f32_16x16x32_bf16 v[42:45], v[136:139], v[50:53], v[42:45]
  buffer_load_dwordx4 v[180:183], v5, s[48:51], s21 offen offset:2048 nt
  buffer_load_dwordx4 v[184:187], v5, s[48:51], s21 offen offset:2304 nt
  s_mov_b32 s96, 35840
  buffer_load_dwordx4 a[168:171], v6, s[56:59], s96 offen offset:512
  v_and_b32_dpp v50, v25, v8 row_newbcast:12 row_mask:0xf bank_mask:0xf
  v_and_b32_dpp v51, v25, v9 row_newbcast:12 row_mask:0xf bank_mask:0xf
  v_and_b32_dpp v52, v25, v10 row_newbcast:12 row_mask:0xf bank_mask:0xf
  v_and_b32_dpp v53, v25, v11 row_newbcast:12 row_mask:0xf bank_mask:0xf
  s_waitcnt vmcnt(20)
  v_mfma_f32_16x16x32_bf16 v[38:41], v[140:143], v[46:49], v[38:41]
  v_mfma_f32_16x16x32_bf16 v[42:45], v[144:147], v[46:49], v[42:45]
  s_add_u32 s21, s21, 16384
  s_cmp_eq_u32 s21, s20
  s_cselect_b32 s21, 0, s21
  buffer_load_dwordx4 v[188:191], v5, s[48:51], s21 offen offset:0 nt
  buffer_load_dwordx4 v[192:195], v5, s[48:51], s21 offen offset:256 nt
  s_mov_b32 s96, 35840
  buffer_load_dwordx4 a[172:175], v7, s[56:59], s96 offen offset:768
  s_mov_b32 s96, 39424
  buffer_load_dwordx4 a[176:179], v6, s[56:59], s96 offen offset:0
  v_and_b32_dpp v46, v26, v8 row_newbcast:0 row_mask:0xf bank_mask:0xf
  v_and_b32_dpp v47, v26, v9 row_newbcast:0 row_mask:0xf bank_mask:0xf
  v_and_b32_dpp v48, v26, v10 row_newbcast:0 row_mask:0xf bank_mask:0xf
  v_and_b32_dpp v49, v26, v11 row_newbcast:0 row_mask:0xf bank_mask:0xf
  s_waitcnt vmcnt(20)
  v_mfma_f32_16x16x32_bf16 v[38:41], v[148:151], v[50:53], v[38:41]
  v_mfma_f32_16x16x32_bf16 v[42:45], v[152:155], v[50:53], v[42:45]
  buffer_load_dwordx4 v[196:199], v5, s[48:51], s21 offen offset:2048 nt
  buffer_load_dwordx4 v[200:203], v5, s[48:51], s21 offen offset:2304 nt
  s_mov_b32 s96, 39424
  buffer_load_dwordx4 a[180:183], v6, s[56:59], s96 offen offset:256
  v_and_b32_dpp v50, v26, v8 row_newbcast:4 row_mask:0xf bank_mask:0xf
  v_and_b32_dpp v51, v26, v9 row_newbcast:4 row_mask:0xf bank_mask:0xf
  v_and_b32_dpp v52, v26, v10 row_newbcast:4 row_mask:0xf bank_mask:0xf
  v_and_b32_dpp v53, v26, v11 row_newbcast:4 row_mask:0xf bank_mask:0xf
  s_waitcnt vmcnt(19)
  v_mfma_f32_16x16x32_bf16 v[38:41], v[156:159], v[46:49], v[38:41]
  v_mfma_f32_16x16x32_bf16 v[42:45], v[160:163], v[46:49], v[42:45]
  s_add_u32 s21, s21, 16384
  s_cmp_eq_u32 s21, s20
  s_cselect_b32 s21, 0, s21
  buffer_load_dwordx4 v[204:207], v5, s[48:51], s21 offen offset:0 nt
  buffer_load_dwordx4 v[208:211], v5, s[48:51], s21 offen offset:256 nt
  s_mov_b32 s96, 39424
  buffer_load_dwordx4 a[184:187], v6, s[56:59], s96 offen offset:512
  s_mov_b32 s96, 39424
  buffer_load_dwordx4 a[188:191], v7, s[56:59], s96 offen offset:768
  v_and_b32_dpp v46, v26, v8 row_newbcast:8 row_mask:0xf bank_mask:0xf
  v_and_b32_dpp v47, v26, v9 row_newbcast:8 row_mask:0xf bank_mask:0xf
  v_and_b32_dpp v48, v26, v10 row_newbcast:8 row_mask:0xf bank_mask:0xf
  v_and_b32_dpp v49, v26, v11 row_newbcast:8 row_mask:0xf bank_mask:0xf
  s_waitcnt vmcnt(20)
  v_mfma_f32_16x16x32_bf16 v[38:41], v[164:167], v[50:53], v[38:41]
  v_mfma_f32_16x16x32_bf16 v[42:45], v[168:171], v[50:53], v[42:45]
  buffer_load_dwordx4 v[212:215], v5, s[48:51], s21 offen offset:2048 nt
  buffer_load_dwordx4 v[216:219], v5, s[48:51], s21 offen offset:2304 nt
  s_mov_b32 s96, 43008
  buffer_load_dwordx4 a[192:195], v6, s[56:59], s96 offen offset:0
  s_mov_b32 s96, 43008
  buffer_load_dwordx4 a[196:199], v6, s[56:59], s96 offen offset:256
  v_and_b32_dpp v50, v26, v8 row_newbcast:12 row_mask:0xf bank_mask:0xf
  v_and_b32_dpp v51, v26, v9 row_newbcast:12 row_mask:0xf bank_mask:0xf
  v_and_b32_dpp v52, v26, v10 row_newbcast:12 row_mask:0xf bank_mask:0xf
  v_and_b32_dpp v53, v26, v11 row_newbcast:12 row_mask:0xf bank_mask:0xf
  s_waitcnt vmcnt(20)
  v_mfma_f32_16x16x32_bf16 v[38:41], v[172:175], v[46:49], v[38:41]
  v_mfma_f32_16x16x32_bf16 v[42:45], v[176:179], v[46:49], v[42:45]
  s_add_u32 s21, s21, 16384
  s_cmp_eq_u32 s21, s20
  s_cselect_b32 s21, 0, s21
  buffer_load_dwordx4 v[220:223], v5, s[48:51], s21 offen offset:0 nt
  buffer_load_dwordx4 v[224:227], v5, s[48:51], s21 offen offset:256 nt
  s_mov_b32 s96, 43008
  buffer_load_dwordx4 a[200:203], v6, s[56:59], s96 offen offset:512
  v_and_b32_dpp v46, v27, v8 row_newbcast:0 row_mask:0xf bank_mask:0xf
  v_and_b32_dpp v47, v27, v9 row_newbcast:0 row_mask:0xf bank_mask:0xf
  v_and_b32_dpp v48, v27, v10 row_newbcast:0 row_mask:0xf bank_mask:0xf
  v_and_b32_dpp v49, v27, v11 row_newbcast:0 row_mask:0xf bank_mask:0xf
  s_waitcnt vmcnt(19)
  v_mfma_f32_16x16x32_bf16 v[38:41], v[180:183], v[50:53], v[38:41]
  v_mfma_f32_16x16x32_bf16 v[42:45], v[184:187], v[50:53], v[42:45]
  buffer_load_dwordx4 v[228:231], v5, s[48:51], s21 offen offset:2048 nt
  buffer_load_dwordx4 v[232:235], v5, s[48:51], s21 offen offset:2304 nt
  s_mov_b32 s96, 43008
  buffer_load_dwordx4 a[204:207], v7, s[56:59], s96 offen offset:768
  s_mov_b32 s96, 46592
  buffer_load_dwordx4 a[208:211], v6, s[56:59], s96 offen offset:0
  v_and_b32_dpp v50, v27, v8 row_newbcast:4 row_mask:0xf bank_mask:0xf
  v_and_b32_dpp v51, v27, v9 row_newbcast:4 row_mask:0xf bank_mask:0xf
  v_and_b32_dpp v52, v27, v10 row_newbcast:4 row_mask:0xf bank_mask:0xf
  v_and_b32_dpp v53, v27, v11 row_newbcast:4 row_mask:0xf bank_mask:0xf
  s_waitcnt vmcnt(20)
  v_mfma_f32_16x16x32_bf16 v[38:41], v[188:191], v[46:49], v[38:41]
  v_mfma_f32_16x16x32_bf16 v[42:45], v[192:195], v[46:49], v[42:45]
  s_add_u32 s21, s21, 16384
  s_cmp_eq_u32 s21, s20
  s_cselect_b32 s21, 0, s21
  buffer_load_dwordx4 v[236:239], v5, s[48:51], s21 offen offset:0 nt
  buffer_load_dwordx4 v[240:243], v5, s[48:51], s21 offen offset:256 nt
  s_mov_b32 s96, 46592
  buffer_load_dwordx4 a[212:215], v6, s[56:59], s96 offen offset:256
  s_mov_b32 s96, 46592
  buffer_load_dwordx4 a[216:219], v6, s[56:59], s96 offen offset:512
  v_and_b32_dpp v46, v27, v8 row_newbcast:8 row_mask:0xf bank_mask:0xf
  v_and_b32_dpp v47, v27, v9 row_newbcast:8 row_mask:0xf bank_mask:0xf
  v_and_b32_dpp v48, v27, v10 row_newbcast:8 row_mask:0xf bank_mask:0xf
  v_and_b32_dpp v49, v27, v11 row_newbcast:8 row_mask:0xf bank_mask:0xf
  s_waitcnt vmcnt(20)
  v_mfma_f32_16x16x32_bf16 v[38:41], v[196:199], v[50:53], v[38:41]
  v_mfma_f32_16x16x32_bf16 v[42:45], v[200:203], v[50:53], v[42:45]
  buffer_load_dwordx4 v[244:247], v5, s[48:51], s21 offen offset:2048 nt
  buffer_load_dwordx4 v[248:251], v5, s[48:51], s21 offen offset:2304 nt
  s_mov_b32 s96, 46592
  buffer_load_dwordx4 a[220:223], v7, s[56:59], s96 offen offset:768
  v_and_b32_dpp v50, v27, v8 row_newbcast:12 row_mask:0xf bank_mask:0xf
  v_and_b32_dpp v51, v27, v9 row_newbcast:12 row_mask:0xf bank_mask:0xf
  v_and_b32_dpp v52, v27, v10 row_newbcast:12 row_mask:0xf bank_mask:0xf
  v_and_b32_dpp v53, v27, v11 row_newbcast:12 row_mask:0xf bank_mask:0xf
  s_waitcnt vmcnt(20)
  v_mfma_f32_16x16x32_bf16 v[38:41], v[204:207], v[46:49], v[38:41]
  v_mfma_f32_16x16x32_bf16 v[42:45], v[208:211], v[46:49], v[42:45]
  s_add_u32 s21, s21, 16384
  s_cmp_eq_u32 s21, s20
  s_cselect_b32 s21, 0, s21
  buffer_load_dwordx4 v[252:255], v5, s[48:51], s21 offen offset:0 nt
  buffer_load_dwordx4 v[96:99], v5, s[48:51], s21 offen offset:256 nt
  s_mov_b32 s96, 50176
  buffer_load_dwordx4 a[224:227], v6, s[56:59], s96 offen offset:0
  s_mov_b32 s96, 50176
  buffer_load_dwordx4 a[228:231], v6, s[56:59], s96 offen offset:256
  v_and_b32_dpp v46, v28, v8 row_newbcast:0 row_mask:0xf bank_mask:0xf
  v_and_b32_dpp v47, v28, v9 row_newbcast:0 row_mask:0xf bank_mask:0xf
  v_and_b32_dpp v48, v28, v10 row_newbcast:0 row_mask:0xf bank_mask:0xf
  v_and_b32_dpp v49, v28, v11 row_newbcast:0 row_mask:0xf bank_mask:0xf
  s_waitcnt vmcnt(20)
  v_mfma_f32_16x16x32_bf16 v[38:41], v[212:215], v[50:53], v[38:41]
  v_mfma_f32_16x16x32_bf16 v[42:45], v[216:219], v[50:53], v[42:45]
  buffer_load_dwordx4 v[100:103], v5, s[48:51], s21 offen offset:2048 nt
  buffer_load_dwordx4 v[104:107], v5, s[48:51], s21 offen offset:2304 nt
  s_mov_b32 s96, 50176
  buffer_load_dwordx4 a[232:235], v6, s[56:59], s96 offen offset:512
  s_mov_b32 s96, 50176
  buffer_load_dwordx4 a[236:239], v7, s[56:59], s96 offen offset:768
  v_and_b32_dpp v50, v28, v8 row_newbcast:4 row_mask:0xf bank_mask:0xf
  v_and_b32_dpp v51, v28, v9 row_newbcast:4 row_mask:0xf bank_mask:0xf
  v_and_b32_dpp v52, v28, v10 row_newbcast:4 row_mask:0xf bank_mask:0xf
  v_and_b32_dpp v53, v28, v11 row_newbcast:4 row_mask:0xf bank_mask:0xf
  s_waitcnt vmcnt(20)
  v_mfma_f32_16x16x32_bf16 v[38:41], v[220:223], v[46:49], v[38:41]
  v_mfma_f32_16x16x32_bf16 v[42:45], v[224:227], v[46:49], v[42:45]
  s_add_u32 s21, s21, 16384
  s_cmp_eq_u32 s21, s20
  s_cselect_b32 s21, 0, s21
  buffer_load_dwordx4 v[108:111], v5, s[48:51], s21 offen offset:0 nt
  buffer_load_dwordx4 v[112:115], v5, s[48:51], s21 offen offset:256 nt
  s_mov_b32 s96, 53760
  buffer_load_dwordx4 a[240:243], v6, s[56:59], s96 offen offset:0
  v_lshrrev_b32 v80, 2, v1
  v_lshl_add_u32 v87, v80, 12, v94
  s_cmp_eq_u32 s3, 0
  s_cselect_b32 s12, 0, 0x40000000
  v_add_u32 v87, s12, v87
  v_add_u32 v88, 65536, v87
  v_mov_b32 v83, 0x7ff00000
  v_cmp_gt_u32 vcc, 12, v80
  s_nop 1
  v_cndmask_b32 v88, v83, v88, vcc
  buffer_load_dword v12, v87, s[64:67], s99 offen offset:0 sc1
  buffer_load_dword v13, v87, s[64:67], s99 offen offset:16 sc1
  buffer_load_dword v14, v87, s[64:67], s99 offen offset:32 sc1
  buffer_load_dword v15, v87, s[64:67], s99 offen offset:48 sc1
  buffer_load_dword v16, v88, s[64:67], s99 offen offset:0 sc1
  buffer_load_dword v17, v88, s[64:67], s99 offen offset:16 sc1
  buffer_load_dword v18, v88, s[64:67], s99 offen offset:32 sc1
  buffer_load_dword v19, v88, s[64:67], s99 offen offset:48 sc1
  v_lshrrev_b32 v80, 2, v1
  v_lshlrev_b32 v80, 6, v80
  s_cmp_eq_u32 s3, 0
  s_cselect_b32 s12, 0, 0x40000000
  v_add_u32 v80, s12, v80
  s_lshl_b32 s12, s97, 10
  s_add_u32 s12, s12, 786432
  buffer_load_dwordx4 v[54:57], v80, s[64:67], s12 offen offset:0 sc1
  buffer_load_dwordx4 v[58:61], v80, s[64:67], s12 offen offset:16 sc1
  buffer_load_dwordx4 v[62:65], v80, s[64:67], s12 offen offset:32 sc1
  buffer_load_dwordx4 v[66:69], v80, s[64:67], s12 offen offset:48 sc1
  v_and_b32_dpp v46, v28, v8 row_newbcast:8 row_mask:0xf bank_mask:0xf
  v_and_b32_dpp v47, v28, v9 row_newbcast:8 row_mask:0xf bank_mask:0xf
  v_and_b32_dpp v48, v28, v10 row_newbcast:8 row_mask:0xf bank_mask:0xf
  v_and_b32_dpp v49, v28, v11 row_newbcast:8 row_mask:0xf bank_mask:0xf
  s_waitcnt vmcnt(32)
  v_mfma_f32_16x16x32_bf16 v[38:41], v[228:231], v[50:53], v[38:41]
  v_mfma_f32_16x16x32_bf16 v[42:45], v[232:235], v[50:53], v[42:45]
  buffer_load_dwordx4 v[116:119], v5, s[48:51], s21 offen offset:2048 nt
  buffer_load_dwordx4 v[120:123], v5, s[48:51], s21 offen offset:2304 nt
  s_mov_b32 s96, 53760
  buffer_load_dwordx4 a[244:247], v6, s[56:59], s96 offen offset:256
  s_mov_b32 s96, 53760
  buffer_load_dwordx4 a[248:251], v6, s[56:59], s96 offen offset:512
  v_and_b32_dpp v50, v28, v8 row_newbcast:12 row_mask:0xf bank_mask:0xf
  v_and_b32_dpp v51, v28, v9 row_newbcast:12 row_mask:0xf bank_mask:0xf
  v_and_b32_dpp v52, v28, v10 row_newbcast:12 row_mask:0xf bank_mask:0xf
  v_and_b32_dpp v53, v28, v11 row_newbcast:12 row_mask:0xf bank_mask:0xf
  s_waitcnt vmcnt(32)
  v_mfma_f32_16x16x32_bf16 v[38:41], v[236:239], v[46:49], v[38:41]
  v_mfma_f32_16x16x32_bf16 v[42:45], v[240:243], v[46:49], v[42:45]
  s_add_u32 s21, s21, 16384
  s_cmp_eq_u32 s21, s20
  s_cselect_b32 s21, 0, s21
  buffer_load_dwordx4 v[124:127], v5, s[48:51], s21 offen offset:0 nt
  buffer_load_dwordx4 v[128:131], v5, s[48:51], s21 offen offset:256 nt
  s_mov_b32 s96, 53760
  buffer_load_dwordx4 a[252:255], v7, s[56:59], s96 offen offset:768
  v_and_b32_dpp v46, v29, v8 row_newbcast:0 row_mask:0xf bank_mask:0xf
  v_and_b32_dpp v47, v29, v9 row_newbcast:0 row_mask:0xf bank_mask:0xf
  v_and_b32_dpp v48, v29, v10 row_newbcast:0 row_mask:0xf bank_mask:0xf
  v_and_b32_dpp v49, v29, v11 row_newbcast:0 row_mask:0xf bank_mask:0xf
  s_waitcnt vmcnt(31)
  v_mfma_f32_16x16x32_bf16 v[38:41], v[244:247], v[50:53], v[38:41]
  v_mfma_f32_16x16x32_bf16 v[42:45], v[248:251], v[50:53], v[42:45]
  buffer_load_dwordx4 v[132:135], v5, s[48:51], s21 offen offset:2048 nt
  buffer_load_dwordx4 v[136:139], v5, s[48:51], s21 offen offset:2304 nt
  v_and_b32_dpp v50, v29, v8 row_newbcast:4 row_mask:0xf bank_mask:0xf
  v_and_b32_dpp v51, v29, v9 row_newbcast:4 row_mask:0xf bank_mask:0xf
  v_and_b32_dpp v52, v29, v10 row_newbcast:4 row_mask:0xf bank_mask:0xf
  v_and_b32_dpp v53, v29, v11 row_newbcast:4 row_mask:0xf bank_mask:0xf
  s_waitcnt vmcnt(30)
  v_mfma_f32_16x16x32_bf16 v[38:41], v[252:255], v[46:49], v[38:41]
  v_mfma_f32_16x16x32_bf16 v[42:45], v[96:99], v[46:49], v[42:45]
  s_add_u32 s21, s21, 16384
  s_cmp_eq_u32 s21, s20
  s_cselect_b32 s21, 0, s21
  buffer_load_dwordx4 v[140:143], v5, s[48:51], s21 offen offset:0 nt
  buffer_load_dwordx4 v[144:147], v5, s[48:51], s21 offen offset:256 nt
  s_waitcnt vmcnt(15)
  v_max3_u32 v86, v12, v13, v14
  v_max3_u32 v86, v86, v15, v16
  v_max3_u32 v86, v86, v17, v18
  v_max_u32 v86, v86, v19
  v_cmp_eq_u32 vcc, -1, v86
  s_nop 4
  s_cbranch_vccz L_ryb_okB
  s_mov_b32 s93, 0
L_ryb_spinB:
  buffer_load_dword v12, v87, s[64:67], s99 offen offset:0 sc1
  buffer_load_dword v13, v87, s[64:67], s99 offen offset:16 sc1
  buffer_load_dword v14, v87, s[64:67], s99 offen offset:32 sc1
  buffer_load_dword v15, v87, s[64:67], s99 offen offset:48 sc1
  buffer_load_dword v16, v88, s[64:67], s99 offen offset:0 sc1
  buffer_load_dword v17, v88, s[64:67], s99 offen offset:16 sc1
  buffer_load_dword v18, v88, s[64:67], s99 offen offset:32 sc1
  buffer_load_dword v19, v88, s[64:67], s99 offen offset:48 sc1
  s_waitcnt vmcnt(0)
  v_max3_u32 v86, v12, v13, v14
  v_max3_u32 v86, v86, v15, v16
  v_max3_u32 v86, v86, v17, v18
  v_max_u32 v86, v86, v19
  v_cmp_eq_u32 vcc, -1, v86
  s_nop 4
  s_cbranch_vccz L_ryb_okB
  s_add_u32 s93, s93, 1
  s_cmp_lt_u32 s93, 0x40000
  s_cbranch_scc0 L_ryb_okB
  s_sleep 4
  s_branch L_ryb_spinB
L_ryb_okB:
  v_sub_f32 v85, 1.0, v70
  v_add_f32 v12, v12, v16
  v_add_f32 v13, v13, v17
  v_add_f32 v14, v14, v18
  v_add_f32 v15, v15, v19
  v_mul_f32 v12, v12, v85
  v_mul_f32 v13, v13, v85
  v_mul_f32 v14, v14, v85
  v_mul_f32 v15, v15, v85
  s_waitcnt vmcnt(11)
  v_max3_u32 v81, v54, v55, v56
  v_max3_u32 v81, v81, v57, v58
  v_max3_u32 v81, v81, v59, v60
  v_max3_u32 v81, v81, v61, v62
  v_max3_u32 v81, v81, v63, v64
  v_max3_u32 v81, v81, v65, v66
  v_max3_u32 v81, v81, v67, v68
  v_max_u32 v81, v81, v69
  v_cmp_eq_u32 vcc, -1, v81
  s_nop 4
  s_cbranch_vccz L_rml_okB
  s_mov_b32 s93, 0
L_rml_spinB:
  s_lshl_b32 s12, s97, 10
  s_add_u32 s12, s12, 786432
  buffer_load_dwordx4 v[54:57], v80, s[64:67], s12 offen offset:0 sc1
  buffer_load_dwordx4 v[58:61], v80, s[64:67], s12 offen offset:16 sc1
  buffer_load_dwordx4 v[62:65], v80, s[64:67], s12 offen offset:32 sc1
  buffer_load_dwordx4 v[66:69], v80, s[64:67], s12 offen offset:48 sc1
  s_waitcnt vmcnt(0)
  v_max3_u32 v81, v54, v55, v56
  v_max3_u32 v81, v81, v57, v58
  v_max3_u32 v81, v81, v59, v60
  v_max3_u32 v81, v81, v61, v62
  v_max3_u32 v81, v81, v63, v64
  v_max3_u32 v81, v81, v65, v66
  v_max3_u32 v81, v81, v67, v68
  v_max_u32 v81, v81, v69
  v_cmp_eq_u32 vcc, -1, v81
  s_nop 4
  s_cbranch_vccz L_rml_okB
  s_add_u32 s93, s93, 1
  s_cmp_lt_u32 s93, 0x40000
  s_cbranch_scc0 L_rml_okB
  s_sleep 4
  s_branch L_rml_spinB
L_rml_okB:
  v_max3_f32 v81, v54, v56, v58
  v_max3_f32 v81, v81, v60, v62
  v_max3_f32 v81, v81, v64, v66
  v_max_f32 v81, v81, v68
  v_sub_f32 v54, v54, v81
  v_sub_f32 v56, v56, v81
  v_sub_f32 v58, v58, v81
  v_sub_f32 v60, v60, v81
  v_sub_f32 v62, v62, v81
  v_sub_f32 v64, v64, v81
  v_sub_f32 v66, v66, v81
  v_sub_f32 v68, v68, v81
  v_exp_f32 v54, v54
  v_exp_f32 v56, v56
  v_exp_f32 v58, v58
  v_exp_f32 v60, v60
  v_exp_f32 v62, v62
  v_exp_f32 v64, v64
  v_exp_f32 v66, v66
  v_exp_f32 v68, v68
  v_mul_f32 v82, v54, v55
  v_fmac_f32 v82, v56, v57
  v_fmac_f32 v82, v58, v59
  v_fmac_f32 v82, v60, v61
  v_fmac_f32 v82, v62, v63
  v_fmac_f32 v82, v64, v65
  v_fmac_f32 v82, v66, v67
  v_fmac_f32 v82, v68, v69
  v_rcp_f32 v82, v82
  s_nop 0
  v_mul_f32 v82, v82, v70
  v_mul_f32 v70, v54, v82
  v_mul_f32 v71, v56, v82
  v_mul_f32 v72, v58, v82
  v_mul_f32 v73, v60, v82
  v_mul_f32 v74, v62, v82
  v_mul_f32 v75, v64, v82
  v_mul_f32 v76, v66, v82
  v_mul_f32 v77, v68, v82
  v_and_b32_dpp v46, v29, v8 row_newbcast:8 row_mask:0xf bank_mask:0xf
  v_and_b32_dpp v47, v29, v9 row_newbcast:8 row_mask:0xf bank_mask:0xf
  v_and_b32_dpp v48, v29, v10 row_newbcast:8 row_mask:0xf bank_mask:0xf
  v_and_b32_dpp v49, v29, v11 row_newbcast:8 row_mask:0xf bank_mask:0xf
  v_mfma_f32_16x16x32_bf16 v[38:41], v[100:103], v[50:53], v[38:41]
  v_mfma_f32_16x16x32_bf16 v[42:45], v[104:107], v[50:53], v[42:45]
  buffer_load_dwordx4 v[148:151], v5, s[48:51], s21 offen offset:2048 nt
  buffer_load_dwordx4 v[152:155], v5, s[48:51], s21 offen offset:2304 nt
  v_and_b32_dpp v50, v29, v8 row_newbcast:12 row_mask:0xf bank_mask:0xf
  v_and_b32_dpp v51, v29, v9 row_newbcast:12 row_mask:0xf bank_mask:0xf
  v_and_b32_dpp v52, v29, v10 row_newbcast:12 row_mask:0xf bank_mask:0xf
  v_and_b32_dpp v53, v29, v11 row_newbcast:12 row_mask:0xf bank_mask:0xf
  v_mfma_f32_16x16x32_bf16 v[38:41], v[108:111], v[46:49], v[38:41]
  v_mfma_f32_16x16x32_bf16 v[42:45], v[112:115], v[46:49], v[42:45]
  s_add_u32 s21, s21, 16384
  s_cmp_eq_u32 s21, s20
  s_cselect_b32 s21, 0, s21
  buffer_load_dwordx4 v[156:159], v5, s[48:51], s21 offen offset:0 nt
  buffer_load_dwordx4 v[160:163], v5, s[48:51], s21 offen offset:256 nt
  v_and_b32_dpp v46, v30, v8 row_newbcast:0 row_mask:0xf bank_mask:0xf
  v_and_b32_dpp v47, v30, v9 row_newbcast:0 row_mask:0xf bank_mask:0xf
  v_and_b32_dpp v48, v30, v10 row_newbcast:0 row_mask:0xf bank_mask:0xf
  v_and_b32_dpp v49, v30, v11 row_newbcast:0 row_mask:0xf bank_mask:0xf
  s_waitcnt vmcnt(13)
  v_mfma_f32_16x16x32_bf16 v[38:41], v[116:119], v[50:53], v[38:41]
  v_mfma_f32_16x16x32_bf16 v[42:45], v[120:123], v[50:53], v[42:45]
  buffer_load_dwordx4 v[164:167], v5, s[48:51], s21 offen offset:2048 nt
  buffer_load_dwordx4 v[168:171], v5, s[48:51], s21 offen offset:2304 nt
  v_and_b32_dpp v50, v30, v8 row_newbcast:4 row_mask:0xf bank_mask:0xf
  v_and_b32_dpp v51, v30, v9 row_newbcast:4 row_mask:0xf bank_mask:0xf
  v_and_b32_dpp v52, v30, v10 row_newbcast:4 row_mask:0xf bank_mask:0xf
  v_and_b32_dpp v53, v30, v11 row_newbcast:4 row_mask:0xf bank_mask:0xf
  s_waitcnt vmcnt(11)
  v_mfma_f32_16x16x32_bf16 v[38:41], v[124:127], v[46:49], v[38:41]
  v_mfma_f32_16x16x32_bf16 v[42:45], v[128:131], v[46:49], v[42:45]
  s_add_u32 s21, s21, 16384
  s_cmp_eq_u32 s21, s20
  s_cselect_b32 s21, 0, s21
  buffer_load_dwordx4 v[172:175], v5, s[48:51], s21 offen offset:0 nt
  buffer_load_dwordx4 v[176:179], v5, s[48:51], s21 offen offset:256 nt
  v_and_b32_dpp v46, v30, v8 row_newbcast:8 row_mask:0xf bank_mask:0xf
  v_and_b32_dpp v47, v30, v9 row_newbcast:8 row_mask:0xf bank_mask:0xf
  v_and_b32_dpp v48, v30, v10 row_newbcast:8 row_mask:0xf bank_mask:0xf
  v_and_b32_dpp v49, v30, v11 row_newbcast:8 row_mask:0xf bank_mask:0xf
  s_waitcnt vmcnt(10)
  v_mfma_f32_16x16x32_bf16 v[38:41], v[132:135], v[50:53], v[38:41]
  v_mfma_f32_16x16x32_bf16 v[42:45], v[136:139], v[50:53], v[42:45]
  buffer_load_dwordx4 v[180:183], v5, s[48:51], s21 offen offset:2048 nt
  buffer_load_dwordx4 v[184:187], v5, s[48:51], s21 offen offset:2304 nt
  v_and_b32_dpp v50, v30, v8 row_newbcast:12 row_mask:0xf bank_mask:0xf
  v_and_b32_dpp v51, v30, v9 row_newbcast:12 row_mask:0xf bank_mask:0xf
  v_and_b32_dpp v52, v30, v10 row_newbcast:12 row_mask:0xf bank_mask:0xf
  v_and_b32_dpp v53, v30, v11 row_newbcast:12 row_mask:0xf bank_mask:0xf
  s_waitcnt vmcnt(10)
  v_mfma_f32_16x16x32_bf16 v[38:41], v[140:143], v[46:49], v[38:41]
  v_mfma_f32_16x16x32_bf16 v[42:45], v[144:147], v[46:49], v[42:45]
  s_add_u32 s21, s21, 16384
  s_cmp_eq_u32 s21, s20
  s_cselect_b32 s21, 0, s21
  buffer_load_dwordx4 v[188:191], v5, s[48:51], s21 offen offset:0 nt
  buffer_load_dwordx4 v[192:195], v5, s[48:51], s21 offen offset:256 nt
  v_lshrrev_b32 v80, 1, v2
  v_lshl_add_u32 v80, v3, 4, v80
  v_lshlrev_b32 v80, 5, v80
  v_and_b32 v81, 1, v2
  v_lshl_add_u32 v80, v81, 2, v80
  s_lshl_b32 s12, s3, 3
  s_add_u32 s12, s12, 4096
  v_add_u32 v80, s12, v80
  v_add_u32 v81, 2048, v80
  v_lshrrev_b32 v82, 2, v2
  v_lshlrev_b32 v82, 1, v82
  v_and_b32 v83, 1, v3
  v_add_u32 v82, v82, v83
  v_lshlrev_b32 v82, 5, v82
  s_lshl_b32 s13, s3, 10
  s_add_u32 s13, s13, 4096
  v_add_u32 v82, s13, v82
  v_lshlrev_b32 v83, 4, v1
  s_lshl_b32 s14, s3, 11
  v_add_u32 v83, s14, v83
  v_and_b32 v85, 127, v0
  v_lshlrev_b32 v85, 4, v85
  v_and_b32 v84, 0x68, v0
  v_mov_b32 v86, 0x68
  v_cmp_ne_u32 vcc, v84, v86
  v_mov_b32 v87, 0x7ff00000
  s_nop 0
  v_cndmask_b32 v86, v87, v85, vcc
  v_mov_b32 v84, 128
  v_cmp_gt_u32 vcc, v84, v0
  s_nop 1
  v_cndmask_b32 v86, v87, v86, vcc
  s_lshl_b32 s15, s10, 11
  s_add_u32 s15, s15, 262144
  v_bfe_u32 v90, v2, 2, 1
  v_lshrrev_b32 v87, 1, v3
  v_lshrrev_b32 v88, 3, v2
  v_cmp_eq_u32 s[94:95], v87, v88
  v_cmp_eq_u32 vcc, 0, v90
  s_nop 2
  s_and_b64 vcc, vcc, s[94:95]
  v_mov_b32 v89, 0xffff
  v_cndmask_b32 v62, 0, v89, vcc
  v_cmp_eq_u32 vcc, 1, v90
  s_nop 2
  s_and_b64 vcc, vcc, s[94:95]
  v_mov_b32 v89, 0xffff
  v_cndmask_b32 v63, 0, v89, vcc
  v_cmp_eq_u32 vcc, 0, v90
  s_nop 2
  s_and_b64 vcc, vcc, s[94:95]
  v_mov_b32 v89, 0xffff0000
  v_cndmask_b32 v64, 0, v89, vcc
  v_cmp_eq_u32 vcc, 1, v90
  s_nop 2
  s_and_b64 vcc, vcc, s[94:95]
  v_mov_b32 v89, 0xffff0000
  v_cndmask_b32 v65, 0, v89, vcc
  v_and_b32 v90, 3, v2
  v_add_u32 v87, 1, v90
  v_and_b32 v87, 3, v87
  v_lshl_or_b32 v88, v87, 2, v90
  v_lshl_or_b32 v89, v90, 2, v87
  v_lshl_or_b32 v88, v88, 4, v88
  v_lshl_or_b32 v89, v89, 4, v89
  v_lshl_or_b32 v66, v89, 8, v88
  v_mov_b32 v54, 0
  v_mov_b32 v55, 0
  v_mov_b32 v56, 0
  v_mov_b32 v57, 0
  v_mov_b32 v58, 0
  v_mov_b32 v59, 0
  v_mov_b32 v60, 0
  v_mov_b32 v61, 0
  v_and_b32_dpp v46, v31, v8 row_newbcast:0 row_mask:0xf bank_mask:0xf
  v_and_b32_dpp v47, v31, v9 row_newbcast:0 row_mask:0xf bank_mask:0xf
  v_and_b32_dpp v48, v31, v10 row_newbcast:0 row_mask:0xf bank_mask:0xf
  v_and_b32_dpp v49, v31, v11 row_newbcast:0 row_mask:0xf bank_mask:0xf
  s_waitcnt vmcnt(10)
  v_mfma_f32_16x16x32_bf16 v[38:41], v[148:151], v[50:53], v[38:41]
  v_mfma_f32_16x16x32_bf16 v[42:45], v[152:155], v[50:53], v[42:45]
  buffer_load_dwordx4 v[196:199], v5, s[48:51], s21 offen offset:2048 nt
  buffer_load_dwordx4 v[200:203], v5, s[48:51], s21 offen offset:2304 nt
  v_and_b32_dpp v50, v31, v8 row_newbcast:4 row_mask:0xf bank_mask:0xf
  v_and_b32_dpp v51, v31, v9 row_newbcast:4 row_mask:0xf bank_mask:0xf
  v_and_b32_dpp v52, v31, v10 row_newbcast:4 row_mask:0xf bank_mask:0xf
  v_and_b32_dpp v53, v31, v11 row_newbcast:4 row_mask:0xf bank_mask:0xf
  s_waitcnt vmcnt(10)
  v_mfma_f32_16x16x32_bf16 v[38:41], v[156:159], v[46:49], v[38:41]
  v_mfma_f32_16x16x32_bf16 v[42:45], v[160:163], v[46:49], v[42:45]
  v_and_b32_dpp v46, v31, v8 row_newbcast:8 row_mask:0xf bank_mask:0xf
  v_and_b32_dpp v47, v31, v9 row_newbcast:8 row_mask:0xf bank_mask:0xf
  v_and_b32_dpp v48, v31, v10 row_newbcast:8 row_mask:0xf bank_mask:0xf
  v_and_b32_dpp v49, v31, v11 row_newbcast:8 row_mask:0xf bank_mask:0xf
  s_waitcnt vmcnt(8)
  v_mfma_f32_16x16x32_bf16 v[38:41], v[164:167], v[50:53], v[38:41]
  v_mfma_f32_16x16x32_bf16 v[42:45], v[168:171], v[50:53], v[42:45]
  v_and_b32_dpp v50, v31, v8 row_newbcast:12 row_mask:0xf bank_mask:0xf
  v_and_b32_dpp v51, v31, v9 row_newbcast:12 row_mask:0xf bank_mask:0xf
  v_and_b32_dpp v52, v31, v10 row_newbcast:12 row_mask:0xf bank_mask:0xf
  v_and_b32_dpp v53, v31, v11 row_newbcast:12 row_mask:0xf bank_mask:0xf
  s_waitcnt vmcnt(6)
  v_mfma_f32_16x16x32_bf16 v[38:41], v[172:175], v[46:49], v[38:41]
  v_mfma_f32_16x16x32_bf16 v[42:45], v[176:179], v[46:49], v[42:45]
  v_and_b32_dpp v46, v32, v8 row_newbcast:0 row_mask:0xf bank_mask:0xf
  v_and_b32_dpp v47, v32, v9 row_newbcast:0 row_mask:0xf bank_mask:0xf
  v_and_b32_dpp v48, v32, v10 row_newbcast:0 row_mask:0xf bank_mask:0xf
  v_and_b32_dpp v49, v32, v11 row_newbcast:0 row_mask:0xf bank_mask:0xf
  s_waitcnt vmcnt(4)
  v_mfma_f32_16x16x32_bf16 v[38:41], v[180:183], v[50:53], v[38:41]
  v_mfma_f32_16x16x32_bf16 v[42:45], v[184:187], v[50:53], v[42:45]
  v_and_b32_dpp v50, v32, v8 row_newbcast:4 row_mask:0xf bank_mask:0xf
  v_and_b32_dpp v51, v32, v9 row_newbcast:4 row_mask:0xf bank_mask:0xf
  v_and_b32_dpp v52, v32, v10 row_newbcast:4 row_mask:0xf bank_mask:0xf
  v_and_b32_dpp v53, v32, v11 row_newbcast:4 row_mask:0xf bank_mask:0xf
  s_waitcnt vmcnt(2)
  v_mfma_f32_16x16x32_bf16 v[38:41], v[188:191], v[46:49], v[38:41]
  v_mfma_f32_16x16x32_bf16 v[42:45], v[192:195], v[46:49], v[42:45]
  s_waitcnt vmcnt(0)
  v_mfma_f32_16x16x32_bf16 v[38:41], v[196:199], v[50:53], v[38:41]
  v_mfma_f32_16x16x32_bf16 v[42:45], v[200:203], v[50:53], v[42:45]
  s_mov_b32 exec_lo, 0x00ff00ff
  s_mov_b32 exec_hi, 0x00ff00ff
  s_nop 4
  ds_write2_b32 v80, v38, v39 offset0:0 offset1:32
  ds_write2_b32 v80, v40, v41 offset0:64 offset1:96
  ds_write2_b32 v81, v42, v43 offset0:0 offset1:32
  ds_write2_b32 v81, v44, v45 offset0:64 offset1:96
  s_mov_b64 exec, -1
  s_waitcnt lgkmcnt(0)
  s_barrier
  ds_read_b128 v[20:23], v82 offset:0
  ds_read_b128 v[24:27], v82 offset:16
  ds_read_b128 v[28:31], v82 offset:256
  ds_read_b128 v[32:35], v82 offset:272
  ds_read_b128 v[38:41], v82 offset:512
  ds_read_b128 v[42:45], v82 offset:528
  ds_read_b128 v[46:49], v82 offset:768
  ds_read_b128 v[50:53], v82 offset:784
  s_waitcnt vmcnt(0)
  s_waitcnt lgkmcnt(6)
  v_pk_add_f32 v[20:21], v[20:21], v[22:23]
  v_pk_add_f32 v[24:25], v[24:25], v[26:27]
  v_pk_add_f32 v[20:21], v[20:21], v[24:25]
  v_cvt_pk_bf16_f32 v36, v20, v21
  s_waitcnt lgkmcnt(4)
  v_pk_add_f32 v[28:29], v[28:29], v[30:31]
  v_pk_add_f32 v[32:33], v[32:33], v[34:35]
  v_pk_add_f32 v[28:29], v[28:29], v[32:33]
  v_cvt_pk_bf16_f32 v37, v28, v29
  s_waitcnt lgkmcnt(2)
  v_pk_add_f32 v[38:39], v[38:39], v[40:41]
  v_pk_add_f32 v[42:43], v[42:43], v[44:45]
  v_pk_add_f32 v[38:39], v[38:39], v[42:43]
  v_cvt_pk_bf16_f32 v88, v38, v39
  s_waitcnt lgkmcnt(0)
  v_pk_add_f32 v[46:47], v[46:47], v[48:49]
  v_pk_add_f32 v[50:51], v[50:51], v[52:53]
  v_pk_add_f32 v[46:47], v[46:47], v[50:51]
  v_cvt_pk_bf16_f32 v89, v46, v47
  s_nop 0
  v_and_b32_dpp v46, v36, v62 row_newbcast:0 row_mask:0xf bank_mask:0xf
  v_and_b32_dpp v47, v36, v63 row_newbcast:0 row_mask:0xf bank_mask:0xf
  v_and_b32_dpp v48, v36, v64 row_newbcast:0 row_mask:0xf bank_mask:0xf
  v_and_b32_dpp v49, v36, v65 row_newbcast:0 row_mask:0xf bank_mask:0xf
  v_and_b32_dpp v50, v36, v62 row_newbcast:4 row_mask:0xf bank_mask:0xf
  v_and_b32_dpp v51, v36, v63 row_newbcast:4 row_mask:0xf bank_mask:0xf
  v_smfmac_f32_16x16x64_bf16 v[54:57], v[46:49], a[0:7], v66
  v_and_b32_dpp v52, v36, v64 row_newbcast:4 row_mask:0xf bank_mask:0xf
  v_and_b32_dpp v53, v36, v65 row_newbcast:4 row_mask:0xf bank_mask:0xf
  v_smfmac_f32_16x16x64_bf16 v[58:61], v[46:49], a[8:15], v66
  v_and_b32_dpp v46, v36, v62 row_newbcast:8 row_mask:0xf bank_mask:0xf
  v_and_b32_dpp v47, v36, v63 row_newbcast:8 row_mask:0xf bank_mask:0xf
  v_smfmac_f32_16x16x64_bf16 v[54:57], v[50:53], a[16:23], v66
  v_and_b32_dpp v48, v36, v64 row_newbcast:8 row_mask:0xf bank_mask:0xf
  v_and_b32_dpp v49, v36, v65 row_newbcast:8 row_mask:0xf bank_mask:0xf
  v_smfmac_f32_16x16x64_bf16 v[58:61], v[50:53], a[24:31], v66
  v_and_b32_dpp v50, v36, v62 row_newbcast:12 row_mask:0xf bank_mask:0xf
  v_and_b32_dpp v51, v36, v63 row_newbcast:12 row_mask:0xf bank_mask:0xf
  v_smfmac_f32_16x16x64_bf16 v[54:57], v[46:49], a[32:39], v66
  v_and_b32_dpp v52, v36, v64 row_newbcast:12 row_mask:0xf bank_mask:0xf
  v_and_b32_dpp v53, v36, v65 row_newbcast:12 row_mask:0xf bank_mask:0xf
  v_smfmac_f32_16x16x64_bf16 v[58:61], v[46:49], a[40:47], v66
  v_and_b32_dpp v46, v37, v62 row_newbcast:0 row_mask:0xf bank_mask:0xf
  v_and_b32_dpp v47, v37, v63 row_newbcast:0 row_mask:0xf bank_mask:0xf
  v_smfmac_f32_16x16x64_bf16 v[54:57], v[50:53], a[48:55], v66
  v_and_b32_dpp v48, v37, v64 row_newbcast:0 row_mask:0xf bank_mask:0xf
  v_and_b32_dpp v49, v37, v65 row_newbcast:0 row_mask:0xf bank_mask:0xf
  v_smfmac_f32_16x16x64_bf16 v[58:61], v[50:53], a[56:63], v66
  v_and_b32_dpp v50, v37, v62 row_newbcast:4 row_mask:0xf bank_mask:0xf
  v_and_b32_dpp v51, v37, v63 row_newbcast:4 row_mask:0xf bank_mask:0xf
  v_smfmac_f32_16x16x64_bf16 v[54:57], v[46:49], a[64:71], v66
  v_and_b32_dpp v52, v37, v64 row_newbcast:4 row_mask:0xf bank_mask:0xf
  v_and_b32_dpp v53, v37, v65 row_newbcast:4 row_mask:0xf bank_mask:0xf
  v_smfmac_f32_16x16x64_bf16 v[58:61], v[46:49], a[72:79], v66
  v_and_b32_dpp v46, v37, v62 row_newbcast:8 row_mask:0xf bank_mask:0xf
  v_and_b32_dpp v47, v37, v63 row_newbcast:8 row_mask:0xf bank_mask:0xf
  v_smfmac_f32_16x16x64_bf16 v[54:57], v[50:53], a[80:87], v66
  v_and_b32_dpp v48, v37, v64 row_newbcast:8 row_mask:0xf bank_mask:0xf
  v_and_b32_dpp v49, v37, v65 row_newbcast:8 row_mask:0xf bank_mask:0xf
  v_smfmac_f32_16x16x64_bf16 v[58:61], v[50:53], a[88:95], v66
  v_and_b32_dpp v50, v37, v62 row_newbcast:12 row_mask:0xf bank_mask:0xf
  v_and_b32_dpp v51, v37, v63 row_newbcast:12 row_mask:0xf bank_mask:0xf
  v_smfmac_f32_16x16x64_bf16 v[54:57], v[46:49], a[96:103], v66
  v_and_b32_dpp v52, v37, v64 row_newbcast:12 row_mask:0xf bank_mask:0xf
  v_and_b32_dpp v53, v37, v65 row_newbcast:12 row_mask:0xf bank_mask:0xf
  v_smfmac_f32_16x16x64_bf16 v[58:61], v[46:49], a[104:111], v66
  v_and_b32_dpp v46, v88, v62 row_newbcast:0 row_mask:0xf bank_mask:0xf
  v_and_b32_dpp v47, v88, v63 row_newbcast:0 row_mask:0xf bank_mask:0xf
  v_smfmac_f32_16x16x64_bf16 v[54:57], v[50:53], a[112:119], v66
  v_and_b32_dpp v48, v88, v64 row_newbcast:0 row_mask:0xf bank_mask:0xf
  v_and_b32_dpp v49, v88, v65 row_newbcast:0 row_mask:0xf bank_mask:0xf
  v_smfmac_f32_16x16x64_bf16 v[58:61], v[50:53], a[120:127], v66
  v_and_b32_dpp v50, v88, v62 row_newbcast:4 row_mask:0xf bank_mask:0xf
  v_and_b32_dpp v51, v88, v63 row_newbcast:4 row_mask:0xf bank_mask:0xf
  v_smfmac_f32_16x16x64_bf16 v[54:57], v[46:49], a[128:135], v66
  v_and_b32_dpp v52, v88, v64 row_newbcast:4 row_mask:0xf bank_mask:0xf
  v_and_b32_dpp v53, v88, v65 row_newbcast:4 row_mask:0xf bank_mask:0xf
  v_smfmac_f32_16x16x64_bf16 v[58:61], v[46:49], a[136:143], v66
  v_and_b32_dpp v46, v88, v62 row_newbcast:8 row_mask:0xf bank_mask:0xf
  v_and_b32_dpp v47, v88, v63 row_newbcast:8 row_mask:0xf bank_mask:0xf
  v_smfmac_f32_16x16x64_bf16 v[54:57], v[50:53], a[144:151], v66
  v_and_b32_dpp v48, v88, v64 row_newbcast:8 row_mask:0xf bank_mask:0xf
  v_and_b32_dpp v49, v88, v65 row_newbcast:8 row_mask:0xf bank_mask:0xf
  v_smfmac_f32_16x16x64_bf16 v[58:61], v[50:53], a[152:159], v66
  v_and_b32_dpp v50, v88, v62 row_newbcast:12 row_mask:0xf bank_mask:0xf
  v_and_b32_dpp v51, v88, v63 row_newbcast:12 row_mask:0xf bank_mask:0xf
  v_smfmac_f32_16x16x64_bf16 v[54:57], v[46:49], a[160:167], v66
  v_and_b32_dpp v52, v88, v64 row_newbcast:12 row_mask:0xf bank_mask:0xf
  v_and_b32_dpp v53, v88, v65 row_newbcast:12 row_mask:0xf bank_mask:0xf
  v_smfmac_f32_16x16x64_bf16 v[58:61], v[46:49], a[168:175], v66
  v_and_b32_dpp v46, v89, v62 row_newbcast:0 row_mask:0xf bank_mask:0xf
  v_and_b32_dpp v47, v89, v63 row_newbcast:0 row_mask:0xf bank_mask:0xf
  v_smfmac_f32_16x16x64_bf16 v[54:57], v[50:53], a[176:183], v66
  v_and_b32_dpp v48, v89, v64 row_newbcast:0 row_mask:0xf bank_mask:0xf
  v_and_b32_dpp v49, v89, v65 row_newbcast:0 row_mask:0xf bank_mask:0xf
  v_smfmac_f32_16x16x64_bf16 v[58:61], v[50:53], a[184:191], v66
  v_and_b32_dpp v50, v89, v62 row_newbcast:4 row_mask:0xf bank_mask:0xf
  v_and_b32_dpp v51, v89, v63 row_newbcast:4 row_mask:0xf bank_mask:0xf
  v_smfmac_f32_16x16x64_bf16 v[54:57], v[46:49], a[192:199], v66
  v_and_b32_dpp v52, v89, v64 row_newbcast:4 row_mask:0xf bank_mask:0xf
  v_and_b32_dpp v53, v89, v65 row_newbcast:4 row_mask:0xf bank_mask:0xf
  v_smfmac_f32_16x16x64_bf16 v[58:61], v[46:49], a[200:207], v66
  v_and_b32_dpp v46, v89, v62 row_newbcast:8 row_mask:0xf bank_mask:0xf
  v_and_b32_dpp v47, v89, v63 row_newbcast:8 row_mask:0xf bank_mask:0xf
  v_smfmac_f32_16x16x64_bf16 v[54:57], v[50:53], a[208:215], v66
  v_and_b32_dpp v48, v89, v64 row_newbcast:8 row_mask:0xf bank_mask:0xf
  v_and_b32_dpp v49, v89, v65 row_newbcast:8 row_mask:0xf bank_mask:0xf
  v_smfmac_f32_16x16x64_bf16 v[58:61], v[50:53], a[216:223], v66
  v_and_b32_dpp v50, v89, v62 row_newbcast:12 row_mask:0xf bank_mask:0xf
  v_and_b32_dpp v51, v89, v63 row_newbcast:12 row_mask:0xf bank_mask:0xf
  v_smfmac_f32_16x16x64_bf16 v[54:57], v[46:49], a[224:231], v66
  v_and_b32_dpp v52, v89, v64 row_newbcast:12 row_mask:0xf bank_mask:0xf
  v_and_b32_dpp v53, v89, v65 row_newbcast:12 row_mask:0xf bank_mask:0xf
  v_smfmac_f32_16x16x64_bf16 v[58:61], v[46:49], a[232:239], v66
  s_nop 0
  v_smfmac_f32_16x16x64_bf16 v[54:57], v[50:53], a[240:247], v66
  v_smfmac_f32_16x16x64_bf16 v[58:61], v[50:53], a[248:255], v66
  s_nop 6
  ds_write_b128 v83, v[54:57] offset:16384
  ds_write_b128 v83, v[58:61] offset:17408
  s_waitcnt lgkmcnt(0)
  s_barrier
  ds_read_b128 v[20:23], v85 offset:16384
  ds_read_b128 v[24:27], v85 offset:18432
  ds_read_b128 v[28:31], v85 offset:20480
  ds_read_b128 v[32:35], v85 offset:22528
  s_waitcnt lgkmcnt(2)
  v_pk_add_f32 v[20:21], v[20:21], v[24:25]
  v_pk_add_f32 v[22:23], v[22:23], v[26:27]
  s_waitcnt lgkmcnt(0)
  v_pk_add_f32 v[28:29], v[28:29], v[32:33]
  v_pk_add_f32 v[30:31], v[30:31], v[34:35]
  v_pk_add_f32 v[20:21], v[20:21], v[28:29]
  v_pk_add_f32 v[22:23], v[22:23], v[30:31]
  v_min_u32 v20, -2, v20
  v_min_u32 v21, -2, v21
  v_min_u32 v22, -2, v22
  v_min_u32 v23, -2, v23
  buffer_store_dwordx4 v[20:23], v86, s[64:67], s15 offen sc1
  s_cmp_eq_u32 s3, 0
  s_cbranch_scc0 L_ry_endB
  s_add_u32 s12, s98, 4096
  s_add_u32 s13, s98, 8192
  s_add_u32 s14, s98, 12288
  s_mov_b32 s93, 0
  buffer_load_dwordx4 v[20:23], v92, s[64:67], s98 offen offset:0 sc1
  buffer_load_dwordx4 v[24:27], v92, s[64:67], s98 offen offset:2048 sc1
  buffer_load_dwordx4 v[28:31], v92, s[64:67], s12 offen offset:0 sc1
  buffer_load_dwordx4 v[32:35], v92, s[64:67], s12 offen offset:2048 sc1
  buffer_load_dwordx4 v[36:39], v92, s[64:67], s13 offen offset:0 sc1
  buffer_load_dwordx4 v[40:43], v92, s[64:67], s13 offen offset:2048 sc1
  buffer_load_dwordx4 v[44:47], v92, s[64:67], s14 offen offset:0 sc1
  buffer_load_dwordx4 v[48:51], v92, s[64:67], s14 offen offset:2048 sc1
L_ry_spinB:
  s_waitcnt vmcnt(0)
  v_max3_u32 v80, v20, v21, v22
  v_max3_u32 v81, v24, v25, v26
  v_max3_u32 v82, v28, v29, v30
  v_max3_u32 v83, v32, v33, v34
  v_max3_u32 v84, v36, v37, v38
  v_max3_u32 v85, v40, v41, v42
  v_max3_u32 v86, v44, v45, v46
  v_max3_u32 v87, v48, v49, v50
  v_max_u32 v80, v80, v23
  v_max_u32 v81, v81, v27
  v_max_u32 v82, v82, v31
  v_max_u32 v83, v83, v35
  v_max_u32 v84, v84, v39
  v_max_u32 v85, v85, v43
  v_max_u32 v86, v86, v47
  v_max_u32 v87, v87, v51
  v_cmp_eq_u32 s[16:17], -1, v80
  v_cmp_eq_u32 s[18:19], -1, v81
  v_cmp_eq_u32 s[20:21], -1, v82
  v_cmp_eq_u32 s[22:23], -1, v83
  v_cmp_eq_u32 s[24:25], -1, v84
  v_cmp_eq_u32 s[26:27], -1, v85
  v_cmp_eq_u32 s[28:29], -1, v86
  v_cmp_eq_u32 s[30:31], -1, v87
  s_or_b64 s[94:95], s[16:17], s[18:19]
  s_or_b64 s[94:95], s[94:95], s[20:21]
  s_or_b64 s[94:95], s[94:95], s[22:23]
  s_or_b64 s[94:95], s[94:95], s[24:25]
  s_or_b64 s[94:95], s[94:95], s[26:27]
  s_or_b64 s[94:95], s[94:95], s[28:29]
  s_or_b64 s[94:95], s[94:95], s[30:31]
  s_cbranch_scc0 L_ry_okB
  s_add_u32 s93, s93, 1
  s_cmp_lt_u32 s93, 0x40000
  s_cbranch_scc0 L_ry_okB
  s_bcnt1_i32_b64 s15, s[94:95]
  s_cmp_gt_u32 s15, 32
  s_cbranch_scc0 L_ry_shortB
  s_sleep 5
L_ry_shortB:
  s_sleep 1
  s_mov_b64 exec, s[16:17]
  s_cbranch_execz L_ry_skip0B
  buffer_load_dwordx4 v[20:23], v92, s[64:67], s98 offen offset:0 sc1
L_ry_skip0B:
  s_mov_b64 exec, s[18:19]
  s_cbranch_execz L_ry_skip1B
  buffer_load_dwordx4 v[24:27], v92, s[64:67], s98 offen offset:2048 sc1
L_ry_skip1B:
  s_mov_b64 exec, s[20:21]
  s_cbranch_execz L_ry_skip2B
  buffer_load_dwordx4 v[28:31], v92, s[64:67], s12 offen offset:0 sc1
L_ry_skip2B:
  s_mov_b64 exec, s[22:23]
  s_cbranch_execz L_ry_skip3B
  buffer_load_dwordx4 v[32:35], v92, s[64:67], s12 offen offset:2048 sc1
L_ry_skip3B:
  s_mov_b64 exec, s[24:25]
  s_cbranch_execz L_ry_skip4B
  buffer_load_dwordx4 v[36:39], v92, s[64:67], s13 offen offset:0 sc1
L_ry_skip4B:
  s_mov_b64 exec, s[26:27]
  s_cbranch_execz L_ry_skip5B
  buffer_load_dwordx4 v[40:43], v92, s[64:67], s13 offen offset:2048 sc1
L_ry_skip5B:
  s_mov_b64 exec, s[28:29]
  s_cbranch_execz L_ry_skip6B
  buffer_load_dwordx4 v[44:47], v92, s[64:67], s14 offen offset:0 sc1
L_ry_skip6B:
  s_mov_b64 exec, s[30:31]
  s_cbranch_execz L_ry_skip7B
  buffer_load_dwordx4 v[48:51], v92, s[64:67], s14 offen offset:2048 sc1
L_ry_skip7B:
  s_mov_b64 exec, -1
  s_branch L_ry_spinB
L_ry_okB:
  v_fmac_f32 v12, v20, v70
  v_fmac_f32 v13, v21, v70
  v_fmac_f32 v14, v22, v70
  v_fmac_f32 v15, v23, v70
  v_fmac_f32 v12, v24, v71
  v_fmac_f32 v13, v25, v71
  v_fmac_f32 v14, v26, v71
  v_fmac_f32 v15, v27, v71
  v_fmac_f32 v12, v28, v72
  v_fmac_f32 v13, v29, v72
  v_fmac_f32 v14, v30, v72
  v_fmac_f32 v15, v31, v72
  v_fmac_f32 v12, v32, v73
  v_fmac_f32 v13, v33, v73
  v_fmac_f32 v14, v34, v73
  v_fmac_f32 v15, v35, v73
  v_fmac_f32 v12, v36, v74
  v_fmac_f32 v13, v37, v74
  v_fmac_f32 v14, v38, v74
  v_fmac_f32 v15, v39, v74
  v_fmac_f32 v12, v40, v75
  v_fmac_f32 v13, v41, v75
  v_fmac_f32 v14, v42, v75
  v_fmac_f32 v15, v43, v75
  v_fmac_f32 v12, v44, v76
  v_fmac_f32 v13, v45, v76
  v_fmac_f32 v14, v46, v76
  v_fmac_f32 v15, v47, v76
  v_fmac_f32 v12, v48, v77
  v_fmac_f32 v13, v49, v77
  v_fmac_f32 v14, v50, v77
  v_fmac_f32 v15, v51, v77
  v_add_f32_dpp v12, v12, v12 row_ror:4 row_mask:0xf bank_mask:0xf
  v_add_f32_dpp v13, v13, v13 row_ror:4 row_mask:0xf bank_mask:0xf
  v_add_f32_dpp v14, v14, v14 row_ror:4 row_mask:0xf bank_mask:0xf
  v_add_f32_dpp v15, v15, v15 row_ror:4 row_mask:0xf bank_mask:0xf
  v_add_f32_dpp v12, v12, v12 row_ror:8 row_mask:0xf bank_mask:0xf
  v_add_f32_dpp v13, v13, v13 row_ror:8 row_mask:0xf bank_mask:0xf
  v_add_f32_dpp v14, v14, v14 row_ror:8 row_mask:0xf bank_mask:0xf
  v_add_f32_dpp v15, v15, v15 row_ror:8 row_mask:0xf bank_mask:0xf
  v_mov_b32 v16, v12
  v_mov_b32 v17, v13
  v_mov_b32 v18, v14
  v_mov_b32 v19, v15
  v_permlane16_swap_b32 v12, v16
  v_permlane16_swap_b32 v13, v17
  v_permlane16_swap_b32 v14, v18
  v_permlane16_swap_b32 v15, v19
  v_add_f32 v12, v12, v16
  v_add_f32 v13, v13, v17
  v_add_f32 v14, v14, v18
  v_add_f32 v15, v15, v19
  v_mov_b32 v16, v12
  v_mov_b32 v17, v13
  v_mov_b32 v18, v14
  v_mov_b32 v19, v15
  v_permlane32_swap_b32 v12, v16
  v_permlane32_swap_b32 v13, v17
  v_permlane32_swap_b32 v14, v18
  v_permlane32_swap_b32 v15, v19
  v_add_f32 v12, v12, v16
  v_add_f32 v13, v13, v17
  v_add_f32 v14, v14, v18
  v_add_f32 v15, v15, v19
  v_cvt_pk_bf16_f32 v16, v12, v13
  v_cvt_pk_bf16_f32 v17, v14, v15
  buffer_store_dwordx2 v[16:17], v93, s[72:75], 0 offen
L_ry_endB:
  s_endpgm
L_end:
  s_endpgm
.section .rodata,"a"
.p2align 6
.amdhsa_kernel gated_mix__mha_block_cached__glu_gated_glu__decode_kernel
  .amdhsa_next_free_vgpr 512
  .amdhsa_next_free_sgpr 102
  .amdhsa_accum_offset 256
  .amdhsa_group_segment_fixed_size 0
  .amdhsa_kernarg_size 104
  .amdhsa_user_sgpr_count 2
  .amdhsa_user_sgpr_kernarg_segment_ptr 1
  .amdhsa_system_sgpr_workgroup_id_x 1
.end_amdhsa_kernel
```
